```python
import torch

def _softmax(x, axis=-1):
    return torch.softmax(x, dim=axis)
def _gelu(x):
    return torch.nn.functional.gelu(x, approximate="tanh")
def _silu(x):
    return torch.nn.functional.silu(x)
def _sigmoid(x):
    return torch.sigmoid(x)
def _layernorm(x, axis=-1, eps=1e-5):
    m = x.mean(dim=axis, keepdim=True)
    v = x.var(dim=axis, keepdim=True, unbiased=False)
    return (x - m) / torch.sqrt(v + eps)
def _scatter_add(tgt, idx, src, axis=0):
    return tgt.clone().index_add_(axis, idx, src)
def _segment_sum(src, seg, n):
    out = torch.zeros((n,) + src.shape[1:], dtype=src.dtype)
    return out.index_add_(0, seg, src)
def _pad(x, pw):
    flat = tuple(v for pair in reversed(pw) for v in pair)
    return torch.nn.functional.pad(x, flat)

kernel_name = 'interleave_layers__linear_kernel_hedgehog__geglu_ffn__prompt'

def setup_inputs():

    _w = (lambda a: (lambda t: t.to(torch.bfloat16) if t.is_floating_point() else t)(torch.as_tensor(a)))
    def _A_setup():
        B, S, D, H = 1, 2048, 1024, 32
        Dh = D // H
        return {
            "x": _w((lambda *s: torch.randn(*s, dtype=torch.bfloat16) * 0.05)(B, S, D)),
            "wqkv": _w((lambda *s: torch.randn(*s, dtype=torch.bfloat16) * 0.2)(D, 3 * D)),
            "w_phi": _w((lambda *s: torch.randn(*s, dtype=torch.bfloat16) * 0.2)(H, Dh, Dh) * (Dh ** -0.5)),
            "wo": _w((lambda *s: torch.randn(*s, dtype=torch.bfloat16) * 0.05)(D, D)),
        }
    _A_in = _A_setup()

    def _B_setup():
        B, S, D, F = 1, 2048, 1024, 3584
        return {
            "x": _w((lambda *s: torch.randn(*s, dtype=torch.bfloat16) * 0.05)(B, S, D)),
            "w_gate": _w((lambda *s: torch.randn(*s, dtype=torch.bfloat16) * 0.05)(D, F)),
            "w_up": _w((lambda *s: torch.randn(*s, dtype=torch.bfloat16) * 0.05)(D, F)),
            "w_down": _w((lambda *s: torch.randn(*s, dtype=torch.bfloat16) * 0.05)(F, D)),
        }
    _B_in = _B_setup()

    return {
        "A_x": _A_in["x"],
        "A_wqkv": _A_in["wqkv"],
        "A_w_phi": _A_in["w_phi"],
        "A_wo": _A_in["wo"],
        "B_x": _B_in["x"],
        "B_w_gate": _B_in["w_gate"],
        "B_w_up": _B_in["w_up"],
        "B_w_down": _B_in["w_down"],
    }

def reference(A_x, A_wqkv, A_w_phi, A_wo, B_x, B_w_gate, B_w_up, B_w_down):
    def _A_ref(x, wqkv, w_phi, wo):
        B, S, D = x.shape
        H = 32; Dh = D // H
        qkv = (lambda x, *d: x.permute(*d))((x @ wqkv).reshape(B, S, 3, H, Dh), 2, 0, 3, 1, 4)
        q, k, v = qkv[0], qkv[1], qkv[2]
        pq = torch.einsum("bhsd,hdf->bhsf", q, w_phi)
        pk = torch.einsum("bhsd,hdf->bhsf", k, w_phi)
        phi_q = torch.concatenate([_softmax(pq, axis=-1), _softmax(-pq, axis=-1)], axis=-1)
        phi_k = torch.concatenate([_softmax(pk, axis=-1), _softmax(-pk, axis=-1)], axis=-1)
        kv = torch.einsum("bhsf,bhsd->bhfd", phi_k, v)
        z  = torch.einsum("bhsf->bhf", phi_k)
        num = torch.einsum("bhqf,bhfd->bhqd", phi_q, kv)
        den = torch.einsum("bhqf,bhf->bhq", phi_q, z)[..., None] + 1e-6
        o = num / den
        return (lambda x, *d: x.permute(*d))(o, 0, 2, 1, 3).reshape(B, S, D) @ wo

    def _B_ref(x, w_gate, w_up, w_down):
        return (_gelu(x @ w_gate) * (x @ w_up)) @ w_down

    x = A_x
    x = x + _A_ref(_layernorm(x, axis=-1), A_wqkv, A_w_phi, A_wo)
    x = x + _B_ref(_layernorm(x, axis=-1), B_w_gate, B_w_up, B_w_down)
    x = x + _A_ref(_layernorm(x, axis=-1), A_wqkv, A_w_phi, A_wo)
    x = x + _B_ref(_layernorm(x, axis=-1), B_w_gate, B_w_up, B_w_down)
    return x
```

```asm
; @launch grid=(256,1,1) block=(512,1,1) lds=147520
.amdgcn_target "amdgcn-amd-amdhsa--gfx950"
.text
.globl interleave_layers__linear_kernel_hedgehog__geglu_ffn__prompt_kernel
.p2align 8
.type interleave_layers__linear_kernel_hedgehog__geglu_ffn__prompt_kernel,@function
interleave_layers__linear_kernel_hedgehog__geglu_ffn__prompt_kernel:
    s_cmp_ge_u32 s2, 256
    s_cbranch_scc1 interleave_layers__linear_kernel_hedgehog__geglu_ffn__prompt_kernel_done1
    s_load_dwordx8 s[32:39], s[0:1], 0
    s_load_dwordx2 s[68:69], s[0:1], 80
    s_load_dwordx4 s[64:67], s[0:1], 40
    s_load_dwordx4 s[72:75], s[0:1], 56
    s_load_dwordx2 s[62:63], s[0:1], 72
    v_lshrrev_b32 v1, 6, v0
    v_and_b32 v0, 63, v0
    v_readfirstlane_b32 s40, v1
    v_mov_b32 v2, 147456
    v_mov_b32 v4, 0
    v_mov_b32 v5, 0
    v_mov_b32 v6, 0
    v_mov_b32 v7, 0
    ds_write_b128 v2, v[4:7]
    s_and_b32 s61, s40, 3
    s_cmp_ge_u32 s40, 4
    s_cbranch_scc1 interleave_layers__linear_kernel_hedgehog__geglu_ffn__prompt_kernel_crit2
    s_and_b32 s52, s2, 15
    s_lshr_b32 s53, s2, 4
    .long 0x8e2dff35, 0x2
    s_add_u32 s45, s45, s40
    s_mul_i32 s45, s45, 114688
    .long 0x862eff34, 0x7
    s_mul_i32 s46, s46, 896
    s_add_u32 s45, s45, s46
    v_min_u32 v20, 55, v0
    v_lshlrev_b32_e64 v20, 4, v20
    s_waitcnt lgkmcnt(0)
    s_mov_b64 s[70:71], s[74:75]
    s_add_u32 s56, s68, 0x6000000
    .long 0x8239ff45, 0x0
    s_mov_b32 s58, 0x100000
    s_mov_b32 s59, 0x00020000
    s_mov_b32 s16, s62
    s_mov_b32 s17, s63
    s_mov_b32 s18, 0x100
    s_mov_b32 s19, 0x00020000
    v_mov_b32_e64 v6, 0
    s_or_b32 s46, s2, s40
    s_cbranch_scc1 interleave_layers__linear_kernel_hedgehog__geglu_ffn__prompt_kernel_n04
    s_memrealtime s[46:47]
    s_waitcnt lgkmcnt(0)
    s_or_b32 s46, s46, 1
    v_mov_b32 v7, s46
    s_mov_b64 exec, 1
    buffer_store_dword v7, v6, s[16:19], 0 offen sc0 sc1
    s_mov_b64 exec, -1
interleave_layers__linear_kernel_hedgehog__geglu_ffn__prompt_kernel_n04:
    s_cmp_ge_u32 s52, 8
    s_cselect_b32 s12, s66, s64
    s_cselect_b32 s13, s67, s65
    s_mov_b32 s14, 7340032
    s_mov_b32 s15, 0x00020000
    s_barrier
    s_cmp_lg_u32 s40, 0
    s_cbranch_scc1 interleave_layers__linear_kernel_hedgehog__geglu_ffn__prompt_kernel_nn3
    s_mov_b32 s74, 0
interleave_layers__linear_kernel_hedgehog__geglu_ffn__prompt_kernel_nl5:
    buffer_load_dword v7, v6, s[16:19], 0 offen sc1
    s_add_u32 s74, s74, 1
    s_waitcnt vmcnt(0)
    v_readfirstlane_b32 s75, v7
    s_nop 0
    s_cmp_lg_u32 s75, 0
    s_cbranch_scc1 interleave_layers__linear_kernel_hedgehog__geglu_ffn__prompt_kernel_ng6
    s_cmp_lt_u32 s74, 50000
    s_cbranch_scc1 interleave_layers__linear_kernel_hedgehog__geglu_ffn__prompt_kernel_nl5
    v_mov_b32 v7, 1
interleave_layers__linear_kernel_hedgehog__geglu_ffn__prompt_kernel_ng6:
    v_mov_b32 v6, 147464
    ds_write_b32 v6, v7
interleave_layers__linear_kernel_hedgehog__geglu_ffn__prompt_kernel_nn3:
    buffer_load_dwordx4 v[24:27], v20, s[12:15], s45 offen
    s_add_u32 s45, s45, 7168
    buffer_load_dwordx4 v[28:31], v20, s[12:15], s45 offen
    s_add_u32 s45, s45, 7168
    buffer_load_dwordx4 v[32:35], v20, s[12:15], s45 offen
    s_add_u32 s45, s45, 7168
    buffer_load_dwordx4 v[36:39], v20, s[12:15], s45 offen
    s_add_u32 s45, s45, 7168
    buffer_load_dwordx4 v[40:43], v20, s[12:15], s45 offen
    s_add_u32 s45, s45, 7168
    buffer_load_dwordx4 v[44:47], v20, s[12:15], s45 offen
    s_add_u32 s45, s45, 7168
    buffer_load_dwordx4 v[48:51], v20, s[12:15], s45 offen
    s_add_u32 s45, s45, 7168
    buffer_load_dwordx4 v[52:55], v20, s[12:15], s45 offen
    s_add_u32 s45, s45, 7168
    buffer_load_dwordx4 v[56:59], v20, s[12:15], s45 offen
    s_add_u32 s45, s45, 7168
    buffer_load_dwordx4 v[60:63], v20, s[12:15], s45 offen
    s_add_u32 s45, s45, 7168
    buffer_load_dwordx4 v[64:67], v20, s[12:15], s45 offen
    s_add_u32 s45, s45, 7168
    buffer_load_dwordx4 v[68:71], v20, s[12:15], s45 offen
    s_add_u32 s45, s45, 7168
    buffer_load_dwordx4 v[72:75], v20, s[12:15], s45 offen
    s_add_u32 s45, s45, 7168
    buffer_load_dwordx4 v[76:79], v20, s[12:15], s45 offen
    s_add_u32 s45, s45, 7168
    buffer_load_dwordx4 v[80:83], v20, s[12:15], s45 offen
    s_add_u32 s45, s45, 7168
    buffer_load_dwordx4 v[84:87], v20, s[12:15], s45 offen
    s_mov_b32 s79, 0xffff0000
    s_add_u32 s24, s68, 0x5f00000
    .long 0x8219ff45, 0x0
    s_mov_b32 s26, 0x70000
    s_mov_b32 s27, 0x00020000
    s_waitcnt vmcnt(15)
    v_lshlrev_b32 v8, 16, v24
    v_and_b32 v9, s79, v24
    v_lshlrev_b32 v10, 16, v25
    v_and_b32 v11, s79, v25
    v_lshlrev_b32 v12, 16, v26
    v_and_b32 v13, s79, v26
    v_lshlrev_b32 v14, 16, v27
    v_and_b32 v15, s79, v27
    s_waitcnt vmcnt(14)
    v_lshlrev_b32 v88, 16, v28
    v_and_b32 v89, s79, v28
    v_lshlrev_b32 v90, 16, v29
    v_and_b32 v91, s79, v29
    v_lshlrev_b32 v92, 16, v30
    v_and_b32 v93, s79, v30
    v_lshlrev_b32 v94, 16, v31
    v_and_b32 v95, s79, v31
    v_pk_add_f32 v[8:9], v[8:9], v[88:89]
    v_pk_add_f32 v[10:11], v[10:11], v[90:91]
    v_pk_add_f32 v[12:13], v[12:13], v[92:93]
    v_pk_add_f32 v[14:15], v[14:15], v[94:95]
    s_waitcnt vmcnt(13)
    v_lshlrev_b32 v88, 16, v32
    v_and_b32 v89, s79, v32
    v_lshlrev_b32 v90, 16, v33
    v_and_b32 v91, s79, v33
    v_lshlrev_b32 v92, 16, v34
    v_and_b32 v93, s79, v34
    v_lshlrev_b32 v94, 16, v35
    v_and_b32_e64 v95, s79, v35
    v_pk_add_f32 v[8:9], v[8:9], v[88:89]
    v_pk_add_f32 v[10:11], v[10:11], v[90:91]
    v_pk_add_f32 v[12:13], v[12:13], v[92:93]
    v_pk_add_f32 v[14:15], v[14:15], v[94:95]
    s_waitcnt vmcnt(12)
    v_lshlrev_b32 v88, 16, v36
    v_and_b32 v89, s79, v36
    v_lshlrev_b32 v90, 16, v37
    v_and_b32 v91, s79, v37
    v_lshlrev_b32 v92, 16, v38
    v_and_b32 v93, s79, v38
    v_lshlrev_b32 v94, 16, v39
    v_and_b32_e64 v95, s79, v39
    v_pk_add_f32 v[8:9], v[8:9], v[88:89]
    v_pk_add_f32 v[10:11], v[10:11], v[90:91]
    v_pk_add_f32 v[12:13], v[12:13], v[92:93]
    v_pk_add_f32 v[14:15], v[14:15], v[94:95]
    s_waitcnt vmcnt(11)
    v_lshlrev_b32 v88, 16, v40
    v_and_b32 v89, s79, v40
    v_lshlrev_b32 v90, 16, v41
    v_and_b32 v91, s79, v41
    v_lshlrev_b32 v92, 16, v42
    v_and_b32 v93, s79, v42
    v_lshlrev_b32 v94, 16, v43
    v_and_b32_e64 v95, s79, v43
    v_pk_add_f32 v[8:9], v[8:9], v[88:89]
    v_pk_add_f32 v[10:11], v[10:11], v[90:91]
    v_pk_add_f32 v[12:13], v[12:13], v[92:93]
    v_pk_add_f32 v[14:15], v[14:15], v[94:95]
    s_waitcnt vmcnt(10)
    v_lshlrev_b32 v88, 16, v44
    v_and_b32 v89, s79, v44
    v_lshlrev_b32 v90, 16, v45
    v_and_b32 v91, s79, v45
    v_lshlrev_b32 v92, 16, v46
    v_and_b32 v93, s79, v46
    v_lshlrev_b32 v94, 16, v47
    v_and_b32_e64 v95, s79, v47
    v_pk_add_f32 v[8:9], v[8:9], v[88:89]
    v_pk_add_f32 v[10:11], v[10:11], v[90:91]
    v_pk_add_f32 v[12:13], v[12:13], v[92:93]
    v_pk_add_f32 v[14:15], v[14:15], v[94:95]
    s_waitcnt vmcnt(9)
    v_lshlrev_b32 v88, 16, v48
    v_and_b32 v89, s79, v48
    v_lshlrev_b32 v90, 16, v49
    v_and_b32 v91, s79, v49
    v_lshlrev_b32 v92, 16, v50
    v_and_b32 v93, s79, v50
    v_lshlrev_b32 v94, 16, v51
    v_and_b32_e64 v95, s79, v51
    v_pk_add_f32 v[8:9], v[8:9], v[88:89]
    v_pk_add_f32 v[10:11], v[10:11], v[90:91]
    v_pk_add_f32 v[12:13], v[12:13], v[92:93]
    v_pk_add_f32 v[14:15], v[14:15], v[94:95]
    s_waitcnt vmcnt(8)
    v_lshlrev_b32 v88, 16, v52
    v_and_b32 v89, s79, v52
    v_lshlrev_b32 v90, 16, v53
    v_and_b32 v91, s79, v53
    v_lshlrev_b32 v92, 16, v54
    v_and_b32 v93, s79, v54
    v_lshlrev_b32 v94, 16, v55
    v_and_b32_e64 v95, s79, v55
    v_pk_add_f32 v[8:9], v[8:9], v[88:89]
    v_pk_add_f32 v[10:11], v[10:11], v[90:91]
    v_pk_add_f32 v[12:13], v[12:13], v[92:93]
    v_pk_add_f32 v[14:15], v[14:15], v[94:95]
    s_waitcnt vmcnt(7)
    v_lshlrev_b32 v88, 16, v56
    v_and_b32 v89, s79, v56
    v_lshlrev_b32 v90, 16, v57
    v_and_b32 v91, s79, v57
    v_lshlrev_b32 v92, 16, v58
    v_and_b32 v93, s79, v58
    v_lshlrev_b32 v94, 16, v59
    v_and_b32_e64 v95, s79, v59
    v_pk_add_f32 v[8:9], v[8:9], v[88:89]
    v_pk_add_f32 v[10:11], v[10:11], v[90:91]
    v_pk_add_f32 v[12:13], v[12:13], v[92:93]
    v_pk_add_f32 v[14:15], v[14:15], v[94:95]
    s_waitcnt vmcnt(6)
    v_lshlrev_b32 v88, 16, v60
    v_and_b32 v89, s79, v60
    v_lshlrev_b32 v90, 16, v61
    v_and_b32 v91, s79, v61
    v_lshlrev_b32 v92, 16, v62
    v_and_b32 v93, s79, v62
    v_lshlrev_b32 v94, 16, v63
    v_and_b32_e64 v95, s79, v63
    v_pk_add_f32 v[8:9], v[8:9], v[88:89]
    v_pk_add_f32 v[10:11], v[10:11], v[90:91]
    v_pk_add_f32 v[12:13], v[12:13], v[92:93]
    v_pk_add_f32 v[14:15], v[14:15], v[94:95]
    s_waitcnt vmcnt(5)
    v_lshlrev_b32 v88, 16, v64
    v_and_b32 v89, s79, v64
    v_lshlrev_b32 v90, 16, v65
    v_and_b32 v91, s79, v65
    v_lshlrev_b32 v92, 16, v66
    v_and_b32 v93, s79, v66
    v_lshlrev_b32 v94, 16, v67
    v_and_b32_e64 v95, s79, v67
    v_pk_add_f32 v[8:9], v[8:9], v[88:89]
    v_pk_add_f32 v[10:11], v[10:11], v[90:91]
    v_pk_add_f32 v[12:13], v[12:13], v[92:93]
    v_pk_add_f32 v[14:15], v[14:15], v[94:95]
    s_waitcnt vmcnt(4)
    v_lshlrev_b32 v88, 16, v68
    v_and_b32 v89, s79, v68
    v_lshlrev_b32 v90, 16, v69
    v_and_b32 v91, s79, v69
    v_lshlrev_b32 v92, 16, v70
    v_and_b32 v93, s79, v70
    v_lshlrev_b32 v94, 16, v71
    v_and_b32_e64 v95, s79, v71
    v_pk_add_f32 v[8:9], v[8:9], v[88:89]
    v_pk_add_f32 v[10:11], v[10:11], v[90:91]
    v_pk_add_f32 v[12:13], v[12:13], v[92:93]
    v_pk_add_f32 v[14:15], v[14:15], v[94:95]
    s_waitcnt vmcnt(3)
    v_lshlrev_b32 v88, 16, v72
    v_and_b32 v89, s79, v72
    v_lshlrev_b32 v90, 16, v73
    v_and_b32 v91, s79, v73
    v_lshlrev_b32 v92, 16, v74
    v_and_b32 v93, s79, v74
    v_lshlrev_b32 v94, 16, v75
    v_and_b32_e64 v95, s79, v75
    v_pk_add_f32 v[8:9], v[8:9], v[88:89]
    v_pk_add_f32 v[10:11], v[10:11], v[90:91]
    v_pk_add_f32 v[12:13], v[12:13], v[92:93]
    v_pk_add_f32 v[14:15], v[14:15], v[94:95]
    s_waitcnt vmcnt(2)
    v_lshlrev_b32 v88, 16, v76
    v_and_b32 v89, s79, v76
    v_lshlrev_b32 v90, 16, v77
    v_and_b32 v91, s79, v77
    v_lshlrev_b32 v92, 16, v78
    v_and_b32 v93, s79, v78
    v_lshlrev_b32 v94, 16, v79
    v_and_b32_e64 v95, s79, v79
    v_pk_add_f32 v[8:9], v[8:9], v[88:89]
    v_pk_add_f32 v[10:11], v[10:11], v[90:91]
    v_pk_add_f32 v[12:13], v[12:13], v[92:93]
    v_pk_add_f32 v[14:15], v[14:15], v[94:95]
    s_waitcnt vmcnt(1)
    v_lshlrev_b32 v88, 16, v80
    v_and_b32 v89, s79, v80
    v_lshlrev_b32 v90, 16, v81
    v_and_b32 v91, s79, v81
    v_lshlrev_b32 v92, 16, v82
    v_and_b32 v93, s79, v82
    v_lshlrev_b32 v94, 16, v83
    v_and_b32_e64 v95, s79, v83
    v_pk_add_f32 v[8:9], v[8:9], v[88:89]
    v_pk_add_f32 v[10:11], v[10:11], v[90:91]
    v_pk_add_f32 v[12:13], v[12:13], v[92:93]
    v_pk_add_f32 v[14:15], v[14:15], v[94:95]
    s_waitcnt vmcnt(0)
    v_lshlrev_b32 v88, 16, v84
    v_and_b32 v89, s79, v84
    v_lshlrev_b32 v90, 16, v85
    v_and_b32 v91, s79, v85
    v_lshlrev_b32 v92, 16, v86
    v_and_b32 v93, s79, v86
    v_lshlrev_b32 v94, 16, v87
    v_and_b32_e64 v95, s79, v87
    v_pk_add_f32 v[8:9], v[8:9], v[88:89]
    v_pk_add_f32 v[10:11], v[10:11], v[90:91]
    v_pk_add_f32 v[12:13], v[12:13], v[92:93]
    v_pk_add_f32 v[14:15], v[14:15], v[94:95]
    .long 0x8e2dff28, 0xb
    s_add_u32 s45, s45, 137216
    v_lshlrev_b32 v21, 5, v0
    v_add_u32 v21, s45, v21
    ds_write_b128 v21, v[8:11]
    ds_write_b128 v21, v[12:15] offset:16
    v_mov_b32 v22, 147464
interleave_layers__linear_kernel_hedgehog__geglu_ffn__prompt_kernel_non7:
    ds_read_b32 v23, v22
    s_waitcnt lgkmcnt(0)
    v_readfirstlane_b32 s60, v23
    s_nop 0
    .long 0xbf06ff3c, 0x0
    s_cbranch_scc1 interleave_layers__linear_kernel_hedgehog__geglu_ffn__prompt_kernel_non7
    v_mov_b32 v22, 147460
    v_mov_b32 v23, 1
    s_mov_b64 exec, 1
    ds_add_rtn_u32 v23, v22, v23
    s_mov_b64 exec, -1
    s_waitcnt lgkmcnt(0)
    v_readfirstlane_b32 s75, v23
    s_nop 0
    s_cmp_lg_u32 s75, 3
    s_cbranch_scc1 interleave_layers__linear_kernel_hedgehog__geglu_ffn__prompt_kernel_na8
    v_add_u32 v21, 137216, v20
    ds_read_b128 v[24:27], v21 offset:0
    ds_read_b128 v[28:31], v21 offset:2048
    ds_read_b128 v[32:35], v21 offset:4096
    ds_read_b128 v[36:39], v21 offset:6144
    ds_read_b128 v[40:43], v21 offset:896
    ds_read_b128 v[44:47], v21 offset:2944
    ds_read_b128 v[48:51], v21 offset:4992
    ds_read_b128 v[52:55], v21 offset:7040
    s_mul_i32 s45, s53, 28672
    s_mul_i32 s46, s52, 1792
    s_add_u32 s45, s45, s46
    s_waitcnt lgkmcnt(0)
    v_pk_add_f32 v[24:25], v[24:25], v[28:29]
    v_pk_add_f32 v[26:27], v[26:27], v[30:31]
    v_pk_add_f32 v[24:25], v[24:25], v[32:33]
    v_pk_add_f32 v[26:27], v[26:27], v[34:35]
    v_pk_add_f32 v[24:25], v[24:25], v[36:37]
    v_pk_add_f32 v[26:27], v[26:27], v[38:39]
    buffer_store_dwordx4 v[24:27], v20, s[24:27], s45 offen offset:0 sc0 sc1
    v_pk_add_f32 v[40:41], v[40:41], v[44:45]
    v_pk_add_f32 v[42:43], v[42:43], v[46:47]
    v_pk_add_f32 v[40:41], v[40:41], v[48:49]
    v_pk_add_f32 v[42:43], v[42:43], v[50:51]
    v_pk_add_f32 v[40:41], v[40:41], v[52:53]
    v_pk_add_f32 v[42:43], v[42:43], v[54:55]
    buffer_store_dwordx4 v[40:43], v20, s[24:27], s45 offen offset:896 sc0 sc1
    .long 0x8e4aff02, 0x7
    s_add_u32 s74, s74, 622592
    s_waitcnt vmcnt(0)
    v_mov_b32 v239, 0
    v_mov_b32 v240, s60
    s_mov_b64 exec, 1
    buffer_store_dword v240, v239, s[56:59], s74 offen sc0 sc1
    s_mov_b64 exec, -1
interleave_layers__linear_kernel_hedgehog__geglu_ffn__prompt_kernel_na8:
    s_branch mega_ph0
interleave_layers__linear_kernel_hedgehog__geglu_ffn__prompt_kernel_crit2:
    s_lshl_b32 s41, s2, 2
    s_add_u32 s41, s41, s61
    s_mul_hi_u32 s42, s41, 89478486
    s_mul_i32 s43, s42, 48
    s_sub_u32 s43, s41, s43
    s_and_b32 s50, s43, 15
    s_lshr_b32 s51, s43, 4
    s_mul_i32 s44, s50, 393216
    s_lshl_b32 s45, s51, 11
    s_add_u32 s44, s44, s45
    s_lshl_b32 s47, s42, 7
    s_add_u32 s44, s44, s47
    s_mul_i32 s46, s42, 393216
    s_add_u32 s46, s46, s45
    s_mul_i32 s52, s50, 12288
    s_add_u32 s46, s46, s52
    s_add_u32 s47, s47, s45
    .long 0x8e2fff2f, 0x1
    s_add_u32 s47, s47, s52
    s_sub_u32 s50, s41, 768
    s_lshr_b32 s51, s50, 4
    s_and_b32 s50, s50, 15
    s_lshl_b32 s52, s51, 17
    s_lshl_b32 s45, s50, 7
    s_add_u32 s52, s52, s45
    s_lshl_b32 s53, s50, 17
    s_lshl_b32 s45, s51, 13
    s_add_u32 s53, s53, s45
    s_add_u32 s53, s53, 6291456
    s_cmp_ge_u32 s41, 768
    s_cselect_b32 s44, s52, s44
    s_cselect_b32 s46, s53, s46
    s_cselect_b32 s47, 196608, s47
    s_mov_b32 s48, 194560
    s_cselect_b32 s48, 0, s48
    s_movk_i32 s49, 6144
    s_cselect_b32 s49, 4096, s49
    s_movk_i32 s54, 6144
    s_cselect_b32 s54, 2048, s54
    s_mov_b32 s6, 6291456
    s_cselect_b32 s6, 2097152, s6
    s_mov_b32 s7, 0x00020000
    s_waitcnt lgkmcnt(0)
    s_cselect_b32 s4, s38, s34
    s_cselect_b32 s5, s39, s35
    s_lshl_b32 s55, s54, 3
    s_add_u32 s48, s48, s46
    v_lshrrev_b32 v3, 3, v0
    v_and_b32 v3, 6, v3
    v_xor_b32 v3, v3, v0
    v_and_b32 v3, 7, v3
    v_lshlrev_b32 v3, 4, v3
    v_lshrrev_b32 v4, 3, v0
    v_mul_u32_u24 v4, s54, v4
    v_add_u32_e64 v2, v3, v4
    s_lshl_b32 s61, s61, 13
    s_add_u32 m0, s61, 0
    s_nop 0
    buffer_load_dwordx4 v2, s[4:7], s44 offen nt lds
    s_add_u32 m0, s61, 1024
    s_add_u32 s44, s44, s55
    buffer_load_dwordx4 v2, s[4:7], s44 offen nt lds
    s_add_u32 m0, s61, 2048
    s_add_u32 s44, s44, s55
    buffer_load_dwordx4 v2, s[4:7], s44 offen nt lds
    s_add_u32 m0, s61, 3072
    s_add_u32 s44, s44, s55
    buffer_load_dwordx4 v2, s[4:7], s44 offen nt lds
    s_add_u32 m0, s61, 4096
    s_add_u32 s44, s44, s55
    buffer_load_dwordx4 v2, s[4:7], s44 offen nt lds
    s_add_u32 m0, s61, 5120
    s_add_u32 s44, s44, s55
    buffer_load_dwordx4 v2, s[4:7], s44 offen nt lds
    s_add_u32 m0, s61, 6144
    s_add_u32 s44, s44, s55
    buffer_load_dwordx4 v2, s[4:7], s44 offen nt lds
    s_add_u32 m0, s61, 7168
    s_add_u32 s44, s44, s55
    buffer_load_dwordx4 v2, s[4:7], s44 offen nt lds
    s_mov_b32 s8, s32
    s_mov_b32 s9, s33
    s_mov_b32 s10, 0x400000
    s_mov_b32 s11, 0x00020000
    s_lshr_b32 s50, s41, 3
    s_and_b32 s51, s41, 7
    s_lshl_b32 s52, s50, 15
    s_lshl_b32 s45, s51, 8
    s_add_u32 s52, s52, s45
    v_and_b32 v9, 15, v0
    v_lshrrev_b32 v10, 4, v0
    v_lshlrev_b32_e64 v11, 11, v9
    v_lshl_add_u32 v11, v10, 3, v11
    buffer_load_dwordx2 v[12:13], v11, s[8:11], s52 offen offset:0 nt
    buffer_load_dwordx2 v[14:15], v11, s[8:11], s52 offen offset:32 nt
    buffer_load_dwordx2 v[16:17], v11, s[8:11], s52 offen offset:64 nt
    buffer_load_dwordx2 v[18:19], v11, s[8:11], s52 offen offset:96 nt
    buffer_load_dwordx2 v[20:21], v11, s[8:11], s52 offen offset:128 nt
    buffer_load_dwordx2 v[22:23], v11, s[8:11], s52 offen offset:160 nt
    buffer_load_dwordx2 v[24:25], v11, s[8:11], s52 offen offset:192 nt
    buffer_load_dwordx2 v[26:27], v11, s[8:11], s52 offen offset:224 nt
    s_mov_b32 s12, s36
    s_mov_b32 s13, s37
    s_mov_b32 s14, 0x10000
    s_mov_b32 s15, 0x00020000
    s_lshl_b32 s53, s41, 11
    v_lshrrev_b32 v28, 4, v0
    v_and_b32 v29, 15, v0
    v_lshlrev_b32 v29, 1, v29
    v_lshl_add_u32 v29, v28, 8, v29
    s_cmp_ge_u32 s41, 32
    s_cbranch_scc1 interleave_layers__linear_kernel_hedgehog__geglu_ffn__prompt_kernel_nph9
    buffer_load_ushort v96, v29, s[12:15], s53 offen offset:0
    buffer_load_ushort v104, v29, s[12:15], s53 offen offset:64
    buffer_load_ushort v97, v29, s[12:15], s53 offen offset:128
    buffer_load_ushort v105, v29, s[12:15], s53 offen offset:192
    buffer_load_ushort v98, v29, s[12:15], s53 offen offset:1024
    buffer_load_ushort v106, v29, s[12:15], s53 offen offset:1088
    buffer_load_ushort v99, v29, s[12:15], s53 offen offset:1152
    buffer_load_ushort v107, v29, s[12:15], s53 offen offset:1216
    buffer_load_ushort v100, v29, s[12:15], s53 offen offset:32
    buffer_load_ushort v108, v29, s[12:15], s53 offen offset:96
    buffer_load_ushort v101, v29, s[12:15], s53 offen offset:160
    buffer_load_ushort v109, v29, s[12:15], s53 offen offset:224
    buffer_load_ushort v102, v29, s[12:15], s53 offen offset:1056
    buffer_load_ushort v110, v29, s[12:15], s53 offen offset:1120
    buffer_load_ushort v103, v29, s[12:15], s53 offen offset:1184
    buffer_load_ushort v111, v29, s[12:15], s53 offen offset:1248
interleave_layers__linear_kernel_hedgehog__geglu_ffn__prompt_kernel_nph9:
    s_waitcnt lgkmcnt(0)
    s_mov_b64 s[70:71], s[74:75]
    s_add_u32 s56, s68, 0x6000000
    .long 0x8239ff45, 0x0
    s_mov_b32 s58, 0x100000
    s_mov_b32 s59, 0x00020000
    s_barrier
    s_add_u32 s16, s68, 0x4f00000
    s_addc_u32 s17, s69, 0
    s_mov_b32 s18, 0x800000
    s_mov_b32 s19, 0x00020000
    s_add_u32 s24, s68, 0x5e00000
    .long 0x8219ff45, 0x0
    s_mov_b32 s26, 0x30000
    s_mov_b32 s27, 0x00020000
    v_lshrrev_b32 v5, 2, v0
    v_lshlrev_b32 v3, 7, v5
    v_and_b32_e64 v4, 3, v0
    v_lshl_add_u32 v3, v4, 3, v3
    v_bfe_u32 v4, v0, 3, 2
    v_add_u32 v3, s61, v3
    v_xor_b32 v5, 0, v4
    v_lshl_add_u32 v5, v5, 5, v3
    v_xor_b32_e64 v6, 1, v4
    v_lshl_add_u32 v6, v6, 5, v3
    v_xor_b32_e64 v7, 2, v4
    v_lshl_add_u32 v7, v7, 5, v3
    v_xor_b32_e64 v8, 3, v4
    v_lshl_add_u32 v8, v8, 5, v3
    v_lshlrev_b32_e64 v3, 4, v0
    s_mov_b32 s78, 0x3f803f80
    s_mov_b32 s8, s68
    s_mov_b32 s9, s69
    s_mov_b32 s10, 0x400000
    s_mov_b32 s11, 0x00020000
    s_add_u32 s28, s68, 0x4c40000
    .long 0x821dff45, 0x0
    s_mov_b32 s30, 0x40000
    s_mov_b32 s31, 0x00020000
    s_add_u32 s12, s68, 0x4dc0000
    .long 0x820dff45, 0x0
    s_mov_b32 s14, 0x10000
    s_mov_b32 s15, 0x00020000
    v_lshlrev_b32_e64 v11, 4, v0
    s_lshl_b32 s45, s51, 19
    s_lshl_b32 s52, s50, 10
    s_add_u32 s45, s45, s52
    s_waitcnt vmcnt(0)
    ds_read_b64_tr_b16 v[56:57], v5 offset:0
    ds_read_b64_tr_b16 v[58:59], v5 offset:2048
    ds_read_b64_tr_b16 v[60:61], v6 offset:0
    ds_read_b64_tr_b16 v[62:63], v6 offset:2048
    ds_read_b64_tr_b16 v[64:65], v7 offset:0
    ds_read_b64_tr_b16 v[66:67], v7 offset:2048
    ds_read_b64_tr_b16 v[68:69], v8 offset:0
    ds_read_b64_tr_b16 v[70:71], v8 offset:2048
    ds_read_b64_tr_b16 v[72:73], v5 offset:4096
    ds_read_b64_tr_b16 v[74:75], v5 offset:6144
    ds_read_b64_tr_b16 v[76:77], v6 offset:4096
    ds_read_b64_tr_b16 v[78:79], v6 offset:6144
    ds_read_b64_tr_b16 v[80:81], v7 offset:4096
    ds_read_b64_tr_b16 v[82:83], v7 offset:6144
    ds_read_b64_tr_b16 v[84:85], v8 offset:4096
    ds_read_b64_tr_b16 v[86:87], v8 offset:6144
    buffer_store_dwordx4 v[12:15], v11, s[8:11], s45 offen sc0 sc1
    s_add_u32 s45, s45, 131072
    buffer_store_dwordx4 v[16:19], v11, s[8:11], s45 offen sc0 sc1
    s_add_u32 s45, s45, 131072
    buffer_store_dwordx4 v[20:23], v11, s[8:11], s45 offen sc0 sc1
    s_add_u32 s45, s45, 131072
    buffer_store_dwordx4 v[24:27], v11, s[8:11], s45 offen sc0 sc1
    s_waitcnt lgkmcnt(8)
    buffer_store_dwordx4 v[56:59], v3, s[16:19], s46 offen offset:0 sc0 sc1
    buffer_store_dwordx4 v[60:63], v3, s[16:19], s46 offen offset:1024 sc0 sc1
    buffer_store_dwordx4 v[64:67], v3, s[16:19], s48 offen offset:2048 sc0 sc1
    buffer_store_dwordx4 v[68:71], v3, s[16:19], s48 offen offset:3072 sc0 sc1
    s_add_u32 s46, s46, s49
    s_add_u32 s48, s48, s49
    s_waitcnt lgkmcnt(0)
    buffer_store_dwordx4 v[72:75], v3, s[16:19], s46 offen offset:0 sc0 sc1
    buffer_store_dwordx4 v[76:79], v3, s[16:19], s46 offen offset:1024 sc0 sc1
    buffer_store_dwordx4 v[80:83], v3, s[16:19], s48 offen offset:2048 sc0 sc1
    buffer_store_dwordx4 v[84:87], v3, s[16:19], s48 offen offset:3072 sc0 sc1
    v_lshl_or_b32 v96, v104, 16, v96
    v_lshl_or_b32 v97, v105, 16, v97
    v_lshl_or_b32 v98, v106, 16, v98
    v_lshl_or_b32 v99, v107, 16, v99
    v_lshl_or_b32 v100, v108, 16, v100
    v_lshl_or_b32 v101, v109, 16, v101
    v_lshl_or_b32 v102, v110, 16, v102
    v_lshl_or_b32 v103, v111, 16, v103
    buffer_store_dwordx4 v[96:99], v3, s[12:15], s53 offen sc0 sc1
    buffer_store_dwordx4 v[100:103], v3, s[12:15], s53 offen offset:1024 sc0 sc1
    v_dot2_f32_bf16 v88, v56, s78, 0
    v_dot2_f32_bf16 v89, v60, s78, 0
    v_dot2_f32_bf16 v90, v64, s78, 0
    v_dot2_f32_bf16 v91, v68, s78, 0
    v_dot2_f32_bf16 v88, v57, s78, v88
    v_dot2_f32_bf16 v89, v61, s78, v89
    v_dot2_f32_bf16 v90, v65, s78, v90
    v_dot2_f32_bf16 v91, v69, s78, v91
    v_dot2_f32_bf16 v88, v58, s78, v88
    v_dot2_f32_bf16 v89, v62, s78, v89
    v_dot2_f32_bf16 v90, v66, s78, v90
    v_dot2_f32_bf16 v91, v70, s78, v91
    v_dot2_f32_bf16 v88, v59, s78, v88
    v_dot2_f32_bf16 v89, v63, s78, v89
    v_dot2_f32_bf16 v90, v67, s78, v90
    v_dot2_f32_bf16 v91, v71, s78, v91
    v_dot2_f32_bf16 v88, v72, s78, v88
    v_dot2_f32_bf16 v89, v76, s78, v89
    v_dot2_f32_bf16 v90, v80, s78, v90
    v_dot2_f32_bf16 v91, v84, s78, v91
    v_dot2_f32_bf16 v88, v73, s78, v88
    v_dot2_f32_bf16 v89, v77, s78, v89
    v_dot2_f32_bf16 v90, v81, s78, v90
    v_dot2_f32_bf16 v91, v85, s78, v91
    v_dot2_f32_bf16 v88, v74, s78, v88
    v_dot2_f32_bf16 v89, v78, s78, v89
    v_dot2_f32_bf16 v90, v82, s78, v90
    v_dot2_f32_bf16 v91, v86, s78, v91
    v_dot2_f32_bf16 v88, v75, s78, v88
    v_dot2_f32_bf16 v89, v79, s78, v89
    v_dot2_f32_bf16 v90, v83, s78, v90
    v_dot2_f32_bf16 v91, v87, s78, v91
    v_dot2_f32_bf16 v30, v12, s78, 0
    v_dot2_f32_bf16 v31, v12, v12, 0
    v_dot2_f32_bf16 v30, v13, s78, v30
    v_dot2_f32_bf16 v31, v13, v13, v31
    v_dot2_f32_bf16 v30, v14, s78, v30
    v_dot2_f32_bf16 v31, v14, v14, v31
    v_dot2_f32_bf16 v30, v15, s78, v30
    v_dot2_f32_bf16 v31, v15, v15, v31
    v_dot2_f32_bf16 v30, v16, s78, v30
    v_dot2_f32_bf16 v31, v16, v16, v31
    v_dot2_f32_bf16 v30, v17, s78, v30
    v_dot2_f32_bf16 v31, v17, v17, v31
    v_dot2_f32_bf16 v30, v18, s78, v30
    v_dot2_f32_bf16 v31, v18, v18, v31
    v_dot2_f32_bf16 v30, v19, s78, v30
    v_dot2_f32_bf16 v31, v19, v19, v31
    v_dot2_f32_bf16 v32, v20, s78, 0
    v_dot2_f32_bf16 v33, v20, v20, 0
    v_dot2_f32_bf16 v32, v21, s78, v32
    v_dot2_f32_bf16 v33, v21, v21, v33
    v_dot2_f32_bf16 v32, v22, s78, v32
    v_dot2_f32_bf16 v33, v22, v22, v33
    v_dot2_f32_bf16 v32, v23, s78, v32
    v_dot2_f32_bf16 v33, v23, v23, v33
    v_dot2_f32_bf16 v32, v24, s78, v32
    v_dot2_f32_bf16 v33, v24, v24, v33
    v_dot2_f32_bf16 v32, v25, s78, v32
    v_dot2_f32_bf16 v33, v25, v25, v33
    v_dot2_f32_bf16 v32, v26, s78, v32
    v_dot2_f32_bf16 v33, v26, v26, v33
    v_dot2_f32_bf16 v32, v27, s78, v32
    v_dot2_f32_bf16 v33, v27, v27, v33
    v_permlane32_swap_b32 v88, v89
    v_permlane32_swap_b32 v90, v91
    v_add_f32 v88, v88, v89
    v_add_f32 v90, v90, v91
    v_mov_b32 v92, v88
    v_mov_b32 v93, v90
    s_nop 0
    v_permlane16_swap_b32 v88, v92
    v_permlane16_swap_b32 v90, v93
    v_add_f32 v88, v88, v92
    v_add_f32 v90, v90, v93
    v_mov_b32 v89, v88
    v_mov_b32 v91, v90
    s_nop 0
    v_permlane32_swap_b32 v88, v89
    v_permlane32_swap_b32 v90, v91
    v_cmp_gt_u32 vcc, 16, v0
    s_nop 1
    v_cndmask_b32 v89, v89, v88, vcc
    v_cmp_gt_u32 vcc, 48, v0
    s_nop 1
    v_cndmask_b32 v91, v91, v90, vcc
    v_cmp_gt_u32 vcc, 32, v0
    s_nop 1
    v_cndmask_b32 v91, v91, v89, vcc
    v_lshlrev_b32 v4, 2, v0
    buffer_store_dword v91, v4, s[24:27], s47 offen sc0 sc1
    v_permlane32_swap_b32 v30, v31
    v_permlane32_swap_b32 v32, v33
    v_add_f32 v30, v30, v31
    v_add_f32 v32, v32, v33
    v_mov_b32 v34, v30
    v_mov_b32 v35, v32
    s_nop 0
    v_permlane16_swap_b32 v30, v34
    v_permlane16_swap_b32 v32, v35
    v_add_f32 v30, v30, v34
    v_add_f32 v32, v32, v35
    v_mov_b32 v31, v30
    v_mov_b32 v33, v32
    s_nop 0
    v_permlane32_swap_b32 v30, v31
    v_permlane32_swap_b32 v32, v33
    v_cmp_eq_u32 vcc, 1, v10
    s_nop 1
    v_cndmask_b32 v30, v30, v32, vcc
    v_cndmask_b32 v31, v31, v33, vcc
    s_lshl_b32 s45, s50, 11
    s_lshl_b32 s52, s51, 8
    s_add_u32 s45, s45, s52
    v_lshlrev_b32 v9, 3, v9
    v_lshl_add_u32 v9, v10, 7, v9
    .long 0xbeff00ff, 0x0
    buffer_store_dwordx2 v[30:31], v9, s[28:31], s45 offen sc0 sc1
    s_mov_b64 exec, -1
    v_mov_b32 v22, 147464
interleave_layers__linear_kernel_hedgehog__geglu_ffn__prompt_kernel_non10:
    ds_read_b32 v23, v22
    s_waitcnt lgkmcnt(0)
    v_readfirstlane_b32 s60, v23
    s_nop 0
    .long 0xbf06ff3c, 0x0
    s_cbranch_scc1 interleave_layers__linear_kernel_hedgehog__geglu_ffn__prompt_kernel_non10
    s_waitcnt vmcnt(0)
    v_mov_b32 v22, 147456
    v_mov_b32 v23, 1
    s_mov_b64 exec, 1
    ds_add_rtn_u32 v23, v22, v23
    s_mov_b64 exec, -1
    s_waitcnt lgkmcnt(0)
    v_readfirstlane_b32 s75, v23
    s_nop 0
    s_cmp_lg_u32 s75, 3
    s_cbranch_scc1 interleave_layers__linear_kernel_hedgehog__geglu_ffn__prompt_kernel_na11
    .long 0x8e4aff02, 0x7
    s_add_u32 s74, s74, 589824
    v_mov_b32 v239, 0
    v_mov_b32_e64 v240, s60
    s_mov_b64 exec, 1
    buffer_store_dword v240, v239, s[56:59], s74 offen sc0 sc1
    s_mov_b64 exec, -1
interleave_layers__linear_kernel_hedgehog__geglu_ffn__prompt_kernel_na11:
interleave_layers__linear_kernel_hedgehog__geglu_ffn__prompt_kernel_sp012:
    ds_read_b32 v23, v22
    s_waitcnt lgkmcnt(0)
    v_readfirstlane_b32 s75, v23
    s_nop 0
    s_cmp_lt_u32 s75, 4
    s_cbranch_scc1 interleave_layers__linear_kernel_hedgehog__geglu_ffn__prompt_kernel_sp012
mega_ph0:
    s_and_b32 s45, s2, 7
    s_lshr_b32 s49, s2, 3
    s_and_b32 s41, s45, 1
    s_lshl_b32 s41, s41, 2
    s_lshr_b32 s42, s45, 1
    s_mul_i32 s42, s42, 8
    s_and_b32 s45, s49, 3
    s_add_u32 s41, s41, s45
    s_lshr_b32 s45, s49, 2
    s_add_u32 s42, s42, s45
    s_and_b32 s52, s40, 3
    v_lshlrev_b32 v3, 4, v0
    s_mul_i32 s47, s42, 196608
    s_add_u32 s8, s68, 0x4f00000
    .long 0x8209ff45, 0x0
    s_mov_b32 s10, 0x600000
    s_mov_b32 s11, 0x00020000
    s_cmp_lt_u32 s40, 4
    s_cbranch_scc1 interleave_layers__linear_kernel_hedgehog__geglu_ffn__prompt_kernel_np13
    s_lshl_b32 s45, s41, 5
    v_add_u32 v7, s45, v0
    s_lshr_b32 s45, s42, 1
    s_mul_i32 s45, s45, 12
    s_sub_u32 s45, s45, 32
    v_add_u32 v5, s45, v0
    v_cmp_lt_u32 vcc, 31, v0
    s_nop 1
    v_cndmask_b32 v7, v7, v5, vcc
    s_lshr_b32 s45, s42, 2
    v_mov_b32 v5, s45
    v_cmp_lt_u32 vcc, 43, v0
    s_nop 1
    v_cndmask_b32 v7, v7, v5, vcc
    v_lshlrev_b32_e64 v7, 7, v7
    s_mov_b32 s45, 589824
    .long 0xbefe00ff, 0xffffffff
    s_mov_b32 exec_hi, 0x1fff
    .long 0xbeca00ff, 0x0
interleave_layers__linear_kernel_hedgehog__geglu_ffn__prompt_kernel_poll14:
    buffer_load_dword v244, v7, s[56:59], s45 offen sc1
    s_add_u32 s74, s74, 1
    s_waitcnt vmcnt(0)
    v_cmp_ne_u32 vcc, s60, v244
    s_nop 0
    s_cmp_eq_u64 vcc, 0
    s_cbranch_scc1 interleave_layers__linear_kernel_hedgehog__geglu_ffn__prompt_kernel_polled15
    s_mov_b64 exec, vcc
    s_sleep 4
    s_cmp_lt_u32 s74, 50000
    s_cbranch_scc1 interleave_layers__linear_kernel_hedgehog__geglu_ffn__prompt_kernel_poll14
interleave_layers__linear_kernel_hedgehog__geglu_ffn__prompt_kernel_polled15:
    s_mov_b64 exec, -1
    s_mul_i32 s51, s52, 12288
    s_add_u32 s45, s47, s51
    .long 0x807cff33, 0x0
    s_nop 0
    buffer_load_dwordx4 v3, s[8:11], s45 offen offset:0 lds
    buffer_load_dwordx4 v3, s[8:11], s45 offen offset:1024 lds
    buffer_load_dwordx4 v3, s[8:11], s45 offen offset:2048 lds
    buffer_load_dwordx4 v3, s[8:11], s45 offen offset:3072 lds
    s_add_u32 s45, s45, 4096
    s_add_u32 m0, s51, 4096
    s_mov_b32 s99, 0x1000
    buffer_load_dwordx4 v3, s[8:11], s45 offen offset:0 lds
    buffer_load_dwordx4 v3, s[8:11], s45 offen offset:1024 lds
    buffer_load_dwordx4 v3, s[8:11], s45 offen offset:2048 lds
    buffer_load_dwordx4 v3, s[8:11], s45 offen offset:3072 lds
    s_add_u32 s45, s45, 4096
    s_add_u32 m0, s51, 8192
    s_mov_b32 s99, 0x1000
    buffer_load_dwordx4 v3, s[8:11], s45 offen offset:0 lds
    buffer_load_dwordx4 v3, s[8:11], s45 offen offset:1024 lds
    buffer_load_dwordx4 v3, s[8:11], s45 offen offset:2048 lds
    buffer_load_dwordx4 v3, s[8:11], s45 offen offset:3072 lds
    s_add_u32 s45, s45, 4096
interleave_layers__linear_kernel_hedgehog__geglu_ffn__prompt_kernel_np13:
    s_add_u32 s47, s47, 49152
    s_mul_i32 s51, s40, 3072
    v_add_u32 v11, s51, v3
    v_mov_b32_e64 v13, v3
    s_lshl_b32 s46, s41, 14
    s_lshl_b32 s45, s40, 11
    s_add_u32 s46, s46, s45
    s_mov_b32 s4, s68
    s_mov_b32 s5, s69
    s_mov_b32 s6, 0x400000
    s_mov_b32 s7, 0x00020000
    s_add_u32 s12, s68, 0x4c40000
    .long 0x820dff45, 0x0
    s_mov_b32 s14, 0x40000
    s_mov_b32 s15, 0x00020000
    s_add_u32 s16, s68, 0x5e00000
    .long 0x8211ff45, 0x0
    s_mov_b32 s18, 0x30000
    s_mov_b32 s19, 0x00020000
    s_add_u32 s24, s68, 0x4dc0000
    .long 0x8219ff45, 0x0
    s_mov_b32 s26, 0x10000
    s_mov_b32 s27, 0x00020000
    s_lshl_b32 s45, s41, 8
    s_lshl_b32 s48, s40, 5
    s_add_u32 s45, s45, s48
    v_and_b32 v15, 15, v0
    v_lshlrev_b32 v15, 3, v15
    s_lshl_b32 s74, s45, 7
    v_add_u32 v15, s74, v15
    v_lshrrev_b32 v5, 4, v0
    v_lshl_add_u32 v15, v5, 9, v15
    v_lshrrev_b32_e64 v17, 3, v0
    v_mul_u32_u24 v17, 24576, v17
    v_and_b32_e64 v9, 7, v0
    v_lshl_add_u32 v17, v9, 4, v17
    s_min_u32 s48, s40, 2
    s_lshl_b32 s49, s48, 12
    s_lshl_b32 s53, s42, 7
    s_add_u32 s49, s49, s53
    s_add_u32 s43, s49, 12288
    .long 0x8e2dff2a, 0xb
    s_waitcnt vmcnt(0)
    s_barrier
    buffer_load_dwordx4 v[116:119], v3, s[4:7], s46 offen
    buffer_load_dwordx4 v[120:123], v3, s[4:7], s46 offen offset:1024
    s_add_u32 s46, s46, 131072
    buffer_load_dwordx4 v[124:127], v3, s[4:7], s46 offen
    buffer_load_dwordx4 v[128:131], v3, s[4:7], s46 offen offset:1024
    s_add_u32 s46, s46, 131072
    buffer_load_dwordx4 v[132:135], v3, s[4:7], s46 offen
    buffer_load_dwordx4 v[136:139], v3, s[4:7], s46 offen offset:1024
    s_add_u32 s46, s46, 131072
    ds_read_b128 v[68:71], v13 offset:0
    ds_read_b128 v[72:75], v13 offset:1024
    ds_read_b128 v[76:79], v13 offset:2048
    ds_read_b128 v[80:83], v13 offset:3072
    ds_read_b128 v[84:87], v13 offset:4096
    ds_read_b128 v[88:91], v13 offset:5120
    s_waitcnt vmcnt(4) lgkmcnt(0)
    s_nop 0
    v_mfma_f32_16x16x32_bf16 v[36:39], v[76:79], v[116:119], 0
    v_mfma_f32_16x16x32_bf16 v[40:43], v[76:79], v[120:123], 0
    ds_read_b128 v[92:95], v13 offset:6144
    v_mfma_f32_16x16x32_bf16 v[44:47], v[80:83], v[116:119], 0
    ds_read_b128 v[96:99], v13 offset:7168
    buffer_load_dwordx4 v[140:143], v3, s[4:7], s46 offen
    v_mfma_f32_16x16x32_bf16 v[48:51], v[80:83], v[120:123], 0
    ds_read_b128 v[100:103], v13 offset:8192
    v_mfma_f32_16x16x32_bf16 v[52:55], v[116:119], v[84:87], 0
    ds_read_b128 v[104:107], v13 offset:9216
    v_mfma_f32_16x16x32_bf16 v[56:59], v[120:123], v[84:87], 0
    ds_read_b128 v[108:111], v13 offset:10240
    v_mfma_f32_16x16x32_bf16 v[60:63], v[116:119], v[88:91], 0
    ds_read_b128 v[112:115], v13 offset:11264
    buffer_load_dwordx4 v[144:147], v3, s[4:7], s46 offen offset:1024
    s_add_u32 s46, s46, 131072
    v_mfma_f32_16x16x32_bf16 v[64:67], v[120:123], v[88:91], 0
    s_add_u32 m0, s51, 49152
    s_mov_b32 s99, 0x1000
    buffer_load_dwordx4 v11, s[8:11], s47 offen offset:0 lds
    v_mfma_f32_16x16x32_bf16 v[20:23], v[68:71], v[116:119], 0
    buffer_load_dwordx4 v11, s[8:11], s47 offen offset:1024 lds
    v_mfma_f32_16x16x32_bf16 v[24:27], v[68:71], v[120:123], 0
    buffer_load_dwordx4 v11, s[8:11], s47 offen offset:2048 lds
    s_add_u32 s47, s47, 24576
    v_mfma_f32_16x16x32_bf16 v[28:31], v[72:75], v[116:119], 0
    v_mfma_f32_16x16x32_bf16 v[32:35], v[72:75], v[120:123], 0
    s_waitcnt vmcnt(7) lgkmcnt(0)
    s_nop 0
    v_mfma_f32_16x16x32_bf16 v[36:39], v[100:103], v[124:127], v[36:39]
    v_mfma_f32_16x16x32_bf16 v[40:43], v[100:103], v[128:131], v[40:43]
    ds_read_b128 v[68:71], v13 offset:12288
    v_mfma_f32_16x16x32_bf16 v[44:47], v[104:107], v[124:127], v[44:47]
    ds_read_b128 v[72:75], v13 offset:13312
    buffer_load_dwordx4 v[116:119], v3, s[4:7], s46 offen
    v_mfma_f32_16x16x32_bf16 v[48:51], v[104:107], v[128:131], v[48:51]
    ds_read_b128 v[76:79], v13 offset:14336
    v_mfma_f32_16x16x32_bf16 v[52:55], v[124:127], v[108:111], v[52:55]
    ds_read_b128 v[80:83], v13 offset:15360
    v_mfma_f32_16x16x32_bf16 v[56:59], v[128:131], v[108:111], v[56:59]
    ds_read_b128 v[84:87], v13 offset:16384
    v_mfma_f32_16x16x32_bf16 v[60:63], v[124:127], v[112:115], v[60:63]
    ds_read_b128 v[88:91], v13 offset:17408
    buffer_load_dwordx4 v[120:123], v3, s[4:7], s46 offen offset:1024
    s_add_u32 s46, s46, 131072
    v_mfma_f32_16x16x32_bf16 v[64:67], v[128:131], v[112:115], v[64:67]
    s_add_u32 m0, s51, 73728
    s_mov_b32 s99, 0x1000
    buffer_load_dwordx4 v11, s[8:11], s47 offen offset:0 lds
    v_mfma_f32_16x16x32_bf16 v[20:23], v[92:95], v[124:127], v[20:23]
    buffer_load_dwordx4 v11, s[8:11], s47 offen offset:1024 lds
    v_mfma_f32_16x16x32_bf16 v[24:27], v[92:95], v[128:131], v[24:27]
    buffer_load_dwordx4 v11, s[8:11], s47 offen offset:2048 lds
    s_add_u32 s47, s47, 24576
    v_mfma_f32_16x16x32_bf16 v[28:31], v[96:99], v[124:127], v[28:31]
    v_mfma_f32_16x16x32_bf16 v[32:35], v[96:99], v[128:131], v[32:35]
    s_waitcnt vmcnt(10) lgkmcnt(0)
    s_nop 0
    v_mfma_f32_16x16x32_bf16 v[36:39], v[76:79], v[132:135], v[36:39]
    v_mfma_f32_16x16x32_bf16 v[40:43], v[76:79], v[136:139], v[40:43]
    ds_read_b128 v[92:95], v13 offset:18432
    v_mfma_f32_16x16x32_bf16 v[44:47], v[80:83], v[132:135], v[44:47]
    ds_read_b128 v[96:99], v13 offset:19456
    buffer_load_dwordx4 v[124:127], v3, s[4:7], s46 offen
    v_mfma_f32_16x16x32_bf16 v[48:51], v[80:83], v[136:139], v[48:51]
    ds_read_b128 v[100:103], v13 offset:20480
    v_mfma_f32_16x16x32_bf16 v[52:55], v[132:135], v[84:87], v[52:55]
    ds_read_b128 v[104:107], v13 offset:21504
    v_mfma_f32_16x16x32_bf16 v[56:59], v[136:139], v[84:87], v[56:59]
    ds_read_b128 v[108:111], v13 offset:22528
    v_mfma_f32_16x16x32_bf16 v[60:63], v[132:135], v[88:91], v[60:63]
    ds_read_b128 v[112:115], v13 offset:23552
    buffer_load_dwordx4 v[128:131], v3, s[4:7], s46 offen offset:1024
    s_add_u32 s46, s46, 131072
    v_mfma_f32_16x16x32_bf16 v[64:67], v[136:139], v[88:91], v[64:67]
    v_mfma_f32_16x16x32_bf16 v[20:23], v[68:71], v[132:135], v[20:23]
    v_mfma_f32_16x16x32_bf16 v[24:27], v[68:71], v[136:139], v[24:27]
    v_mfma_f32_16x16x32_bf16 v[28:31], v[72:75], v[132:135], v[28:31]
    v_mfma_f32_16x16x32_bf16 v[32:35], v[72:75], v[136:139], v[32:35]
    s_waitcnt vmcnt(10) lgkmcnt(0)
    v_mfma_f32_16x16x32_bf16 v[36:39], v[100:103], v[140:143], v[36:39]
    s_barrier
    v_mfma_f32_16x16x32_bf16 v[40:43], v[100:103], v[144:147], v[40:43]
    ds_read_b128 v[68:71], v13 offset:24576
    v_mfma_f32_16x16x32_bf16 v[44:47], v[104:107], v[140:143], v[44:47]
    ds_read_b128 v[72:75], v13 offset:25600
    buffer_load_dwordx4 v[132:135], v3, s[4:7], s46 offen
    v_mfma_f32_16x16x32_bf16 v[48:51], v[104:107], v[144:147], v[48:51]
    ds_read_b128 v[76:79], v13 offset:26624
    v_mfma_f32_16x16x32_bf16 v[52:55], v[140:143], v[108:111], v[52:55]
    ds_read_b128 v[80:83], v13 offset:27648
    v_mfma_f32_16x16x32_bf16 v[56:59], v[144:147], v[108:111], v[56:59]
    ds_read_b128 v[84:87], v13 offset:28672
    v_mfma_f32_16x16x32_bf16 v[60:63], v[140:143], v[112:115], v[60:63]
    ds_read_b128 v[88:91], v13 offset:29696
    buffer_load_dwordx4 v[136:139], v3, s[4:7], s46 offen offset:1024
    s_add_u32 s46, s46, 131072
    v_mfma_f32_16x16x32_bf16 v[64:67], v[144:147], v[112:115], v[64:67]
    s_add_u32 m0, s51, 98304
    s_mov_b32 s99, 0x1000
    buffer_load_dwordx4 v11, s[8:11], s47 offen offset:0 lds
    v_mfma_f32_16x16x32_bf16 v[20:23], v[92:95], v[140:143], v[20:23]
    buffer_load_dwordx4 v11, s[8:11], s47 offen offset:1024 lds
    v_mfma_f32_16x16x32_bf16 v[24:27], v[92:95], v[144:147], v[24:27]
    buffer_load_dwordx4 v11, s[8:11], s47 offen offset:2048 lds
    s_add_u32 s47, s47, 24576
    v_mfma_f32_16x16x32_bf16 v[28:31], v[96:99], v[140:143], v[28:31]
    v_mfma_f32_16x16x32_bf16 v[32:35], v[96:99], v[144:147], v[32:35]
    s_waitcnt vmcnt(10) lgkmcnt(0)
    s_nop 0
    v_mfma_f32_16x16x32_bf16 v[36:39], v[76:79], v[116:119], v[36:39]
    v_mfma_f32_16x16x32_bf16 v[40:43], v[76:79], v[120:123], v[40:43]
    ds_read_b128 v[92:95], v13 offset:30720
    v_mfma_f32_16x16x32_bf16 v[44:47], v[80:83], v[116:119], v[44:47]
    ds_read_b128 v[96:99], v13 offset:31744
    buffer_load_dwordx4 v[140:143], v3, s[4:7], s46 offen
    v_mfma_f32_16x16x32_bf16 v[48:51], v[80:83], v[120:123], v[48:51]
    ds_read_b128 v[100:103], v13 offset:32768
    v_mfma_f32_16x16x32_bf16 v[52:55], v[116:119], v[84:87], v[52:55]
    ds_read_b128 v[104:107], v13 offset:33792
    v_mfma_f32_16x16x32_bf16 v[56:59], v[120:123], v[84:87], v[56:59]
    ds_read_b128 v[108:111], v13 offset:34816
    v_mfma_f32_16x16x32_bf16 v[60:63], v[116:119], v[88:91], v[60:63]
    ds_read_b128 v[112:115], v13 offset:35840
    buffer_load_dwordx4 v[144:147], v3, s[4:7], s46 offen offset:1024
    s_add_u32 s46, s46, 131072
    v_mfma_f32_16x16x32_bf16 v[64:67], v[120:123], v[88:91], v[64:67]
    s_add_u32 m0, s51, 0
    s_nop 0
    buffer_load_dwordx4 v11, s[8:11], s47 offen offset:0 lds
    v_mfma_f32_16x16x32_bf16 v[20:23], v[68:71], v[116:119], v[20:23]
    buffer_load_dwordx4 v11, s[8:11], s47 offen offset:1024 lds
    v_mfma_f32_16x16x32_bf16 v[24:27], v[68:71], v[120:123], v[24:27]
    buffer_load_dwordx4 v11, s[8:11], s47 offen offset:2048 lds
    s_add_u32 s47, s47, 24576
    v_mfma_f32_16x16x32_bf16 v[28:31], v[72:75], v[116:119], v[28:31]
    v_mfma_f32_16x16x32_bf16 v[32:35], v[72:75], v[120:123], v[32:35]
    s_waitcnt vmcnt(10) lgkmcnt(0)
    s_nop 0
    v_mfma_f32_16x16x32_bf16 v[36:39], v[100:103], v[124:127], v[36:39]
    v_mfma_f32_16x16x32_bf16 v[40:43], v[100:103], v[128:131], v[40:43]
    ds_read_b128 v[68:71], v13 offset:36864
    v_mfma_f32_16x16x32_bf16 v[44:47], v[104:107], v[124:127], v[44:47]
    ds_read_b128 v[72:75], v13 offset:37888
    buffer_load_dwordx4 v[116:119], v3, s[4:7], s46 offen
    v_mfma_f32_16x16x32_bf16 v[48:51], v[104:107], v[128:131], v[48:51]
    ds_read_b128 v[76:79], v13 offset:38912
    v_mfma_f32_16x16x32_bf16 v[52:55], v[124:127], v[108:111], v[52:55]
    ds_read_b128 v[80:83], v13 offset:39936
    v_mfma_f32_16x16x32_bf16 v[56:59], v[128:131], v[108:111], v[56:59]
    ds_read_b128 v[84:87], v13 offset:40960
    v_mfma_f32_16x16x32_bf16 v[60:63], v[124:127], v[112:115], v[60:63]
    ds_read_b128 v[88:91], v13 offset:41984
    buffer_load_dwordx4 v[120:123], v3, s[4:7], s46 offen offset:1024
    s_add_u32 s46, s46, 131072
    v_mfma_f32_16x16x32_bf16 v[64:67], v[128:131], v[112:115], v[64:67]
    v_mfma_f32_16x16x32_bf16 v[20:23], v[92:95], v[124:127], v[20:23]
    v_mfma_f32_16x16x32_bf16 v[24:27], v[92:95], v[128:131], v[24:27]
    v_mfma_f32_16x16x32_bf16 v[28:31], v[96:99], v[124:127], v[28:31]
    v_mfma_f32_16x16x32_bf16 v[32:35], v[96:99], v[128:131], v[32:35]
    s_waitcnt vmcnt(10) lgkmcnt(0)
    s_nop 0
    v_mfma_f32_16x16x32_bf16 v[36:39], v[76:79], v[132:135], v[36:39]
    v_mfma_f32_16x16x32_bf16 v[40:43], v[76:79], v[136:139], v[40:43]
    ds_read_b128 v[92:95], v13 offset:43008
    v_mfma_f32_16x16x32_bf16 v[44:47], v[80:83], v[132:135], v[44:47]
    ds_read_b128 v[96:99], v13 offset:44032
    buffer_load_dwordx4 v[124:127], v3, s[4:7], s46 offen
    v_mfma_f32_16x16x32_bf16 v[48:51], v[80:83], v[136:139], v[48:51]
    ds_read_b128 v[100:103], v13 offset:45056
    v_mfma_f32_16x16x32_bf16 v[52:55], v[132:135], v[84:87], v[52:55]
    ds_read_b128 v[104:107], v13 offset:46080
    v_mfma_f32_16x16x32_bf16 v[56:59], v[136:139], v[84:87], v[56:59]
    ds_read_b128 v[108:111], v13 offset:47104
    v_mfma_f32_16x16x32_bf16 v[60:63], v[132:135], v[88:91], v[60:63]
    ds_read_b128 v[112:115], v13 offset:48128
    buffer_load_dwordx4 v[128:131], v3, s[4:7], s46 offen offset:1024
    s_add_u32 s46, s46, 131072
    v_mfma_f32_16x16x32_bf16 v[64:67], v[136:139], v[88:91], v[64:67]
    buffer_load_dwordx2 v[220:221], v15, s[12:15], 0 offen offset:0
    buffer_load_dwordx2 v[222:223], v15, s[12:15], 0 offen offset:128
    v_mfma_f32_16x16x32_bf16 v[20:23], v[68:71], v[132:135], v[20:23]
    buffer_load_dwordx2 v[224:225], v15, s[12:15], 0 offen offset:256
    buffer_load_dwordx2 v[226:227], v15, s[12:15], 0 offen offset:384
    v_mfma_f32_16x16x32_bf16 v[24:27], v[68:71], v[136:139], v[24:27]
    buffer_load_dwordx2 v[228:229], v15, s[12:15], 0 offen offset:2048
    buffer_load_dwordx2 v[230:231], v15, s[12:15], 0 offen offset:2176
    v_mfma_f32_16x16x32_bf16 v[28:31], v[72:75], v[132:135], v[28:31]
    buffer_load_dwordx2 v[232:233], v15, s[12:15], 0 offen offset:2304
    buffer_load_dwordx2 v[234:235], v15, s[12:15], 0 offen offset:2432
    v_mfma_f32_16x16x32_bf16 v[32:35], v[72:75], v[136:139], v[32:35]
    s_waitcnt vmcnt(15) lgkmcnt(0)
    v_mfma_f32_16x16x32_bf16 v[36:39], v[100:103], v[140:143], v[36:39]
    s_barrier
    v_mfma_f32_16x16x32_bf16 v[40:43], v[100:103], v[144:147], v[40:43]
    ds_read_b128 v[68:71], v13 offset:49152
    v_mfma_f32_16x16x32_bf16 v[44:47], v[104:107], v[140:143], v[44:47]
    ds_read_b128 v[72:75], v13 offset:50176
    buffer_load_dwordx4 v[132:135], v3, s[4:7], s46 offen
    v_mfma_f32_16x16x32_bf16 v[48:51], v[104:107], v[144:147], v[48:51]
    ds_read_b128 v[76:79], v13 offset:51200
    v_mfma_f32_16x16x32_bf16 v[52:55], v[140:143], v[108:111], v[52:55]
    ds_read_b128 v[80:83], v13 offset:52224
    v_mfma_f32_16x16x32_bf16 v[56:59], v[144:147], v[108:111], v[56:59]
    ds_read_b128 v[84:87], v13 offset:53248
    v_mfma_f32_16x16x32_bf16 v[60:63], v[140:143], v[112:115], v[60:63]
    ds_read_b128 v[88:91], v13 offset:54272
    buffer_load_dwordx4 v[136:139], v3, s[4:7], s46 offen offset:1024
    s_add_u32 s46, s46, 131072
    v_mfma_f32_16x16x32_bf16 v[64:67], v[144:147], v[112:115], v[64:67]
    s_add_u32 m0, s51, 24576
    s_mov_b32 s99, 0x1000
    buffer_load_dwordx4 v11, s[8:11], s47 offen offset:0 lds
    v_mfma_f32_16x16x32_bf16 v[20:23], v[92:95], v[140:143], v[20:23]
    buffer_load_dwordx4 v11, s[8:11], s47 offen offset:1024 lds
    v_mfma_f32_16x16x32_bf16 v[24:27], v[92:95], v[144:147], v[24:27]
    buffer_load_dwordx4 v11, s[8:11], s47 offen offset:2048 lds
    s_add_u32 s47, s47, 24576
    v_mfma_f32_16x16x32_bf16 v[28:31], v[96:99], v[140:143], v[28:31]
    v_mfma_f32_16x16x32_bf16 v[32:35], v[96:99], v[144:147], v[32:35]
    s_waitcnt vmcnt(15) lgkmcnt(0)
    s_nop 0
    v_mfma_f32_16x16x32_bf16 v[36:39], v[76:79], v[116:119], v[36:39]
    v_mfma_f32_16x16x32_bf16 v[40:43], v[76:79], v[120:123], v[40:43]
    ds_read_b128 v[92:95], v13 offset:55296
    v_mfma_f32_16x16x32_bf16 v[44:47], v[80:83], v[116:119], v[44:47]
    ds_read_b128 v[96:99], v13 offset:56320
    buffer_load_dwordx4 v[140:143], v3, s[4:7], s46 offen
    v_mfma_f32_16x16x32_bf16 v[48:51], v[80:83], v[120:123], v[48:51]
    ds_read_b128 v[100:103], v13 offset:57344
    v_mfma_f32_16x16x32_bf16 v[52:55], v[116:119], v[84:87], v[52:55]
    ds_read_b128 v[104:107], v13 offset:58368
    v_mfma_f32_16x16x32_bf16 v[56:59], v[120:123], v[84:87], v[56:59]
    ds_read_b128 v[108:111], v13 offset:59392
    v_mfma_f32_16x16x32_bf16 v[60:63], v[116:119], v[88:91], v[60:63]
    ds_read_b128 v[112:115], v13 offset:60416
    buffer_load_dwordx4 v[144:147], v3, s[4:7], s46 offen offset:1024
    s_add_u32 s46, s46, 131072
    v_mfma_f32_16x16x32_bf16 v[64:67], v[120:123], v[88:91], v[64:67]
    v_mfma_f32_16x16x32_bf16 v[20:23], v[68:71], v[116:119], v[20:23]
    v_mfma_f32_16x16x32_bf16 v[24:27], v[68:71], v[120:123], v[24:27]
    v_mfma_f32_16x16x32_bf16 v[28:31], v[72:75], v[116:119], v[28:31]
    v_mfma_f32_16x16x32_bf16 v[32:35], v[72:75], v[120:123], v[32:35]
    s_waitcnt vmcnt(15) lgkmcnt(0)
    s_nop 0
    v_add_u32 v13, 61440, v3
    v_mfma_f32_16x16x32_bf16 v[36:39], v[100:103], v[124:127], v[36:39]
    v_mfma_f32_16x16x32_bf16 v[40:43], v[100:103], v[128:131], v[40:43]
    ds_read_b128 v[68:71], v13 offset:0
    v_mfma_f32_16x16x32_bf16 v[44:47], v[104:107], v[124:127], v[44:47]
    ds_read_b128 v[72:75], v13 offset:1024
    buffer_load_dwordx4 v[116:119], v3, s[4:7], s46 offen
    v_mfma_f32_16x16x32_bf16 v[48:51], v[104:107], v[128:131], v[48:51]
    ds_read_b128 v[76:79], v13 offset:2048
    v_mfma_f32_16x16x32_bf16 v[52:55], v[124:127], v[108:111], v[52:55]
    ds_read_b128 v[80:83], v13 offset:3072
    v_mfma_f32_16x16x32_bf16 v[56:59], v[128:131], v[108:111], v[56:59]
    ds_read_b128 v[84:87], v13 offset:4096
    v_mfma_f32_16x16x32_bf16 v[60:63], v[124:127], v[112:115], v[60:63]
    ds_read_b128 v[88:91], v13 offset:5120
    buffer_load_dwordx4 v[120:123], v3, s[4:7], s46 offen offset:1024
    s_add_u32 s46, s46, 131072
    v_mfma_f32_16x16x32_bf16 v[64:67], v[128:131], v[112:115], v[64:67]
    v_mfma_f32_16x16x32_bf16 v[20:23], v[92:95], v[124:127], v[20:23]
    v_mfma_f32_16x16x32_bf16 v[24:27], v[92:95], v[128:131], v[24:27]
    v_mfma_f32_16x16x32_bf16 v[28:31], v[96:99], v[124:127], v[28:31]
    v_mfma_f32_16x16x32_bf16 v[32:35], v[96:99], v[128:131], v[32:35]
    s_waitcnt vmcnt(7) lgkmcnt(0)
    s_nop 0
    v_mfma_f32_16x16x32_bf16 v[36:39], v[76:79], v[132:135], v[36:39]
    v_mfma_f32_16x16x32_bf16 v[40:43], v[76:79], v[136:139], v[40:43]
    ds_read_b128 v[92:95], v13 offset:6144
    v_mfma_f32_16x16x32_bf16 v[44:47], v[80:83], v[132:135], v[44:47]
    ds_read_b128 v[96:99], v13 offset:7168
    buffer_load_dwordx4 v[124:127], v3, s[4:7], s46 offen
    v_mfma_f32_16x16x32_bf16 v[48:51], v[80:83], v[136:139], v[48:51]
    ds_read_b128 v[100:103], v13 offset:8192
    v_mfma_f32_16x16x32_bf16 v[52:55], v[132:135], v[84:87], v[52:55]
    ds_read_b128 v[104:107], v13 offset:9216
    v_mfma_f32_16x16x32_bf16 v[56:59], v[136:139], v[84:87], v[56:59]
    ds_read_b128 v[108:111], v13 offset:10240
    v_mfma_f32_16x16x32_bf16 v[60:63], v[132:135], v[88:91], v[60:63]
    ds_read_b128 v[112:115], v13 offset:11264
    buffer_load_dwordx4 v[128:131], v3, s[4:7], s46 offen offset:1024
    s_add_u32 s46, s46, 131072
    v_mfma_f32_16x16x32_bf16 v[64:67], v[136:139], v[88:91], v[64:67]
    v_mfma_f32_16x16x32_bf16 v[20:23], v[68:71], v[132:135], v[20:23]
    v_mfma_f32_16x16x32_bf16 v[24:27], v[68:71], v[136:139], v[24:27]
    v_mfma_f32_16x16x32_bf16 v[28:31], v[72:75], v[132:135], v[28:31]
    buffer_load_dwordx4 v[172:175], v17, s[16:19], s49 offen
    v_mfma_f32_16x16x32_bf16 v[32:35], v[72:75], v[136:139], v[32:35]
    buffer_load_dwordx4 v[176:179], v17, s[16:19], s43 offen
    s_waitcnt vmcnt(6) lgkmcnt(0)
    v_mfma_f32_16x16x32_bf16 v[36:39], v[100:103], v[140:143], v[36:39]
    s_barrier
    v_mfma_f32_16x16x32_bf16 v[40:43], v[100:103], v[144:147], v[40:43]
    ds_read_b128 v[68:71], v13 offset:12288
    v_mfma_f32_16x16x32_bf16 v[44:47], v[104:107], v[140:143], v[44:47]
    ds_read_b128 v[72:75], v13 offset:13312
    buffer_load_dwordx4 v[132:135], v3, s[4:7], s46 offen
    v_mfma_f32_16x16x32_bf16 v[48:51], v[104:107], v[144:147], v[48:51]
    ds_read_b128 v[76:79], v13 offset:14336
    v_mfma_f32_16x16x32_bf16 v[52:55], v[140:143], v[108:111], v[52:55]
    ds_read_b128 v[80:83], v13 offset:15360
    v_mfma_f32_16x16x32_bf16 v[56:59], v[144:147], v[108:111], v[56:59]
    ds_read_b128 v[84:87], v13 offset:16384
    v_mfma_f32_16x16x32_bf16 v[60:63], v[140:143], v[112:115], v[60:63]
    ds_read_b128 v[88:91], v13 offset:17408
    buffer_load_dwordx4 v[136:139], v3, s[4:7], s46 offen offset:1024
    s_add_u32 s46, s46, 131072
    v_mfma_f32_16x16x32_bf16 v[64:67], v[144:147], v[112:115], v[64:67]
    s_add_u32 m0, s51, 49152
    s_mov_b32 s99, 0x1000
    buffer_load_dwordx4 v11, s[8:11], s47 offen offset:0 lds
    v_mfma_f32_16x16x32_bf16 v[20:23], v[92:95], v[140:143], v[20:23]
    buffer_load_dwordx4 v11, s[8:11], s47 offen offset:1024 lds
    v_mfma_f32_16x16x32_bf16 v[24:27], v[92:95], v[144:147], v[24:27]
    buffer_load_dwordx4 v11, s[8:11], s47 offen offset:2048 lds
    s_add_u32 s47, s47, 24576
    v_mfma_f32_16x16x32_bf16 v[28:31], v[96:99], v[140:143], v[28:31]
    v_mfma_f32_16x16x32_bf16 v[32:35], v[96:99], v[144:147], v[32:35]
    s_waitcnt vmcnt(5) lgkmcnt(0)
    s_nop 0
    v_mfma_f32_16x16x32_bf16 v[36:39], v[76:79], v[116:119], v[36:39]
    v_pk_add_f32 v[220:221], v[220:221], v[222:223]
    v_pk_add_f32 v[224:225], v[224:225], v[226:227]
    v_mfma_f32_16x16x32_bf16 v[40:43], v[76:79], v[120:123], v[40:43]
    ds_read_b128 v[92:95], v13 offset:18432
    v_pk_add_f32 v[228:229], v[228:229], v[230:231]
    v_pk_add_f32 v[232:233], v[232:233], v[234:235]
    v_mfma_f32_16x16x32_bf16 v[44:47], v[80:83], v[116:119], v[44:47]
    ds_read_b128 v[96:99], v13 offset:19456
    buffer_load_dwordx4 v[140:143], v3, s[4:7], s46 offen
    v_pk_add_f32 v[220:221], v[220:221], v[224:225]
    v_mfma_f32_16x16x32_bf16 v[48:51], v[80:83], v[120:123], v[48:51]
    ds_read_b128 v[100:103], v13 offset:20480
    v_pk_add_f32 v[228:229], v[228:229], v[232:233]
    v_permlane32_swap_b32 v220, v221
    v_mfma_f32_16x16x32_bf16 v[52:55], v[116:119], v[84:87], v[52:55]
    ds_read_b128 v[104:107], v13 offset:21504
    v_permlane32_swap_b32 v228, v229
    v_add_f32_e64 v220, v220, v221
    v_mfma_f32_16x16x32_bf16 v[56:59], v[120:123], v[84:87], v[56:59]
    ds_read_b128 v[108:111], v13 offset:22528
    v_add_f32_e64 v228, v228, v229
    v_mfma_f32_16x16x32_bf16 v[60:63], v[116:119], v[88:91], v[60:63]
    ds_read_b128 v[112:115], v13 offset:23552
    buffer_load_dwordx4 v[144:147], v3, s[4:7], s46 offen offset:1024
    s_add_u32 s46, s46, 131072
    v_mov_b32 v224, v220
    v_mov_b32 v232, v228
    v_mfma_f32_16x16x32_bf16 v[64:67], v[120:123], v[88:91], v[64:67]
    v_permlane16_swap_b32 v220, v224
    v_permlane16_swap_b32 v228, v232
    v_mfma_f32_16x16x32_bf16 v[20:23], v[68:71], v[116:119], v[20:23]
    v_add_f32_e64 v220, v220, v224
    v_mfma_f32_16x16x32_bf16 v[24:27], v[68:71], v[120:123], v[24:27]
    v_add_f32 v228, v228, v232
    v_mov_b32 v221, v220
    v_mfma_f32_16x16x32_bf16 v[28:31], v[72:75], v[116:119], v[28:31]
    v_mov_b32 v229, v228
    v_permlane32_swap_b32 v220, v221
    v_mfma_f32_16x16x32_bf16 v[32:35], v[72:75], v[120:123], v[32:35]
    v_permlane32_swap_b32 v228, v229
    s_waitcnt vmcnt(9) lgkmcnt(0)
    v_mfma_f32_16x16x32_bf16 v[36:39], v[100:103], v[124:127], v[36:39]
    s_mov_b32 s74, 0xba800000
    s_mov_b32 s75, 0x3727c5ac
    v_mfma_f32_16x16x32_bf16 v[40:43], v[100:103], v[128:131], v[40:43]
    ds_read_b128 v[68:71], v13 offset:24576
    v_mul_f32 v223, s74, v220
    v_mul_f32 v221, s74, v221
    v_mfma_f32_16x16x32_bf16 v[44:47], v[104:107], v[124:127], v[44:47]
    ds_read_b128 v[72:75], v13 offset:25600
    buffer_load_dwordx4 v[116:119], v3, s[4:7], s46 offen
    v_mul_f32_e64 v231, s74, v228
    v_mfma_f32_16x16x32_bf16 v[48:51], v[104:107], v[128:131], v[48:51]
    ds_read_b128 v[76:79], v13 offset:26624
    v_mul_f32_e64 v229, s74, v229
    v_fma_f32 v221, -v223, v223, -v221
    v_mfma_f32_16x16x32_bf16 v[52:55], v[124:127], v[108:111], v[52:55]
    ds_read_b128 v[80:83], v13 offset:27648
    v_fma_f32 v229, -v231, v231, -v229
    v_max_f32_e64 v221, 0, v221
    v_mfma_f32_16x16x32_bf16 v[56:59], v[128:131], v[108:111], v[56:59]
    ds_read_b128 v[84:87], v13 offset:28672
    v_max_f32_e64 v229, 0, v229
    v_mfma_f32_16x16x32_bf16 v[60:63], v[124:127], v[112:115], v[60:63]
    ds_read_b128 v[88:91], v13 offset:29696
    buffer_load_dwordx4 v[120:123], v3, s[4:7], s46 offen offset:1024
    s_add_u32 s46, s46, 131072
    v_add_f32 v221, s75, v221
    v_add_f32 v229, s75, v229
    v_mfma_f32_16x16x32_bf16 v[64:67], v[128:131], v[112:115], v[64:67]
    v_rsq_f32 v222, v221
    v_rsq_f32 v230, v229
    v_mfma_f32_16x16x32_bf16 v[20:23], v[92:95], v[124:127], v[20:23]
    v_pk_add_f32 v[172:173], v[172:173], v[176:177]
    v_mfma_f32_16x16x32_bf16 v[24:27], v[92:95], v[128:131], v[24:27]
    v_pk_add_f32 v[174:175], v[174:175], v[178:179]
    v_add_f32_dpp v172, v172, v172 row_ror:8 row_mask:0xf bank_mask:0xf
    v_mfma_f32_16x16x32_bf16 v[28:31], v[96:99], v[124:127], v[28:31]
    v_add_f32_dpp v173, v173, v173 row_ror:8 row_mask:0xf bank_mask:0xf
    v_add_f32_dpp v174, v174, v174 row_ror:8 row_mask:0xf bank_mask:0xf
    v_mfma_f32_16x16x32_bf16 v[32:35], v[96:99], v[128:131], v[32:35]
    v_add_f32_dpp v175, v175, v175 row_ror:8 row_mask:0xf bank_mask:0xf
    s_waitcnt vmcnt(7) lgkmcnt(0)
    v_mfma_f32_16x16x32_bf16 v[36:39], v[76:79], v[132:135], v[36:39]
    v_permlane32_swap_b32 v172, v173
    v_permlane32_swap_b32 v174, v175
    v_mfma_f32_16x16x32_bf16 v[40:43], v[76:79], v[136:139], v[40:43]
    ds_read_b128 v[92:95], v13 offset:30720
    v_add_f32 v172, v172, v173
    v_add_f32_e64 v174, v174, v175
    v_mfma_f32_16x16x32_bf16 v[44:47], v[80:83], v[132:135], v[44:47]
    ds_read_b128 v[96:99], v13 offset:31744
    buffer_load_dwordx4 v[124:127], v3, s[4:7], s46 offen
    v_mov_b32_e64 v176, v172
    v_mfma_f32_16x16x32_bf16 v[48:51], v[80:83], v[136:139], v[48:51]
    ds_read_b128 v[100:103], v13 offset:32768
    v_mov_b32 v177, v174
    v_permlane16_swap_b32 v172, v176
    v_mfma_f32_16x16x32_bf16 v[52:55], v[132:135], v[84:87], v[52:55]
    ds_read_b128 v[104:107], v13 offset:33792
    v_permlane16_swap_b32 v174, v177
    v_add_f32 v172, v172, v176
    v_mfma_f32_16x16x32_bf16 v[56:59], v[136:139], v[84:87], v[56:59]
    ds_read_b128 v[108:111], v13 offset:34816
    v_add_f32_e64 v174, v174, v177
    v_mfma_f32_16x16x32_bf16 v[60:63], v[132:135], v[88:91], v[60:63]
    ds_read_b128 v[112:115], v13 offset:35840
    buffer_load_dwordx4 v[128:131], v3, s[4:7], s46 offen offset:1024
    s_add_u32 s46, s46, 131072
    v_mov_b32 v173, v172
    v_mov_b32 v175, v174
    v_mfma_f32_16x16x32_bf16 v[64:67], v[136:139], v[88:91], v[64:67]
    v_permlane32_swap_b32 v172, v173
    v_permlane32_swap_b32 v174, v175
    v_mfma_f32_16x16x32_bf16 v[20:23], v[68:71], v[132:135], v[20:23]
    .long 0x8e4cff28, 0x7
    v_mfma_f32_16x16x32_bf16 v[24:27], v[68:71], v[136:139], v[24:27]
    s_add_u32 s76, s76, 135168
    v_and_b32_e64 v5, 15, v0
    v_mfma_f32_16x16x32_bf16 v[28:31], v[72:75], v[132:135], v[28:31]
    v_lshlrev_b32 v5, 2, v5
    v_add_u32 v7, s76, v5
    v_mfma_f32_16x16x32_bf16 v[32:35], v[72:75], v[136:139], v[32:35]
    ds_write_b32 v7, v222 offset:0
    s_waitcnt vmcnt(4) lgkmcnt(0)
    v_mfma_f32_16x16x32_bf16 v[36:39], v[100:103], v[140:143], v[36:39]
    s_barrier
    ds_write_b32 v7, v223 offset:1024
    v_mul_f32 v2, 0x3fb8aa3b, v222
    v_mfma_f32_16x16x32_bf16 v[40:43], v[100:103], v[144:147], v[40:43]
    ds_read_b128 v[68:71], v13 offset:36864
    v_mov_b32_e64 v4, v223
    ds_write_b32 v7, v230 offset:64
    v_mfma_f32_16x16x32_bf16 v[44:47], v[104:107], v[140:143], v[44:47]
    ds_read_b128 v[72:75], v13 offset:37888
    buffer_load_dwordx4 v[132:135], v3, s[4:7], s46 offen
    ds_write_b32 v7, v231 offset:1088
    v_mfma_f32_16x16x32_bf16 v[48:51], v[104:107], v[144:147], v[48:51]
    ds_read_b128 v[76:79], v13 offset:38912
    v_mul_f32 v6, 0x3fb8aa3b, v230
    v_mov_b32_e64 v8, v231
    v_mfma_f32_16x16x32_bf16 v[52:55], v[140:143], v[108:111], v[52:55]
    ds_read_b128 v[80:83], v13 offset:39936
    .long 0x8e4dff30, 0x7
    s_add_u32 s77, s77, 137216
    v_mfma_f32_16x16x32_bf16 v[56:59], v[144:147], v[108:111], v[56:59]
    ds_read_b128 v[84:87], v13 offset:40960
    v_lshlrev_b32_e64 v9, 4, v9
    v_mfma_f32_16x16x32_bf16 v[60:63], v[140:143], v[112:115], v[60:63]
    ds_read_b128 v[88:91], v13 offset:41984
    buffer_load_dwordx4 v[136:139], v3, s[4:7], s46 offen offset:1024
    s_add_u32 s46, s46, 131072
    v_add_u32_e64 v9, s77, v9
    ds_write_b128 v9, v[172:175]
    v_mfma_f32_16x16x32_bf16 v[64:67], v[144:147], v[112:115], v[64:67]
    v_mov_b32 v7, 137600
    v_mov_b32_e64 v9, 0
    v_mfma_f32_16x16x32_bf16 v[20:23], v[92:95], v[140:143], v[20:23]
    ds_write_b32 v7, v9
    v_mfma_f32_16x16x32_bf16 v[24:27], v[92:95], v[144:147], v[24:27]
    v_lshrrev_b32 v7, 4, v0
    v_lshlrev_b32 v7, 4, v7
    v_mfma_f32_16x16x32_bf16 v[28:31], v[96:99], v[140:143], v[28:31]
    v_add_u32_e64 v15, s76, v7
    v_add_u32 v17, 137216, v7
    v_mfma_f32_16x16x32_bf16 v[32:35], v[96:99], v[144:147], v[32:35]
    v_add_u32 v9, 137472, v5
    s_waitcnt vmcnt(4) lgkmcnt(0)
    s_nop 0
    v_mfma_f32_16x16x32_bf16 v[36:39], v[76:79], v[116:119], v[36:39]
    v_mfma_f32_16x16x32_bf16 v[40:43], v[76:79], v[120:123], v[40:43]
    ds_read_b128 v[92:95], v13 offset:43008
    v_mfma_f32_16x16x32_bf16 v[44:47], v[80:83], v[116:119], v[44:47]
    ds_read_b128 v[96:99], v13 offset:44032
    buffer_load_dwordx4 v[140:143], v3, s[4:7], s46 offen
    v_mfma_f32_16x16x32_bf16 v[48:51], v[80:83], v[120:123], v[48:51]
    ds_read_b128 v[100:103], v13 offset:45056
    v_mfma_f32_16x16x32_bf16 v[52:55], v[116:119], v[84:87], v[52:55]
    ds_read_b128 v[104:107], v13 offset:46080
    v_mfma_f32_16x16x32_bf16 v[56:59], v[120:123], v[84:87], v[56:59]
    ds_read_b128 v[108:111], v13 offset:47104
    v_mfma_f32_16x16x32_bf16 v[60:63], v[116:119], v[88:91], v[60:63]
    ds_read_b128 v[112:115], v13 offset:48128
    buffer_load_dwordx4 v[144:147], v3, s[4:7], s46 offen offset:1024
    s_add_u32 s46, s46, 131072
    v_mfma_f32_16x16x32_bf16 v[64:67], v[120:123], v[88:91], v[64:67]
    v_mfma_f32_16x16x32_bf16 v[20:23], v[68:71], v[116:119], v[20:23]
    v_mfma_f32_16x16x32_bf16 v[24:27], v[68:71], v[120:123], v[24:27]
    v_mfma_f32_16x16x32_bf16 v[28:31], v[72:75], v[116:119], v[28:31]
    v_mfma_f32_16x16x32_bf16 v[32:35], v[72:75], v[120:123], v[32:35]
    s_waitcnt vmcnt(4) lgkmcnt(0)
    s_nop 0
    v_mfma_f32_16x16x32_bf16 v[36:39], v[100:103], v[124:127], v[36:39]
    v_mfma_f32_16x16x32_bf16 v[40:43], v[100:103], v[128:131], v[40:43]
    ds_read_b128 v[68:71], v13 offset:49152
    v_mfma_f32_16x16x32_bf16 v[44:47], v[104:107], v[124:127], v[44:47]
    ds_read_b128 v[72:75], v13 offset:50176
    buffer_load_dwordx4 v[116:119], v3, s[4:7], s46 offen
    v_mfma_f32_16x16x32_bf16 v[48:51], v[104:107], v[128:131], v[48:51]
    ds_read_b128 v[76:79], v13 offset:51200
    v_mfma_f32_16x16x32_bf16 v[52:55], v[124:127], v[108:111], v[52:55]
    ds_read_b128 v[80:83], v13 offset:52224
    v_mfma_f32_16x16x32_bf16 v[56:59], v[128:131], v[108:111], v[56:59]
    ds_read_b128 v[84:87], v13 offset:53248
    v_mfma_f32_16x16x32_bf16 v[60:63], v[124:127], v[112:115], v[60:63]
    ds_read_b128 v[88:91], v13 offset:54272
    buffer_load_dwordx4 v[120:123], v3, s[4:7], s46 offen offset:1024
    s_add_u32 s46, s46, 131072
    v_mfma_f32_16x16x32_bf16 v[64:67], v[128:131], v[112:115], v[64:67]
    v_mfma_f32_16x16x32_bf16 v[20:23], v[92:95], v[124:127], v[20:23]
    v_mfma_f32_16x16x32_bf16 v[24:27], v[92:95], v[128:131], v[24:27]
    v_mfma_f32_16x16x32_bf16 v[28:31], v[96:99], v[124:127], v[28:31]
    v_mfma_f32_16x16x32_bf16 v[32:35], v[96:99], v[128:131], v[32:35]
    s_waitcnt vmcnt(4) lgkmcnt(0)
    s_nop 0
    v_mfma_f32_16x16x32_bf16 v[36:39], v[76:79], v[132:135], v[36:39]
    v_mfma_f32_16x16x32_bf16 v[40:43], v[76:79], v[136:139], v[40:43]
    ds_read_b128 v[92:95], v13 offset:55296
    v_mfma_f32_16x16x32_bf16 v[44:47], v[80:83], v[132:135], v[44:47]
    ds_read_b128 v[96:99], v13 offset:56320
    buffer_load_dwordx4 v[124:127], v3, s[4:7], s46 offen
    v_mfma_f32_16x16x32_bf16 v[48:51], v[80:83], v[136:139], v[48:51]
    ds_read_b128 v[100:103], v13 offset:57344
    v_mfma_f32_16x16x32_bf16 v[52:55], v[132:135], v[84:87], v[52:55]
    ds_read_b128 v[104:107], v13 offset:58368
    v_mfma_f32_16x16x32_bf16 v[56:59], v[136:139], v[84:87], v[56:59]
    ds_read_b128 v[108:111], v13 offset:59392
    v_mfma_f32_16x16x32_bf16 v[60:63], v[132:135], v[88:91], v[60:63]
    ds_read_b128 v[112:115], v13 offset:60416
    buffer_load_dwordx4 v[128:131], v3, s[4:7], s46 offen offset:1024
    s_add_u32 s46, s46, 131072
    v_mfma_f32_16x16x32_bf16 v[64:67], v[136:139], v[88:91], v[64:67]
    v_mfma_f32_16x16x32_bf16 v[20:23], v[68:71], v[132:135], v[20:23]
    v_mfma_f32_16x16x32_bf16 v[24:27], v[68:71], v[136:139], v[24:27]
    v_mfma_f32_16x16x32_bf16 v[28:31], v[72:75], v[132:135], v[28:31]
    v_mfma_f32_16x16x32_bf16 v[32:35], v[72:75], v[136:139], v[32:35]
    s_waitcnt vmcnt(4) lgkmcnt(0)
    v_add_u32 v13, 0, v3
    v_mfma_f32_16x16x32_bf16 v[36:39], v[100:103], v[140:143], v[36:39]
    s_barrier
    s_nop 0
    v_mfma_f32_16x16x32_bf16 v[40:43], v[100:103], v[144:147], v[40:43]
    ds_read_b128 v[68:71], v13 offset:0
    v_mfma_f32_16x16x32_bf16 v[44:47], v[104:107], v[140:143], v[44:47]
    ds_read_b128 v[72:75], v13 offset:1024
    buffer_load_dwordx4 v[132:135], v3, s[4:7], s46 offen
    v_mfma_f32_16x16x32_bf16 v[48:51], v[104:107], v[144:147], v[48:51]
    ds_read_b128 v[76:79], v13 offset:2048
    v_mfma_f32_16x16x32_bf16 v[52:55], v[140:143], v[108:111], v[52:55]
    ds_read_b128 v[80:83], v13 offset:3072
    v_mfma_f32_16x16x32_bf16 v[56:59], v[144:147], v[108:111], v[56:59]
    ds_read_b128 v[84:87], v13 offset:4096
    v_mfma_f32_16x16x32_bf16 v[60:63], v[140:143], v[112:115], v[60:63]
    ds_read_b128 v[88:91], v13 offset:5120
    buffer_load_dwordx4 v[136:139], v3, s[4:7], s46 offen offset:1024
    s_add_u32 s46, s46, 131072
    v_mfma_f32_16x16x32_bf16 v[64:67], v[144:147], v[112:115], v[64:67]
    v_mfma_f32_16x16x32_bf16 v[20:23], v[92:95], v[140:143], v[20:23]
    v_mfma_f32_16x16x32_bf16 v[24:27], v[92:95], v[144:147], v[24:27]
    v_mfma_f32_16x16x32_bf16 v[28:31], v[96:99], v[140:143], v[28:31]
    v_mfma_f32_16x16x32_bf16 v[32:35], v[96:99], v[144:147], v[32:35]
    s_waitcnt vmcnt(4) lgkmcnt(0)
    s_nop 0
    v_mfma_f32_16x16x32_bf16 v[36:39], v[76:79], v[116:119], v[36:39]
    v_mfma_f32_16x16x32_bf16 v[40:43], v[76:79], v[120:123], v[40:43]
    ds_read_b128 v[92:95], v13 offset:6144
    v_mfma_f32_16x16x32_bf16 v[44:47], v[80:83], v[116:119], v[44:47]
    ds_read_b128 v[96:99], v13 offset:7168
    buffer_load_dwordx4 v[140:143], v3, s[4:7], s46 offen
    v_mfma_f32_16x16x32_bf16 v[48:51], v[80:83], v[120:123], v[48:51]
    ds_read_b128 v[100:103], v13 offset:8192
    v_mfma_f32_16x16x32_bf16 v[52:55], v[116:119], v[84:87], v[52:55]
    ds_read_b128 v[104:107], v13 offset:9216
    v_mfma_f32_16x16x32_bf16 v[56:59], v[120:123], v[84:87], v[56:59]
    ds_read_b128 v[108:111], v13 offset:10240
    v_mfma_f32_16x16x32_bf16 v[60:63], v[116:119], v[88:91], v[60:63]
    ds_read_b128 v[112:115], v13 offset:11264
    buffer_load_dwordx4 v[144:147], v3, s[4:7], s46 offen offset:1024
    s_add_u32 s46, s46, 131072
    v_mfma_f32_16x16x32_bf16 v[64:67], v[120:123], v[88:91], v[64:67]
    v_mfma_f32_16x16x32_bf16 v[20:23], v[68:71], v[116:119], v[20:23]
    v_mfma_f32_16x16x32_bf16 v[24:27], v[68:71], v[120:123], v[24:27]
    v_mfma_f32_16x16x32_bf16 v[28:31], v[72:75], v[116:119], v[28:31]
    v_mfma_f32_16x16x32_bf16 v[32:35], v[72:75], v[120:123], v[32:35]
    s_waitcnt vmcnt(4) lgkmcnt(0)
    s_nop 0
    v_mfma_f32_16x16x32_bf16 v[36:39], v[100:103], v[124:127], v[36:39]
    v_mfma_f32_16x16x32_bf16 v[40:43], v[100:103], v[128:131], v[40:43]
    ds_read_b128 v[68:71], v13 offset:12288
    v_mfma_f32_16x16x32_bf16 v[44:47], v[104:107], v[124:127], v[44:47]
    ds_read_b128 v[72:75], v13 offset:13312
    buffer_load_dwordx4 v[116:119], v3, s[4:7], s46 offen
    v_mfma_f32_16x16x32_bf16 v[48:51], v[104:107], v[128:131], v[48:51]
    ds_read_b128 v[76:79], v13 offset:14336
    v_mfma_f32_16x16x32_bf16 v[52:55], v[124:127], v[108:111], v[52:55]
    ds_read_b128 v[80:83], v13 offset:15360
    v_mfma_f32_16x16x32_bf16 v[56:59], v[128:131], v[108:111], v[56:59]
    ds_read_b128 v[84:87], v13 offset:16384
    v_mfma_f32_16x16x32_bf16 v[60:63], v[124:127], v[112:115], v[60:63]
    ds_read_b128 v[88:91], v13 offset:17408
    buffer_load_dwordx4 v[120:123], v3, s[4:7], s46 offen offset:1024
    s_add_u32 s46, s46, 131072
    v_mfma_f32_16x16x32_bf16 v[64:67], v[128:131], v[112:115], v[64:67]
    v_mfma_f32_16x16x32_bf16 v[20:23], v[92:95], v[124:127], v[20:23]
    v_mfma_f32_16x16x32_bf16 v[24:27], v[92:95], v[128:131], v[24:27]
    v_mfma_f32_16x16x32_bf16 v[28:31], v[96:99], v[124:127], v[28:31]
    v_mfma_f32_16x16x32_bf16 v[32:35], v[96:99], v[128:131], v[32:35]
    s_waitcnt vmcnt(4) lgkmcnt(0)
    s_nop 0
    v_mfma_f32_16x16x32_bf16 v[36:39], v[76:79], v[132:135], v[36:39]
    v_mfma_f32_16x16x32_bf16 v[40:43], v[76:79], v[136:139], v[40:43]
    ds_read_b128 v[92:95], v13 offset:18432
    v_mfma_f32_16x16x32_bf16 v[44:47], v[80:83], v[132:135], v[44:47]
    ds_read_b128 v[96:99], v13 offset:19456
    buffer_load_dwordx4 v[124:127], v3, s[4:7], s46 offen
    v_mfma_f32_16x16x32_bf16 v[48:51], v[80:83], v[136:139], v[48:51]
    ds_read_b128 v[100:103], v13 offset:20480
    v_mfma_f32_16x16x32_bf16 v[52:55], v[132:135], v[84:87], v[52:55]
    ds_read_b128 v[104:107], v13 offset:21504
    v_mfma_f32_16x16x32_bf16 v[56:59], v[136:139], v[84:87], v[56:59]
    ds_read_b128 v[108:111], v13 offset:22528
    v_mfma_f32_16x16x32_bf16 v[60:63], v[132:135], v[88:91], v[60:63]
    ds_read_b128 v[112:115], v13 offset:23552
    buffer_load_dwordx4 v[128:131], v3, s[4:7], s46 offen offset:1024
    s_add_u32 s46, s46, 131072
    v_mfma_f32_16x16x32_bf16 v[64:67], v[136:139], v[88:91], v[64:67]
    v_mfma_f32_16x16x32_bf16 v[20:23], v[68:71], v[132:135], v[20:23]
    v_mfma_f32_16x16x32_bf16 v[24:27], v[68:71], v[136:139], v[24:27]
    v_mfma_f32_16x16x32_bf16 v[28:31], v[72:75], v[132:135], v[28:31]
    v_mfma_f32_16x16x32_bf16 v[32:35], v[72:75], v[136:139], v[32:35]
    s_waitcnt vmcnt(4) lgkmcnt(0)
    v_mfma_f32_16x16x32_bf16 v[36:39], v[100:103], v[140:143], v[36:39]
    s_barrier
    v_mfma_f32_16x16x32_bf16 v[40:43], v[100:103], v[144:147], v[40:43]
    ds_read_b128 v[68:71], v13 offset:24576
    v_mfma_f32_16x16x32_bf16 v[44:47], v[104:107], v[140:143], v[44:47]
    ds_read_b128 v[72:75], v13 offset:25600
    buffer_load_dwordx4 v[132:135], v3, s[4:7], s46 offen
    v_mfma_f32_16x16x32_bf16 v[48:51], v[104:107], v[144:147], v[48:51]
    ds_read_b128 v[76:79], v13 offset:26624
    v_mfma_f32_16x16x32_bf16 v[52:55], v[140:143], v[108:111], v[52:55]
    ds_read_b128 v[80:83], v13 offset:27648
    v_mfma_f32_16x16x32_bf16 v[56:59], v[144:147], v[108:111], v[56:59]
    ds_read_b128 v[84:87], v13 offset:28672
    v_mfma_f32_16x16x32_bf16 v[60:63], v[140:143], v[112:115], v[60:63]
    ds_read_b128 v[88:91], v13 offset:29696
    buffer_load_dwordx4 v[136:139], v3, s[4:7], s46 offen offset:1024
    s_add_u32 s46, s46, 131072
    v_mfma_f32_16x16x32_bf16 v[64:67], v[144:147], v[112:115], v[64:67]
    v_mfma_f32_16x16x32_bf16 v[20:23], v[92:95], v[140:143], v[20:23]
    v_mfma_f32_16x16x32_bf16 v[24:27], v[92:95], v[144:147], v[24:27]
    v_mfma_f32_16x16x32_bf16 v[28:31], v[96:99], v[140:143], v[28:31]
    v_mfma_f32_16x16x32_bf16 v[32:35], v[96:99], v[144:147], v[32:35]
    s_waitcnt vmcnt(4) lgkmcnt(0)
    s_nop 0
    v_mfma_f32_16x16x32_bf16 v[36:39], v[76:79], v[116:119], v[36:39]
    v_mfma_f32_16x16x32_bf16 v[40:43], v[76:79], v[120:123], v[40:43]
    ds_read_b128 v[92:95], v13 offset:30720
    v_mfma_f32_16x16x32_bf16 v[44:47], v[80:83], v[116:119], v[44:47]
    ds_read_b128 v[96:99], v13 offset:31744
    buffer_load_dwordx4 v[140:143], v3, s[4:7], s46 offen
    v_mfma_f32_16x16x32_bf16 v[48:51], v[80:83], v[120:123], v[48:51]
    ds_read_b128 v[100:103], v13 offset:32768
    v_mfma_f32_16x16x32_bf16 v[52:55], v[116:119], v[84:87], v[52:55]
    ds_read_b128 v[104:107], v13 offset:33792
    v_mfma_f32_16x16x32_bf16 v[56:59], v[120:123], v[84:87], v[56:59]
    ds_read_b128 v[108:111], v13 offset:34816
    v_mfma_f32_16x16x32_bf16 v[60:63], v[116:119], v[88:91], v[60:63]
    ds_read_b128 v[112:115], v13 offset:35840
    buffer_load_dwordx4 v[144:147], v3, s[4:7], s46 offen offset:1024
    s_add_u32 s46, s46, 131072
    v_mfma_f32_16x16x32_bf16 v[64:67], v[120:123], v[88:91], v[64:67]
    v_mfma_f32_16x16x32_bf16 v[20:23], v[68:71], v[116:119], v[20:23]
    v_mfma_f32_16x16x32_bf16 v[24:27], v[68:71], v[120:123], v[24:27]
    v_mfma_f32_16x16x32_bf16 v[28:31], v[72:75], v[116:119], v[28:31]
    v_mfma_f32_16x16x32_bf16 v[32:35], v[72:75], v[120:123], v[32:35]
    s_waitcnt vmcnt(4) lgkmcnt(0)
    s_nop 0
    v_mfma_f32_16x16x32_bf16 v[36:39], v[100:103], v[124:127], v[36:39]
    v_mfma_f32_16x16x32_bf16 v[40:43], v[100:103], v[128:131], v[40:43]
    ds_read_b128 v[68:71], v13 offset:36864
    v_mfma_f32_16x16x32_bf16 v[44:47], v[104:107], v[124:127], v[44:47]
    ds_read_b128 v[72:75], v13 offset:37888
    buffer_load_dwordx4 v[116:119], v3, s[4:7], s46 offen
    v_mfma_f32_16x16x32_bf16 v[48:51], v[104:107], v[128:131], v[48:51]
    ds_read_b128 v[76:79], v13 offset:38912
    v_mfma_f32_16x16x32_bf16 v[52:55], v[124:127], v[108:111], v[52:55]
    ds_read_b128 v[80:83], v13 offset:39936
    v_mfma_f32_16x16x32_bf16 v[56:59], v[128:131], v[108:111], v[56:59]
    ds_read_b128 v[84:87], v13 offset:40960
    v_mfma_f32_16x16x32_bf16 v[60:63], v[124:127], v[112:115], v[60:63]
    ds_read_b128 v[88:91], v13 offset:41984
    buffer_load_dwordx4 v[120:123], v3, s[4:7], s46 offen offset:1024
    s_add_u32 s46, s46, 131072
    v_mfma_f32_16x16x32_bf16 v[64:67], v[128:131], v[112:115], v[64:67]
    v_mfma_f32_16x16x32_bf16 v[20:23], v[92:95], v[124:127], v[20:23]
    v_mfma_f32_16x16x32_bf16 v[24:27], v[92:95], v[128:131], v[24:27]
    v_mfma_f32_16x16x32_bf16 v[28:31], v[96:99], v[124:127], v[28:31]
    v_mfma_f32_16x16x32_bf16 v[32:35], v[96:99], v[128:131], v[32:35]
    s_waitcnt vmcnt(4) lgkmcnt(0)
    s_nop 0
    v_mfma_f32_16x16x32_bf16 v[36:39], v[76:79], v[132:135], v[36:39]
    v_mfma_f32_16x16x32_bf16 v[40:43], v[76:79], v[136:139], v[40:43]
    ds_read_b128 v[92:95], v13 offset:43008
    v_mfma_f32_16x16x32_bf16 v[44:47], v[80:83], v[132:135], v[44:47]
    ds_read_b128 v[96:99], v13 offset:44032
    buffer_load_dwordx4 v[124:127], v3, s[4:7], s46 offen
    v_mfma_f32_16x16x32_bf16 v[48:51], v[80:83], v[136:139], v[48:51]
    ds_read_b128 v[100:103], v13 offset:45056
    v_mfma_f32_16x16x32_bf16 v[52:55], v[132:135], v[84:87], v[52:55]
    ds_read_b128 v[104:107], v13 offset:46080
    v_mfma_f32_16x16x32_bf16 v[56:59], v[136:139], v[84:87], v[56:59]
    ds_read_b128 v[108:111], v13 offset:47104
    v_mfma_f32_16x16x32_bf16 v[60:63], v[132:135], v[88:91], v[60:63]
    ds_read_b128 v[112:115], v13 offset:48128
    buffer_load_dwordx4 v[128:131], v3, s[4:7], s46 offen offset:1024
    s_add_u32 s46, s46, 131072
    v_mfma_f32_16x16x32_bf16 v[64:67], v[136:139], v[88:91], v[64:67]
    v_mfma_f32_16x16x32_bf16 v[20:23], v[68:71], v[132:135], v[20:23]
    v_mfma_f32_16x16x32_bf16 v[24:27], v[68:71], v[136:139], v[24:27]
    v_mfma_f32_16x16x32_bf16 v[28:31], v[72:75], v[132:135], v[28:31]
    v_mfma_f32_16x16x32_bf16 v[32:35], v[72:75], v[136:139], v[32:35]
    s_waitcnt vmcnt(4) lgkmcnt(0)
    v_mfma_f32_16x16x32_bf16 v[36:39], v[100:103], v[140:143], v[36:39]
    s_barrier
    v_mfma_f32_16x16x32_bf16 v[40:43], v[100:103], v[144:147], v[40:43]
    ds_read_b128 v[68:71], v13 offset:49152
    v_mfma_f32_16x16x32_bf16 v[44:47], v[104:107], v[140:143], v[44:47]
    ds_read_b128 v[72:75], v13 offset:50176
    buffer_load_dwordx4 v[132:135], v3, s[4:7], s46 offen
    v_mfma_f32_16x16x32_bf16 v[48:51], v[104:107], v[144:147], v[48:51]
    ds_read_b128 v[76:79], v13 offset:51200
    v_mfma_f32_16x16x32_bf16 v[52:55], v[140:143], v[108:111], v[52:55]
    ds_read_b128 v[80:83], v13 offset:52224
    v_mfma_f32_16x16x32_bf16 v[56:59], v[144:147], v[108:111], v[56:59]
    ds_read_b128 v[84:87], v13 offset:53248
    v_mfma_f32_16x16x32_bf16 v[60:63], v[140:143], v[112:115], v[60:63]
    ds_read_b128 v[88:91], v13 offset:54272
    buffer_load_dwordx4 v[136:139], v3, s[4:7], s46 offen offset:1024
    s_add_u32 s46, s46, 131072
    v_mfma_f32_16x16x32_bf16 v[64:67], v[144:147], v[112:115], v[64:67]
    v_mfma_f32_16x16x32_bf16 v[20:23], v[92:95], v[140:143], v[20:23]
    v_mfma_f32_16x16x32_bf16 v[24:27], v[92:95], v[144:147], v[24:27]
    v_mfma_f32_16x16x32_bf16 v[28:31], v[96:99], v[140:143], v[28:31]
    v_mfma_f32_16x16x32_bf16 v[32:35], v[96:99], v[144:147], v[32:35]
    s_waitcnt vmcnt(4) lgkmcnt(0)
    s_nop 0
    v_mfma_f32_16x16x32_bf16 v[36:39], v[76:79], v[116:119], v[36:39]
    v_mfma_f32_16x16x32_bf16 v[40:43], v[76:79], v[120:123], v[40:43]
    ds_read_b128 v[92:95], v13 offset:55296
    v_mfma_f32_16x16x32_bf16 v[44:47], v[80:83], v[116:119], v[44:47]
    ds_read_b128 v[96:99], v13 offset:56320
    buffer_load_dwordx4 v[140:143], v3, s[4:7], s46 offen
    v_mfma_f32_16x16x32_bf16 v[48:51], v[80:83], v[120:123], v[48:51]
    ds_read_b128 v[100:103], v13 offset:57344
    v_mfma_f32_16x16x32_bf16 v[52:55], v[116:119], v[84:87], v[52:55]
    ds_read_b128 v[104:107], v13 offset:58368
    v_mfma_f32_16x16x32_bf16 v[56:59], v[120:123], v[84:87], v[56:59]
    ds_read_b128 v[108:111], v13 offset:59392
    v_mfma_f32_16x16x32_bf16 v[60:63], v[116:119], v[88:91], v[60:63]
    ds_read_b128 v[112:115], v13 offset:60416
    buffer_load_dwordx4 v[144:147], v3, s[4:7], s46 offen offset:1024
    s_add_u32 s46, s46, 131072
    v_mfma_f32_16x16x32_bf16 v[64:67], v[120:123], v[88:91], v[64:67]
    v_mfma_f32_16x16x32_bf16 v[20:23], v[68:71], v[116:119], v[20:23]
    v_mfma_f32_16x16x32_bf16 v[24:27], v[68:71], v[120:123], v[24:27]
    v_mfma_f32_16x16x32_bf16 v[28:31], v[72:75], v[116:119], v[28:31]
    buffer_load_dwordx4 v[148:151], v3, s[24:27], s45 offen
    v_mfma_f32_16x16x32_bf16 v[32:35], v[72:75], v[120:123], v[32:35]
    buffer_load_dwordx4 v[152:155], v3, s[24:27], s45 offen offset:1024
    s_waitcnt vmcnt(6) lgkmcnt(0)
    s_nop 0
    v_add_u32 v13, 61440, v3
    v_mfma_f32_16x16x32_bf16 v[36:39], v[100:103], v[124:127], v[36:39]
    v_mfma_f32_16x16x32_bf16 v[40:43], v[100:103], v[128:131], v[40:43]
    ds_read_b128 v[68:71], v13 offset:0
    v_mfma_f32_16x16x32_bf16 v[44:47], v[104:107], v[124:127], v[44:47]
    ds_read_b128 v[72:75], v13 offset:1024
    v_mfma_f32_16x16x32_bf16 v[48:51], v[104:107], v[128:131], v[48:51]
    ds_read_b128 v[76:79], v13 offset:2048
    v_mfma_f32_16x16x32_bf16 v[52:55], v[124:127], v[108:111], v[52:55]
    ds_read_b128 v[80:83], v13 offset:3072
    v_mfma_f32_16x16x32_bf16 v[56:59], v[128:131], v[108:111], v[56:59]
    ds_read_b128 v[84:87], v13 offset:4096
    v_mfma_f32_16x16x32_bf16 v[60:63], v[124:127], v[112:115], v[60:63]
    ds_read_b128 v[88:91], v13 offset:5120
    v_mfma_f32_16x16x32_bf16 v[64:67], v[128:131], v[112:115], v[64:67]
    v_mfma_f32_16x16x32_bf16 v[20:23], v[92:95], v[124:127], v[20:23]
    v_mfma_f32_16x16x32_bf16 v[24:27], v[92:95], v[128:131], v[24:27]
    v_mfma_f32_16x16x32_bf16 v[28:31], v[96:99], v[124:127], v[28:31]
    v_mfma_f32_16x16x32_bf16 v[32:35], v[96:99], v[128:131], v[32:35]
    s_waitcnt vmcnt(4) lgkmcnt(0)
    s_nop 0
    v_mfma_f32_16x16x32_bf16 v[36:39], v[76:79], v[132:135], v[36:39]
    v_mfma_f32_16x16x32_bf16 v[40:43], v[76:79], v[136:139], v[40:43]
    ds_read_b128 v[92:95], v13 offset:6144
    v_mfma_f32_16x16x32_bf16 v[44:47], v[80:83], v[132:135], v[44:47]
    ds_read_b128 v[96:99], v13 offset:7168
    v_mfma_f32_16x16x32_bf16 v[48:51], v[80:83], v[136:139], v[48:51]
    ds_read_b128 v[100:103], v13 offset:8192
    v_mfma_f32_16x16x32_bf16 v[52:55], v[132:135], v[84:87], v[52:55]
    ds_read_b128 v[104:107], v13 offset:9216
    v_mfma_f32_16x16x32_bf16 v[56:59], v[136:139], v[84:87], v[56:59]
    ds_read_b128 v[108:111], v13 offset:10240
    v_mfma_f32_16x16x32_bf16 v[60:63], v[132:135], v[88:91], v[60:63]
    ds_read_b128 v[112:115], v13 offset:11264
    v_mfma_f32_16x16x32_bf16 v[64:67], v[136:139], v[88:91], v[64:67]
    v_mfma_f32_16x16x32_bf16 v[20:23], v[68:71], v[132:135], v[20:23]
    v_mfma_f32_16x16x32_bf16 v[24:27], v[68:71], v[136:139], v[24:27]
    v_mfma_f32_16x16x32_bf16 v[28:31], v[72:75], v[132:135], v[28:31]
    v_mfma_f32_16x16x32_bf16 v[32:35], v[72:75], v[136:139], v[32:35]
    s_waitcnt vmcnt(2) lgkmcnt(0)
    v_mfma_f32_16x16x32_bf16 v[36:39], v[100:103], v[140:143], v[36:39]
    s_barrier
    v_mfma_f32_16x16x32_bf16 v[40:43], v[100:103], v[144:147], v[40:43]
    ds_read_b128 v[164:167], v17 offset:128
    ds_read_b128 v[168:171], v17 offset:192
    v_mfma_f32_16x16x32_bf16 v[44:47], v[104:107], v[140:143], v[44:47]
    ds_read_b32 v10, v9
    ds_read_b32 v12, v9 offset:64
    v_mfma_f32_16x16x32_bf16 v[48:51], v[104:107], v[144:147], v[48:51]
    ds_read_b128 v[220:223], v15
    ds_read_b128 v[224:227], v15 offset:1024
    v_mfma_f32_16x16x32_bf16 v[52:55], v[140:143], v[108:111], v[52:55]
    ds_read_b128 v[228:231], v15 offset:64
    ds_read_b128 v[232:235], v15 offset:1088
    v_mfma_f32_16x16x32_bf16 v[56:59], v[144:147], v[108:111], v[56:59]
    ds_read_b128 v[156:159], v17
    ds_read_b128 v[160:163], v17 offset:64
    v_mfma_f32_16x16x32_bf16 v[60:63], v[140:143], v[112:115], v[60:63]
    v_mfma_f32_16x16x32_bf16 v[64:67], v[144:147], v[112:115], v[64:67]
    v_mfma_f32_16x16x32_bf16 v[20:23], v[92:95], v[140:143], v[20:23]
    v_mfma_f32_16x16x32_bf16 v[24:27], v[92:95], v[144:147], v[24:27]
    v_mfma_f32_16x16x32_bf16 v[28:31], v[96:99], v[140:143], v[28:31]
    v_mfma_f32_16x16x32_bf16 v[32:35], v[96:99], v[144:147], v[32:35]
    s_add_u32 s28, s68, 0x4400000
    .long 0x821dff45, 0x0
    s_mov_b32 s30, 0x200000
    s_mov_b32 s31, 0x00020000
    s_add_u32 s32, s68, 0x4c00000
    .long 0x8221ff45, 0x0
    s_mov_b32 s34, 0x10000
    s_mov_b32 s35, 0x00020000
    s_waitcnt vmcnt(0) lgkmcnt(0)
    s_nop 0
    v_pk_fma_f32 v[36:37], v[164:165], v[4:5], v[36:37] op_sel_hi:[1,0,1]
    v_pk_fma_f32 v[38:39], v[166:167], v[4:5], v[38:39] op_sel_hi:[1,0,1]
    v_pk_fma_f32 v[44:45], v[168:169], v[4:5], v[44:45] op_sel_hi:[1,0,1]
    v_pk_fma_f32 v[46:47], v[170:171], v[4:5], v[46:47] op_sel_hi:[1,0,1]
    v_pk_fma_f32 v[40:41], v[164:165], v[8:9], v[40:41] op_sel_hi:[1,0,1]
    v_pk_fma_f32 v[42:43], v[166:167], v[8:9], v[42:43] op_sel_hi:[1,0,1]
    v_pk_fma_f32 v[48:49], v[168:169], v[8:9], v[48:49] op_sel_hi:[1,0,1]
    v_pk_fma_f32 v[50:51], v[170:171], v[8:9], v[50:51] op_sel_hi:[1,0,1]
    v_cvt_pk_bf16_f32 v68, v36, v37
    v_cvt_pk_bf16_f32 v69, v38, v39
    v_cvt_pk_bf16_f32 v70, v44, v45
    v_cvt_pk_bf16_f32 v71, v46, v47
    v_cvt_pk_bf16_f32 v72, v40, v41
    v_cvt_pk_bf16_f32 v73, v42, v43
    v_cvt_pk_bf16_f32 v74, v48, v49
    v_cvt_pk_bf16_f32 v75, v50, v51
    v_mfma_f32_16x16x32_bf16 v[104:107], v[148:151], v[68:71], 0
    v_mfma_f32_16x16x32_bf16 v[108:111], v[152:155], v[68:71], 0
    v_mfma_f32_16x16x32_bf16 v[112:115], v[148:151], v[72:75], 0
    v_mfma_f32_16x16x32_bf16 v[116:119], v[152:155], v[72:75], 0
    v_pk_fma_f32 v[52:53], v[224:225], v[10:11], v[52:53] op_sel_hi:[1,0,1]
    v_pk_fma_f32 v[54:55], v[226:227], v[10:11], v[54:55] op_sel_hi:[1,0,1]
    v_pk_fma_f32 v[56:57], v[232:233], v[10:11], v[56:57] op_sel_hi:[1,0,1]
    v_pk_fma_f32 v[58:59], v[234:235], v[10:11], v[58:59] op_sel_hi:[1,0,1]
    v_pk_fma_f32 v[60:61], v[224:225], v[12:13], v[60:61] op_sel_hi:[1,0,1]
    v_pk_fma_f32 v[62:63], v[226:227], v[12:13], v[62:63] op_sel_hi:[1,0,1]
    v_pk_fma_f32 v[64:65], v[232:233], v[12:13], v[64:65] op_sel_hi:[1,0,1]
    v_pk_fma_f32 v[66:67], v[234:235], v[12:13], v[66:67] op_sel_hi:[1,0,1]
    v_pk_mul_f32 v[52:53], v[52:53], v[220:221]
    v_pk_mul_f32 v[54:55], v[54:55], v[222:223]
    v_pk_mul_f32 v[56:57], v[56:57], v[228:229]
    v_pk_mul_f32 v[58:59], v[58:59], v[230:231]
    v_pk_mul_f32 v[60:61], v[60:61], v[220:221]
    v_pk_mul_f32 v[62:63], v[62:63], v[222:223]
    v_pk_mul_f32 v[64:65], v[64:65], v[228:229]
    v_pk_mul_f32 v[66:67], v[66:67], v[230:231]
    v_cvt_pk_bf16_f32 v76, v52, v53
    v_cvt_pk_bf16_f32 v77, v54, v55
    v_cvt_pk_bf16_f32 v78, v56, v57
    v_cvt_pk_bf16_f32 v79, v58, v59
    v_cvt_pk_bf16_f32 v80, v60, v61
    v_cvt_pk_bf16_f32 v81, v62, v63
    v_cvt_pk_bf16_f32 v82, v64, v65
    v_cvt_pk_bf16_f32 v83, v66, v67
    s_lshl_b32 s45, s40, 11
    v_add_u32 v11, s45, v3
    ds_write_b128 v11, v[76:79] offset:0
    ds_write_b128 v11, v[80:83] offset:1024
    v_and_b32 v5, 15, v0
    v_lshrrev_b32 v9, 2, v7
    v_sub_u32_e64 v5, v5, v9
    v_mov_b32 v92, 0x3f80
    v_mov_b32 v93, 1.0
    v_cmp_eq_u32 vcc, 0, v5
    s_nop 1
    v_cndmask_b32 v84, 0, v92, vcc
    v_cmp_eq_u32 vcc, 1, v5
    s_nop 1
    v_cndmask_b32 v84, v84, v93, vcc
    v_cmp_eq_u32 vcc, 2, v5
    s_nop 1
    v_cndmask_b32 v85, 0, v92, vcc
    v_cmp_eq_u32 vcc, 3, v5
    s_nop 1
    v_cndmask_b32 v85, v85, v93, vcc
    v_mov_b32 v86, 0
    v_mov_b32 v87, 0
    v_mov_b32 v88, 0
    v_mov_b32 v89, 0
    v_mov_b32 v90, v84
    v_mov_b32_e64 v91, v85
    v_mov_b32 v92, 0x3f803f80
    v_mov_b32 v93, 0x3f803f80
    v_mov_b32 v94, 0x3f803f80
    v_mov_b32 v95, 0x3f803f80
    v_max3_f32 v96, v104, v105, v106
    v_max3_f32 v98, -v104, -v105, -v106
    v_max3_f32 v100, v112, v113, v114
    v_max3_f32 v102, -v112, -v113, -v114
    v_max3_f32 v96, v96, v107, v108
    v_max3_f32 v98, v98, -v107, -v108
    v_max3_f32 v100, v100, v115, v116
    v_max3_f32 v102, v102, -v115, -v116
    v_max3_f32 v96, v96, v109, v110
    v_max3_f32 v98, v98, -v109, -v110
    v_max3_f32 v100, v100, v117, v118
    v_max3_f32 v102, v102, -v117, -v118
    v_max_f32_e64 v96, v96, v111
    v_max_f32_e64 v98, v98, -v111
    v_max_f32_e64 v100, v100, v119
    v_max_f32_e64 v102, v102, -v119
    v_permlane32_swap_b32 v96, v98
    s_nop 0
    v_permlane32_swap_b32 v100, v102
    v_max_f32 v96, v96, v98
    v_max_f32 v100, v100, v102
    v_mov_b32 v97, v96
    v_mov_b32 v101, v100
    s_nop 0
    v_permlane16_swap_b32 v96, v97
    v_permlane16_swap_b32 v100, v101
    v_max_f32 v96, v96, v97
    v_max_f32 v100, v100, v101
    v_mov_b32 v98, v96
    v_mov_b32 v102, v100
    s_nop 0
    v_permlane32_swap_b32 v96, v98
    v_permlane32_swap_b32 v100, v102
    v_mul_f32 v96, v2, v96
    v_mul_f32 v98, v2, v98
    v_mul_f32 v100, v6, v100
    v_mul_f32_e64 v102, v6, v102
    v_pk_fma_f32 v[120:121], v[104:105], v[2:3], v[98:99] op_sel_hi:[1,0,0] neg_lo:[1,0,1] neg_hi:[1,0,1]
    v_pk_fma_f32 v[122:123], v[106:107], v[2:3], v[98:99] op_sel_hi:[1,0,0] neg_lo:[1,0,1] neg_hi:[1,0,1]
    v_pk_fma_f32 v[124:125], v[108:109], v[2:3], v[98:99] op_sel_hi:[1,0,0] neg_lo:[1,0,1] neg_hi:[1,0,1]
    v_pk_fma_f32 v[126:127], v[110:111], v[2:3], v[98:99] op_sel_hi:[1,0,0] neg_lo:[1,0,1] neg_hi:[1,0,1]
    v_pk_fma_f32 v[104:105], v[104:105], v[2:3], v[96:97] op_sel_hi:[1,0,0] neg_lo:[0,0,1] neg_hi:[0,0,1]
    v_pk_fma_f32 v[106:107], v[106:107], v[2:3], v[96:97] op_sel_hi:[1,0,0] neg_lo:[0,0,1] neg_hi:[0,0,1]
    v_pk_fma_f32 v[108:109], v[108:109], v[2:3], v[96:97] op_sel_hi:[1,0,0] neg_lo:[0,0,1] neg_hi:[0,0,1]
    v_pk_fma_f32 v[110:111], v[110:111], v[2:3], v[96:97] op_sel_hi:[1,0,0] neg_lo:[0,0,1] neg_hi:[0,0,1]
    v_pk_fma_f32 v[128:129], v[112:113], v[6:7], v[102:103] op_sel_hi:[1,0,0] neg_lo:[1,0,1] neg_hi:[1,0,1]
    v_pk_fma_f32 v[130:131], v[114:115], v[6:7], v[102:103] op_sel_hi:[1,0,0] neg_lo:[1,0,1] neg_hi:[1,0,1]
    v_pk_fma_f32 v[132:133], v[116:117], v[6:7], v[102:103] op_sel_hi:[1,0,0] neg_lo:[1,0,1] neg_hi:[1,0,1]
    v_pk_fma_f32 v[134:135], v[118:119], v[6:7], v[102:103] op_sel_hi:[1,0,0] neg_lo:[1,0,1] neg_hi:[1,0,1]
    v_pk_fma_f32 v[112:113], v[112:113], v[6:7], v[100:101] op_sel_hi:[1,0,0] neg_lo:[0,0,1] neg_hi:[0,0,1]
    v_pk_fma_f32 v[114:115], v[114:115], v[6:7], v[100:101] op_sel_hi:[1,0,0] neg_lo:[0,0,1] neg_hi:[0,0,1]
    v_pk_fma_f32 v[116:117], v[116:117], v[6:7], v[100:101] op_sel_hi:[1,0,0] neg_lo:[0,0,1] neg_hi:[0,0,1]
    v_pk_fma_f32 v[118:119], v[118:119], v[6:7], v[100:101] op_sel_hi:[1,0,0] neg_lo:[0,0,1] neg_hi:[0,0,1]
    v_exp_f32 v104, v104
    v_exp_f32 v105, v105
    v_exp_f32 v106, v106
    v_exp_f32 v107, v107
    v_exp_f32 v108, v108
    v_exp_f32 v109, v109
    v_exp_f32 v110, v110
    v_exp_f32 v111, v111
    v_exp_f32 v120, v120
    v_exp_f32 v121, v121
    v_exp_f32 v122, v122
    v_exp_f32 v123, v123
    v_exp_f32 v124, v124
    v_exp_f32 v125, v125
    v_exp_f32 v126, v126
    v_exp_f32 v127, v127
    v_exp_f32 v112, v112
    v_exp_f32 v113, v113
    v_exp_f32 v114, v114
    v_exp_f32 v115, v115
    v_exp_f32 v116, v116
    v_exp_f32 v117, v117
    v_exp_f32 v118, v118
    v_exp_f32 v119, v119
    v_exp_f32 v128, v128
    v_exp_f32 v129, v129
    v_exp_f32 v130, v130
    v_exp_f32 v131, v131
    v_exp_f32 v132, v132
    v_exp_f32 v133, v133
    v_exp_f32 v134, v134
    v_exp_f32 v135, v135
    v_pk_add_f32 v[96:97], v[104:105], v[106:107]
    v_pk_add_f32 v[98:99], v[120:121], v[122:123]
    v_pk_add_f32 v[100:101], v[112:113], v[114:115]
    v_pk_add_f32 v[102:103], v[128:129], v[130:131]
    v_pk_add_f32 v[96:97], v[96:97], v[108:109]
    v_pk_add_f32 v[98:99], v[98:99], v[124:125]
    v_pk_add_f32 v[100:101], v[100:101], v[116:117]
    v_pk_add_f32 v[102:103], v[102:103], v[132:133]
    v_pk_add_f32 v[96:97], v[96:97], v[110:111]
    v_pk_add_f32 v[98:99], v[98:99], v[126:127]
    v_pk_add_f32 v[100:101], v[100:101], v[118:119]
    v_pk_add_f32 v[102:103], v[102:103], v[134:135]
    v_add_f32 v96, v96, v97
    v_add_f32 v98, v98, v99
    v_add_f32 v100, v100, v101
    v_add_f32 v102, v102, v103
    v_permlane32_swap_b32 v96, v98
    s_nop 0
    v_permlane32_swap_b32 v100, v102
    v_add_f32 v96, v96, v98
    v_add_f32 v100, v100, v102
    v_mov_b32 v97, v96
    v_mov_b32 v101, v100
    s_nop 0
    v_permlane16_swap_b32 v96, v97
    v_permlane16_swap_b32 v100, v101
    v_add_f32 v96, v96, v97
    v_add_f32 v100, v100, v101
    v_mov_b32 v98, v96
    v_mov_b32 v102, v100
    s_nop 0
    v_permlane32_swap_b32 v96, v98
    v_permlane32_swap_b32 v100, v102
    v_rcp_f32 v96, v96
    v_rcp_f32 v98, v98
    v_rcp_f32 v100, v100
    v_rcp_f32_e64 v102, v102
    v_pk_mul_f32 v[104:105], v[104:105], v[96:97] op_sel_hi:[1,0]
    v_pk_mul_f32 v[106:107], v[106:107], v[96:97] op_sel_hi:[1,0]
    v_pk_mul_f32 v[108:109], v[108:109], v[96:97] op_sel_hi:[1,0]
    v_pk_mul_f32 v[110:111], v[110:111], v[96:97] op_sel_hi:[1,0]
    v_pk_mul_f32 v[120:121], v[120:121], v[98:99] op_sel_hi:[1,0]
    v_pk_mul_f32 v[122:123], v[122:123], v[98:99] op_sel_hi:[1,0]
    v_pk_mul_f32 v[124:125], v[124:125], v[98:99] op_sel_hi:[1,0]
    v_pk_mul_f32 v[126:127], v[126:127], v[98:99] op_sel_hi:[1,0]
    v_cvt_pk_bf16_f32 v104, v104, v105
    v_cvt_pk_bf16_f32 v105, v106, v107
    v_cvt_pk_bf16_f32 v106, v108, v109
    v_cvt_pk_bf16_f32 v107, v110, v111
    v_cvt_pk_bf16_f32 v120, v120, v121
    v_cvt_pk_bf16_f32 v121, v122, v123
    v_cvt_pk_bf16_f32 v122, v124, v125
    v_cvt_pk_bf16_f32 v123, v126, v127
    v_mfma_f32_16x16x32_bf16 v[172:175], v[104:107], v[84:87], 0
    s_mov_b32 s99, 0x1000
    v_mfma_f32_16x16x32_bf16 v[188:191], v[120:123], v[84:87], 0
    v_mfma_f32_16x16x32_bf16 v[180:183], v[104:107], v[88:91], 0
    v_mfma_f32_16x16x32_bf16 v[196:199], v[120:123], v[88:91], 0
    v_pk_mul_f32 v[112:113], v[112:113], v[100:101] op_sel_hi:[1,0]
    v_pk_mul_f32 v[114:115], v[114:115], v[100:101] op_sel_hi:[1,0]
    v_pk_mul_f32 v[116:117], v[116:117], v[100:101] op_sel_hi:[1,0]
    v_pk_mul_f32 v[118:119], v[118:119], v[100:101] op_sel_hi:[1,0]
    v_pk_mul_f32 v[128:129], v[128:129], v[102:103] op_sel_hi:[1,0]
    v_pk_mul_f32 v[130:131], v[130:131], v[102:103] op_sel_hi:[1,0]
    v_pk_mul_f32 v[132:133], v[132:133], v[102:103] op_sel_hi:[1,0]
    v_pk_mul_f32 v[134:135], v[134:135], v[102:103] op_sel_hi:[1,0]
    v_cvt_pk_bf16_f32 v112, v112, v113
    v_cvt_pk_bf16_f32 v113, v114, v115
    v_cvt_pk_bf16_f32 v114, v116, v117
    v_cvt_pk_bf16_f32 v115, v118, v119
    v_cvt_pk_bf16_f32 v128, v128, v129
    v_cvt_pk_bf16_f32 v129, v130, v131
    v_cvt_pk_bf16_f32 v130, v132, v133
    v_cvt_pk_bf16_f32 v131, v134, v135
    v_mfma_f32_16x16x32_bf16 v[176:179], v[112:115], v[84:87], 0
    s_mov_b32 s99, 0x1000
    v_mfma_f32_16x16x32_bf16 v[192:195], v[128:131], v[84:87], 0
    v_mfma_f32_16x16x32_bf16 v[184:187], v[112:115], v[88:91], 0
    v_mfma_f32_16x16x32_bf16 v[200:203], v[128:131], v[88:91], 0
    s_lshl_b32 s45, s40, 10
    v_add_u32 v11, s45, v3
    v_mov_b32 v13, 137600
    v_mov_b32_e64 v9, 1
    v_cvt_pk_bf16_f32 v204, v172, v173
    v_cvt_pk_bf16_f32 v205, v174, v175
    v_cvt_pk_bf16_f32 v206, v176, v177
    v_cvt_pk_bf16_f32 v207, v178, v179
    ds_write_b128 v11, v[204:207] offset:16384
    v_cvt_pk_bf16_f32 v208, v180, v181
    v_cvt_pk_bf16_f32 v209, v182, v183
    v_cvt_pk_bf16_f32 v210, v184, v185
    v_cvt_pk_bf16_f32 v211, v186, v187
    ds_write_b128 v11, v[208:211] offset:24576
    v_cvt_pk_bf16_f32 v212, v188, v189
    v_cvt_pk_bf16_f32 v213, v190, v191
    v_cvt_pk_bf16_f32 v214, v192, v193
    v_cvt_pk_bf16_f32 v215, v194, v195
    ds_write_b128 v11, v[212:215] offset:32768
    v_cvt_pk_bf16_f32 v216, v196, v197
    v_cvt_pk_bf16_f32 v217, v198, v199
    v_cvt_pk_bf16_f32 v218, v200, v201
    v_cvt_pk_bf16_f32 v219, v202, v203
    ds_write_b128 v11, v[216:219] offset:40960
    s_waitcnt lgkmcnt(0)
    s_mov_b64 exec, 1
    ds_add_u32 v13, v9
    s_mov_b64 exec, -1
    s_cmp_ge_u32 s40, 4
    s_cbranch_scc1 interleave_layers__linear_kernel_hedgehog__geglu_ffn__prompt_kernel_hi16
    s_lshl_b32 s45, s40, 13
    v_add_u32_e64 v11, s45, v3
    s_lshl_b32 s53, s42, 3
    s_add_u32 s48, s53, s41
    s_lshl_b32 s49, s48, 13
    s_lshl_b32 s54, s40, 11
    s_add_u32 s49, s49, s54
    s_lshl_b32 s48, s48, 8
    s_lshl_b32 s43, s40, 6
    s_add_u32 s48, s48, s43
interleave_layers__linear_kernel_hedgehog__geglu_ffn__prompt_kernel_spin18:
    ds_read_b32 v9, v13
    s_waitcnt lgkmcnt(0)
    v_readfirstlane_b32 s74, v9
    s_nop 0
    .long 0xbf0aff4a, 0x8
    s_cbranch_scc1 interleave_layers__linear_kernel_hedgehog__geglu_ffn__prompt_kernel_spin18
    ds_read_b128 v[104:107], v11 offset:16384
    ds_read_b128 v[172:175], v3 offset:0
    ds_read_b128 v[176:179], v3 offset:1024
    ds_read_b128 v[108:111], v11 offset:17408
    ds_read_b128 v[180:183], v3 offset:2048
    ds_read_b128 v[184:187], v3 offset:3072
    ds_read_b128 v[112:115], v11 offset:18432
    ds_read_b128 v[188:191], v3 offset:4096
    ds_read_b128 v[192:195], v3 offset:5120
    ds_read_b128 v[116:119], v11 offset:19456
    ds_read_b128 v[196:199], v3 offset:6144
    ds_read_b128 v[200:203], v3 offset:7168
    s_waitcnt lgkmcnt(9)
    v_mfma_f32_16x16x32_bf16 v[136:139], v[104:107], v[172:175], 0
    v_mfma_f32_16x16x32_bf16 v[140:143], v[104:107], v[176:179], 0
    v_mfma_f32_16x16x32_bf16 v[144:147], v[104:107], v[92:95], 0
    ds_read_b128 v[120:123], v11 offset:20480
    ds_read_b128 v[204:207], v3 offset:8192
    ds_read_b128 v[208:211], v3 offset:9216
    s_waitcnt lgkmcnt(9)
    v_mfma_f32_16x16x32_bf16 v[136:139], v[108:111], v[180:183], v[136:139]
    v_mfma_f32_16x16x32_bf16 v[140:143], v[108:111], v[184:187], v[140:143]
    v_mfma_f32_16x16x32_bf16 v[144:147], v[108:111], v[92:95], v[144:147]
    ds_read_b128 v[124:127], v11 offset:21504
    ds_read_b128 v[212:215], v3 offset:10240
    ds_read_b128 v[216:219], v3 offset:11264
    s_waitcnt lgkmcnt(9)
    v_mfma_f32_16x16x32_bf16 v[136:139], v[112:115], v[188:191], v[136:139]
    v_mfma_f32_16x16x32_bf16 v[140:143], v[112:115], v[192:195], v[140:143]
    v_mfma_f32_16x16x32_bf16 v[144:147], v[112:115], v[92:95], v[144:147]
    ds_read_b128 v[128:131], v11 offset:22528
    ds_read_b128 v[220:223], v3 offset:12288
    ds_read_b128 v[224:227], v3 offset:13312
    s_waitcnt lgkmcnt(9)
    v_mfma_f32_16x16x32_bf16 v[136:139], v[116:119], v[196:199], v[136:139]
    v_mfma_f32_16x16x32_bf16 v[140:143], v[116:119], v[200:203], v[140:143]
    v_mfma_f32_16x16x32_bf16 v[144:147], v[116:119], v[92:95], v[144:147]
    ds_read_b128 v[132:135], v11 offset:23552
    ds_read_b128 v[228:231], v3 offset:14336
    ds_read_b128 v[232:235], v3 offset:15360
    s_waitcnt lgkmcnt(9)
    v_mfma_f32_16x16x32_bf16 v[136:139], v[120:123], v[204:207], v[136:139]
    v_mfma_f32_16x16x32_bf16 v[140:143], v[120:123], v[208:211], v[140:143]
    v_mfma_f32_16x16x32_bf16 v[144:147], v[120:123], v[92:95], v[144:147]
    s_waitcnt lgkmcnt(6)
    v_mfma_f32_16x16x32_bf16 v[136:139], v[124:127], v[212:215], v[136:139]
    v_mfma_f32_16x16x32_bf16 v[140:143], v[124:127], v[216:219], v[140:143]
    v_mfma_f32_16x16x32_bf16 v[144:147], v[124:127], v[92:95], v[144:147]
    s_waitcnt lgkmcnt(3)
    v_mfma_f32_16x16x32_bf16 v[136:139], v[128:131], v[220:223], v[136:139]
    v_mfma_f32_16x16x32_bf16 v[140:143], v[128:131], v[224:227], v[140:143]
    v_mfma_f32_16x16x32_bf16 v[144:147], v[128:131], v[92:95], v[144:147]
    s_waitcnt lgkmcnt(0)
    v_mfma_f32_16x16x32_bf16 v[136:139], v[132:135], v[228:231], v[136:139]
    v_mfma_f32_16x16x32_bf16 v[140:143], v[132:135], v[232:235], v[140:143]
    v_mfma_f32_16x16x32_bf16 v[144:147], v[132:135], v[92:95], v[144:147]
    s_lshl_b32 s74, s42, 12
    s_add_u32 s74, s74, 0
    s_lshl_b32 s75, s40, 7
    s_add_u32 s74, s74, s75
    s_lshl_b32 s75, s41, 9
    s_add_u32 s74, s74, s75
    buffer_store_dwordx4 v[136:139], v3, s[28:31], s49 offen offset:0 sc0 sc1
    buffer_store_dwordx4 v[140:143], v3, s[28:31], s49 offen offset:1024 sc0 sc1
    s_mov_b32 exec_lo, 0x00010001
    s_mov_b32 exec_hi, 0x00010001
    buffer_store_dwordx4 v[144:147], v7, s[32:35], s48 offen sc0 sc1
    s_mov_b64 exec, -1
    s_nop 0
    v_pk_fma_f32 v[20:21], v[156:157], v[4:5], v[20:21] op_sel_hi:[1,0,1]
    v_pk_fma_f32 v[22:23], v[158:159], v[4:5], v[22:23] op_sel_hi:[1,0,1]
    v_pk_fma_f32 v[28:29], v[160:161], v[4:5], v[28:29] op_sel_hi:[1,0,1]
    v_pk_fma_f32 v[30:31], v[162:163], v[4:5], v[30:31] op_sel_hi:[1,0,1]
    v_pk_fma_f32 v[24:25], v[156:157], v[8:9], v[24:25] op_sel_hi:[1,0,1]
    v_pk_fma_f32 v[26:27], v[158:159], v[8:9], v[26:27] op_sel_hi:[1,0,1]
    v_pk_fma_f32 v[32:33], v[160:161], v[8:9], v[32:33] op_sel_hi:[1,0,1]
    v_pk_fma_f32 v[34:35], v[162:163], v[8:9], v[34:35] op_sel_hi:[1,0,1]
    v_cvt_pk_bf16_f32 v68, v20, v21
    v_cvt_pk_bf16_f32 v69, v22, v23
    v_cvt_pk_bf16_f32 v70, v28, v29
    v_cvt_pk_bf16_f32 v71, v30, v31
    v_cvt_pk_bf16_f32 v72, v24, v25
    v_cvt_pk_bf16_f32 v73, v26, v27
    v_cvt_pk_bf16_f32 v74, v32, v33
    v_cvt_pk_bf16_f32 v75, v34, v35
    v_mfma_f32_16x16x32_bf16 v[36:39], v[148:151], v[68:71], 0
    v_mfma_f32_16x16x32_bf16 v[40:43], v[152:155], v[68:71], 0
    v_mfma_f32_16x16x32_bf16 v[44:47], v[148:151], v[72:75], 0
    v_mfma_f32_16x16x32_bf16 v[48:51], v[152:155], v[72:75], 0
    s_waitcnt vmcnt(0)
    v_mov_b32 v239, 0
    v_mov_b32 v240, s60
    s_mov_b64 exec, 1
    buffer_store_dword v240, v239, s[56:59], s74 offen sc0 sc1
    s_mov_b64 exec, -1
    s_nop 0
    v_max3_f32 v96, v36, v37, v38
    v_max3_f32 v98, -v36, -v37, -v38
    v_max3_f32 v100, v44, v45, v46
    v_max3_f32 v102, -v44, -v45, -v46
    v_max3_f32 v96, v96, v39, v40
    v_max3_f32 v98, v98, -v39, -v40
    v_max3_f32 v100, v100, v47, v48
    v_max3_f32 v102, v102, -v47, -v48
    v_max3_f32 v96, v96, v41, v42
    v_max3_f32 v98, v98, -v41, -v42
    v_max3_f32 v100, v100, v49, v50
    v_max3_f32 v102, v102, -v49, -v50
    v_max_f32_e64 v96, v96, v43
    v_max_f32_e64 v98, v98, -v43
    v_max_f32_e64 v100, v100, v51
    v_max_f32_e64 v102, v102, -v51
    v_permlane32_swap_b32 v96, v98
    s_nop 0
    v_permlane32_swap_b32 v100, v102
    v_max_f32 v96, v96, v98
    v_max_f32 v100, v100, v102
    v_mov_b32 v97, v96
    v_mov_b32 v101, v100
    s_nop 0
    v_permlane16_swap_b32 v96, v97
    v_permlane16_swap_b32 v100, v101
    v_max_f32 v96, v96, v97
    v_max_f32 v100, v100, v101
    v_mov_b32 v98, v96
    v_mov_b32 v102, v100
    s_nop 0
    v_permlane32_swap_b32 v96, v98
    v_permlane32_swap_b32 v100, v102
    v_mul_f32 v96, v2, v96
    v_mul_f32 v98, v2, v98
    v_mul_f32 v100, v6, v100
    v_mul_f32_e64 v102, v6, v102
    v_pk_fma_f32 v[52:53], v[36:37], v[2:3], v[98:99] op_sel_hi:[1,0,0] neg_lo:[1,0,1] neg_hi:[1,0,1]
    v_pk_fma_f32 v[54:55], v[38:39], v[2:3], v[98:99] op_sel_hi:[1,0,0] neg_lo:[1,0,1] neg_hi:[1,0,1]
    v_pk_fma_f32 v[56:57], v[40:41], v[2:3], v[98:99] op_sel_hi:[1,0,0] neg_lo:[1,0,1] neg_hi:[1,0,1]
    v_pk_fma_f32 v[58:59], v[42:43], v[2:3], v[98:99] op_sel_hi:[1,0,0] neg_lo:[1,0,1] neg_hi:[1,0,1]
    v_pk_fma_f32 v[36:37], v[36:37], v[2:3], v[96:97] op_sel_hi:[1,0,0] neg_lo:[0,0,1] neg_hi:[0,0,1]
    v_pk_fma_f32 v[38:39], v[38:39], v[2:3], v[96:97] op_sel_hi:[1,0,0] neg_lo:[0,0,1] neg_hi:[0,0,1]
    v_pk_fma_f32 v[40:41], v[40:41], v[2:3], v[96:97] op_sel_hi:[1,0,0] neg_lo:[0,0,1] neg_hi:[0,0,1]
    v_pk_fma_f32 v[42:43], v[42:43], v[2:3], v[96:97] op_sel_hi:[1,0,0] neg_lo:[0,0,1] neg_hi:[0,0,1]
    v_pk_fma_f32 v[60:61], v[44:45], v[6:7], v[102:103] op_sel_hi:[1,0,0] neg_lo:[1,0,1] neg_hi:[1,0,1]
    v_pk_fma_f32 v[62:63], v[46:47], v[6:7], v[102:103] op_sel_hi:[1,0,0] neg_lo:[1,0,1] neg_hi:[1,0,1]
    v_pk_fma_f32 v[64:65], v[48:49], v[6:7], v[102:103] op_sel_hi:[1,0,0] neg_lo:[1,0,1] neg_hi:[1,0,1]
    v_pk_fma_f32 v[66:67], v[50:51], v[6:7], v[102:103] op_sel_hi:[1,0,0] neg_lo:[1,0,1] neg_hi:[1,0,1]
    v_pk_fma_f32 v[44:45], v[44:45], v[6:7], v[100:101] op_sel_hi:[1,0,0] neg_lo:[0,0,1] neg_hi:[0,0,1]
    v_pk_fma_f32 v[46:47], v[46:47], v[6:7], v[100:101] op_sel_hi:[1,0,0] neg_lo:[0,0,1] neg_hi:[0,0,1]
    v_pk_fma_f32 v[48:49], v[48:49], v[6:7], v[100:101] op_sel_hi:[1,0,0] neg_lo:[0,0,1] neg_hi:[0,0,1]
    v_pk_fma_f32 v[50:51], v[50:51], v[6:7], v[100:101] op_sel_hi:[1,0,0] neg_lo:[0,0,1] neg_hi:[0,0,1]
    v_exp_f32 v36, v36
    v_exp_f32 v37, v37
    v_exp_f32 v38, v38
    v_exp_f32 v39, v39
    v_exp_f32 v40, v40
    v_exp_f32 v41, v41
    v_exp_f32 v42, v42
    v_exp_f32 v43, v43
    v_exp_f32 v52, v52
    v_exp_f32 v53, v53
    v_exp_f32 v54, v54
    v_exp_f32 v55, v55
    v_exp_f32 v56, v56
    v_exp_f32 v57, v57
    v_exp_f32 v58, v58
    v_exp_f32 v59, v59
    v_exp_f32 v44, v44
    v_exp_f32 v45, v45
    v_exp_f32 v46, v46
    v_exp_f32 v47, v47
    v_exp_f32 v48, v48
    v_exp_f32 v49, v49
    v_exp_f32 v50, v50
    v_exp_f32 v51, v51
    v_exp_f32 v60, v60
    v_exp_f32 v61, v61
    v_exp_f32 v62, v62
    v_exp_f32 v63, v63
    v_exp_f32 v64, v64
    v_exp_f32 v65, v65
    v_exp_f32 v66, v66
    v_exp_f32 v67, v67
    v_pk_add_f32 v[96:97], v[36:37], v[38:39]
    v_pk_add_f32 v[98:99], v[52:53], v[54:55]
    v_pk_add_f32 v[100:101], v[44:45], v[46:47]
    v_pk_add_f32 v[102:103], v[60:61], v[62:63]
    v_pk_add_f32 v[96:97], v[96:97], v[40:41]
    v_pk_add_f32 v[98:99], v[98:99], v[56:57]
    v_pk_add_f32 v[100:101], v[100:101], v[48:49]
    v_pk_add_f32 v[102:103], v[102:103], v[64:65]
    v_pk_add_f32 v[96:97], v[96:97], v[42:43]
    v_pk_add_f32 v[98:99], v[98:99], v[58:59]
    v_pk_add_f32 v[100:101], v[100:101], v[50:51]
    v_pk_add_f32 v[102:103], v[102:103], v[66:67]
    v_add_f32 v96, v96, v97
    v_add_f32 v98, v98, v99
    v_add_f32 v100, v100, v101
    v_add_f32 v102, v102, v103
    v_permlane32_swap_b32 v96, v98
    s_nop 0
    v_permlane32_swap_b32 v100, v102
    v_add_f32 v96, v96, v98
    v_add_f32 v100, v100, v102
    v_mov_b32 v97, v96
    v_mov_b32 v101, v100
    s_nop 0
    v_permlane16_swap_b32 v96, v97
    v_permlane16_swap_b32 v100, v101
    v_add_f32 v96, v96, v97
    v_add_f32 v100, v100, v101
    v_mov_b32 v98, v96
    v_mov_b32 v102, v100
    s_nop 0
    v_permlane32_swap_b32 v96, v98
    v_permlane32_swap_b32 v100, v102
    v_rcp_f32 v96, v96
    v_rcp_f32 v98, v98
    v_rcp_f32 v100, v100
    v_rcp_f32_e64 v102, v102
    v_pk_mul_f32 v[36:37], v[36:37], v[96:97] op_sel_hi:[1,0]
    v_pk_mul_f32 v[38:39], v[38:39], v[96:97] op_sel_hi:[1,0]
    v_pk_mul_f32 v[40:41], v[40:41], v[96:97] op_sel_hi:[1,0]
    v_pk_mul_f32 v[42:43], v[42:43], v[96:97] op_sel_hi:[1,0]
    v_pk_mul_f32 v[52:53], v[52:53], v[98:99] op_sel_hi:[1,0]
    v_pk_mul_f32 v[54:55], v[54:55], v[98:99] op_sel_hi:[1,0]
    v_pk_mul_f32 v[56:57], v[56:57], v[98:99] op_sel_hi:[1,0]
    v_pk_mul_f32 v[58:59], v[58:59], v[98:99] op_sel_hi:[1,0]
    v_cvt_pk_bf16_f32 v36, v36, v37
    v_cvt_pk_bf16_f32 v37, v38, v39
    v_cvt_pk_bf16_f32 v38, v40, v41
    v_cvt_pk_bf16_f32 v39, v42, v43
    v_cvt_pk_bf16_f32 v52, v52, v53
    v_cvt_pk_bf16_f32 v53, v54, v55
    v_cvt_pk_bf16_f32 v54, v56, v57
    v_cvt_pk_bf16_f32 v55, v58, v59
    v_pk_mul_f32 v[44:45], v[44:45], v[100:101] op_sel_hi:[1,0]
    v_pk_mul_f32 v[46:47], v[46:47], v[100:101] op_sel_hi:[1,0]
    v_pk_mul_f32 v[48:49], v[48:49], v[100:101] op_sel_hi:[1,0]
    v_pk_mul_f32 v[50:51], v[50:51], v[100:101] op_sel_hi:[1,0]
    v_pk_mul_f32 v[60:61], v[60:61], v[102:103] op_sel_hi:[1,0]
    v_pk_mul_f32 v[62:63], v[62:63], v[102:103] op_sel_hi:[1,0]
    v_pk_mul_f32 v[64:65], v[64:65], v[102:103] op_sel_hi:[1,0]
    v_pk_mul_f32 v[66:67], v[66:67], v[102:103] op_sel_hi:[1,0]
    v_cvt_pk_bf16_f32 v44, v44, v45
    v_cvt_pk_bf16_f32 v45, v46, v47
    v_cvt_pk_bf16_f32 v46, v48, v49
    v_cvt_pk_bf16_f32 v47, v50, v51
    v_cvt_pk_bf16_f32 v60, v60, v61
    v_cvt_pk_bf16_f32 v61, v62, v63
    v_cvt_pk_bf16_f32 v62, v64, v65
    v_cvt_pk_bf16_f32 v63, v66, v67
    s_cmp_ge_u32 s2, 28
    s_cbranch_scc1 interleave_layers__linear_kernel_hedgehog__geglu_ffn__prompt_kernel_ncf19
    s_lshl_b32 s49, s2, 2
    s_add_u32 s49, s49, s40
    s_mul_hi_u32 s48, s49, 613566757
    .long 0x8e30ff30, 0x7
    s_add_u32 s48, s48, 622592
    v_lshlrev_b32_e64 v9, 11, v0
    s_mov_b32 exec_lo, 0xffff
    s_mov_b32 exec_hi, 0x0
    s_mov_b32 s74, 0
interleave_layers__linear_kernel_hedgehog__geglu_ffn__prompt_kernel_poll20:
    buffer_load_dword v244, v9, s[56:59], s48 offen sc1
    s_add_u32 s74, s74, 1
    s_waitcnt vmcnt(0)
    v_cmp_ne_u32 vcc, s60, v244
    s_nop 0
    s_cmp_eq_u64 vcc, 0
    s_cbranch_scc1 interleave_layers__linear_kernel_hedgehog__geglu_ffn__prompt_kernel_polled21
    s_mov_b64 exec, vcc
    s_sleep 4
    s_cmp_lt_u32 s74, 50000
    s_cbranch_scc1 interleave_layers__linear_kernel_hedgehog__geglu_ffn__prompt_kernel_poll20
interleave_layers__linear_kernel_hedgehog__geglu_ffn__prompt_kernel_polled21:
    s_mov_b64 exec, -1
    s_add_u32 s28, s68, 0x5f00000
    .long 0x821dff45, 0x0
    s_mov_b32 s30, 0x70000
    s_mov_b32 s31, 0x00020000
    s_add_u32 s32, s68, 0x4d40000
    .long 0x8221ff45, 0x0
    s_mov_b32 s34, 0x7000
    s_mov_b32 s35, 0x00020000
    v_lshrrev_b32_e64 v5, 4, v0
    v_mul_u32_u24 v5, 114688, v5
    v_and_b32 v9, 15, v0
    v_lshlrev_b32 v9, 4, v9
    v_add_u32_e64 v5, v5, v9
    s_lshl_b32 s48, s49, 8
    s_mov_b32 s43, s48
    buffer_load_dwordx4 v[172:175], v5, s[28:31], s43 offen
    s_add_u32 s43, s43, 28672
    buffer_load_dwordx4 v[176:179], v5, s[28:31], s43 offen
    s_add_u32 s43, s43, 28672
    buffer_load_dwordx4 v[180:183], v5, s[28:31], s43 offen
    s_add_u32 s43, s43, 28672
    buffer_load_dwordx4 v[184:187], v5, s[28:31], s43 offen
    s_waitcnt vmcnt(0)
    s_nop 0
    v_pk_add_f32 v[172:173], v[172:173], v[176:177]
    v_pk_add_f32 v[174:175], v[174:175], v[178:179]
    v_pk_add_f32 v[172:173], v[172:173], v[180:181]
    v_pk_add_f32 v[174:175], v[174:175], v[182:183]
    v_pk_add_f32 v[172:173], v[172:173], v[184:185]
    v_pk_add_f32 v[174:175], v[174:175], v[186:187]
    s_nop 0
    v_permlane32_swap_b32 v172, v173
    v_permlane32_swap_b32 v174, v175
    v_add_f32 v172, v172, v173
    v_add_f32 v174, v174, v175
    v_mov_b32 v176, v172
    v_mov_b32 v177, v174
    s_nop 0
    v_permlane16_swap_b32 v172, v176
    v_permlane16_swap_b32 v174, v177
    v_add_f32 v172, v172, v176
    v_add_f32 v174, v174, v177
    v_mov_b32 v173, v172
    v_mov_b32_e64 v175, v174
    s_nop 0
    v_permlane32_swap_b32 v172, v173
    v_permlane32_swap_b32 v174, v175
    s_mov_b64 exec, 0xffff
    buffer_store_dwordx4 v[172:175], v9, s[32:35], s48 offen sc0 sc1
    s_mov_b64 exec, -1
    s_lshl_b32 s74, s49, 7
    s_add_u32 s74, s74, 655360
    s_waitcnt vmcnt(0)
    v_mov_b32 v239, 0
    v_mov_b32 v240, s60
    s_mov_b64 exec, 1
    buffer_store_dword v240, v239, s[56:59], s74 offen sc0 sc1
    s_mov_b64 exec, -1
interleave_layers__linear_kernel_hedgehog__geglu_ffn__prompt_kernel_ncf19:
    s_branch interleave_layers__linear_kernel_hedgehog__geglu_ffn__prompt_kernel_jn17
interleave_layers__linear_kernel_hedgehog__geglu_ffn__prompt_kernel_hi16:
    v_pk_fma_f32 v[20:21], v[156:157], v[4:5], v[20:21] op_sel_hi:[1,0,1]
    v_pk_fma_f32 v[22:23], v[158:159], v[4:5], v[22:23] op_sel_hi:[1,0,1]
    v_pk_fma_f32 v[28:29], v[160:161], v[4:5], v[28:29] op_sel_hi:[1,0,1]
    v_pk_fma_f32 v[30:31], v[162:163], v[4:5], v[30:31] op_sel_hi:[1,0,1]
    v_pk_fma_f32 v[24:25], v[156:157], v[8:9], v[24:25] op_sel_hi:[1,0,1]
    v_pk_fma_f32 v[26:27], v[158:159], v[8:9], v[26:27] op_sel_hi:[1,0,1]
    v_pk_fma_f32 v[32:33], v[160:161], v[8:9], v[32:33] op_sel_hi:[1,0,1]
    v_pk_fma_f32 v[34:35], v[162:163], v[8:9], v[34:35] op_sel_hi:[1,0,1]
    v_cvt_pk_bf16_f32 v68, v20, v21
    v_cvt_pk_bf16_f32 v69, v22, v23
    v_cvt_pk_bf16_f32 v70, v28, v29
    v_cvt_pk_bf16_f32 v71, v30, v31
    v_cvt_pk_bf16_f32 v72, v24, v25
    v_cvt_pk_bf16_f32 v73, v26, v27
    v_cvt_pk_bf16_f32 v74, v32, v33
    v_cvt_pk_bf16_f32 v75, v34, v35
    v_mfma_f32_16x16x32_bf16 v[36:39], v[148:151], v[68:71], 0
    v_mfma_f32_16x16x32_bf16 v[40:43], v[152:155], v[68:71], 0
    v_mfma_f32_16x16x32_bf16 v[44:47], v[148:151], v[72:75], 0
    v_mfma_f32_16x16x32_bf16 v[48:51], v[152:155], v[72:75], 0
    s_nop 4
    s_nop 0
    v_max3_f32 v96, v36, v37, v38
    v_max3_f32 v98, -v36, -v37, -v38
    v_max3_f32 v100, v44, v45, v46
    v_max3_f32 v102, -v44, -v45, -v46
    v_max3_f32 v96, v96, v39, v40
    v_max3_f32 v98, v98, -v39, -v40
    v_max3_f32 v100, v100, v47, v48
    v_max3_f32 v102, v102, -v47, -v48
    v_max3_f32 v96, v96, v41, v42
    v_max3_f32 v98, v98, -v41, -v42
    v_max3_f32 v100, v100, v49, v50
    v_max3_f32 v102, v102, -v49, -v50
    v_max_f32_e64 v96, v96, v43
    v_max_f32_e64 v98, v98, -v43
    v_max_f32_e64 v100, v100, v51
    v_max_f32_e64 v102, v102, -v51
    v_permlane32_swap_b32 v96, v98
    s_nop 0
    v_permlane32_swap_b32 v100, v102
    v_max_f32 v96, v96, v98
    v_max_f32 v100, v100, v102
    v_mov_b32 v97, v96
    v_mov_b32 v101, v100
    s_nop 0
    v_permlane16_swap_b32 v96, v97
    v_permlane16_swap_b32 v100, v101
    v_max_f32 v96, v96, v97
    v_max_f32 v100, v100, v101
    v_mov_b32 v98, v96
    v_mov_b32 v102, v100
    s_nop 0
    v_permlane32_swap_b32 v96, v98
    v_permlane32_swap_b32 v100, v102
    v_mul_f32 v96, v2, v96
    v_mul_f32 v98, v2, v98
    v_mul_f32 v100, v6, v100
    v_mul_f32_e64 v102, v6, v102
    v_pk_fma_f32 v[52:53], v[36:37], v[2:3], v[98:99] op_sel_hi:[1,0,0] neg_lo:[1,0,1] neg_hi:[1,0,1]
    v_pk_fma_f32 v[54:55], v[38:39], v[2:3], v[98:99] op_sel_hi:[1,0,0] neg_lo:[1,0,1] neg_hi:[1,0,1]
    v_pk_fma_f32 v[56:57], v[40:41], v[2:3], v[98:99] op_sel_hi:[1,0,0] neg_lo:[1,0,1] neg_hi:[1,0,1]
    v_pk_fma_f32 v[58:59], v[42:43], v[2:3], v[98:99] op_sel_hi:[1,0,0] neg_lo:[1,0,1] neg_hi:[1,0,1]
    v_pk_fma_f32 v[36:37], v[36:37], v[2:3], v[96:97] op_sel_hi:[1,0,0] neg_lo:[0,0,1] neg_hi:[0,0,1]
    v_pk_fma_f32 v[38:39], v[38:39], v[2:3], v[96:97] op_sel_hi:[1,0,0] neg_lo:[0,0,1] neg_hi:[0,0,1]
    v_pk_fma_f32 v[40:41], v[40:41], v[2:3], v[96:97] op_sel_hi:[1,0,0] neg_lo:[0,0,1] neg_hi:[0,0,1]
    v_pk_fma_f32 v[42:43], v[42:43], v[2:3], v[96:97] op_sel_hi:[1,0,0] neg_lo:[0,0,1] neg_hi:[0,0,1]
    v_pk_fma_f32 v[60:61], v[44:45], v[6:7], v[102:103] op_sel_hi:[1,0,0] neg_lo:[1,0,1] neg_hi:[1,0,1]
    v_pk_fma_f32 v[62:63], v[46:47], v[6:7], v[102:103] op_sel_hi:[1,0,0] neg_lo:[1,0,1] neg_hi:[1,0,1]
    v_pk_fma_f32 v[64:65], v[48:49], v[6:7], v[102:103] op_sel_hi:[1,0,0] neg_lo:[1,0,1] neg_hi:[1,0,1]
    v_pk_fma_f32 v[66:67], v[50:51], v[6:7], v[102:103] op_sel_hi:[1,0,0] neg_lo:[1,0,1] neg_hi:[1,0,1]
    v_pk_fma_f32 v[44:45], v[44:45], v[6:7], v[100:101] op_sel_hi:[1,0,0] neg_lo:[0,0,1] neg_hi:[0,0,1]
    v_pk_fma_f32 v[46:47], v[46:47], v[6:7], v[100:101] op_sel_hi:[1,0,0] neg_lo:[0,0,1] neg_hi:[0,0,1]
    v_pk_fma_f32 v[48:49], v[48:49], v[6:7], v[100:101] op_sel_hi:[1,0,0] neg_lo:[0,0,1] neg_hi:[0,0,1]
    v_pk_fma_f32 v[50:51], v[50:51], v[6:7], v[100:101] op_sel_hi:[1,0,0] neg_lo:[0,0,1] neg_hi:[0,0,1]
    v_exp_f32 v36, v36
    v_exp_f32 v37, v37
    v_exp_f32 v38, v38
    v_exp_f32 v39, v39
    v_exp_f32 v40, v40
    v_exp_f32 v41, v41
    v_exp_f32 v42, v42
    v_exp_f32 v43, v43
    v_exp_f32 v52, v52
    v_exp_f32 v53, v53
    v_exp_f32 v54, v54
    v_exp_f32 v55, v55
    v_exp_f32 v56, v56
    v_exp_f32 v57, v57
    v_exp_f32 v58, v58
    v_exp_f32 v59, v59
    v_exp_f32 v44, v44
    v_exp_f32 v45, v45
    v_exp_f32 v46, v46
    v_exp_f32 v47, v47
    v_exp_f32 v48, v48
    v_exp_f32 v49, v49
    v_exp_f32 v50, v50
    v_exp_f32 v51, v51
    v_exp_f32 v60, v60
    v_exp_f32 v61, v61
    v_exp_f32 v62, v62
    v_exp_f32 v63, v63
    v_exp_f32 v64, v64
    v_exp_f32 v65, v65
    v_exp_f32 v66, v66
    v_exp_f32 v67, v67
    v_pk_add_f32 v[96:97], v[36:37], v[38:39]
    v_pk_add_f32 v[98:99], v[52:53], v[54:55]
    v_pk_add_f32 v[100:101], v[44:45], v[46:47]
    v_pk_add_f32 v[102:103], v[60:61], v[62:63]
    v_pk_add_f32 v[96:97], v[96:97], v[40:41]
    v_pk_add_f32 v[98:99], v[98:99], v[56:57]
    v_pk_add_f32 v[100:101], v[100:101], v[48:49]
    v_pk_add_f32 v[102:103], v[102:103], v[64:65]
    v_pk_add_f32 v[96:97], v[96:97], v[42:43]
    v_pk_add_f32 v[98:99], v[98:99], v[58:59]
    v_pk_add_f32 v[100:101], v[100:101], v[50:51]
    v_pk_add_f32 v[102:103], v[102:103], v[66:67]
    v_add_f32 v96, v96, v97
    v_add_f32 v98, v98, v99
    v_add_f32 v100, v100, v101
    v_add_f32 v102, v102, v103
    v_permlane32_swap_b32 v96, v98
    s_nop 0
    v_permlane32_swap_b32 v100, v102
    v_add_f32 v96, v96, v98
    v_add_f32 v100, v100, v102
    v_mov_b32 v97, v96
    v_mov_b32 v101, v100
    s_nop 0
    v_permlane16_swap_b32 v96, v97
    v_permlane16_swap_b32 v100, v101
    v_add_f32 v96, v96, v97
    v_add_f32 v100, v100, v101
    v_mov_b32 v98, v96
    v_mov_b32 v102, v100
    s_nop 0
    v_permlane32_swap_b32 v96, v98
    v_permlane32_swap_b32 v100, v102
    v_rcp_f32 v96, v96
    v_rcp_f32 v98, v98
    v_rcp_f32 v100, v100
    v_rcp_f32_e64 v102, v102
    v_pk_mul_f32 v[36:37], v[36:37], v[96:97] op_sel_hi:[1,0]
    v_pk_mul_f32 v[38:39], v[38:39], v[96:97] op_sel_hi:[1,0]
    v_pk_mul_f32 v[40:41], v[40:41], v[96:97] op_sel_hi:[1,0]
    v_pk_mul_f32 v[42:43], v[42:43], v[96:97] op_sel_hi:[1,0]
    v_pk_mul_f32 v[52:53], v[52:53], v[98:99] op_sel_hi:[1,0]
    v_pk_mul_f32 v[54:55], v[54:55], v[98:99] op_sel_hi:[1,0]
    v_pk_mul_f32 v[56:57], v[56:57], v[98:99] op_sel_hi:[1,0]
    v_pk_mul_f32 v[58:59], v[58:59], v[98:99] op_sel_hi:[1,0]
    v_cvt_pk_bf16_f32 v36, v36, v37
    v_cvt_pk_bf16_f32 v37, v38, v39
    v_cvt_pk_bf16_f32 v38, v40, v41
    v_cvt_pk_bf16_f32 v39, v42, v43
    v_cvt_pk_bf16_f32 v52, v52, v53
    v_cvt_pk_bf16_f32 v53, v54, v55
    v_cvt_pk_bf16_f32 v54, v56, v57
    v_cvt_pk_bf16_f32 v55, v58, v59
    v_pk_mul_f32 v[44:45], v[44:45], v[100:101] op_sel_hi:[1,0]
    v_pk_mul_f32 v[46:47], v[46:47], v[100:101] op_sel_hi:[1,0]
    v_pk_mul_f32 v[48:49], v[48:49], v[100:101] op_sel_hi:[1,0]
    v_pk_mul_f32 v[50:51], v[50:51], v[100:101] op_sel_hi:[1,0]
    v_pk_mul_f32 v[60:61], v[60:61], v[102:103] op_sel_hi:[1,0]
    v_pk_mul_f32 v[62:63], v[62:63], v[102:103] op_sel_hi:[1,0]
    v_pk_mul_f32 v[64:65], v[64:65], v[102:103] op_sel_hi:[1,0]
    v_pk_mul_f32 v[66:67], v[66:67], v[102:103] op_sel_hi:[1,0]
    v_cvt_pk_bf16_f32 v44, v44, v45
    v_cvt_pk_bf16_f32 v45, v46, v47
    v_cvt_pk_bf16_f32 v46, v48, v49
    v_cvt_pk_bf16_f32 v47, v50, v51
    v_cvt_pk_bf16_f32 v60, v60, v61
    v_cvt_pk_bf16_f32 v61, v62, v63
    v_cvt_pk_bf16_f32 v62, v64, v65
    v_cvt_pk_bf16_f32 v63, v66, v67
    s_add_u32 s12, s68, 0x4400000
    .long 0x820dff45, 0x0
    s_mov_b32 s14, 0x200000
    s_mov_b32 s15, 0x00020000
    s_add_u32 s16, s68, 0x4c00000
    .long 0x8211ff45, 0x0
    s_mov_b32 s18, 0x10000
    s_mov_b32 s19, 0x00020000
    s_lshl_b32 s53, s42, 12
    s_add_u32 s53, s53, 0
    s_lshl_b32 s74, s52, 7
    s_add_u32 s53, s53, s74
    s_lshl_b32 s49, s42, 16
    s_lshl_b32 s74, s52, 11
    s_add_u32 s49, s49, s74
    s_lshl_b32 s48, s42, 11
    s_lshl_b32 s74, s52, 6
    s_add_u32 s48, s48, s74
    v_and_b32_e64 v5, 7, v0
    v_lshl_add_u32 v5, v5, 8, v7
    v_lshlrev_b32_e64 v9, 9, v0
    s_mov_b32 exec_lo, 0xff
    s_mov_b32 exec_hi, 0x0
    s_mov_b32 s74, 0
interleave_layers__linear_kernel_hedgehog__geglu_ffn__prompt_kernel_poll22:
    buffer_load_dword v244, v9, s[56:59], s53 offen sc1
    s_add_u32 s74, s74, 1
    s_waitcnt vmcnt(0)
    v_cmp_ne_u32 vcc, s60, v244
    s_nop 0
    s_cmp_eq_u64 vcc, 0
    s_cbranch_scc1 interleave_layers__linear_kernel_hedgehog__geglu_ffn__prompt_kernel_polled23
    s_mov_b64 exec, vcc
    s_sleep 4
    s_cmp_lt_u32 s74, 50000
    s_cbranch_scc1 interleave_layers__linear_kernel_hedgehog__geglu_ffn__prompt_kernel_poll22
interleave_layers__linear_kernel_hedgehog__geglu_ffn__prompt_kernel_polled23:
    s_mov_b64 exec, -1
    buffer_load_dwordx4 v[68:71], v3, s[12:15], s49 offen offset:0
    buffer_load_dwordx4 v[72:75], v3, s[12:15], s49 offen offset:1024
    s_add_u32 s49, s49, 8192
    buffer_load_dwordx4 v[76:79], v3, s[12:15], s49 offen offset:0
    buffer_load_dwordx4 v[80:83], v3, s[12:15], s49 offen offset:1024
    s_add_u32 s49, s49, 8192
    buffer_load_dwordx4 v[84:87], v3, s[12:15], s49 offen offset:0
    buffer_load_dwordx4 v[88:91], v3, s[12:15], s49 offen offset:1024
    s_add_u32 s49, s49, 8192
    buffer_load_dwordx4 v[92:95], v3, s[12:15], s49 offen offset:0
    buffer_load_dwordx4 v[96:99], v3, s[12:15], s49 offen offset:1024
    s_add_u32 s49, s49, 8192
    buffer_load_dwordx4 v[100:103], v3, s[12:15], s49 offen offset:0
    buffer_load_dwordx4 v[104:107], v3, s[12:15], s49 offen offset:1024
    s_add_u32 s49, s49, 8192
    buffer_load_dwordx4 v[108:111], v3, s[12:15], s49 offen offset:0
    buffer_load_dwordx4 v[112:115], v3, s[12:15], s49 offen offset:1024
    s_add_u32 s49, s49, 8192
    buffer_load_dwordx4 v[116:119], v3, s[12:15], s49 offen offset:0
    buffer_load_dwordx4 v[120:123], v3, s[12:15], s49 offen offset:1024
    s_add_u32 s49, s49, 8192
    buffer_load_dwordx4 v[124:127], v3, s[12:15], s49 offen offset:0
    buffer_load_dwordx4 v[128:131], v3, s[12:15], s49 offen offset:1024
    buffer_load_dwordx4 v[132:135], v5, s[16:19], s48 offen
    .long 0x8f35ff34, 0x1
    s_mul_i32 s53, s53, 3072
    s_and_b32 s74, s52, 1
    .long 0x8e4aff4a, 0x3
    s_add_u32 s53, s53, s74
    s_add_u32 s53, s53, 81920
    v_add_u32 v9, s53, v3
    s_waitcnt vmcnt(13)
    v_pk_add_f32 v[68:69], v[68:69], v[76:77]
    v_pk_add_f32 v[70:71], v[70:71], v[78:79]
    v_pk_add_f32 v[72:73], v[72:73], v[80:81]
    v_pk_add_f32 v[74:75], v[74:75], v[82:83]
    s_waitcnt vmcnt(11)
    v_pk_add_f32 v[68:69], v[68:69], v[84:85]
    v_pk_add_f32 v[70:71], v[70:71], v[86:87]
    v_pk_add_f32 v[72:73], v[72:73], v[88:89]
    v_pk_add_f32 v[74:75], v[74:75], v[90:91]
    s_waitcnt vmcnt(9)
    v_pk_add_f32 v[68:69], v[68:69], v[92:93]
    v_pk_add_f32 v[70:71], v[70:71], v[94:95]
    v_pk_add_f32 v[72:73], v[72:73], v[96:97]
    v_pk_add_f32 v[74:75], v[74:75], v[98:99]
    s_waitcnt vmcnt(7)
    v_pk_add_f32 v[68:69], v[68:69], v[100:101]
    v_pk_add_f32 v[70:71], v[70:71], v[102:103]
    v_pk_add_f32 v[72:73], v[72:73], v[104:105]
    v_pk_add_f32 v[74:75], v[74:75], v[106:107]
    s_waitcnt vmcnt(5)
    v_pk_add_f32 v[68:69], v[68:69], v[108:109]
    v_pk_add_f32 v[70:71], v[70:71], v[110:111]
    v_pk_add_f32 v[72:73], v[72:73], v[112:113]
    v_pk_add_f32 v[74:75], v[74:75], v[114:115]
    s_waitcnt vmcnt(3)
    v_pk_add_f32 v[68:69], v[68:69], v[116:117]
    v_pk_add_f32 v[70:71], v[70:71], v[118:119]
    v_pk_add_f32 v[72:73], v[72:73], v[120:121]
    v_pk_add_f32 v[74:75], v[74:75], v[122:123]
    s_waitcnt vmcnt(1)
    v_pk_add_f32 v[68:69], v[68:69], v[124:125]
    v_pk_add_f32 v[70:71], v[70:71], v[126:127]
    v_pk_add_f32 v[72:73], v[72:73], v[128:129]
    v_pk_add_f32 v[74:75], v[74:75], v[130:131]
    v_cvt_pk_bf16_f32 v76, v68, v69
    v_cvt_pk_bf16_f32 v77, v70, v71
    v_cvt_pk_bf16_f32 v78, v72, v73
    v_cvt_pk_bf16_f32 v79, v74, v75
    ds_write_b64 v9, v[76:77]
    ds_write_b64 v9, v[78:79] offset:1024
    s_waitcnt vmcnt(0)
    s_nop 0
    v_add_f32_dpp v132, v132, v132 row_ror:4 row_mask:0xf bank_mask:0xf
    v_add_f32_dpp v133, v133, v133 row_ror:4 row_mask:0xf bank_mask:0xf
    v_add_f32_dpp v134, v134, v134 row_ror:4 row_mask:0xf bank_mask:0xf
    v_add_f32_dpp v135, v135, v135 row_ror:4 row_mask:0xf bank_mask:0xf
    v_add_f32_dpp v132, v132, v132 row_ror:2 row_mask:0xf bank_mask:0xf
    v_add_f32_dpp v133, v133, v133 row_ror:2 row_mask:0xf bank_mask:0xf
    v_add_f32_dpp v134, v134, v134 row_ror:2 row_mask:0xf bank_mask:0xf
    v_add_f32_dpp v135, v135, v135 row_ror:2 row_mask:0xf bank_mask:0xf
    v_add_f32_dpp v132, v132, v132 row_ror:1 row_mask:0xf bank_mask:0xf
    v_add_f32_dpp v133, v133, v133 row_ror:1 row_mask:0xf bank_mask:0xf
    v_add_f32_dpp v134, v134, v134 row_ror:1 row_mask:0xf bank_mask:0xf
    v_add_f32_dpp v135, v135, v135 row_ror:1 row_mask:0xf bank_mask:0xf
    v_cvt_pk_bf16_f32 v136, v132, v133
    v_cvt_pk_bf16_f32 v137, v134, v135
    ds_write_b64 v9, v[136:137] offset:2048
    s_waitcnt lgkmcnt(0)
interleave_layers__linear_kernel_hedgehog__geglu_ffn__prompt_kernel_jn17:
    s_add_u32 s28, s68, 0x1000000
    s_addc_u32 s29, s69, 0
    s_mov_b32 s30, 0x400000
    s_mov_b32 s31, 0x00020000
    s_lshl_b32 s45, s42, 17
    s_lshl_b32 s48, s41, 14
    s_add_u32 s45, s45, s48
    .long 0x8e30ff28, 0xb
    s_add_u32 s45, s45, s48
    s_mov_b32 s76, 0x358637bd
    v_add_u32 v5, 81920, v3
    s_barrier
    s_nop 0
    ds_read_b128 v[180:183], v5 offset:2048
    ds_read_b128 v[172:175], v5 offset:0
    ds_read_b128 v[176:179], v5 offset:1024
    ds_read_b128 v[192:195], v5 offset:5120
    ds_read_b128 v[184:187], v5 offset:3072
    ds_read_b128 v[188:191], v5 offset:4096
    s_waitcnt lgkmcnt(3)
    v_mfma_f32_16x16x32_bf16 v[204:207], v[180:183], v[36:39], 0
    v_mfma_f32_16x16x32_bf16 v[216:219], v[180:183], v[44:47], 0
    v_mfma_f32_16x16x32_bf16 v[196:199], v[172:175], v[36:39], 0
    v_mfma_f32_16x16x32_bf16 v[208:211], v[172:175], v[44:47], 0
    v_mfma_f32_16x16x32_bf16 v[200:203], v[176:179], v[36:39], 0
    v_mfma_f32_16x16x32_bf16 v[212:215], v[176:179], v[44:47], 0
    s_waitcnt lgkmcnt(0)
    v_mfma_f32_16x16x32_bf16 v[204:207], v[192:195], v[52:55], v[204:207]
    v_mfma_f32_16x16x32_bf16 v[216:219], v[192:195], v[60:63], v[216:219]
    v_mfma_f32_16x16x32_bf16 v[196:199], v[184:187], v[52:55], v[196:199]
    v_mfma_f32_16x16x32_bf16 v[208:211], v[184:187], v[60:63], v[208:211]
    v_mfma_f32_16x16x32_bf16 v[200:203], v[188:191], v[52:55], v[200:203]
    v_mfma_f32_16x16x32_bf16 v[212:215], v[188:191], v[60:63], v[212:215]
    s_nop 2
    v_add_f32 v204, s76, v204
    v_add_f32 v216, s76, v216
    v_rcp_f32 v204, v204
    v_rcp_f32_e64 v216, v216
    v_pk_mul_f32 v[196:197], v[196:197], v[204:205] op_sel_hi:[1,0]
    v_pk_mul_f32 v[198:199], v[198:199], v[204:205] op_sel_hi:[1,0]
    v_pk_mul_f32 v[200:201], v[200:201], v[204:205] op_sel_hi:[1,0]
    v_pk_mul_f32 v[202:203], v[202:203], v[204:205] op_sel_hi:[1,0]
    v_cvt_pk_bf16_f32 v20, v196, v197
    v_cvt_pk_bf16_f32 v21, v198, v199
    v_cvt_pk_bf16_f32 v22, v200, v201
    v_cvt_pk_bf16_f32 v23, v202, v203
    buffer_store_dwordx4 v[20:23], v3, s[28:31], s45 offen offset:0 sc0 sc1
    v_pk_mul_f32 v[208:209], v[208:209], v[216:217] op_sel_hi:[1,0]
    v_pk_mul_f32 v[210:211], v[210:211], v[216:217] op_sel_hi:[1,0]
    v_pk_mul_f32 v[212:213], v[212:213], v[216:217] op_sel_hi:[1,0]
    v_pk_mul_f32 v[214:215], v[214:215], v[216:217] op_sel_hi:[1,0]
    v_cvt_pk_bf16_f32 v24, v208, v209
    v_cvt_pk_bf16_f32 v25, v210, v211
    v_cvt_pk_bf16_f32 v26, v212, v213
    v_cvt_pk_bf16_f32 v27, v214, v215
    buffer_store_dwordx4 v[24:27], v3, s[28:31], s45 offen offset:1024 sc0 sc1
    s_waitcnt vmcnt(0) lgkmcnt(0)
    s_barrier
    s_cmp_lg_u32 s40, 0
    s_cbranch_scc1 interleave_layers__linear_kernel_hedgehog__geglu_ffn__prompt_kernel_nf24
    s_lshl_b32 s74, s41, 12
    .long 0x8e4bff2a, 0x7
    s_add_u32 s74, s74, s75
    s_add_u32 s74, s74, 262144
    v_mov_b32 v239, 0
    v_mov_b32_e64 v240, s60
    s_mov_b64 exec, 1
    buffer_store_dword v240, v239, s[56:59], s74 offen sc0 sc1
    s_mov_b64 exec, -1
interleave_layers__linear_kernel_hedgehog__geglu_ffn__prompt_kernel_nf24:
    s_branch mega_ph1
mega_ph1:
    s_and_b32 s45, s2, 7
    s_lshr_b32 s49, s2, 3
    s_and_b32 s41, s45, 3
    s_lshl_b32 s41, s41, 2
    s_lshr_b32 s42, s45, 2
    s_mul_i32 s42, s42, 8
    s_and_b32 s45, s49, 3
    s_add_u32 s41, s41, s45
    s_lshr_b32 s45, s49, 2
    s_add_u32 s42, s42, s45
    s_and_b32 s52, s40, 3
    s_cmp_lt_u32 s40, 4
    s_cbranch_scc1 interleave_layers__linear_kernel_hedgehog__geglu_ffn__prompt_kernel_comp25
    s_lshl_b32 s50, s52, 11
    v_lshlrev_b32 v3, 4, v0
    v_add_u32 v3, s50, v3
    s_mul_i32 s47, s42, 131072
    s_add_u32 s8, s68, 0x5500000
    .long 0x8209ff45, 0x0
    s_mov_b32 s10, 0x200000
    s_mov_b32 s11, 0x00020000
    s_mov_b32 s45, 614400
    v_lshlrev_b32 v6, 7, v0
    s_mov_b32 exec_lo, 0xffffffff
    s_mov_b32 exec_hi, 0xffffffff
    s_mov_b32 s74, 0
interleave_layers__linear_kernel_hedgehog__geglu_ffn__prompt_kernel_poll26:
    buffer_load_dword v244, v6, s[56:59], s45 offen sc1
    s_add_u32 s74, s74, 1
    s_waitcnt vmcnt(0)
    v_cmp_ne_u32 vcc, s60, v244
    s_nop 0
    s_cmp_eq_u64 vcc, 0
    s_cbranch_scc1 interleave_layers__linear_kernel_hedgehog__geglu_ffn__prompt_kernel_polled27
    s_mov_b64 exec, vcc
    s_sleep 4
    s_cmp_lt_u32 s74, 50000
    s_cbranch_scc1 interleave_layers__linear_kernel_hedgehog__geglu_ffn__prompt_kernel_poll26
interleave_layers__linear_kernel_hedgehog__geglu_ffn__prompt_kernel_polled27:
    s_mov_b64 exec, -1
    s_add_u32 m0, s50, 0
    s_nop 0
    buffer_load_dwordx4 v3, s[8:11], s47 offen lds
    buffer_load_dwordx4 v3, s[8:11], s47 offen offset:1024 lds
    s_add_u32 s47, s47, 8192
    s_add_u32 m0, s50, 8192
    s_mov_b32 s99, 0x1000
    buffer_load_dwordx4 v3, s[8:11], s47 offen lds
    buffer_load_dwordx4 v3, s[8:11], s47 offen offset:1024 lds
    s_add_u32 s47, s47, 8192
    s_add_u32 m0, s50, 16384
    s_mov_b32 s99, 0x1000
    buffer_load_dwordx4 v3, s[8:11], s47 offen lds
    buffer_load_dwordx4 v3, s[8:11], s47 offen offset:1024 lds
    s_add_u32 s47, s47, 8192
    s_add_u32 m0, s50, 24576
    s_mov_b32 s99, 0x1000
    buffer_load_dwordx4 v3, s[8:11], s47 offen lds
    buffer_load_dwordx4 v3, s[8:11], s47 offen offset:1024 lds
    s_add_u32 s47, s47, 8192
    s_add_u32 m0, s50, 32768
    s_mov_b32 s99, 0x1000
    buffer_load_dwordx4 v3, s[8:11], s47 offen lds
    buffer_load_dwordx4 v3, s[8:11], s47 offen offset:1024 lds
    s_add_u32 s47, s47, 8192
    s_add_u32 m0, s50, 40960
    s_mov_b32 s99, 0x1000
    buffer_load_dwordx4 v3, s[8:11], s47 offen lds
    buffer_load_dwordx4 v3, s[8:11], s47 offen offset:1024 lds
    s_add_u32 s47, s47, 8192
    s_add_u32 m0, s50, 49152
    s_mov_b32 s99, 0x1000
    buffer_load_dwordx4 v3, s[8:11], s47 offen lds
    buffer_load_dwordx4 v3, s[8:11], s47 offen offset:1024 lds
    s_add_u32 s47, s47, 8192
    s_add_u32 m0, s50, 57344
    s_mov_b32 s99, 0x1000
    buffer_load_dwordx4 v3, s[8:11], s47 offen lds
    buffer_load_dwordx4 v3, s[8:11], s47 offen offset:1024 lds
    s_add_u32 s47, s47, 8192
    s_add_u32 m0, s50, 65536
    s_mov_b32 s99, 0x1000
    buffer_load_dwordx4 v3, s[8:11], s47 offen lds
    buffer_load_dwordx4 v3, s[8:11], s47 offen offset:1024 lds
    s_add_u32 s47, s47, 8192
    s_add_u32 m0, s50, 73728
    s_mov_b32 s99, 0x1000
    buffer_load_dwordx4 v3, s[8:11], s47 offen lds
    buffer_load_dwordx4 v3, s[8:11], s47 offen offset:1024 lds
    s_add_u32 s47, s47, 8192
    s_add_u32 m0, s50, 81920
    s_mov_b32 s99, 0x1000
    buffer_load_dwordx4 v3, s[8:11], s47 offen lds
    buffer_load_dwordx4 v3, s[8:11], s47 offen offset:1024 lds
    s_add_u32 s47, s47, 8192
    s_add_u32 m0, s50, 90112
    s_mov_b32 s99, 0x1000
    buffer_load_dwordx4 v3, s[8:11], s47 offen lds
    buffer_load_dwordx4 v3, s[8:11], s47 offen offset:1024 lds
    s_add_u32 s47, s47, 8192
    s_cmp_lg_u32 s40, 4
    s_cbranch_scc1 interleave_layers__linear_kernel_hedgehog__geglu_ffn__prompt_kernel_np28
    s_lshr_b32 s45, s41, 1
    s_lshl_b32 s45, s45, 12
    s_add_u32 s45, s45, 262144
    v_lshlrev_b32 v6, 7, v0
    s_mov_b32 exec_lo, 0xffffffff
    s_mov_b32 exec_hi, 0x0
    s_mov_b32 s74, 0
interleave_layers__linear_kernel_hedgehog__geglu_ffn__prompt_kernel_poll29:
    buffer_load_dword v244, v6, s[56:59], s45 offen sc1
    s_add_u32 s74, s74, 1
    s_waitcnt vmcnt(0)
    v_cmp_ne_u32 vcc, s60, v244
    s_nop 0
    s_cmp_eq_u64 vcc, 0
    s_cbranch_scc1 interleave_layers__linear_kernel_hedgehog__geglu_ffn__prompt_kernel_polled30
    s_mov_b64 exec, vcc
    s_sleep 4
    s_cmp_lt_u32 s74, 50000
    s_cbranch_scc1 interleave_layers__linear_kernel_hedgehog__geglu_ffn__prompt_kernel_poll29
interleave_layers__linear_kernel_hedgehog__geglu_ffn__prompt_kernel_polled30:
    s_mov_b64 exec, -1
interleave_layers__linear_kernel_hedgehog__geglu_ffn__prompt_kernel_np28:
    s_waitcnt vmcnt(16)
    s_barrier
    s_add_u32 m0, s50, 98304
    s_mov_b32 s99, 0x1000
    buffer_load_dwordx4 v3, s[8:11], s47 offen lds
    buffer_load_dwordx4 v3, s[8:11], s47 offen offset:1024 lds
    s_add_u32 s47, s47, 8192
    s_add_u32 m0, s50, 106496
    s_mov_b32 s99, 0x1000
    buffer_load_dwordx4 v3, s[8:11], s47 offen lds
    buffer_load_dwordx4 v3, s[8:11], s47 offen offset:1024 lds
    s_add_u32 s47, s47, 8192
    s_add_u32 m0, s50, 114688
    s_mov_b32 s99, 0x1000
    buffer_load_dwordx4 v3, s[8:11], s47 offen lds
    buffer_load_dwordx4 v3, s[8:11], s47 offen offset:1024 lds
    s_add_u32 s47, s47, 8192
    s_add_u32 m0, s50, 122880
    s_mov_b32 s99, 0x1000
    buffer_load_dwordx4 v3, s[8:11], s47 offen lds
    buffer_load_dwordx4 v3, s[8:11], s47 offen offset:1024 lds
    s_add_u32 s47, s47, 8192
    s_waitcnt vmcnt(16)
    s_barrier
    s_waitcnt vmcnt(8)
    s_barrier
    s_waitcnt vmcnt(0)
    s_barrier
    s_barrier
    s_waitcnt vmcnt(0) lgkmcnt(0)
    s_barrier
    s_cmp_lg_u32 s40, 0
    s_cbranch_scc1 interleave_layers__linear_kernel_hedgehog__geglu_ffn__prompt_kernel_nf31
    s_lshl_b32 s74, s41, 11
    s_lshl_b32 s75, s42, 7
    s_add_u32 s74, s74, s75
    s_add_u32 s74, s74, 327680
    v_mov_b32 v239, 0
    v_mov_b32_e64 v240, s60
    s_mov_b64 exec, 1
    buffer_store_dword v240, v239, s[56:59], s74 offen sc0 sc1
    s_mov_b64 exec, -1
interleave_layers__linear_kernel_hedgehog__geglu_ffn__prompt_kernel_nf31:
    s_branch mega_ph2
interleave_layers__linear_kernel_hedgehog__geglu_ffn__prompt_kernel_comp25:
    v_lshlrev_b32 v5, 4, v0
    s_lshl_b32 s49, s41, 13
    s_lshl_b32 s48, s40, 11
    s_add_u32 s49, s49, s48
    s_lshl_b32 s46, s42, 18
    s_add_u32 s46, s46, s49
    s_add_u32 s47, s46, 131072
    s_add_u32 s51, s49, 131072
    v_lshlrev_b32_e64 v4, 4, v0
    s_add_u32 s4, s68, 0x1000000
    .long 0x8205ff45, 0x0
    s_mov_b32 s6, 0x400000
    s_mov_b32 s7, 0x00020000
    s_mov_b32 s12, s68
    s_mov_b32 s13, s69
    s_mov_b32 s14, 0x400000
    s_mov_b32 s15, 0x00020000
    s_add_u32 s16, s68, 0x400000
    .long 0x8211ff45, 0x0
    s_mov_b32 s18, 0x400000
    s_mov_b32 s19, 0x00020000
    s_add_u32 s24, s68, 0x4c80000
    .long 0x8219ff45, 0x0
    s_mov_b32 s26, 0x40000
    s_mov_b32 s27, 0x00020000
    s_barrier
    s_nop 0
    buffer_load_dwordx4 v[96:99], v5, s[4:7], s49 offen offset:0
    buffer_load_dwordx4 v[100:103], v5, s[4:7], s49 offen offset:1024
    s_add_u32 s49, s49, 262144
    buffer_load_dwordx4 v[104:107], v5, s[4:7], s51 offen offset:0
    buffer_load_dwordx4 v[108:111], v5, s[4:7], s51 offen offset:1024
    s_add_u32 s51, s51, 262144
    buffer_load_dwordx4 v[112:115], v5, s[4:7], s49 offen offset:0
    buffer_load_dwordx4 v[116:119], v5, s[4:7], s49 offen offset:1024
    s_add_u32 s49, s49, 262144
    buffer_load_dwordx4 v[120:123], v5, s[4:7], s51 offen offset:0
    buffer_load_dwordx4 v[124:127], v5, s[4:7], s51 offen offset:1024
    s_add_u32 s51, s51, 262144
    buffer_load_dwordx4 v[128:131], v5, s[4:7], s49 offen offset:0
    buffer_load_dwordx4 v[132:135], v5, s[4:7], s49 offen offset:1024
    s_add_u32 s49, s49, 262144
    buffer_load_dwordx4 v[136:139], v5, s[4:7], s51 offen offset:0
    buffer_load_dwordx4 v[140:143], v5, s[4:7], s51 offen offset:1024
    s_add_u32 s51, s51, 262144
    ds_read_b128 v[40:43], v4 offset:0
    ds_read_b128 v[44:47], v4 offset:1024
    ds_read_b128 v[48:51], v4 offset:2048
    ds_read_b128 v[52:55], v4 offset:3072
    s_mov_b32 s44, 0
    .long 0xbeab00ff, 0x0
    s_waitcnt vmcnt(8) lgkmcnt(0)
    v_mfma_f32_16x16x32_bf16 v[8:11], v[40:43], v[96:99], 0
    ds_read_b128 v[56:59], v4 offset:4096
    v_mfma_f32_16x16x32_bf16 v[12:15], v[40:43], v[100:103], 0
    ds_read_b128 v[60:63], v4 offset:5120
    v_mfma_f32_16x16x32_bf16 v[16:19], v[44:47], v[96:99], 0
    ds_read_b128 v[64:67], v4 offset:6144
    v_mfma_f32_16x16x32_bf16 v[20:23], v[44:47], v[100:103], 0
    ds_read_b128 v[68:71], v4 offset:7168
    v_mfma_f32_16x16x32_bf16 v[24:27], v[48:51], v[96:99], 0
    buffer_load_dwordx4 v[144:147], v5, s[4:7], s49 offen offset:0
    v_mfma_f32_16x16x32_bf16 v[28:31], v[48:51], v[100:103], 0
    buffer_load_dwordx4 v[148:151], v5, s[4:7], s49 offen offset:1024
    s_add_u32 s49, s49, 262144
    v_mfma_f32_16x16x32_bf16 v[32:35], v[52:55], v[96:99], 0
    v_mfma_f32_16x16x32_bf16 v[36:39], v[52:55], v[100:103], 0
    s_waitcnt lgkmcnt(0)
    s_nop 0
    v_mfma_f32_16x16x32_bf16 v[8:11], v[56:59], v[104:107], v[8:11]
    ds_read_b128 v[40:43], v4 offset:8192
    v_mfma_f32_16x16x32_bf16 v[12:15], v[56:59], v[108:111], v[12:15]
    ds_read_b128 v[44:47], v4 offset:9216
    v_mfma_f32_16x16x32_bf16 v[16:19], v[60:63], v[104:107], v[16:19]
    ds_read_b128 v[48:51], v4 offset:10240
    v_mfma_f32_16x16x32_bf16 v[20:23], v[60:63], v[108:111], v[20:23]
    ds_read_b128 v[52:55], v4 offset:11264
    v_mfma_f32_16x16x32_bf16 v[24:27], v[64:67], v[104:107], v[24:27]
    buffer_load_dwordx4 v[152:155], v5, s[4:7], s51 offen offset:0
    v_mfma_f32_16x16x32_bf16 v[28:31], v[64:67], v[108:111], v[28:31]
    buffer_load_dwordx4 v[156:159], v5, s[4:7], s51 offen offset:1024
    s_add_u32 s51, s51, 262144
    v_mfma_f32_16x16x32_bf16 v[32:35], v[68:71], v[104:107], v[32:35]
    v_mfma_f32_16x16x32_bf16 v[36:39], v[68:71], v[108:111], v[36:39]
    s_waitcnt vmcnt(8) lgkmcnt(0)
    s_nop 0
    v_mfma_f32_16x16x32_bf16 v[8:11], v[40:43], v[112:115], v[8:11]
    ds_read_b128 v[56:59], v4 offset:12288
    v_mfma_f32_16x16x32_bf16 v[12:15], v[40:43], v[116:119], v[12:15]
    ds_read_b128 v[60:63], v4 offset:13312
    v_mfma_f32_16x16x32_bf16 v[16:19], v[44:47], v[112:115], v[16:19]
    ds_read_b128 v[64:67], v4 offset:14336
    v_mfma_f32_16x16x32_bf16 v[20:23], v[44:47], v[116:119], v[20:23]
    ds_read_b128 v[68:71], v4 offset:15360
    v_mfma_f32_16x16x32_bf16 v[24:27], v[48:51], v[112:115], v[24:27]
    buffer_load_dwordx4 v[96:99], v5, s[4:7], s49 offen offset:0
    v_mfma_f32_16x16x32_bf16 v[28:31], v[48:51], v[116:119], v[28:31]
    buffer_load_dwordx4 v[100:103], v5, s[4:7], s49 offen offset:1024
    s_add_u32 s49, s49, 262144
    v_mfma_f32_16x16x32_bf16 v[32:35], v[52:55], v[112:115], v[32:35]
    v_mfma_f32_16x16x32_bf16 v[36:39], v[52:55], v[116:119], v[36:39]
    s_waitcnt lgkmcnt(0)
    s_nop 0
    v_mfma_f32_16x16x32_bf16 v[8:11], v[56:59], v[120:123], v[8:11]
    ds_read_b128 v[40:43], v4 offset:16384
    v_mfma_f32_16x16x32_bf16 v[12:15], v[56:59], v[124:127], v[12:15]
    ds_read_b128 v[44:47], v4 offset:17408
    v_mfma_f32_16x16x32_bf16 v[16:19], v[60:63], v[120:123], v[16:19]
    ds_read_b128 v[48:51], v4 offset:18432
    v_mfma_f32_16x16x32_bf16 v[20:23], v[60:63], v[124:127], v[20:23]
    ds_read_b128 v[52:55], v4 offset:19456
    v_mfma_f32_16x16x32_bf16 v[24:27], v[64:67], v[120:123], v[24:27]
    buffer_load_dwordx4 v[104:107], v5, s[4:7], s51 offen offset:0
    v_mfma_f32_16x16x32_bf16 v[28:31], v[64:67], v[124:127], v[28:31]
    buffer_load_dwordx4 v[108:111], v5, s[4:7], s51 offen offset:1024
    s_add_u32 s51, s51, 262144
    v_mfma_f32_16x16x32_bf16 v[32:35], v[68:71], v[120:123], v[32:35]
    v_mfma_f32_16x16x32_bf16 v[36:39], v[68:71], v[124:127], v[36:39]
    s_waitcnt vmcnt(8) lgkmcnt(0)
    s_nop 0
    v_mfma_f32_16x16x32_bf16 v[8:11], v[40:43], v[128:131], v[8:11]
    ds_read_b128 v[56:59], v4 offset:20480
    v_mfma_f32_16x16x32_bf16 v[12:15], v[40:43], v[132:135], v[12:15]
    ds_read_b128 v[60:63], v4 offset:21504
    v_mfma_f32_16x16x32_bf16 v[16:19], v[44:47], v[128:131], v[16:19]
    ds_read_b128 v[64:67], v4 offset:22528
    v_mfma_f32_16x16x32_bf16 v[20:23], v[44:47], v[132:135], v[20:23]
    ds_read_b128 v[68:71], v4 offset:23552
    v_mfma_f32_16x16x32_bf16 v[24:27], v[48:51], v[128:131], v[24:27]
    buffer_load_dwordx4 v[112:115], v5, s[4:7], s49 offen offset:0
    v_mfma_f32_16x16x32_bf16 v[28:31], v[48:51], v[132:135], v[28:31]
    buffer_load_dwordx4 v[116:119], v5, s[4:7], s49 offen offset:1024
    s_add_u32 s49, s49, 262144
    v_mfma_f32_16x16x32_bf16 v[32:35], v[52:55], v[128:131], v[32:35]
    v_mfma_f32_16x16x32_bf16 v[36:39], v[52:55], v[132:135], v[36:39]
    s_waitcnt lgkmcnt(0)
    s_nop 0
    v_mfma_f32_16x16x32_bf16 v[8:11], v[56:59], v[136:139], v[8:11]
    ds_read_b128 v[40:43], v4 offset:24576
    v_mfma_f32_16x16x32_bf16 v[12:15], v[56:59], v[140:143], v[12:15]
    ds_read_b128 v[44:47], v4 offset:25600
    v_mfma_f32_16x16x32_bf16 v[16:19], v[60:63], v[136:139], v[16:19]
    ds_read_b128 v[48:51], v4 offset:26624
    v_mfma_f32_16x16x32_bf16 v[20:23], v[60:63], v[140:143], v[20:23]
    ds_read_b128 v[52:55], v4 offset:27648
    v_mfma_f32_16x16x32_bf16 v[24:27], v[64:67], v[136:139], v[24:27]
    buffer_load_dwordx4 v[120:123], v5, s[4:7], s51 offen offset:0
    v_mfma_f32_16x16x32_bf16 v[28:31], v[64:67], v[140:143], v[28:31]
    buffer_load_dwordx4 v[124:127], v5, s[4:7], s51 offen offset:1024
    s_add_u32 s51, s51, 262144
    v_mfma_f32_16x16x32_bf16 v[32:35], v[68:71], v[136:139], v[32:35]
    v_mfma_f32_16x16x32_bf16 v[36:39], v[68:71], v[140:143], v[36:39]
    s_waitcnt vmcnt(8) lgkmcnt(0)
    s_nop 0
    v_mfma_f32_16x16x32_bf16 v[8:11], v[40:43], v[144:147], v[8:11]
    ds_read_b128 v[56:59], v4 offset:28672
    v_mfma_f32_16x16x32_bf16 v[12:15], v[40:43], v[148:151], v[12:15]
    ds_read_b128 v[60:63], v4 offset:29696
    v_mfma_f32_16x16x32_bf16 v[16:19], v[44:47], v[144:147], v[16:19]
    ds_read_b128 v[64:67], v4 offset:30720
    v_mfma_f32_16x16x32_bf16 v[20:23], v[44:47], v[148:151], v[20:23]
    ds_read_b128 v[68:71], v4 offset:31744
    v_mfma_f32_16x16x32_bf16 v[24:27], v[48:51], v[144:147], v[24:27]
    buffer_load_dwordx4 v[128:131], v5, s[4:7], s49 offen offset:0
    v_mfma_f32_16x16x32_bf16 v[28:31], v[48:51], v[148:151], v[28:31]
    buffer_load_dwordx4 v[132:135], v5, s[4:7], s49 offen offset:1024
    s_add_u32 s49, s49, 262144
    s_add_u32 s54, s44, 32768
    s_cmp_eq_u32 s54, 131072
    .long 0x853636ff, 0x0
    s_sub_u32 s54, s54, s44
    s_add_u32 s44, s44, s54
    v_mfma_f32_16x16x32_bf16 v[32:35], v[52:55], v[144:147], v[32:35]
    v_add_u32_e64 v4, s54, v4
    v_mfma_f32_16x16x32_bf16 v[36:39], v[52:55], v[148:151], v[36:39]
    s_waitcnt lgkmcnt(0)
    s_barrier
    v_mfma_f32_16x16x32_bf16 v[8:11], v[56:59], v[152:155], v[8:11]
    ds_read_b128 v[40:43], v4 offset:0
    v_mfma_f32_16x16x32_bf16 v[12:15], v[56:59], v[156:159], v[12:15]
    ds_read_b128 v[44:47], v4 offset:1024
    v_mfma_f32_16x16x32_bf16 v[16:19], v[60:63], v[152:155], v[16:19]
    ds_read_b128 v[48:51], v4 offset:2048
    v_mfma_f32_16x16x32_bf16 v[20:23], v[60:63], v[156:159], v[20:23]
    ds_read_b128 v[52:55], v4 offset:3072
    v_mfma_f32_16x16x32_bf16 v[24:27], v[64:67], v[152:155], v[24:27]
    buffer_load_dwordx4 v[136:139], v5, s[4:7], s51 offen offset:0
    v_mfma_f32_16x16x32_bf16 v[28:31], v[64:67], v[156:159], v[28:31]
    buffer_load_dwordx4 v[140:143], v5, s[4:7], s51 offen offset:1024
    s_add_u32 s51, s51, 262144
    v_mfma_f32_16x16x32_bf16 v[32:35], v[68:71], v[152:155], v[32:35]
    v_mfma_f32_16x16x32_bf16 v[36:39], v[68:71], v[156:159], v[36:39]
interleave_layers__linear_kernel_hedgehog__geglu_ffn__prompt_kernel_loop32:
    s_waitcnt vmcnt(8) lgkmcnt(0)
    s_nop 0
    v_mfma_f32_16x16x32_bf16 v[8:11], v[40:43], v[96:99], v[8:11]
    ds_read_b128 v[56:59], v4 offset:4096
    v_mfma_f32_16x16x32_bf16 v[12:15], v[40:43], v[100:103], v[12:15]
    ds_read_b128 v[60:63], v4 offset:5120
    v_mfma_f32_16x16x32_bf16 v[16:19], v[44:47], v[96:99], v[16:19]
    ds_read_b128 v[64:67], v4 offset:6144
    v_mfma_f32_16x16x32_bf16 v[20:23], v[44:47], v[100:103], v[20:23]
    ds_read_b128 v[68:71], v4 offset:7168
    v_mfma_f32_16x16x32_bf16 v[24:27], v[48:51], v[96:99], v[24:27]
    buffer_load_dwordx4 v[144:147], v5, s[4:7], s49 offen offset:0
    v_mfma_f32_16x16x32_bf16 v[28:31], v[48:51], v[100:103], v[28:31]
    buffer_load_dwordx4 v[148:151], v5, s[4:7], s49 offen offset:1024
    s_add_u32 s49, s49, 262144
    v_mfma_f32_16x16x32_bf16 v[32:35], v[52:55], v[96:99], v[32:35]
    v_mfma_f32_16x16x32_bf16 v[36:39], v[52:55], v[100:103], v[36:39]
    s_waitcnt lgkmcnt(0)
    s_nop 0
    v_mfma_f32_16x16x32_bf16 v[8:11], v[56:59], v[104:107], v[8:11]
    ds_read_b128 v[40:43], v4 offset:8192
    v_mfma_f32_16x16x32_bf16 v[12:15], v[56:59], v[108:111], v[12:15]
    ds_read_b128 v[44:47], v4 offset:9216
    v_mfma_f32_16x16x32_bf16 v[16:19], v[60:63], v[104:107], v[16:19]
    ds_read_b128 v[48:51], v4 offset:10240
    v_mfma_f32_16x16x32_bf16 v[20:23], v[60:63], v[108:111], v[20:23]
    ds_read_b128 v[52:55], v4 offset:11264
    v_mfma_f32_16x16x32_bf16 v[24:27], v[64:67], v[104:107], v[24:27]
    buffer_load_dwordx4 v[152:155], v5, s[4:7], s51 offen offset:0
    v_mfma_f32_16x16x32_bf16 v[28:31], v[64:67], v[108:111], v[28:31]
    buffer_load_dwordx4 v[156:159], v5, s[4:7], s51 offen offset:1024
    s_add_u32 s51, s51, 262144
    v_mfma_f32_16x16x32_bf16 v[32:35], v[68:71], v[104:107], v[32:35]
    v_mfma_f32_16x16x32_bf16 v[36:39], v[68:71], v[108:111], v[36:39]
    s_waitcnt vmcnt(8) lgkmcnt(0)
    s_nop 0
    v_mfma_f32_16x16x32_bf16 v[8:11], v[40:43], v[112:115], v[8:11]
    ds_read_b128 v[56:59], v4 offset:12288
    v_mfma_f32_16x16x32_bf16 v[12:15], v[40:43], v[116:119], v[12:15]
    ds_read_b128 v[60:63], v4 offset:13312
    v_mfma_f32_16x16x32_bf16 v[16:19], v[44:47], v[112:115], v[16:19]
    ds_read_b128 v[64:67], v4 offset:14336
    v_mfma_f32_16x16x32_bf16 v[20:23], v[44:47], v[116:119], v[20:23]
    ds_read_b128 v[68:71], v4 offset:15360
    v_mfma_f32_16x16x32_bf16 v[24:27], v[48:51], v[112:115], v[24:27]
    buffer_load_dwordx4 v[96:99], v5, s[4:7], s49 offen offset:0
    v_mfma_f32_16x16x32_bf16 v[28:31], v[48:51], v[116:119], v[28:31]
    buffer_load_dwordx4 v[100:103], v5, s[4:7], s49 offen offset:1024
    s_add_u32 s49, s49, 262144
    v_mfma_f32_16x16x32_bf16 v[32:35], v[52:55], v[112:115], v[32:35]
    v_mfma_f32_16x16x32_bf16 v[36:39], v[52:55], v[116:119], v[36:39]
    s_waitcnt lgkmcnt(0)
    s_nop 0
    v_mfma_f32_16x16x32_bf16 v[8:11], v[56:59], v[120:123], v[8:11]
    ds_read_b128 v[40:43], v4 offset:16384
    v_mfma_f32_16x16x32_bf16 v[12:15], v[56:59], v[124:127], v[12:15]
    ds_read_b128 v[44:47], v4 offset:17408
    v_mfma_f32_16x16x32_bf16 v[16:19], v[60:63], v[120:123], v[16:19]
    ds_read_b128 v[48:51], v4 offset:18432
    v_mfma_f32_16x16x32_bf16 v[20:23], v[60:63], v[124:127], v[20:23]
    ds_read_b128 v[52:55], v4 offset:19456
    v_mfma_f32_16x16x32_bf16 v[24:27], v[64:67], v[120:123], v[24:27]
    buffer_load_dwordx4 v[104:107], v5, s[4:7], s51 offen offset:0
    v_mfma_f32_16x16x32_bf16 v[28:31], v[64:67], v[124:127], v[28:31]
    buffer_load_dwordx4 v[108:111], v5, s[4:7], s51 offen offset:1024
    s_add_u32 s51, s51, 262144
    v_mfma_f32_16x16x32_bf16 v[32:35], v[68:71], v[120:123], v[32:35]
    v_mfma_f32_16x16x32_bf16 v[36:39], v[68:71], v[124:127], v[36:39]
    s_waitcnt vmcnt(8) lgkmcnt(0)
    s_nop 0
    v_mfma_f32_16x16x32_bf16 v[8:11], v[40:43], v[128:131], v[8:11]
    ds_read_b128 v[56:59], v4 offset:20480
    v_mfma_f32_16x16x32_bf16 v[12:15], v[40:43], v[132:135], v[12:15]
    ds_read_b128 v[60:63], v4 offset:21504
    v_mfma_f32_16x16x32_bf16 v[16:19], v[44:47], v[128:131], v[16:19]
    ds_read_b128 v[64:67], v4 offset:22528
    v_mfma_f32_16x16x32_bf16 v[20:23], v[44:47], v[132:135], v[20:23]
    ds_read_b128 v[68:71], v4 offset:23552
    v_mfma_f32_16x16x32_bf16 v[24:27], v[48:51], v[128:131], v[24:27]
    buffer_load_dwordx4 v[112:115], v5, s[4:7], s49 offen offset:0
    v_mfma_f32_16x16x32_bf16 v[28:31], v[48:51], v[132:135], v[28:31]
    buffer_load_dwordx4 v[116:119], v5, s[4:7], s49 offen offset:1024
    s_add_u32 s49, s49, 262144
    v_mfma_f32_16x16x32_bf16 v[32:35], v[52:55], v[128:131], v[32:35]
    v_mfma_f32_16x16x32_bf16 v[36:39], v[52:55], v[132:135], v[36:39]
    s_waitcnt lgkmcnt(0)
    s_nop 0
    v_mfma_f32_16x16x32_bf16 v[8:11], v[56:59], v[136:139], v[8:11]
    ds_read_b128 v[40:43], v4 offset:24576
    v_mfma_f32_16x16x32_bf16 v[12:15], v[56:59], v[140:143], v[12:15]
    ds_read_b128 v[44:47], v4 offset:25600
    v_mfma_f32_16x16x32_bf16 v[16:19], v[60:63], v[136:139], v[16:19]
    ds_read_b128 v[48:51], v4 offset:26624
    v_mfma_f32_16x16x32_bf16 v[20:23], v[60:63], v[140:143], v[20:23]
    ds_read_b128 v[52:55], v4 offset:27648
    v_mfma_f32_16x16x32_bf16 v[24:27], v[64:67], v[136:139], v[24:27]
    buffer_load_dwordx4 v[120:123], v5, s[4:7], s51 offen offset:0
    v_mfma_f32_16x16x32_bf16 v[28:31], v[64:67], v[140:143], v[28:31]
    buffer_load_dwordx4 v[124:127], v5, s[4:7], s51 offen offset:1024
    s_add_u32 s51, s51, 262144
    v_mfma_f32_16x16x32_bf16 v[32:35], v[68:71], v[136:139], v[32:35]
    v_mfma_f32_16x16x32_bf16 v[36:39], v[68:71], v[140:143], v[36:39]
    s_waitcnt vmcnt(8) lgkmcnt(0)
    s_nop 0
    v_mfma_f32_16x16x32_bf16 v[8:11], v[40:43], v[144:147], v[8:11]
    ds_read_b128 v[56:59], v4 offset:28672
    v_mfma_f32_16x16x32_bf16 v[12:15], v[40:43], v[148:151], v[12:15]
    ds_read_b128 v[60:63], v4 offset:29696
    v_mfma_f32_16x16x32_bf16 v[16:19], v[44:47], v[144:147], v[16:19]
    ds_read_b128 v[64:67], v4 offset:30720
    v_mfma_f32_16x16x32_bf16 v[20:23], v[44:47], v[148:151], v[20:23]
    ds_read_b128 v[68:71], v4 offset:31744
    v_mfma_f32_16x16x32_bf16 v[24:27], v[48:51], v[144:147], v[24:27]
    buffer_load_dwordx4 v[128:131], v5, s[4:7], s49 offen offset:0
    v_mfma_f32_16x16x32_bf16 v[28:31], v[48:51], v[148:151], v[28:31]
    buffer_load_dwordx4 v[132:135], v5, s[4:7], s49 offen offset:1024
    s_add_u32 s49, s49, 262144
    s_add_u32 s54, s44, 32768
    s_cmp_eq_u32 s54, 131072
    .long 0x853636ff, 0x0
    s_sub_u32 s54, s54, s44
    s_add_u32 s44, s44, s54
    v_mfma_f32_16x16x32_bf16 v[32:35], v[52:55], v[144:147], v[32:35]
    v_add_u32_e64 v4, s54, v4
    v_mfma_f32_16x16x32_bf16 v[36:39], v[52:55], v[148:151], v[36:39]
    s_waitcnt lgkmcnt(0)
    s_barrier
    v_mfma_f32_16x16x32_bf16 v[8:11], v[56:59], v[152:155], v[8:11]
    ds_read_b128 v[40:43], v4 offset:0
    v_mfma_f32_16x16x32_bf16 v[12:15], v[56:59], v[156:159], v[12:15]
    ds_read_b128 v[44:47], v4 offset:1024
    v_mfma_f32_16x16x32_bf16 v[16:19], v[60:63], v[152:155], v[16:19]
    ds_read_b128 v[48:51], v4 offset:2048
    v_mfma_f32_16x16x32_bf16 v[20:23], v[60:63], v[156:159], v[20:23]
    ds_read_b128 v[52:55], v4 offset:3072
    v_mfma_f32_16x16x32_bf16 v[24:27], v[64:67], v[152:155], v[24:27]
    buffer_load_dwordx4 v[136:139], v5, s[4:7], s51 offen offset:0
    v_mfma_f32_16x16x32_bf16 v[28:31], v[64:67], v[156:159], v[28:31]
    buffer_load_dwordx4 v[140:143], v5, s[4:7], s51 offen offset:1024
    s_add_u32 s51, s51, 262144
    v_mfma_f32_16x16x32_bf16 v[32:35], v[68:71], v[152:155], v[32:35]
    v_mfma_f32_16x16x32_bf16 v[36:39], v[68:71], v[156:159], v[36:39]
    s_add_u32 s43, s43, 1
    s_cmp_lt_u32 s43, 2
    s_cbranch_scc1 interleave_layers__linear_kernel_hedgehog__geglu_ffn__prompt_kernel_loop32
    s_waitcnt vmcnt(8) lgkmcnt(0)
    v_mfma_f32_16x16x32_bf16 v[8:11], v[40:43], v[96:99], v[8:11]
    ds_read_b128 v[56:59], v4 offset:4096
    v_mfma_f32_16x16x32_bf16 v[12:15], v[40:43], v[100:103], v[12:15]
    ds_read_b128 v[60:63], v4 offset:5120
    v_mfma_f32_16x16x32_bf16 v[16:19], v[44:47], v[96:99], v[16:19]
    ds_read_b128 v[64:67], v4 offset:6144
    v_mfma_f32_16x16x32_bf16 v[20:23], v[44:47], v[100:103], v[20:23]
    ds_read_b128 v[68:71], v4 offset:7168
    v_mfma_f32_16x16x32_bf16 v[24:27], v[48:51], v[96:99], v[24:27]
    buffer_load_dwordx4 v[144:147], v5, s[4:7], s49 offen offset:0
    v_mfma_f32_16x16x32_bf16 v[28:31], v[48:51], v[100:103], v[28:31]
    buffer_load_dwordx4 v[148:151], v5, s[4:7], s49 offen offset:1024
    s_add_u32 s49, s49, 262144
    v_mfma_f32_16x16x32_bf16 v[32:35], v[52:55], v[96:99], v[32:35]
    v_mfma_f32_16x16x32_bf16 v[36:39], v[52:55], v[100:103], v[36:39]
    s_waitcnt lgkmcnt(0)
    s_nop 0
    v_mfma_f32_16x16x32_bf16 v[8:11], v[56:59], v[104:107], v[8:11]
    ds_read_b128 v[40:43], v4 offset:8192
    v_mfma_f32_16x16x32_bf16 v[12:15], v[56:59], v[108:111], v[12:15]
    ds_read_b128 v[44:47], v4 offset:9216
    v_mfma_f32_16x16x32_bf16 v[16:19], v[60:63], v[104:107], v[16:19]
    ds_read_b128 v[48:51], v4 offset:10240
    v_mfma_f32_16x16x32_bf16 v[20:23], v[60:63], v[108:111], v[20:23]
    ds_read_b128 v[52:55], v4 offset:11264
    v_mfma_f32_16x16x32_bf16 v[24:27], v[64:67], v[104:107], v[24:27]
    buffer_load_dwordx4 v[152:155], v5, s[4:7], s51 offen offset:0
    v_mfma_f32_16x16x32_bf16 v[28:31], v[64:67], v[108:111], v[28:31]
    buffer_load_dwordx4 v[156:159], v5, s[4:7], s51 offen offset:1024
    s_add_u32 s51, s51, 262144
    v_mfma_f32_16x16x32_bf16 v[32:35], v[68:71], v[104:107], v[32:35]
    buffer_load_dwordx4 v[72:75], v5, s[12:15], s46 offen offset:0
    buffer_load_dwordx4 v[76:79], v5, s[12:15], s46 offen offset:1024
    v_mfma_f32_16x16x32_bf16 v[36:39], v[68:71], v[108:111], v[36:39]
    buffer_load_dwordx4 v[80:83], v5, s[12:15], s47 offen offset:0
    buffer_load_dwordx4 v[84:87], v5, s[12:15], s47 offen offset:1024
    s_waitcnt vmcnt(12) lgkmcnt(0)
    s_nop 0
    v_mfma_f32_16x16x32_bf16 v[8:11], v[40:43], v[112:115], v[8:11]
    ds_read_b128 v[56:59], v4 offset:12288
    v_mfma_f32_16x16x32_bf16 v[12:15], v[40:43], v[116:119], v[12:15]
    ds_read_b128 v[60:63], v4 offset:13312
    v_mfma_f32_16x16x32_bf16 v[16:19], v[44:47], v[112:115], v[16:19]
    ds_read_b128 v[64:67], v4 offset:14336
    v_mfma_f32_16x16x32_bf16 v[20:23], v[44:47], v[116:119], v[20:23]
    ds_read_b128 v[68:71], v4 offset:15360
    v_mfma_f32_16x16x32_bf16 v[24:27], v[48:51], v[112:115], v[24:27]
    v_mfma_f32_16x16x32_bf16 v[28:31], v[48:51], v[116:119], v[28:31]
    v_mfma_f32_16x16x32_bf16 v[32:35], v[52:55], v[112:115], v[32:35]
    v_mfma_f32_16x16x32_bf16 v[36:39], v[52:55], v[116:119], v[36:39]
    s_waitcnt lgkmcnt(0)
    s_nop 0
    v_mfma_f32_16x16x32_bf16 v[8:11], v[56:59], v[120:123], v[8:11]
    ds_read_b128 v[40:43], v4 offset:16384
    v_mfma_f32_16x16x32_bf16 v[12:15], v[56:59], v[124:127], v[12:15]
    ds_read_b128 v[44:47], v4 offset:17408
    v_mfma_f32_16x16x32_bf16 v[16:19], v[60:63], v[120:123], v[16:19]
    ds_read_b128 v[48:51], v4 offset:18432
    v_mfma_f32_16x16x32_bf16 v[20:23], v[60:63], v[124:127], v[20:23]
    ds_read_b128 v[52:55], v4 offset:19456
    v_mfma_f32_16x16x32_bf16 v[24:27], v[64:67], v[120:123], v[24:27]
    v_mfma_f32_16x16x32_bf16 v[28:31], v[64:67], v[124:127], v[28:31]
    v_mfma_f32_16x16x32_bf16 v[32:35], v[68:71], v[120:123], v[32:35]
    v_mfma_f32_16x16x32_bf16 v[36:39], v[68:71], v[124:127], v[36:39]
    s_waitcnt vmcnt(8) lgkmcnt(0)
    s_nop 0
    v_mfma_f32_16x16x32_bf16 v[8:11], v[40:43], v[128:131], v[8:11]
    ds_read_b128 v[56:59], v4 offset:20480
    v_mfma_f32_16x16x32_bf16 v[12:15], v[40:43], v[132:135], v[12:15]
    ds_read_b128 v[60:63], v4 offset:21504
    v_mfma_f32_16x16x32_bf16 v[16:19], v[44:47], v[128:131], v[16:19]
    ds_read_b128 v[64:67], v4 offset:22528
    v_mfma_f32_16x16x32_bf16 v[20:23], v[44:47], v[132:135], v[20:23]
    ds_read_b128 v[68:71], v4 offset:23552
    v_mfma_f32_16x16x32_bf16 v[24:27], v[48:51], v[128:131], v[24:27]
    v_mfma_f32_16x16x32_bf16 v[28:31], v[48:51], v[132:135], v[28:31]
    v_mfma_f32_16x16x32_bf16 v[32:35], v[52:55], v[128:131], v[32:35]
    v_mfma_f32_16x16x32_bf16 v[36:39], v[52:55], v[132:135], v[36:39]
    s_waitcnt lgkmcnt(0)
    s_nop 0
    v_mfma_f32_16x16x32_bf16 v[8:11], v[56:59], v[136:139], v[8:11]
    ds_read_b128 v[40:43], v4 offset:24576
    v_mfma_f32_16x16x32_bf16 v[12:15], v[56:59], v[140:143], v[12:15]
    ds_read_b128 v[44:47], v4 offset:25600
    v_mfma_f32_16x16x32_bf16 v[16:19], v[60:63], v[136:139], v[16:19]
    ds_read_b128 v[48:51], v4 offset:26624
    v_mfma_f32_16x16x32_bf16 v[20:23], v[60:63], v[140:143], v[20:23]
    ds_read_b128 v[52:55], v4 offset:27648
    v_mfma_f32_16x16x32_bf16 v[24:27], v[64:67], v[136:139], v[24:27]
    v_mfma_f32_16x16x32_bf16 v[28:31], v[64:67], v[140:143], v[28:31]
    v_mfma_f32_16x16x32_bf16 v[32:35], v[68:71], v[136:139], v[32:35]
    v_mfma_f32_16x16x32_bf16 v[36:39], v[68:71], v[140:143], v[36:39]
    s_waitcnt vmcnt(4) lgkmcnt(0)
    s_nop 0
    v_mfma_f32_16x16x32_bf16 v[8:11], v[40:43], v[144:147], v[8:11]
    ds_read_b128 v[56:59], v4 offset:28672
    v_mfma_f32_16x16x32_bf16 v[12:15], v[40:43], v[148:151], v[12:15]
    ds_read_b128 v[60:63], v4 offset:29696
    v_mfma_f32_16x16x32_bf16 v[16:19], v[44:47], v[144:147], v[16:19]
    ds_read_b128 v[64:67], v4 offset:30720
    v_mfma_f32_16x16x32_bf16 v[20:23], v[44:47], v[148:151], v[20:23]
    ds_read_b128 v[68:71], v4 offset:31744
    v_mfma_f32_16x16x32_bf16 v[24:27], v[48:51], v[144:147], v[24:27]
    v_mfma_f32_16x16x32_bf16 v[28:31], v[48:51], v[148:151], v[28:31]
    s_add_u32 s54, s44, 32768
    s_cmp_eq_u32 s54, 131072
    .long 0x853636ff, 0x0
    s_sub_u32 s54, s54, s44
    s_add_u32 s44, s44, s54
    v_mfma_f32_16x16x32_bf16 v[32:35], v[52:55], v[144:147], v[32:35]
    v_add_u32_e64 v4, s54, v4
    v_mfma_f32_16x16x32_bf16 v[36:39], v[52:55], v[148:151], v[36:39]
    s_waitcnt lgkmcnt(0)
    s_barrier
    v_mfma_f32_16x16x32_bf16 v[8:11], v[56:59], v[152:155], v[8:11]
    ds_read_b128 v[40:43], v4 offset:0
    v_mfma_f32_16x16x32_bf16 v[12:15], v[56:59], v[156:159], v[12:15]
    ds_read_b128 v[44:47], v4 offset:1024
    v_mfma_f32_16x16x32_bf16 v[16:19], v[60:63], v[152:155], v[16:19]
    ds_read_b128 v[48:51], v4 offset:2048
    v_mfma_f32_16x16x32_bf16 v[20:23], v[60:63], v[156:159], v[20:23]
    ds_read_b128 v[52:55], v4 offset:3072
    v_mfma_f32_16x16x32_bf16 v[24:27], v[64:67], v[152:155], v[24:27]
    v_mfma_f32_16x16x32_bf16 v[28:31], v[64:67], v[156:159], v[28:31]
    v_mfma_f32_16x16x32_bf16 v[32:35], v[68:71], v[152:155], v[32:35]
    v_mfma_f32_16x16x32_bf16 v[36:39], v[68:71], v[156:159], v[36:39]
    s_mov_b32 s76, 0xffff0000
    s_waitcnt vmcnt(0) lgkmcnt(0)
    v_lshlrev_b32 v96, 16, v72
    v_and_b32 v97, s76, v72
    v_lshlrev_b32 v98, 16, v73
    v_and_b32_e64 v99, s76, v73
    v_pk_add_f32 v[8:9], v[8:9], v[96:97]
    v_pk_add_f32 v[10:11], v[10:11], v[98:99]
    v_lshlrev_b32 v100, 16, v74
    v_and_b32 v101, s76, v74
    v_lshlrev_b32 v102, 16, v75
    v_and_b32 v103, s76, v75
    v_pk_add_f32 v[16:17], v[16:17], v[100:101]
    v_pk_add_f32 v[18:19], v[18:19], v[102:103]
    v_cvt_pk_bf16_f32 v112, v8, v9
    v_cvt_pk_bf16_f32 v113, v10, v11
    v_cvt_pk_bf16_f32 v114, v16, v17
    v_cvt_pk_bf16_f32 v115, v18, v19
    buffer_store_dwordx4 v[112:115], v5, s[16:19], s46 offen offset:0 sc0 sc1
    v_lshlrev_b32 v104, 16, v76
    v_and_b32 v105, s76, v76
    v_lshlrev_b32 v106, 16, v77
    v_and_b32 v107, s76, v77
    v_pk_add_f32 v[12:13], v[12:13], v[104:105]
    v_pk_add_f32 v[14:15], v[14:15], v[106:107]
    v_lshlrev_b32 v108, 16, v78
    v_and_b32 v109, s76, v78
    v_lshlrev_b32 v110, 16, v79
    v_and_b32 v111, s76, v79
    v_pk_add_f32 v[20:21], v[20:21], v[108:109]
    v_pk_add_f32 v[22:23], v[22:23], v[110:111]
    v_cvt_pk_bf16_f32 v116, v12, v13
    v_cvt_pk_bf16_f32 v117, v14, v15
    v_cvt_pk_bf16_f32 v118, v20, v21
    v_cvt_pk_bf16_f32 v119, v22, v23
    buffer_store_dwordx4 v[116:119], v5, s[16:19], s46 offen offset:1024 sc0 sc1
    v_lshlrev_b32 v96, 16, v80
    v_and_b32 v97, s76, v80
    v_lshlrev_b32 v98, 16, v81
    v_and_b32 v99, s76, v81
    v_pk_add_f32 v[24:25], v[24:25], v[96:97]
    v_pk_add_f32 v[26:27], v[26:27], v[98:99]
    v_lshlrev_b32 v100, 16, v82
    v_and_b32 v101, s76, v82
    v_lshlrev_b32 v102, 16, v83
    v_and_b32 v103, s76, v83
    v_pk_add_f32 v[32:33], v[32:33], v[100:101]
    v_pk_add_f32 v[34:35], v[34:35], v[102:103]
    v_cvt_pk_bf16_f32 v120, v24, v25
    v_cvt_pk_bf16_f32 v121, v26, v27
    v_cvt_pk_bf16_f32 v122, v32, v33
    v_cvt_pk_bf16_f32 v123, v34, v35
    buffer_store_dwordx4 v[120:123], v5, s[16:19], s47 offen offset:0 sc0 sc1
    v_lshlrev_b32 v104, 16, v84
    v_and_b32 v105, s76, v84
    v_lshlrev_b32 v106, 16, v85
    v_and_b32 v107, s76, v85
    v_pk_add_f32 v[28:29], v[28:29], v[104:105]
    v_pk_add_f32 v[30:31], v[30:31], v[106:107]
    v_lshlrev_b32 v108, 16, v86
    v_and_b32 v109, s76, v86
    v_lshlrev_b32 v110, 16, v87
    v_and_b32 v111, s76, v87
    v_pk_add_f32 v[36:37], v[36:37], v[108:109]
    v_pk_add_f32 v[38:39], v[38:39], v[110:111]
    v_cvt_pk_bf16_f32 v124, v28, v29
    v_cvt_pk_bf16_f32 v125, v30, v31
    v_cvt_pk_bf16_f32 v126, v36, v37
    v_cvt_pk_bf16_f32 v127, v38, v39
    buffer_store_dwordx4 v[124:127], v5, s[16:19], s47 offen offset:1024 sc0 sc1
    s_mov_b32 s76, 0x3f803f80
    v_dot2_f32_bf16 v88, v112, s76, 0
    v_dot2_f32_bf16 v89, v112, v112, 0
    v_dot2_f32_bf16 v90, v116, s76, 0
    v_dot2_f32_bf16 v91, v116, v116, 0
    v_dot2_f32_bf16 v88, v113, s76, v88
    v_dot2_f32_bf16 v89, v113, v113, v89
    v_dot2_f32_bf16 v90, v117, s76, v90
    v_dot2_f32_bf16 v91, v117, v117, v91
    v_dot2_f32_bf16 v88, v114, s76, v88
    v_dot2_f32_bf16 v89, v114, v114, v89
    v_dot2_f32_bf16 v90, v118, s76, v90
    v_dot2_f32_bf16 v91, v118, v118, v91
    v_dot2_f32_bf16 v88, v115, s76, v88
    v_dot2_f32_bf16 v89, v115, v115, v89
    v_dot2_f32_bf16 v90, v119, s76, v90
    v_dot2_f32_bf16 v91, v119, v119, v91
    v_dot2_f32_bf16 v88, v120, s76, v88
    v_dot2_f32_bf16 v89, v120, v120, v89
    v_dot2_f32_bf16 v90, v124, s76, v90
    v_dot2_f32_bf16 v91, v124, v124, v91
    v_dot2_f32_bf16 v88, v121, s76, v88
    v_dot2_f32_bf16 v89, v121, v121, v89
    v_dot2_f32_bf16 v90, v125, s76, v90
    v_dot2_f32_bf16 v91, v125, v125, v91
    v_dot2_f32_bf16 v88, v122, s76, v88
    v_dot2_f32_bf16 v89, v122, v122, v89
    v_dot2_f32_bf16 v90, v126, s76, v90
    v_dot2_f32_bf16 v91, v126, v126, v91
    v_dot2_f32_bf16 v88, v123, s76, v88
    v_dot2_f32_bf16 v89, v123, v123, v89
    v_dot2_f32_bf16 v90, v127, s76, v90
    v_dot2_f32_bf16 v91, v127, v127, v91
    s_lshl_b32 s45, s41, 14
    s_lshl_b32 s48, s40, 12
    s_add_u32 s45, s45, s48
    s_lshl_b32 s48, s42, 7
    s_add_u32 s45, s45, s48
    v_lshlrev_b32 v1, 3, v0
    v_permlane32_swap_b32 v88, v89
    v_permlane32_swap_b32 v90, v91
    v_add_f32 v88, v88, v89
    v_add_f32 v90, v90, v91
    v_mov_b32 v92, v88
    v_mov_b32 v93, v90
    s_nop 0
    v_permlane16_swap_b32 v88, v92
    v_permlane16_swap_b32 v90, v93
    v_add_f32 v88, v88, v92
    v_add_f32 v90, v90, v93
    v_mov_b32 v89, v88
    v_mov_b32 v91, v90
    s_nop 0
    v_permlane32_swap_b32 v88, v89
    v_permlane32_swap_b32 v90, v91
    s_mov_b64 exec, 0xffff
    buffer_store_dwordx2 v[88:89], v1, s[24:27], s45 offen offset:0 sc0 sc1
    buffer_store_dwordx2 v[90:91], v1, s[24:27], s45 offen offset:2048 sc0 sc1
    s_mov_b64 exec, -1
    s_waitcnt vmcnt(0) lgkmcnt(0)
    s_barrier
    s_cmp_lg_u32 s40, 0
    s_cbranch_scc1 interleave_layers__linear_kernel_hedgehog__geglu_ffn__prompt_kernel_nf33
    s_lshl_b32 s74, s41, 11
    s_lshl_b32 s75, s42, 7
    s_add_u32 s74, s74, s75
    s_add_u32 s74, s74, 327680
    v_mov_b32 v239, 0
    v_mov_b32_e64 v240, s60
    s_mov_b64 exec, 1
    buffer_store_dword v240, v239, s[56:59], s74 offen sc0 sc1
    s_mov_b64 exec, -1
interleave_layers__linear_kernel_hedgehog__geglu_ffn__prompt_kernel_nf33:
    s_branch mega_ph2
mega_ph2:
    s_cmp_lt_u32 s2, 32
    s_cbranch_scc1 interleave_layers__linear_kernel_hedgehog__geglu_ffn__prompt_kernel_side34
    s_sub_u32 s55, s2, 32
    s_and_b32 s45, s55, 7
    s_lshr_b32 s49, s55, 3
    s_and_b32 s41, s45, 1
    s_lshl_b32 s41, s41, 2
    s_and_b32 s48, s49, 3
    s_add_u32 s41, s41, s48
    s_lshr_b32 s42, s45, 1
    s_mul_i32 s42, s42, 7
    s_lshr_b32 s48, s49, 2
    s_add_u32 s42, s42, s48
    v_lshlrev_b32 v5, 4, v0
    s_lshl_b32 s50, s40, 11
    v_add_u32 v5, s50, v5
    v_lshrrev_b32 v1, 4, v0
    s_lshl_b32 s45, s40, 2
    v_add_u32 v1, s45, v1
    v_lshlrev_b32 v2, 1, v1
    v_xor_b32 v2, v2, v0
    v_and_b32 v2, 15, v2
    v_lshlrev_b32_e64 v2, 4, v2
    v_mul_u32_u24 v1, 7168, v1
    v_add_u32 v6, v1, v2
    s_lshl_b32 s51, s40, 10
    s_add_u32 s51, s51, 16384
    s_lshl_b32 s46, s41, 14
    s_lshl_b32 s47, s42, 8
    s_add_u32 s4, s68, 0x400000
    .long 0x8205ff45, 0x0
    s_mov_b32 s6, 0x400000
    s_mov_b32 s7, 0x00020000
    s_mov_b32 s8, s64
    s_mov_b32 s9, s65
    s_mov_b32 s10, 0x700000
    s_mov_b32 s11, 0x00020000
    s_mov_b32 s12, s66
    s_mov_b32 s13, s67
    s_mov_b32 s14, 0x700000
    s_mov_b32 s15, 0x00020000
    s_lshl_b32 s45, s41, 8
    s_lshl_b32 s48, s40, 5
    s_add_u32 s45, s45, s48
    .long 0x807cff33, 0x0
    s_nop 0
    buffer_load_dwordx4 v6, s[8:11], s47 offen lds
    s_add_u32 m0, s51, 8192
    s_mov_b32 s99, 0x1000
    buffer_load_dwordx4 v6, s[12:15], s47 offen lds
    s_add_u32 s47, s47, 229376
    s_add_u32 m0, s51, 32768
    s_mov_b32 s99, 0x1000
    buffer_load_dwordx4 v6, s[8:11], s47 offen lds
    s_add_u32 m0, s51, 40960
    s_mov_b32 s99, 0x1000
    buffer_load_dwordx4 v6, s[12:15], s47 offen lds
    s_add_u32 s47, s47, 229376
    s_add_u32 m0, s51, 65536
    s_mov_b32 s99, 0x1000
    buffer_load_dwordx4 v6, s[8:11], s47 offen lds
    s_add_u32 m0, s51, 73728
    s_mov_b32 s99, 0x1000
    buffer_load_dwordx4 v6, s[12:15], s47 offen lds
    s_add_u32 s47, s47, 229376
    s_add_u32 s16, s68, 0x4c80000
    .long 0x8211ff45, 0x0
    s_mov_b32 s18, 0x40000
    s_mov_b32 s19, 0x00020000
    s_add_u32 s24, s68, 0x4d40000
    .long 0x8219ff45, 0x0
    s_mov_b32 s26, 0x7000
    s_mov_b32 s27, 0x00020000
    s_add_u32 s28, s68, 0x2800000
    .long 0x821dff45, 0x0
    s_mov_b32 s30, 0xe00000
    s_mov_b32 s31, 0x00020000
    v_and_b32 v236, 15, v0
    v_lshlrev_b32 v236, 3, v236
    s_lshl_b32 s74, s45, 7
    v_add_u32 v236, s74, v236
    v_lshrrev_b32_e64 v3, 4, v0
    v_lshl_add_u32 v236, v3, 9, v236
    v_lshlrev_b32 v7, 4, v0
    s_and_b32 s48, s40, 3
    s_lshl_b32 s48, s48, 12
    v_add_u32 v7, s48, v7
    v_lshrrev_b32 v1, 2, v0
    v_lshlrev_b32 v3, 8, v1
    v_and_b32_e64 v4, 3, v0
    v_lshl_add_u32 v3, v4, 3, v3
    v_bfe_u32 v4, v0, 2, 3
    s_and_b32 s48, s40, 4
    s_add_u32 s53, s48, 0
    v_xor_b32_e64 v2, s53, v4
    v_lshl_add_u32 v8, v2, 5, v3
    v_add_u32 v8, 16384, v8
    s_add_u32 s53, s48, 1
    v_xor_b32 v2, s53, v4
    v_lshl_add_u32 v9, v2, 5, v3
    v_add_u32 v9, 16384, v9
    s_add_u32 s53, s48, 2
    v_xor_b32 v2, s53, v4
    v_lshl_add_u32 v10, v2, 5, v3
    v_add_u32 v10, 16384, v10
    s_add_u32 s53, s48, 3
    v_xor_b32 v2, s53, v4
    v_lshl_add_u32 v11, v2, 5, v3
    v_add_u32 v11, 16384, v11
    s_cmp_lg_u32 s40, 7
    s_cbranch_scc1 interleave_layers__linear_kernel_hedgehog__geglu_ffn__prompt_kernel_np35
    .long 0x8e31ff29, 0xc
    s_add_u32 s49, s49, 327680
    v_lshlrev_b32 v188, 7, v0
    s_mov_b32 exec_lo, 0xffffffff
    s_mov_b32 exec_hi, 0x0
    s_mov_b32 s74, 0
interleave_layers__linear_kernel_hedgehog__geglu_ffn__prompt_kernel_poll36:
    buffer_load_dword v244, v188, s[56:59], s49 offen sc1
    s_add_u32 s74, s74, 1
    s_waitcnt vmcnt(0)
    v_cmp_ne_u32 vcc, s60, v244
    s_nop 0
    s_cmp_eq_u64 vcc, 0
    s_cbranch_scc1 interleave_layers__linear_kernel_hedgehog__geglu_ffn__prompt_kernel_polled37
    s_mov_b64 exec, vcc
    s_sleep 4
    s_cmp_lt_u32 s74, 50000
    s_cbranch_scc1 interleave_layers__linear_kernel_hedgehog__geglu_ffn__prompt_kernel_poll36
interleave_layers__linear_kernel_hedgehog__geglu_ffn__prompt_kernel_polled37:
    s_mov_b64 exec, -1
interleave_layers__linear_kernel_hedgehog__geglu_ffn__prompt_kernel_np35:
    s_barrier
    .long 0x807cff32, 0x0
    s_nop 0
    buffer_load_dwordx4 v5, s[4:7], s46 offen lds
    buffer_load_dwordx4 v5, s[4:7], s46 offen offset:1024 lds
    s_add_u32 s46, s46, 131072
    s_add_u32 m0, s50, 32768
    s_mov_b32 s99, 0x1000
    buffer_load_dwordx4 v5, s[4:7], s46 offen lds
    buffer_load_dwordx4 v5, s[4:7], s46 offen offset:1024 lds
    s_add_u32 s46, s46, 131072
    buffer_load_dwordx2 v[124:125], v236, s[16:19], 0 offen offset:0
    buffer_load_dwordx2 v[126:127], v236, s[16:19], 0 offen offset:128
    buffer_load_dwordx2 v[128:129], v236, s[16:19], 0 offen offset:256
    buffer_load_dwordx2 v[130:131], v236, s[16:19], 0 offen offset:384
    buffer_load_dwordx2 v[132:133], v236, s[16:19], 0 offen offset:2048
    buffer_load_dwordx2 v[134:135], v236, s[16:19], 0 offen offset:2176
    buffer_load_dwordx2 v[136:137], v236, s[16:19], 0 offen offset:2304
    buffer_load_dwordx2 v[138:139], v236, s[16:19], 0 offen offset:2432
    .long 0xbeac00ff, 0x0
    s_waitcnt vmcnt(10)
    s_barrier
    ds_read_b64_tr_b16 v[156:157], v8 offset:0
    ds_read_b64_tr_b16 v[158:159], v8 offset:4096
    ds_read_b128 v[140:143], v7 offset:0
    ds_read_b128 v[144:147], v7 offset:1024
    ds_read_b128 v[148:151], v7 offset:2048
    ds_read_b128 v[152:155], v7 offset:3072
    ds_read_b64_tr_b16 v[160:161], v9 offset:0
    ds_read_b64_tr_b16 v[162:163], v9 offset:4096
    ds_read_b64_tr_b16 v[164:165], v10 offset:0
    ds_read_b64_tr_b16 v[166:167], v10 offset:4096
    ds_read_b64_tr_b16 v[168:169], v11 offset:0
    ds_read_b64_tr_b16 v[170:171], v11 offset:4096
    ds_read_b64_tr_b16 v[172:173], v8 offset:8192
    ds_read_b64_tr_b16 v[174:175], v8 offset:12288
    ds_read_b64_tr_b16 v[176:177], v9 offset:8192
    ds_read_b64_tr_b16 v[178:179], v9 offset:12288
    ds_read_b64_tr_b16 v[180:181], v10 offset:8192
    ds_read_b64_tr_b16 v[182:183], v10 offset:12288
    ds_read_b64_tr_b16 v[184:185], v11 offset:8192
    ds_read_b64_tr_b16 v[186:187], v11 offset:12288
    s_add_u32 s54, s44, 32768
    s_cmp_eq_u32 s54, 131072
    s_cselect_b32 s54, 0, s54
    s_sub_u32 s54, s54, s44
    s_add_u32 s44, s44, s54
    v_add_u32 v7, s54, v7
    v_add_u32 v8, s54, v8
    v_add_u32 v9, s54, v9
    v_add_u32 v10, s54, v10
    v_add_u32 v11, s54, v11
    s_add_u32 m0, s50, 65536
    s_mov_b32 s99, 0x1000
    buffer_load_dwordx4 v5, s[4:7], s46 offen lds
    buffer_load_dwordx4 v5, s[4:7], s46 offen offset:1024 lds
    s_add_u32 s46, s46, 131072
    s_mov_b32 s52, 98304
    s_waitcnt vmcnt(2)
    s_nop 0
    v_pk_add_f32 v[124:125], v[124:125], v[126:127]
    v_pk_add_f32 v[128:129], v[128:129], v[130:131]
    v_pk_add_f32 v[132:133], v[132:133], v[134:135]
    v_pk_add_f32 v[136:137], v[136:137], v[138:139]
    v_pk_add_f32 v[124:125], v[124:125], v[128:129]
    v_pk_add_f32 v[132:133], v[132:133], v[136:137]
    s_nop 0
    v_permlane32_swap_b32 v124, v125
    v_permlane32_swap_b32 v132, v133
    v_add_f32 v124, v124, v125
    v_add_f32 v132, v132, v133
    v_mov_b32 v128, v124
    v_mov_b32 v136, v132
    s_nop 0
    v_permlane16_swap_b32 v124, v128
    v_permlane16_swap_b32 v132, v136
    v_add_f32 v124, v124, v128
    v_add_f32 v132, v132, v136
    v_mov_b32 v125, v124
    v_mov_b32_e64 v133, v132
    s_nop 0
    v_permlane32_swap_b32 v124, v125
    v_permlane32_swap_b32 v132, v133
    s_mov_b32 s74, 0xba800000
    s_mov_b32 s75, 0x3727c5ac
    v_mul_f32 v127, s74, v124
    v_mul_f32 v125, s74, v125
    v_mul_f32 v135, s74, v132
    v_mul_f32 v133, s74, v133
    v_fma_f32 v125, -v127, v127, -v125
    v_fma_f32 v133, -v135, v135, -v133
    v_max_f32 v125, 0, v125
    v_max_f32 v133, 0, v133
    v_add_f32 v125, s75, v125
    v_add_f32 v133, s75, v133
    v_rsq_f32 v126, v125
    v_rsq_f32_e64 v134, v133
    s_lshl_b32 s45, s40, 7
    s_add_u32 s45, s45, 131072
    v_and_b32 v1, 15, v0
    v_lshlrev_b32 v1, 2, v1
    v_add_u32_e64 v1, s45, v1
    ds_write_b32 v1, v126 offset:0
    ds_write_b32 v1, v127 offset:1024
    ds_write_b32 v1, v134 offset:64
    ds_write_b32 v1, v135 offset:1088
    v_mov_b32 v1, 147456
    v_mov_b32_e64 v2, 0
    ds_write_b32 v1, v2
    s_waitcnt lgkmcnt(0)
    s_barrier
    v_mfma_f32_16x16x32_bf16 v[12:15], v[156:159], v[140:143], 0
    ds_read_b64_tr_b16 v[204:205], v8 offset:0
    v_mfma_f32_16x16x32_bf16 v[16:19], v[156:159], v[144:147], 0
    ds_read_b64_tr_b16 v[206:207], v8 offset:4096
    v_mfma_f32_16x16x32_bf16 v[20:23], v[156:159], v[148:151], 0
    ds_read_b128 v[188:191], v7 offset:0
    s_add_u32 m0, s52, s50
    s_nop 0
    buffer_load_dwordx4 v5, s[4:7], s46 offen lds
    v_mfma_f32_16x16x32_bf16 v[24:27], v[156:159], v[152:155], 0
    ds_read_b128 v[192:195], v7 offset:1024
    v_mfma_f32_16x16x32_bf16 v[28:31], v[160:163], v[140:143], 0
    ds_read_b128 v[196:199], v7 offset:2048
    buffer_load_dwordx4 v5, s[4:7], s46 offen offset:1024 lds
    s_add_u32 s46, s46, 131072
    v_mfma_f32_16x16x32_bf16 v[32:35], v[160:163], v[144:147], 0
    ds_read_b128 v[200:203], v7 offset:3072
    v_mfma_f32_16x16x32_bf16 v[36:39], v[160:163], v[148:151], 0
    ds_read_b64_tr_b16 v[208:209], v9 offset:0
    s_add_u32 m0, s52, s51
    s_nop 0
    buffer_load_dwordx4 v6, s[8:11], s47 offen lds
    v_mfma_f32_16x16x32_bf16 v[40:43], v[160:163], v[152:155], 0
    ds_read_b64_tr_b16 v[210:211], v9 offset:4096
    v_mfma_f32_16x16x32_bf16 v[44:47], v[164:167], v[140:143], 0
    ds_read_b64_tr_b16 v[212:213], v10 offset:0
    s_add_u32 m0, m0, 8192
    s_mov_b32 s99, 0x1000
    buffer_load_dwordx4 v6, s[12:15], s47 offen lds
    s_add_u32 s47, s47, 229376
    v_mfma_f32_16x16x32_bf16 v[48:51], v[164:167], v[144:147], 0
    ds_read_b64_tr_b16 v[214:215], v10 offset:4096
    v_mfma_f32_16x16x32_bf16 v[52:55], v[164:167], v[148:151], 0
    ds_read_b64_tr_b16 v[216:217], v11 offset:0
    s_add_u32 s52, s52, 32768
    s_cmp_eq_u32 s52, 131072
    .long 0x853434ff, 0x0
    v_mfma_f32_16x16x32_bf16 v[56:59], v[164:167], v[152:155], 0
    ds_read_b64_tr_b16 v[218:219], v11 offset:4096
    v_mfma_f32_16x16x32_bf16 v[60:63], v[168:171], v[140:143], 0
    ds_read_b64_tr_b16 v[220:221], v8 offset:8192
    s_add_u32 m0, s52, s50
    s_nop 0
    buffer_load_dwordx4 v5, s[4:7], s46 offen lds
    v_mfma_f32_16x16x32_bf16 v[64:67], v[168:171], v[144:147], 0
    ds_read_b64_tr_b16 v[222:223], v8 offset:12288
    v_mfma_f32_16x16x32_bf16 v[68:71], v[168:171], v[148:151], 0
    ds_read_b64_tr_b16 v[224:225], v9 offset:8192
    buffer_load_dwordx4 v5, s[4:7], s46 offen offset:1024 lds
    s_add_u32 s46, s46, 131072
    v_mfma_f32_16x16x32_bf16 v[72:75], v[168:171], v[152:155], 0
    ds_read_b64_tr_b16 v[226:227], v9 offset:12288
    v_mfma_f32_16x16x32_bf16 v[76:79], v[172:175], v[140:143], 0
    ds_read_b64_tr_b16 v[228:229], v10 offset:8192
    s_add_u32 m0, s52, s51
    s_nop 0
    buffer_load_dwordx4 v6, s[8:11], s47 offen lds
    v_mfma_f32_16x16x32_bf16 v[80:83], v[172:175], v[144:147], 0
    ds_read_b64_tr_b16 v[230:231], v10 offset:12288
    v_mfma_f32_16x16x32_bf16 v[84:87], v[172:175], v[148:151], 0
    ds_read_b64_tr_b16 v[232:233], v11 offset:8192
    s_add_u32 m0, m0, 8192
    s_mov_b32 s99, 0x1000
    buffer_load_dwordx4 v6, s[12:15], s47 offen lds
    s_add_u32 s47, s47, 229376
    v_mfma_f32_16x16x32_bf16 v[88:91], v[172:175], v[152:155], 0
    ds_read_b64_tr_b16 v[234:235], v11 offset:12288
    v_mfma_f32_16x16x32_bf16 v[92:95], v[176:179], v[140:143], 0
    s_add_u32 s54, s44, 32768
    s_cmp_eq_u32 s54, 131072
    s_cselect_b32 s54, 0, s54
    s_sub_u32 s54, s54, s44
    s_add_u32 s44, s44, s54
    v_add_u32 v7, s54, v7
    s_add_u32 s52, s52, 32768
    s_cmp_eq_u32 s52, 131072
    .long 0x853434ff, 0x0
    v_mfma_f32_16x16x32_bf16 v[96:99], v[176:179], v[144:147], 0
    v_add_u32 v8, s54, v8
    v_add_u32 v9, s54, v9
    v_mfma_f32_16x16x32_bf16 v[100:103], v[176:179], v[148:151], 0
    v_add_u32 v10, s54, v10
    v_add_u32 v11, s54, v11
    v_mfma_f32_16x16x32_bf16 v[104:107], v[176:179], v[152:155], 0
    v_mfma_f32_16x16x32_bf16 v[108:111], v[180:183], v[140:143], 0
    v_mfma_f32_16x16x32_bf16 v[112:115], v[180:183], v[144:147], 0
    v_mfma_f32_16x16x32_bf16 v[116:119], v[180:183], v[148:151], 0
    s_waitcnt vmcnt(8) lgkmcnt(0)
    s_barrier
    v_mfma_f32_16x16x32_bf16 v[120:123], v[180:183], v[152:155], 0
    v_mfma_f32_16x16x32_bf16 v[124:127], v[184:187], v[140:143], 0
    v_mfma_f32_16x16x32_bf16 v[128:131], v[184:187], v[144:147], 0
    v_mfma_f32_16x16x32_bf16 v[132:135], v[184:187], v[148:151], 0
    v_mfma_f32_16x16x32_bf16 v[136:139], v[184:187], v[152:155], 0
    v_mfma_f32_16x16x32_bf16 v[12:15], v[204:207], v[188:191], v[12:15]
    ds_read_b64_tr_b16 v[156:157], v8 offset:0
    v_mfma_f32_16x16x32_bf16 v[16:19], v[204:207], v[192:195], v[16:19]
    ds_read_b64_tr_b16 v[158:159], v8 offset:4096
    v_mfma_f32_16x16x32_bf16 v[20:23], v[204:207], v[196:199], v[20:23]
    ds_read_b128 v[140:143], v7 offset:0
    s_add_u32 m0, s52, s50
    s_nop 0
    buffer_load_dwordx4 v5, s[4:7], s46 offen lds
    v_mfma_f32_16x16x32_bf16 v[24:27], v[204:207], v[200:203], v[24:27]
    ds_read_b128 v[144:147], v7 offset:1024
    v_mfma_f32_16x16x32_bf16 v[28:31], v[208:211], v[188:191], v[28:31]
    ds_read_b128 v[148:151], v7 offset:2048
    v_mfma_f32_16x16x32_bf16 v[32:35], v[208:211], v[192:195], v[32:35]
    ds_read_b128 v[152:155], v7 offset:3072
    v_mfma_f32_16x16x32_bf16 v[36:39], v[208:211], v[196:199], v[36:39]
    ds_read_b64_tr_b16 v[160:161], v9 offset:0
    v_mfma_f32_16x16x32_bf16 v[40:43], v[208:211], v[200:203], v[40:43]
    ds_read_b64_tr_b16 v[162:163], v9 offset:4096
    buffer_load_dwordx4 v5, s[4:7], s46 offen offset:1024 lds
    s_add_u32 s46, s46, 131072
    v_mfma_f32_16x16x32_bf16 v[44:47], v[212:215], v[188:191], v[44:47]
    ds_read_b64_tr_b16 v[164:165], v10 offset:0
    v_mfma_f32_16x16x32_bf16 v[48:51], v[212:215], v[192:195], v[48:51]
    ds_read_b64_tr_b16 v[166:167], v10 offset:4096
    v_mfma_f32_16x16x32_bf16 v[52:55], v[212:215], v[196:199], v[52:55]
    ds_read_b64_tr_b16 v[168:169], v11 offset:0
    v_mfma_f32_16x16x32_bf16 v[56:59], v[212:215], v[200:203], v[56:59]
    ds_read_b64_tr_b16 v[170:171], v11 offset:4096
    v_mfma_f32_16x16x32_bf16 v[60:63], v[216:219], v[188:191], v[60:63]
    ds_read_b64_tr_b16 v[172:173], v8 offset:8192
    s_add_u32 m0, s52, s51
    s_nop 0
    buffer_load_dwordx4 v6, s[8:11], s47 offen lds
    v_mfma_f32_16x16x32_bf16 v[64:67], v[216:219], v[192:195], v[64:67]
    ds_read_b64_tr_b16 v[174:175], v8 offset:12288
    v_mfma_f32_16x16x32_bf16 v[68:71], v[216:219], v[196:199], v[68:71]
    ds_read_b64_tr_b16 v[176:177], v9 offset:8192
    v_mfma_f32_16x16x32_bf16 v[72:75], v[216:219], v[200:203], v[72:75]
    ds_read_b64_tr_b16 v[178:179], v9 offset:12288
    v_mfma_f32_16x16x32_bf16 v[76:79], v[220:223], v[188:191], v[76:79]
    ds_read_b64_tr_b16 v[180:181], v10 offset:8192
    v_mfma_f32_16x16x32_bf16 v[80:83], v[220:223], v[192:195], v[80:83]
    ds_read_b64_tr_b16 v[182:183], v10 offset:12288
    s_add_u32 m0, m0, 8192
    s_mov_b32 s99, 0x1000
    buffer_load_dwordx4 v6, s[12:15], s47 offen lds
    s_add_u32 s47, s47, 229376
    v_mfma_f32_16x16x32_bf16 v[84:87], v[220:223], v[196:199], v[84:87]
    ds_read_b64_tr_b16 v[184:185], v11 offset:8192
    v_mfma_f32_16x16x32_bf16 v[88:91], v[220:223], v[200:203], v[88:91]
    ds_read_b64_tr_b16 v[186:187], v11 offset:12288
    v_mfma_f32_16x16x32_bf16 v[92:95], v[224:227], v[188:191], v[92:95]
    s_add_u32 s54, s44, 32768
    s_cmp_eq_u32 s54, 131072
    s_cselect_b32 s54, 0, s54
    s_sub_u32 s54, s54, s44
    s_add_u32 s44, s44, s54
    v_add_u32 v7, s54, v7
    v_mfma_f32_16x16x32_bf16 v[96:99], v[224:227], v[192:195], v[96:99]
    v_add_u32 v8, s54, v8
    v_add_u32 v9, s54, v9
    v_mfma_f32_16x16x32_bf16 v[100:103], v[224:227], v[196:199], v[100:103]
    v_add_u32 v10, s54, v10
    v_add_u32 v11, s54, v11
    s_add_u32 s52, s52, 32768
    s_cmp_eq_u32 s52, 131072
    .long 0x853434ff, 0x0
    v_mfma_f32_16x16x32_bf16 v[104:107], v[224:227], v[200:203], v[104:107]
    v_mfma_f32_16x16x32_bf16 v[108:111], v[228:231], v[188:191], v[108:111]
    v_mfma_f32_16x16x32_bf16 v[112:115], v[228:231], v[192:195], v[112:115]
    v_mfma_f32_16x16x32_bf16 v[116:119], v[228:231], v[196:199], v[116:119]
    s_waitcnt vmcnt(8) lgkmcnt(0)
    s_barrier
    v_mfma_f32_16x16x32_bf16 v[120:123], v[228:231], v[200:203], v[120:123]
    v_mfma_f32_16x16x32_bf16 v[124:127], v[232:235], v[188:191], v[124:127]
    v_mfma_f32_16x16x32_bf16 v[128:131], v[232:235], v[192:195], v[128:131]
    v_mfma_f32_16x16x32_bf16 v[132:135], v[232:235], v[196:199], v[132:135]
    v_mfma_f32_16x16x32_bf16 v[136:139], v[232:235], v[200:203], v[136:139]
    .long 0xbeab00ff, 0x0
interleave_layers__linear_kernel_hedgehog__geglu_ffn__prompt_kernel_loop38:
    v_mfma_f32_16x16x32_bf16 v[12:15], v[156:159], v[140:143], v[12:15]
    ds_read_b64_tr_b16 v[204:205], v8 offset:0
    v_mfma_f32_16x16x32_bf16 v[16:19], v[156:159], v[144:147], v[16:19]
    ds_read_b64_tr_b16 v[206:207], v8 offset:4096
    v_mfma_f32_16x16x32_bf16 v[20:23], v[156:159], v[148:151], v[20:23]
    ds_read_b128 v[188:191], v7 offset:0
    s_add_u32 m0, s52, s50
    s_nop 0
    buffer_load_dwordx4 v5, s[4:7], s46 offen lds
    v_mfma_f32_16x16x32_bf16 v[24:27], v[156:159], v[152:155], v[24:27]
    ds_read_b128 v[192:195], v7 offset:1024
    v_mfma_f32_16x16x32_bf16 v[28:31], v[160:163], v[140:143], v[28:31]
    ds_read_b128 v[196:199], v7 offset:2048
    v_mfma_f32_16x16x32_bf16 v[32:35], v[160:163], v[144:147], v[32:35]
    ds_read_b128 v[200:203], v7 offset:3072
    v_mfma_f32_16x16x32_bf16 v[36:39], v[160:163], v[148:151], v[36:39]
    ds_read_b64_tr_b16 v[208:209], v9 offset:0
    v_mfma_f32_16x16x32_bf16 v[40:43], v[160:163], v[152:155], v[40:43]
    ds_read_b64_tr_b16 v[210:211], v9 offset:4096
    buffer_load_dwordx4 v5, s[4:7], s46 offen offset:1024 lds
    s_add_u32 s46, s46, 131072
    v_mfma_f32_16x16x32_bf16 v[44:47], v[164:167], v[140:143], v[44:47]
    ds_read_b64_tr_b16 v[212:213], v10 offset:0
    v_mfma_f32_16x16x32_bf16 v[48:51], v[164:167], v[144:147], v[48:51]
    ds_read_b64_tr_b16 v[214:215], v10 offset:4096
    v_mfma_f32_16x16x32_bf16 v[52:55], v[164:167], v[148:151], v[52:55]
    ds_read_b64_tr_b16 v[216:217], v11 offset:0
    v_mfma_f32_16x16x32_bf16 v[56:59], v[164:167], v[152:155], v[56:59]
    ds_read_b64_tr_b16 v[218:219], v11 offset:4096
    v_mfma_f32_16x16x32_bf16 v[60:63], v[168:171], v[140:143], v[60:63]
    ds_read_b64_tr_b16 v[220:221], v8 offset:8192
    s_add_u32 m0, s52, s51
    s_nop 0
    buffer_load_dwordx4 v6, s[8:11], s47 offen lds
    v_mfma_f32_16x16x32_bf16 v[64:67], v[168:171], v[144:147], v[64:67]
    ds_read_b64_tr_b16 v[222:223], v8 offset:12288
    v_mfma_f32_16x16x32_bf16 v[68:71], v[168:171], v[148:151], v[68:71]
    ds_read_b64_tr_b16 v[224:225], v9 offset:8192
    v_mfma_f32_16x16x32_bf16 v[72:75], v[168:171], v[152:155], v[72:75]
    ds_read_b64_tr_b16 v[226:227], v9 offset:12288
    v_mfma_f32_16x16x32_bf16 v[76:79], v[172:175], v[140:143], v[76:79]
    ds_read_b64_tr_b16 v[228:229], v10 offset:8192
    v_mfma_f32_16x16x32_bf16 v[80:83], v[172:175], v[144:147], v[80:83]
    ds_read_b64_tr_b16 v[230:231], v10 offset:12288
    s_add_u32 m0, m0, 8192
    s_mov_b32 s99, 0x1000
    buffer_load_dwordx4 v6, s[12:15], s47 offen lds
    s_add_u32 s47, s47, 229376
    v_mfma_f32_16x16x32_bf16 v[84:87], v[172:175], v[148:151], v[84:87]
    ds_read_b64_tr_b16 v[232:233], v11 offset:8192
    v_mfma_f32_16x16x32_bf16 v[88:91], v[172:175], v[152:155], v[88:91]
    ds_read_b64_tr_b16 v[234:235], v11 offset:12288
    v_mfma_f32_16x16x32_bf16 v[92:95], v[176:179], v[140:143], v[92:95]
    s_add_u32 s54, s44, 32768
    s_cmp_eq_u32 s54, 131072
    s_cselect_b32 s54, 0, s54
    s_sub_u32 s54, s54, s44
    s_add_u32 s44, s44, s54
    v_add_u32 v7, s54, v7
    v_mfma_f32_16x16x32_bf16 v[96:99], v[176:179], v[144:147], v[96:99]
    v_add_u32 v8, s54, v8
    v_add_u32 v9, s54, v9
    v_mfma_f32_16x16x32_bf16 v[100:103], v[176:179], v[148:151], v[100:103]
    v_add_u32 v10, s54, v10
    v_add_u32 v11, s54, v11
    s_add_u32 s52, s52, 32768
    s_cmp_eq_u32 s52, 131072
    .long 0x853434ff, 0x0
    v_mfma_f32_16x16x32_bf16 v[104:107], v[176:179], v[152:155], v[104:107]
    v_mfma_f32_16x16x32_bf16 v[108:111], v[180:183], v[140:143], v[108:111]
    v_mfma_f32_16x16x32_bf16 v[112:115], v[180:183], v[144:147], v[112:115]
    v_mfma_f32_16x16x32_bf16 v[116:119], v[180:183], v[148:151], v[116:119]
    s_waitcnt vmcnt(8) lgkmcnt(0)
    s_barrier
    v_mfma_f32_16x16x32_bf16 v[120:123], v[180:183], v[152:155], v[120:123]
    v_mfma_f32_16x16x32_bf16 v[124:127], v[184:187], v[140:143], v[124:127]
    v_mfma_f32_16x16x32_bf16 v[128:131], v[184:187], v[144:147], v[128:131]
    v_mfma_f32_16x16x32_bf16 v[132:135], v[184:187], v[148:151], v[132:135]
    v_mfma_f32_16x16x32_bf16 v[136:139], v[184:187], v[152:155], v[136:139]
    v_mfma_f32_16x16x32_bf16 v[12:15], v[204:207], v[188:191], v[12:15]
    ds_read_b64_tr_b16 v[156:157], v8 offset:0
    v_mfma_f32_16x16x32_bf16 v[16:19], v[204:207], v[192:195], v[16:19]
    ds_read_b64_tr_b16 v[158:159], v8 offset:4096
    v_mfma_f32_16x16x32_bf16 v[20:23], v[204:207], v[196:199], v[20:23]
    ds_read_b128 v[140:143], v7 offset:0
    s_add_u32 m0, s52, s50
    s_nop 0
    buffer_load_dwordx4 v5, s[4:7], s46 offen lds
    v_mfma_f32_16x16x32_bf16 v[24:27], v[204:207], v[200:203], v[24:27]
    ds_read_b128 v[144:147], v7 offset:1024
    v_mfma_f32_16x16x32_bf16 v[28:31], v[208:211], v[188:191], v[28:31]
    ds_read_b128 v[148:151], v7 offset:2048
    v_mfma_f32_16x16x32_bf16 v[32:35], v[208:211], v[192:195], v[32:35]
    ds_read_b128 v[152:155], v7 offset:3072
    v_mfma_f32_16x16x32_bf16 v[36:39], v[208:211], v[196:199], v[36:39]
    ds_read_b64_tr_b16 v[160:161], v9 offset:0
    v_mfma_f32_16x16x32_bf16 v[40:43], v[208:211], v[200:203], v[40:43]
    ds_read_b64_tr_b16 v[162:163], v9 offset:4096
    buffer_load_dwordx4 v5, s[4:7], s46 offen offset:1024 lds
    s_add_u32 s46, s46, 131072
    v_mfma_f32_16x16x32_bf16 v[44:47], v[212:215], v[188:191], v[44:47]
    ds_read_b64_tr_b16 v[164:165], v10 offset:0
    v_mfma_f32_16x16x32_bf16 v[48:51], v[212:215], v[192:195], v[48:51]
    ds_read_b64_tr_b16 v[166:167], v10 offset:4096
    v_mfma_f32_16x16x32_bf16 v[52:55], v[212:215], v[196:199], v[52:55]
    ds_read_b64_tr_b16 v[168:169], v11 offset:0
    v_mfma_f32_16x16x32_bf16 v[56:59], v[212:215], v[200:203], v[56:59]
    ds_read_b64_tr_b16 v[170:171], v11 offset:4096
    v_mfma_f32_16x16x32_bf16 v[60:63], v[216:219], v[188:191], v[60:63]
    ds_read_b64_tr_b16 v[172:173], v8 offset:8192
    s_add_u32 m0, s52, s51
    s_nop 0
    buffer_load_dwordx4 v6, s[8:11], s47 offen lds
    v_mfma_f32_16x16x32_bf16 v[64:67], v[216:219], v[192:195], v[64:67]
    ds_read_b64_tr_b16 v[174:175], v8 offset:12288
    v_mfma_f32_16x16x32_bf16 v[68:71], v[216:219], v[196:199], v[68:71]
    ds_read_b64_tr_b16 v[176:177], v9 offset:8192
    v_mfma_f32_16x16x32_bf16 v[72:75], v[216:219], v[200:203], v[72:75]
    ds_read_b64_tr_b16 v[178:179], v9 offset:12288
    v_mfma_f32_16x16x32_bf16 v[76:79], v[220:223], v[188:191], v[76:79]
    ds_read_b64_tr_b16 v[180:181], v10 offset:8192
    v_mfma_f32_16x16x32_bf16 v[80:83], v[220:223], v[192:195], v[80:83]
    ds_read_b64_tr_b16 v[182:183], v10 offset:12288
    s_add_u32 m0, m0, 8192
    s_mov_b32 s99, 0x1000
    buffer_load_dwordx4 v6, s[12:15], s47 offen lds
    s_add_u32 s47, s47, 229376
    v_mfma_f32_16x16x32_bf16 v[84:87], v[220:223], v[196:199], v[84:87]
    ds_read_b64_tr_b16 v[184:185], v11 offset:8192
    v_mfma_f32_16x16x32_bf16 v[88:91], v[220:223], v[200:203], v[88:91]
    ds_read_b64_tr_b16 v[186:187], v11 offset:12288
    v_mfma_f32_16x16x32_bf16 v[92:95], v[224:227], v[188:191], v[92:95]
    s_add_u32 s54, s44, 32768
    s_cmp_eq_u32 s54, 131072
    s_cselect_b32 s54, 0, s54
    s_sub_u32 s54, s54, s44
    s_add_u32 s44, s44, s54
    v_add_u32 v7, s54, v7
    v_mfma_f32_16x16x32_bf16 v[96:99], v[224:227], v[192:195], v[96:99]
    v_add_u32 v8, s54, v8
    v_add_u32 v9, s54, v9
    v_mfma_f32_16x16x32_bf16 v[100:103], v[224:227], v[196:199], v[100:103]
    v_add_u32 v10, s54, v10
    v_add_u32 v11, s54, v11
    s_add_u32 s52, s52, 32768
    s_cmp_eq_u32 s52, 131072
    .long 0x853434ff, 0x0
    v_mfma_f32_16x16x32_bf16 v[104:107], v[224:227], v[200:203], v[104:107]
    v_mfma_f32_16x16x32_bf16 v[108:111], v[228:231], v[188:191], v[108:111]
    v_mfma_f32_16x16x32_bf16 v[112:115], v[228:231], v[192:195], v[112:115]
    v_mfma_f32_16x16x32_bf16 v[116:119], v[228:231], v[196:199], v[116:119]
    s_waitcnt vmcnt(8) lgkmcnt(0)
    s_barrier
    v_mfma_f32_16x16x32_bf16 v[120:123], v[228:231], v[200:203], v[120:123]
    v_mfma_f32_16x16x32_bf16 v[124:127], v[232:235], v[188:191], v[124:127]
    v_mfma_f32_16x16x32_bf16 v[128:131], v[232:235], v[192:195], v[128:131]
    v_mfma_f32_16x16x32_bf16 v[132:135], v[232:235], v[196:199], v[132:135]
    v_mfma_f32_16x16x32_bf16 v[136:139], v[232:235], v[200:203], v[136:139]
    s_add_u32 s43, s43, 2
    .long 0xbf0aff2b, 0x1a
    s_cbranch_scc1 interleave_layers__linear_kernel_hedgehog__geglu_ffn__prompt_kernel_loop38
    v_mfma_f32_16x16x32_bf16 v[12:15], v[156:159], v[140:143], v[12:15]
    ds_read_b64_tr_b16 v[204:205], v8 offset:0
    v_mfma_f32_16x16x32_bf16 v[16:19], v[156:159], v[144:147], v[16:19]
    ds_read_b64_tr_b16 v[206:207], v8 offset:4096
    v_mfma_f32_16x16x32_bf16 v[20:23], v[156:159], v[148:151], v[20:23]
    ds_read_b128 v[188:191], v7 offset:0
    v_mfma_f32_16x16x32_bf16 v[24:27], v[156:159], v[152:155], v[24:27]
    ds_read_b128 v[192:195], v7 offset:1024
    v_mfma_f32_16x16x32_bf16 v[28:31], v[160:163], v[140:143], v[28:31]
    ds_read_b128 v[196:199], v7 offset:2048
    v_mfma_f32_16x16x32_bf16 v[32:35], v[160:163], v[144:147], v[32:35]
    ds_read_b128 v[200:203], v7 offset:3072
    v_mfma_f32_16x16x32_bf16 v[36:39], v[160:163], v[148:151], v[36:39]
    ds_read_b64_tr_b16 v[208:209], v9 offset:0
    v_mfma_f32_16x16x32_bf16 v[40:43], v[160:163], v[152:155], v[40:43]
    ds_read_b64_tr_b16 v[210:211], v9 offset:4096
    v_mfma_f32_16x16x32_bf16 v[44:47], v[164:167], v[140:143], v[44:47]
    ds_read_b64_tr_b16 v[212:213], v10 offset:0
    v_mfma_f32_16x16x32_bf16 v[48:51], v[164:167], v[144:147], v[48:51]
    ds_read_b64_tr_b16 v[214:215], v10 offset:4096
    v_mfma_f32_16x16x32_bf16 v[52:55], v[164:167], v[148:151], v[52:55]
    ds_read_b64_tr_b16 v[216:217], v11 offset:0
    v_mfma_f32_16x16x32_bf16 v[56:59], v[164:167], v[152:155], v[56:59]
    ds_read_b64_tr_b16 v[218:219], v11 offset:4096
    v_mfma_f32_16x16x32_bf16 v[60:63], v[168:171], v[140:143], v[60:63]
    ds_read_b64_tr_b16 v[220:221], v8 offset:8192
    v_mfma_f32_16x16x32_bf16 v[64:67], v[168:171], v[144:147], v[64:67]
    ds_read_b64_tr_b16 v[222:223], v8 offset:12288
    v_mfma_f32_16x16x32_bf16 v[68:71], v[168:171], v[148:151], v[68:71]
    ds_read_b64_tr_b16 v[224:225], v9 offset:8192
    v_mfma_f32_16x16x32_bf16 v[72:75], v[168:171], v[152:155], v[72:75]
    ds_read_b64_tr_b16 v[226:227], v9 offset:12288
    v_mfma_f32_16x16x32_bf16 v[76:79], v[172:175], v[140:143], v[76:79]
    ds_read_b64_tr_b16 v[228:229], v10 offset:8192
    v_mfma_f32_16x16x32_bf16 v[80:83], v[172:175], v[144:147], v[80:83]
    ds_read_b64_tr_b16 v[230:231], v10 offset:12288
    v_mfma_f32_16x16x32_bf16 v[84:87], v[172:175], v[148:151], v[84:87]
    ds_read_b64_tr_b16 v[232:233], v11 offset:8192
    v_mfma_f32_16x16x32_bf16 v[88:91], v[172:175], v[152:155], v[88:91]
    ds_read_b64_tr_b16 v[234:235], v11 offset:12288
    v_mfma_f32_16x16x32_bf16 v[92:95], v[176:179], v[140:143], v[92:95]
    s_add_u32 s54, s44, 32768
    s_cmp_eq_u32 s54, 131072
    s_cselect_b32 s54, 0, s54
    s_sub_u32 s54, s54, s44
    s_add_u32 s44, s44, s54
    v_add_u32 v7, s54, v7
    v_mfma_f32_16x16x32_bf16 v[96:99], v[176:179], v[144:147], v[96:99]
    v_add_u32 v8, s54, v8
    v_add_u32 v9, s54, v9
    v_mfma_f32_16x16x32_bf16 v[100:103], v[176:179], v[148:151], v[100:103]
    v_add_u32 v10, s54, v10
    v_add_u32 v11, s54, v11
    v_mfma_f32_16x16x32_bf16 v[104:107], v[176:179], v[152:155], v[104:107]
    v_mfma_f32_16x16x32_bf16 v[108:111], v[180:183], v[140:143], v[108:111]
    v_mfma_f32_16x16x32_bf16 v[112:115], v[180:183], v[144:147], v[112:115]
    v_mfma_f32_16x16x32_bf16 v[116:119], v[180:183], v[148:151], v[116:119]
    s_waitcnt vmcnt(0) lgkmcnt(0)
    s_barrier
    v_mfma_f32_16x16x32_bf16 v[120:123], v[180:183], v[152:155], v[120:123]
    .long 0xbf09ff28, 0x4
    s_cbranch_scc1 interleave_layers__linear_kernel_hedgehog__geglu_ffn__prompt_kernel_pr39
    s_setprio 2
interleave_layers__linear_kernel_hedgehog__geglu_ffn__prompt_kernel_pr39:
    v_mfma_f32_16x16x32_bf16 v[124:127], v[184:187], v[140:143], v[124:127]
    v_mfma_f32_16x16x32_bf16 v[128:131], v[184:187], v[144:147], v[128:131]
    v_mfma_f32_16x16x32_bf16 v[132:135], v[184:187], v[148:151], v[132:135]
    v_mfma_f32_16x16x32_bf16 v[136:139], v[184:187], v[152:155], v[136:139]
    v_mfma_f32_16x16x32_bf16 v[12:15], v[204:207], v[188:191], v[12:15]
    ds_read_b64_tr_b16 v[156:157], v8 offset:0
    v_mfma_f32_16x16x32_bf16 v[16:19], v[204:207], v[192:195], v[16:19]
    ds_read_b64_tr_b16 v[158:159], v8 offset:4096
    v_mfma_f32_16x16x32_bf16 v[20:23], v[204:207], v[196:199], v[20:23]
    ds_read_b128 v[140:143], v7 offset:0
    v_mfma_f32_16x16x32_bf16 v[24:27], v[204:207], v[200:203], v[24:27]
    ds_read_b128 v[144:147], v7 offset:1024
    v_mfma_f32_16x16x32_bf16 v[28:31], v[208:211], v[188:191], v[28:31]
    ds_read_b128 v[148:151], v7 offset:2048
    v_mfma_f32_16x16x32_bf16 v[32:35], v[208:211], v[192:195], v[32:35]
    ds_read_b128 v[152:155], v7 offset:3072
    v_mfma_f32_16x16x32_bf16 v[36:39], v[208:211], v[196:199], v[36:39]
    ds_read_b64_tr_b16 v[160:161], v9 offset:0
    v_mfma_f32_16x16x32_bf16 v[40:43], v[208:211], v[200:203], v[40:43]
    ds_read_b64_tr_b16 v[162:163], v9 offset:4096
    v_mfma_f32_16x16x32_bf16 v[44:47], v[212:215], v[188:191], v[44:47]
    ds_read_b64_tr_b16 v[164:165], v10 offset:0
    v_mfma_f32_16x16x32_bf16 v[48:51], v[212:215], v[192:195], v[48:51]
    ds_read_b64_tr_b16 v[166:167], v10 offset:4096
    v_mfma_f32_16x16x32_bf16 v[52:55], v[212:215], v[196:199], v[52:55]
    ds_read_b64_tr_b16 v[168:169], v11 offset:0
    v_mfma_f32_16x16x32_bf16 v[56:59], v[212:215], v[200:203], v[56:59]
    ds_read_b64_tr_b16 v[170:171], v11 offset:4096
    v_mfma_f32_16x16x32_bf16 v[60:63], v[216:219], v[188:191], v[60:63]
    ds_read_b64_tr_b16 v[172:173], v8 offset:8192
    v_mfma_f32_16x16x32_bf16 v[64:67], v[216:219], v[192:195], v[64:67]
    ds_read_b64_tr_b16 v[174:175], v8 offset:12288
    v_mfma_f32_16x16x32_bf16 v[68:71], v[216:219], v[196:199], v[68:71]
    ds_read_b64_tr_b16 v[176:177], v9 offset:8192
    v_mfma_f32_16x16x32_bf16 v[72:75], v[216:219], v[200:203], v[72:75]
    ds_read_b64_tr_b16 v[178:179], v9 offset:12288
    v_mfma_f32_16x16x32_bf16 v[76:79], v[220:223], v[188:191], v[76:79]
    ds_read_b64_tr_b16 v[180:181], v10 offset:8192
    v_mfma_f32_16x16x32_bf16 v[80:83], v[220:223], v[192:195], v[80:83]
    ds_read_b64_tr_b16 v[182:183], v10 offset:12288
    v_mfma_f32_16x16x32_bf16 v[84:87], v[220:223], v[196:199], v[84:87]
    ds_read_b64_tr_b16 v[184:185], v11 offset:8192
    v_mfma_f32_16x16x32_bf16 v[88:91], v[220:223], v[200:203], v[88:91]
    ds_read_b64_tr_b16 v[186:187], v11 offset:12288
    v_mfma_f32_16x16x32_bf16 v[92:95], v[224:227], v[188:191], v[92:95]
    s_add_u32 s54, s44, 32768
    s_cmp_eq_u32 s54, 131072
    s_cselect_b32 s54, 0, s54
    s_sub_u32 s54, s54, s44
    s_add_u32 s44, s44, s54
    v_add_u32 v7, s54, v7
    v_mfma_f32_16x16x32_bf16 v[96:99], v[224:227], v[192:195], v[96:99]
    v_add_u32 v8, s54, v8
    v_add_u32 v9, s54, v9
    v_mfma_f32_16x16x32_bf16 v[100:103], v[224:227], v[196:199], v[100:103]
    v_add_u32 v10, s54, v10
    v_add_u32 v11, s54, v11
    v_and_b32_e64 v236, 31, v0
    v_add_u32 v236, 3840, v236
    v_and_b32 v237, 1, v0
    s_lshl_b32 s49, s42, 1
    s_add_u32 s49, s49, 5120
    v_add_u32_e64 v237, s49, v237
    v_mfma_f32_16x16x32_bf16 v[104:107], v[224:227], v[200:203], v[104:107]
    v_bfe_u32 v238, v0, 1, 1
    v_mad_u32_u24 v237, v238, 56, v237
    v_cmp_lt_u32_e64 vcc, 31, v0
    v_mfma_f32_16x16x32_bf16 v[108:111], v[228:231], v[188:191], v[108:111]
    v_mfma_f32_16x16x32_bf16 v[112:115], v[228:231], v[192:195], v[112:115]
    v_cndmask_b32 v236, v236, v237, vcc
    v_lshlrev_b32 v236, 7, v236
    buffer_load_dword v237, v236, s[56:59], 0 offen sc1
    v_mfma_f32_16x16x32_bf16 v[116:119], v[228:231], v[196:199], v[116:119]
    v_mfma_f32_16x16x32_bf16 v[120:123], v[228:231], v[200:203], v[120:123]
    v_mfma_f32_16x16x32_bf16 v[124:127], v[232:235], v[188:191], v[124:127]
    v_mfma_f32_16x16x32_bf16 v[128:131], v[232:235], v[192:195], v[128:131]
    v_mfma_f32_16x16x32_bf16 v[132:135], v[232:235], v[196:199], v[132:135]
    v_mfma_f32_16x16x32_bf16 v[136:139], v[232:235], v[200:203], v[136:139]
    s_waitcnt lgkmcnt(0)
    s_nop 0
    v_mfma_f32_16x16x32_bf16 v[12:15], v[156:159], v[140:143], v[12:15]
    ds_read_b64_tr_b16 v[204:205], v8 offset:0
    v_mfma_f32_16x16x32_bf16 v[16:19], v[156:159], v[144:147], v[16:19]
    ds_read_b64_tr_b16 v[206:207], v8 offset:4096
    v_mfma_f32_16x16x32_bf16 v[20:23], v[156:159], v[148:151], v[20:23]
    ds_read_b128 v[188:191], v7 offset:0
    v_mfma_f32_16x16x32_bf16 v[24:27], v[156:159], v[152:155], v[24:27]
    ds_read_b128 v[192:195], v7 offset:1024
    v_mfma_f32_16x16x32_bf16 v[28:31], v[160:163], v[140:143], v[28:31]
    ds_read_b128 v[196:199], v7 offset:2048
    v_mfma_f32_16x16x32_bf16 v[32:35], v[160:163], v[144:147], v[32:35]
    ds_read_b128 v[200:203], v7 offset:3072
    v_mfma_f32_16x16x32_bf16 v[36:39], v[160:163], v[148:151], v[36:39]
    ds_read_b64_tr_b16 v[208:209], v9 offset:0
    v_mfma_f32_16x16x32_bf16 v[40:43], v[160:163], v[152:155], v[40:43]
    ds_read_b64_tr_b16 v[210:211], v9 offset:4096
    v_mfma_f32_16x16x32_bf16 v[44:47], v[164:167], v[140:143], v[44:47]
    ds_read_b64_tr_b16 v[212:213], v10 offset:0
    v_mfma_f32_16x16x32_bf16 v[48:51], v[164:167], v[144:147], v[48:51]
    ds_read_b64_tr_b16 v[214:215], v10 offset:4096
    v_mfma_f32_16x16x32_bf16 v[52:55], v[164:167], v[148:151], v[52:55]
    ds_read_b64_tr_b16 v[216:217], v11 offset:0
    v_mfma_f32_16x16x32_bf16 v[56:59], v[164:167], v[152:155], v[56:59]
    ds_read_b64_tr_b16 v[218:219], v11 offset:4096
    v_mfma_f32_16x16x32_bf16 v[60:63], v[168:171], v[140:143], v[60:63]
    ds_read_b64_tr_b16 v[220:221], v8 offset:8192
    v_mfma_f32_16x16x32_bf16 v[64:67], v[168:171], v[144:147], v[64:67]
    ds_read_b64_tr_b16 v[222:223], v8 offset:12288
    v_mfma_f32_16x16x32_bf16 v[68:71], v[168:171], v[148:151], v[68:71]
    ds_read_b64_tr_b16 v[224:225], v9 offset:8192
    v_mfma_f32_16x16x32_bf16 v[72:75], v[168:171], v[152:155], v[72:75]
    ds_read_b64_tr_b16 v[226:227], v9 offset:12288
    v_mfma_f32_16x16x32_bf16 v[76:79], v[172:175], v[140:143], v[76:79]
    ds_read_b64_tr_b16 v[228:229], v10 offset:8192
    v_mfma_f32_16x16x32_bf16 v[80:83], v[172:175], v[144:147], v[80:83]
    ds_read_b64_tr_b16 v[230:231], v10 offset:12288
    v_mfma_f32_16x16x32_bf16 v[84:87], v[172:175], v[148:151], v[84:87]
    ds_read_b64_tr_b16 v[232:233], v11 offset:8192
    v_mfma_f32_16x16x32_bf16 v[88:91], v[172:175], v[152:155], v[88:91]
    ds_read_b64_tr_b16 v[234:235], v11 offset:12288
    v_mfma_f32_16x16x32_bf16 v[92:95], v[176:179], v[140:143], v[92:95]
    s_add_u32 s54, s44, 32768
    s_cmp_eq_u32 s54, 131072
    s_cselect_b32 s54, 0, s54
    s_sub_u32 s54, s54, s44
    s_add_u32 s44, s44, s54
    v_add_u32 v7, s54, v7
    v_mfma_f32_16x16x32_bf16 v[96:99], v[176:179], v[144:147], v[96:99]
    v_add_u32 v8, s54, v8
    v_add_u32 v9, s54, v9
    v_mfma_f32_16x16x32_bf16 v[100:103], v[176:179], v[148:151], v[100:103]
    v_add_u32 v10, s54, v10
    v_add_u32 v11, s54, v11
    v_mfma_f32_16x16x32_bf16 v[104:107], v[176:179], v[152:155], v[104:107]
    v_mfma_f32_16x16x32_bf16 v[108:111], v[180:183], v[140:143], v[108:111]
    v_mfma_f32_16x16x32_bf16 v[112:115], v[180:183], v[144:147], v[112:115]
    v_mfma_f32_16x16x32_bf16 v[116:119], v[180:183], v[148:151], v[116:119]
    v_mfma_f32_16x16x32_bf16 v[120:123], v[180:183], v[152:155], v[120:123]
    v_mfma_f32_16x16x32_bf16 v[124:127], v[184:187], v[140:143], v[124:127]
    s_waitcnt vmcnt(0)
    v_cmp_ne_u32 vcc, s60, v237
    v_mfma_f32_16x16x32_bf16 v[128:131], v[184:187], v[144:147], v[128:131]
    v_mfma_f32_16x16x32_bf16 v[132:135], v[184:187], v[148:151], v[132:135]
    s_cmp_lg_u64 vcc, 0
    s_cbranch_scc1 interleave_layers__linear_kernel_hedgehog__geglu_ffn__prompt_kernel_slowfc40
interleave_layers__linear_kernel_hedgehog__geglu_ffn__prompt_kernel_backfc41:
    v_mfma_f32_16x16x32_bf16 v[136:139], v[184:187], v[152:155], v[136:139]
    s_waitcnt lgkmcnt(0)
    v_mfma_f32_16x16x32_bf16 v[12:15], v[204:207], v[188:191], v[12:15]
    v_lshrrev_b32 v1, 4, v0
    v_lshlrev_b32_e64 v1, 4, v1
    s_lshl_b32 s45, s42, 9
    s_and_b32 s48, s40, 4
    s_lshl_b32 s48, s48, 6
    s_add_u32 s45, s45, s48
    s_add_u32 s48, s45, 14336
    v_mfma_f32_16x16x32_bf16 v[16:19], v[204:207], v[192:195], v[16:19]
    buffer_load_dwordx4 v[140:143], v1, s[24:27], s45 offen offset:0
    v_mfma_f32_16x16x32_bf16 v[20:23], v[204:207], v[196:199], v[20:23]
    buffer_load_dwordx4 v[144:147], v1, s[24:27], s45 offen offset:64
    v_mfma_f32_16x16x32_bf16 v[24:27], v[204:207], v[200:203], v[24:27]
    buffer_load_dwordx4 v[148:151], v1, s[24:27], s45 offen offset:128
    v_mfma_f32_16x16x32_bf16 v[28:31], v[208:211], v[188:191], v[28:31]
    buffer_load_dwordx4 v[152:155], v1, s[24:27], s45 offen offset:192
    v_mfma_f32_16x16x32_bf16 v[32:35], v[208:211], v[192:195], v[32:35]
    buffer_load_dwordx4 v[156:159], v1, s[24:27], s48 offen offset:0
    v_mfma_f32_16x16x32_bf16 v[36:39], v[208:211], v[196:199], v[36:39]
    buffer_load_dwordx4 v[160:163], v1, s[24:27], s48 offen offset:64
    v_mfma_f32_16x16x32_bf16 v[40:43], v[208:211], v[200:203], v[40:43]
    buffer_load_dwordx4 v[164:167], v1, s[24:27], s48 offen offset:128
    v_mfma_f32_16x16x32_bf16 v[44:47], v[212:215], v[188:191], v[44:47]
    buffer_load_dwordx4 v[168:171], v1, s[24:27], s48 offen offset:192
    v_mfma_f32_16x16x32_bf16 v[48:51], v[212:215], v[192:195], v[48:51]
    v_mfma_f32_16x16x32_bf16 v[52:55], v[212:215], v[196:199], v[52:55]
    s_and_b32 s49, s40, 3
    s_lshl_b32 s49, s49, 8
    s_add_u32 s49, s49, 131072
    v_and_b32 v2, 15, v0
    v_lshlrev_b32 v3, 2, v2
    v_add_u32_e64 v3, s49, v3
    v_mfma_f32_16x16x32_bf16 v[56:59], v[212:215], v[200:203], v[56:59]
    ds_read_b32 v172, v3 offset:0
    ds_read_b32 v174, v3 offset:1024
    v_mfma_f32_16x16x32_bf16 v[60:63], v[216:219], v[188:191], v[60:63]
    ds_read_b32 v176, v3 offset:64
    ds_read_b32 v178, v3 offset:1088
    v_mfma_f32_16x16x32_bf16 v[64:67], v[216:219], v[192:195], v[64:67]
    ds_read_b32 v180, v3 offset:128
    ds_read_b32 v182, v3 offset:1152
    v_mfma_f32_16x16x32_bf16 v[68:71], v[216:219], v[196:199], v[68:71]
    ds_read_b32 v184, v3 offset:192
    ds_read_b32 v186, v3 offset:1216
    v_mfma_f32_16x16x32_bf16 v[72:75], v[216:219], v[200:203], v[72:75]
    v_mfma_f32_16x16x32_bf16 v[76:79], v[220:223], v[188:191], v[76:79]
    v_mfma_f32_16x16x32_bf16 v[80:83], v[220:223], v[192:195], v[80:83]
    v_mfma_f32_16x16x32_bf16 v[84:87], v[220:223], v[196:199], v[84:87]
    v_mfma_f32_16x16x32_bf16 v[88:91], v[220:223], v[200:203], v[88:91]
    v_mfma_f32_16x16x32_bf16 v[92:95], v[224:227], v[188:191], v[92:95]
    v_mfma_f32_16x16x32_bf16 v[96:99], v[224:227], v[192:195], v[96:99]
    v_mfma_f32_16x16x32_bf16 v[100:103], v[224:227], v[196:199], v[100:103]
    v_mfma_f32_16x16x32_bf16 v[104:107], v[224:227], v[200:203], v[104:107]
    v_mfma_f32_16x16x32_bf16 v[108:111], v[228:231], v[188:191], v[108:111]
    v_mfma_f32_16x16x32_bf16 v[112:115], v[228:231], v[192:195], v[112:115]
    v_mfma_f32_16x16x32_bf16 v[116:119], v[228:231], v[196:199], v[116:119]
    v_mfma_f32_16x16x32_bf16 v[120:123], v[228:231], v[200:203], v[120:123]
    v_mfma_f32_16x16x32_bf16 v[124:127], v[232:235], v[188:191], v[124:127]
    v_mfma_f32_16x16x32_bf16 v[128:131], v[232:235], v[192:195], v[128:131]
    v_mfma_f32_16x16x32_bf16 v[132:135], v[232:235], v[196:199], v[132:135]
    v_mfma_f32_16x16x32_bf16 v[136:139], v[232:235], v[200:203], v[136:139]
    s_setprio 0
    v_lshlrev_b32_e64 v2, 4, v0
    s_lshl_b32 s45, s42, 18
    s_lshl_b32 s48, s41, 14
    s_add_u32 s45, s45, s48
    s_and_b32 s48, s40, 3
    s_lshl_b32 s48, s48, 12
    s_add_u32 s45, s45, s48
    s_and_b32 s48, s40, 4
    s_lshl_b32 s48, s48, 15
    s_add_u32 s45, s45, s48
    v_mov_b32 v3, 147456
    v_mov_b32 v4, 1
    s_waitcnt vmcnt(0) lgkmcnt(0)
    v_mul_f32 v173, v172, v172
    v_mul_f32 v177, v176, v176
    v_mul_f32 v181, v180, v180
    v_mul_f32 v185, v184, v184
    v_mul_f32 v172, 0xc0135761, v172
    v_mul_f32 v176, 0xc0135761, v176
    v_mul_f32 v180, 0xc0135761, v180
    v_mul_f32 v184, 0xc0135761, v184
    v_mul_f32 v220, 0x3d372713, v173
    v_mul_f32 v222, 0x3d372713, v177
    v_mul_f32 v224, 0x3d372713, v181
    v_mul_f32 v226, 0x3d372713, v185
    v_rcp_f32 v173, v173
    v_rcp_f32 v177, v177
    v_rcp_f32 v181, v181
    v_rcp_f32 v185, v185
    v_mul_f32 v220, v220, v172
    v_mul_f32 v222, v222, v176
    v_mul_f32 v224, v224, v180
    v_mul_f32 v226, v226, v184
    v_pk_fma_f32 v[12:13], v[140:141], v[174:175], v[12:13] op_sel_hi:[1,0,1]
    v_pk_fma_f32 v[14:15], v[142:143], v[174:175], v[14:15] op_sel_hi:[1,0,1]
    v_pk_fma_f32 v[28:29], v[144:145], v[174:175], v[28:29] op_sel_hi:[1,0,1]
    v_pk_fma_f32 v[30:31], v[146:147], v[174:175], v[30:31] op_sel_hi:[1,0,1]
    v_pk_fma_f32 v[16:17], v[140:141], v[178:179], v[16:17] op_sel_hi:[1,0,1]
    v_pk_fma_f32 v[18:19], v[142:143], v[178:179], v[18:19] op_sel_hi:[1,0,1]
    v_pk_fma_f32 v[32:33], v[144:145], v[178:179], v[32:33] op_sel_hi:[1,0,1]
    v_pk_fma_f32 v[34:35], v[146:147], v[178:179], v[34:35] op_sel_hi:[1,0,1]
    v_pk_mul_f32 v[188:189], v[12:13], v[12:13]
    v_pk_mul_f32 v[190:191], v[14:15], v[14:15]
    v_pk_mul_f32 v[192:193], v[28:29], v[28:29]
    v_pk_mul_f32 v[194:195], v[30:31], v[30:31]
    v_pk_mul_f32 v[196:197], v[16:17], v[16:17]
    v_pk_mul_f32 v[198:199], v[18:19], v[18:19]
    v_pk_mul_f32 v[200:201], v[32:33], v[32:33]
    v_pk_mul_f32 v[202:203], v[34:35], v[34:35]
    v_pk_fma_f32 v[188:189], v[188:189], v[220:221], v[172:173] op_sel_hi:[1,0,0]
    v_pk_fma_f32 v[190:191], v[190:191], v[220:221], v[172:173] op_sel_hi:[1,0,0]
    v_pk_fma_f32 v[192:193], v[192:193], v[220:221], v[172:173] op_sel_hi:[1,0,0]
    v_pk_fma_f32 v[194:195], v[194:195], v[220:221], v[172:173] op_sel_hi:[1,0,0]
    v_pk_fma_f32 v[196:197], v[196:197], v[222:223], v[176:177] op_sel_hi:[1,0,0]
    v_pk_fma_f32 v[198:199], v[198:199], v[222:223], v[176:177] op_sel_hi:[1,0,0]
    v_pk_fma_f32 v[200:201], v[200:201], v[222:223], v[176:177] op_sel_hi:[1,0,0]
    v_pk_fma_f32 v[202:203], v[202:203], v[222:223], v[176:177] op_sel_hi:[1,0,0]
    v_pk_mul_f32 v[188:189], v[188:189], v[12:13]
    v_pk_mul_f32 v[190:191], v[190:191], v[14:15]
    v_pk_mul_f32 v[192:193], v[192:193], v[28:29]
    v_pk_mul_f32 v[194:195], v[194:195], v[30:31]
    v_pk_mul_f32 v[196:197], v[196:197], v[16:17]
    v_pk_mul_f32 v[198:199], v[198:199], v[18:19]
    v_pk_mul_f32 v[200:201], v[200:201], v[32:33]
    v_pk_mul_f32 v[202:203], v[202:203], v[34:35]
    v_exp_f32 v188, v188
    v_exp_f32 v189, v189
    v_exp_f32 v190, v190
    v_exp_f32 v191, v191
    v_pk_fma_f32 v[76:77], v[156:157], v[174:175], v[76:77] op_sel_hi:[1,0,1]
    v_pk_fma_f32 v[78:79], v[158:159], v[174:175], v[78:79] op_sel_hi:[1,0,1]
    v_exp_f32 v192, v192
    v_exp_f32 v193, v193
    v_exp_f32 v194, v194
    v_exp_f32 v195, v195
    v_pk_fma_f32 v[92:93], v[160:161], v[174:175], v[92:93] op_sel_hi:[1,0,1]
    v_pk_fma_f32 v[94:95], v[162:163], v[174:175], v[94:95] op_sel_hi:[1,0,1]
    v_exp_f32 v196, v196
    v_exp_f32 v197, v197
    v_exp_f32 v198, v198
    v_exp_f32 v199, v199
    v_pk_fma_f32 v[80:81], v[156:157], v[178:179], v[80:81] op_sel_hi:[1,0,1]
    v_pk_fma_f32 v[82:83], v[158:159], v[178:179], v[82:83] op_sel_hi:[1,0,1]
    v_exp_f32 v200, v200
    v_exp_f32 v201, v201
    v_exp_f32 v202, v202
    v_exp_f32 v203, v203
    v_pk_fma_f32 v[96:97], v[160:161], v[178:179], v[96:97] op_sel_hi:[1,0,1]
    v_pk_fma_f32 v[98:99], v[162:163], v[178:179], v[98:99] op_sel_hi:[1,0,1]
    v_fma_f32 v188, v188, v173, v173
    v_fma_f32 v189, v189, v173, v173
    v_fma_f32 v190, v190, v173, v173
    v_fma_f32 v191, v191, v173, v173
    v_fma_f32 v192, v192, v173, v173
    v_fma_f32 v193, v193, v173, v173
    v_fma_f32 v194, v194, v173, v173
    v_fma_f32 v195, v195, v173, v173
    v_fma_f32 v196, v196, v177, v177
    v_fma_f32 v197, v197, v177, v177
    v_fma_f32 v198, v198, v177, v177
    v_fma_f32 v199, v199, v177, v177
    v_fma_f32 v200, v200, v177, v177
    v_fma_f32 v201, v201, v177, v177
    v_fma_f32 v202, v202, v177, v177
    v_fma_f32 v203, v203, v177, v177
    v_rcp_f32 v188, v188
    v_rcp_f32 v189, v189
    v_rcp_f32 v190, v190
    v_rcp_f32 v191, v191
    v_pk_mul_f32 v[76:77], v[76:77], v[12:13]
    v_pk_mul_f32 v[78:79], v[78:79], v[14:15]
    v_rcp_f32 v192, v192
    v_rcp_f32 v193, v193
    v_rcp_f32 v194, v194
    v_rcp_f32 v195, v195
    v_pk_mul_f32 v[92:93], v[92:93], v[28:29]
    v_pk_mul_f32 v[94:95], v[94:95], v[30:31]
    v_rcp_f32 v196, v196
    v_rcp_f32 v197, v197
    v_rcp_f32 v198, v198
    v_rcp_f32 v199, v199
    v_pk_mul_f32 v[80:81], v[80:81], v[16:17]
    v_pk_mul_f32 v[82:83], v[82:83], v[18:19]
    v_rcp_f32 v200, v200
    v_rcp_f32 v201, v201
    v_rcp_f32 v202, v202
    v_rcp_f32 v203, v203
    v_pk_mul_f32 v[96:97], v[96:97], v[32:33]
    v_pk_mul_f32 v[98:99], v[98:99], v[34:35]
    v_pk_mul_f32 v[76:77], v[76:77], v[188:189]
    v_pk_mul_f32 v[78:79], v[78:79], v[190:191]
    v_pk_mul_f32 v[92:93], v[92:93], v[192:193]
    v_pk_mul_f32 v[94:95], v[94:95], v[194:195]
    v_pk_mul_f32 v[80:81], v[80:81], v[196:197]
    v_pk_mul_f32 v[82:83], v[82:83], v[198:199]
    v_pk_mul_f32 v[96:97], v[96:97], v[200:201]
    v_pk_mul_f32 v[98:99], v[98:99], v[202:203]
    v_cvt_pk_bf16_f32 v12, v76, v77
    v_cvt_pk_bf16_f32 v13, v78, v79
    v_cvt_pk_bf16_f32 v14, v92, v93
    v_cvt_pk_bf16_f32 v15, v94, v95
    buffer_store_dwordx4 v[12:15], v2, s[28:31], s45 offen offset:0 sc0 sc1
    v_cvt_pk_bf16_f32 v16, v80, v81
    v_cvt_pk_bf16_f32 v17, v82, v83
    v_cvt_pk_bf16_f32 v18, v96, v97
    v_cvt_pk_bf16_f32 v19, v98, v99
    buffer_store_dwordx4 v[16:19], v2, s[28:31], s45 offen offset:1024 sc0 sc1
    v_pk_fma_f32 v[20:21], v[140:141], v[182:183], v[20:21] op_sel_hi:[1,0,1]
    v_pk_fma_f32 v[22:23], v[142:143], v[182:183], v[22:23] op_sel_hi:[1,0,1]
    v_pk_fma_f32 v[36:37], v[144:145], v[182:183], v[36:37] op_sel_hi:[1,0,1]
    v_pk_fma_f32 v[38:39], v[146:147], v[182:183], v[38:39] op_sel_hi:[1,0,1]
    v_pk_fma_f32 v[24:25], v[140:141], v[186:187], v[24:25] op_sel_hi:[1,0,1]
    v_pk_fma_f32 v[26:27], v[142:143], v[186:187], v[26:27] op_sel_hi:[1,0,1]
    v_pk_fma_f32 v[40:41], v[144:145], v[186:187], v[40:41] op_sel_hi:[1,0,1]
    v_pk_fma_f32 v[42:43], v[146:147], v[186:187], v[42:43] op_sel_hi:[1,0,1]
    v_pk_mul_f32 v[204:205], v[20:21], v[20:21]
    v_pk_mul_f32 v[206:207], v[22:23], v[22:23]
    v_pk_mul_f32 v[208:209], v[36:37], v[36:37]
    v_pk_mul_f32 v[210:211], v[38:39], v[38:39]
    v_pk_mul_f32 v[212:213], v[24:25], v[24:25]
    v_pk_mul_f32 v[214:215], v[26:27], v[26:27]
    v_pk_mul_f32 v[216:217], v[40:41], v[40:41]
    v_pk_mul_f32 v[218:219], v[42:43], v[42:43]
    v_pk_fma_f32 v[204:205], v[204:205], v[224:225], v[180:181] op_sel_hi:[1,0,0]
    v_pk_fma_f32 v[206:207], v[206:207], v[224:225], v[180:181] op_sel_hi:[1,0,0]
    v_pk_fma_f32 v[208:209], v[208:209], v[224:225], v[180:181] op_sel_hi:[1,0,0]
    v_pk_fma_f32 v[210:211], v[210:211], v[224:225], v[180:181] op_sel_hi:[1,0,0]
    v_pk_fma_f32 v[212:213], v[212:213], v[226:227], v[184:185] op_sel_hi:[1,0,0]
    v_pk_fma_f32 v[214:215], v[214:215], v[226:227], v[184:185] op_sel_hi:[1,0,0]
    v_pk_fma_f32 v[216:217], v[216:217], v[226:227], v[184:185] op_sel_hi:[1,0,0]
    v_pk_fma_f32 v[218:219], v[218:219], v[226:227], v[184:185] op_sel_hi:[1,0,0]
    v_pk_mul_f32 v[204:205], v[204:205], v[20:21]
    v_pk_mul_f32 v[206:207], v[206:207], v[22:23]
    v_pk_mul_f32 v[208:209], v[208:209], v[36:37]
    v_pk_mul_f32 v[210:211], v[210:211], v[38:39]
    v_pk_mul_f32 v[212:213], v[212:213], v[24:25]
    v_pk_mul_f32 v[214:215], v[214:215], v[26:27]
    v_pk_mul_f32 v[216:217], v[216:217], v[40:41]
    v_pk_mul_f32 v[218:219], v[218:219], v[42:43]
    v_exp_f32 v204, v204
    v_exp_f32 v205, v205
    v_exp_f32 v206, v206
    v_exp_f32 v207, v207
    v_pk_fma_f32 v[84:85], v[156:157], v[182:183], v[84:85] op_sel_hi:[1,0,1]
    v_pk_fma_f32 v[86:87], v[158:159], v[182:183], v[86:87] op_sel_hi:[1,0,1]
    v_exp_f32 v208, v208
    v_exp_f32 v209, v209
    v_exp_f32 v210, v210
    v_exp_f32 v211, v211
    v_pk_fma_f32 v[100:101], v[160:161], v[182:183], v[100:101] op_sel_hi:[1,0,1]
    v_pk_fma_f32 v[102:103], v[162:163], v[182:183], v[102:103] op_sel_hi:[1,0,1]
    v_exp_f32 v212, v212
    v_exp_f32 v213, v213
    v_exp_f32 v214, v214
    v_exp_f32 v215, v215
    v_pk_fma_f32 v[88:89], v[156:157], v[186:187], v[88:89] op_sel_hi:[1,0,1]
    v_pk_fma_f32 v[90:91], v[158:159], v[186:187], v[90:91] op_sel_hi:[1,0,1]
    v_exp_f32 v216, v216
    v_exp_f32 v217, v217
    v_exp_f32 v218, v218
    v_exp_f32 v219, v219
    v_pk_fma_f32 v[104:105], v[160:161], v[186:187], v[104:105] op_sel_hi:[1,0,1]
    v_pk_fma_f32 v[106:107], v[162:163], v[186:187], v[106:107] op_sel_hi:[1,0,1]
    v_fma_f32 v204, v204, v181, v181
    v_fma_f32 v205, v205, v181, v181
    v_fma_f32 v206, v206, v181, v181
    v_fma_f32 v207, v207, v181, v181
    v_fma_f32 v208, v208, v181, v181
    v_fma_f32 v209, v209, v181, v181
    v_fma_f32 v210, v210, v181, v181
    v_fma_f32 v211, v211, v181, v181
    v_fma_f32 v212, v212, v185, v185
    v_fma_f32 v213, v213, v185, v185
    v_fma_f32 v214, v214, v185, v185
    v_fma_f32 v215, v215, v185, v185
    v_fma_f32 v216, v216, v185, v185
    v_fma_f32 v217, v217, v185, v185
    v_fma_f32 v218, v218, v185, v185
    v_fma_f32 v219, v219, v185, v185
    v_rcp_f32 v204, v204
    v_rcp_f32 v205, v205
    v_rcp_f32 v206, v206
    v_rcp_f32 v207, v207
    v_pk_mul_f32 v[84:85], v[84:85], v[20:21]
    v_pk_mul_f32 v[86:87], v[86:87], v[22:23]
    v_rcp_f32 v208, v208
    v_rcp_f32 v209, v209
    v_rcp_f32 v210, v210
    v_rcp_f32 v211, v211
    v_pk_mul_f32 v[100:101], v[100:101], v[36:37]
    v_pk_mul_f32 v[102:103], v[102:103], v[38:39]
    v_rcp_f32 v212, v212
    v_rcp_f32 v213, v213
    v_rcp_f32 v214, v214
    v_rcp_f32 v215, v215
    v_pk_mul_f32 v[88:89], v[88:89], v[24:25]
    v_pk_mul_f32 v[90:91], v[90:91], v[26:27]
    v_rcp_f32 v216, v216
    v_rcp_f32 v217, v217
    v_rcp_f32 v218, v218
    v_rcp_f32 v219, v219
    v_pk_mul_f32 v[104:105], v[104:105], v[40:41]
    v_pk_mul_f32 v[106:107], v[106:107], v[42:43]
    v_pk_mul_f32 v[84:85], v[84:85], v[204:205]
    v_pk_mul_f32 v[86:87], v[86:87], v[206:207]
    v_pk_mul_f32 v[100:101], v[100:101], v[208:209]
    v_pk_mul_f32 v[102:103], v[102:103], v[210:211]
    v_pk_mul_f32 v[88:89], v[88:89], v[212:213]
    v_pk_mul_f32 v[90:91], v[90:91], v[214:215]
    v_pk_mul_f32 v[104:105], v[104:105], v[216:217]
    v_pk_mul_f32 v[106:107], v[106:107], v[218:219]
    v_cvt_pk_bf16_f32 v20, v84, v85
    v_cvt_pk_bf16_f32 v21, v86, v87
    v_cvt_pk_bf16_f32 v22, v100, v101
    v_cvt_pk_bf16_f32 v23, v102, v103
    buffer_store_dwordx4 v[20:23], v2, s[28:31], s45 offen offset:2048 sc0 sc1
    v_cvt_pk_bf16_f32 v24, v88, v89
    v_cvt_pk_bf16_f32 v25, v90, v91
    v_cvt_pk_bf16_f32 v26, v104, v105
    v_cvt_pk_bf16_f32 v27, v106, v107
    buffer_store_dwordx4 v[24:27], v2, s[28:31], s45 offen offset:3072 sc0 sc1
    s_add_u32 s45, s45, 7340032
    v_pk_fma_f32 v[44:45], v[148:149], v[174:175], v[44:45] op_sel_hi:[1,0,1]
    v_pk_fma_f32 v[46:47], v[150:151], v[174:175], v[46:47] op_sel_hi:[1,0,1]
    v_pk_fma_f32 v[60:61], v[152:153], v[174:175], v[60:61] op_sel_hi:[1,0,1]
    v_pk_fma_f32 v[62:63], v[154:155], v[174:175], v[62:63] op_sel_hi:[1,0,1]
    v_pk_fma_f32 v[48:49], v[148:149], v[178:179], v[48:49] op_sel_hi:[1,0,1]
    v_pk_fma_f32 v[50:51], v[150:151], v[178:179], v[50:51] op_sel_hi:[1,0,1]
    v_pk_fma_f32 v[64:65], v[152:153], v[178:179], v[64:65] op_sel_hi:[1,0,1]
    v_pk_fma_f32 v[66:67], v[154:155], v[178:179], v[66:67] op_sel_hi:[1,0,1]
    v_pk_mul_f32 v[188:189], v[44:45], v[44:45]
    v_pk_mul_f32 v[190:191], v[46:47], v[46:47]
    v_pk_mul_f32 v[192:193], v[60:61], v[60:61]
    v_pk_mul_f32 v[194:195], v[62:63], v[62:63]
    v_pk_mul_f32 v[196:197], v[48:49], v[48:49]
    v_pk_mul_f32 v[198:199], v[50:51], v[50:51]
    v_pk_mul_f32 v[200:201], v[64:65], v[64:65]
    v_pk_mul_f32 v[202:203], v[66:67], v[66:67]
    v_pk_fma_f32 v[188:189], v[188:189], v[220:221], v[172:173] op_sel_hi:[1,0,0]
    v_pk_fma_f32 v[190:191], v[190:191], v[220:221], v[172:173] op_sel_hi:[1,0,0]
    v_pk_fma_f32 v[192:193], v[192:193], v[220:221], v[172:173] op_sel_hi:[1,0,0]
    v_pk_fma_f32 v[194:195], v[194:195], v[220:221], v[172:173] op_sel_hi:[1,0,0]
    v_pk_fma_f32 v[196:197], v[196:197], v[222:223], v[176:177] op_sel_hi:[1,0,0]
    v_pk_fma_f32 v[198:199], v[198:199], v[222:223], v[176:177] op_sel_hi:[1,0,0]
    v_pk_fma_f32 v[200:201], v[200:201], v[222:223], v[176:177] op_sel_hi:[1,0,0]
    v_pk_fma_f32 v[202:203], v[202:203], v[222:223], v[176:177] op_sel_hi:[1,0,0]
    v_pk_mul_f32 v[188:189], v[188:189], v[44:45]
    v_pk_mul_f32 v[190:191], v[190:191], v[46:47]
    v_pk_mul_f32 v[192:193], v[192:193], v[60:61]
    v_pk_mul_f32 v[194:195], v[194:195], v[62:63]
    v_pk_mul_f32 v[196:197], v[196:197], v[48:49]
    v_pk_mul_f32 v[198:199], v[198:199], v[50:51]
    v_pk_mul_f32 v[200:201], v[200:201], v[64:65]
    v_pk_mul_f32 v[202:203], v[202:203], v[66:67]
    v_exp_f32 v188, v188
    v_exp_f32 v189, v189
    v_exp_f32 v190, v190
    v_exp_f32 v191, v191
    v_pk_fma_f32 v[108:109], v[164:165], v[174:175], v[108:109] op_sel_hi:[1,0,1]
    v_pk_fma_f32 v[110:111], v[166:167], v[174:175], v[110:111] op_sel_hi:[1,0,1]
    v_exp_f32 v192, v192
    v_exp_f32 v193, v193
    v_exp_f32 v194, v194
    v_exp_f32 v195, v195
    v_pk_fma_f32 v[124:125], v[168:169], v[174:175], v[124:125] op_sel_hi:[1,0,1]
    v_pk_fma_f32 v[126:127], v[170:171], v[174:175], v[126:127] op_sel_hi:[1,0,1]
    v_exp_f32 v196, v196
    v_exp_f32 v197, v197
    v_exp_f32 v198, v198
    v_exp_f32 v199, v199
    v_pk_fma_f32 v[112:113], v[164:165], v[178:179], v[112:113] op_sel_hi:[1,0,1]
    v_pk_fma_f32 v[114:115], v[166:167], v[178:179], v[114:115] op_sel_hi:[1,0,1]
    v_exp_f32 v200, v200
    v_exp_f32 v201, v201
    v_exp_f32 v202, v202
    v_exp_f32 v203, v203
    v_pk_fma_f32 v[128:129], v[168:169], v[178:179], v[128:129] op_sel_hi:[1,0,1]
    v_pk_fma_f32 v[130:131], v[170:171], v[178:179], v[130:131] op_sel_hi:[1,0,1]
    v_fma_f32 v188, v188, v173, v173
    v_fma_f32 v189, v189, v173, v173
    v_fma_f32 v190, v190, v173, v173
    v_fma_f32 v191, v191, v173, v173
    v_fma_f32 v192, v192, v173, v173
    v_fma_f32 v193, v193, v173, v173
    v_fma_f32 v194, v194, v173, v173
    v_fma_f32 v195, v195, v173, v173
    v_fma_f32 v196, v196, v177, v177
    v_fma_f32 v197, v197, v177, v177
    v_fma_f32 v198, v198, v177, v177
    v_fma_f32 v199, v199, v177, v177
    v_fma_f32 v200, v200, v177, v177
    v_fma_f32 v201, v201, v177, v177
    v_fma_f32 v202, v202, v177, v177
    v_fma_f32 v203, v203, v177, v177
    v_rcp_f32 v188, v188
    v_rcp_f32 v189, v189
    v_rcp_f32 v190, v190
    v_rcp_f32 v191, v191
    v_pk_mul_f32 v[108:109], v[108:109], v[44:45]
    v_pk_mul_f32 v[110:111], v[110:111], v[46:47]
    v_rcp_f32 v192, v192
    v_rcp_f32 v193, v193
    v_rcp_f32 v194, v194
    v_rcp_f32 v195, v195
    v_pk_mul_f32 v[124:125], v[124:125], v[60:61]
    v_pk_mul_f32 v[126:127], v[126:127], v[62:63]
    v_rcp_f32 v196, v196
    v_rcp_f32 v197, v197
    v_rcp_f32 v198, v198
    v_rcp_f32 v199, v199
    v_pk_mul_f32 v[112:113], v[112:113], v[48:49]
    v_pk_mul_f32 v[114:115], v[114:115], v[50:51]
    v_rcp_f32 v200, v200
    v_rcp_f32 v201, v201
    v_rcp_f32 v202, v202
    v_rcp_f32 v203, v203
    v_pk_mul_f32 v[128:129], v[128:129], v[64:65]
    v_pk_mul_f32 v[130:131], v[130:131], v[66:67]
    v_pk_mul_f32 v[108:109], v[108:109], v[188:189]
    v_pk_mul_f32 v[110:111], v[110:111], v[190:191]
    v_pk_mul_f32 v[124:125], v[124:125], v[192:193]
    v_pk_mul_f32 v[126:127], v[126:127], v[194:195]
    v_pk_mul_f32 v[112:113], v[112:113], v[196:197]
    v_pk_mul_f32 v[114:115], v[114:115], v[198:199]
    v_pk_mul_f32 v[128:129], v[128:129], v[200:201]
    v_pk_mul_f32 v[130:131], v[130:131], v[202:203]
    v_cvt_pk_bf16_f32 v44, v108, v109
    v_cvt_pk_bf16_f32 v45, v110, v111
    v_cvt_pk_bf16_f32 v46, v124, v125
    v_cvt_pk_bf16_f32 v47, v126, v127
    buffer_store_dwordx4 v[44:47], v2, s[28:31], s45 offen offset:0 sc0 sc1
    v_cvt_pk_bf16_f32 v48, v112, v113
    v_cvt_pk_bf16_f32 v49, v114, v115
    v_cvt_pk_bf16_f32 v50, v128, v129
    v_cvt_pk_bf16_f32 v51, v130, v131
    buffer_store_dwordx4 v[48:51], v2, s[28:31], s45 offen offset:1024 sc0 sc1
    s_waitcnt vmcnt(2)
    s_mov_b64 exec, 1
    ds_add_rtn_u32 v236, v3, v4
    s_mov_b64 exec, -1
    s_lshl_b32 s62, s41, 12
    s_lshl_b32 s75, s42, 7
    s_add_u32 s62, s62, s75
    s_add_u32 s74, s62, 393216
    s_add_u32 s62, s62, 524288
    s_waitcnt lgkmcnt(0)
    v_readfirstlane_b32 s75, v236
    s_nop 0
    s_cmp_lg_u32 s75, 7
    s_cbranch_scc1 interleave_layers__linear_kernel_hedgehog__geglu_ffn__prompt_kernel_nfa42
    v_mov_b32 v239, 0
    v_mov_b32 v240, s60
    s_mov_b64 exec, 1
    buffer_store_dword v240, v239, s[56:59], s74 offen sc0 sc1
    s_mov_b64 exec, -1
interleave_layers__linear_kernel_hedgehog__geglu_ffn__prompt_kernel_nfa42:
    s_nop 0
    v_pk_fma_f32 v[52:53], v[148:149], v[182:183], v[52:53] op_sel_hi:[1,0,1]
    v_pk_fma_f32 v[54:55], v[150:151], v[182:183], v[54:55] op_sel_hi:[1,0,1]
    v_pk_fma_f32 v[68:69], v[152:153], v[182:183], v[68:69] op_sel_hi:[1,0,1]
    v_pk_fma_f32 v[70:71], v[154:155], v[182:183], v[70:71] op_sel_hi:[1,0,1]
    v_pk_fma_f32 v[56:57], v[148:149], v[186:187], v[56:57] op_sel_hi:[1,0,1]
    v_pk_fma_f32 v[58:59], v[150:151], v[186:187], v[58:59] op_sel_hi:[1,0,1]
    v_pk_fma_f32 v[72:73], v[152:153], v[186:187], v[72:73] op_sel_hi:[1,0,1]
    v_pk_fma_f32 v[74:75], v[154:155], v[186:187], v[74:75] op_sel_hi:[1,0,1]
    v_pk_mul_f32 v[204:205], v[52:53], v[52:53]
    v_pk_mul_f32 v[206:207], v[54:55], v[54:55]
    v_pk_mul_f32 v[208:209], v[68:69], v[68:69]
    v_pk_mul_f32 v[210:211], v[70:71], v[70:71]
    v_pk_mul_f32 v[212:213], v[56:57], v[56:57]
    v_pk_mul_f32 v[214:215], v[58:59], v[58:59]
    v_pk_mul_f32 v[216:217], v[72:73], v[72:73]
    v_pk_mul_f32 v[218:219], v[74:75], v[74:75]
    v_pk_fma_f32 v[204:205], v[204:205], v[224:225], v[180:181] op_sel_hi:[1,0,0]
    v_pk_fma_f32 v[206:207], v[206:207], v[224:225], v[180:181] op_sel_hi:[1,0,0]
    v_pk_fma_f32 v[208:209], v[208:209], v[224:225], v[180:181] op_sel_hi:[1,0,0]
    v_pk_fma_f32 v[210:211], v[210:211], v[224:225], v[180:181] op_sel_hi:[1,0,0]
    v_pk_fma_f32 v[212:213], v[212:213], v[226:227], v[184:185] op_sel_hi:[1,0,0]
    v_pk_fma_f32 v[214:215], v[214:215], v[226:227], v[184:185] op_sel_hi:[1,0,0]
    v_pk_fma_f32 v[216:217], v[216:217], v[226:227], v[184:185] op_sel_hi:[1,0,0]
    v_pk_fma_f32 v[218:219], v[218:219], v[226:227], v[184:185] op_sel_hi:[1,0,0]
    v_pk_mul_f32 v[204:205], v[204:205], v[52:53]
    v_pk_mul_f32 v[206:207], v[206:207], v[54:55]
    v_pk_mul_f32 v[208:209], v[208:209], v[68:69]
    v_pk_mul_f32 v[210:211], v[210:211], v[70:71]
    v_pk_mul_f32 v[212:213], v[212:213], v[56:57]
    v_pk_mul_f32 v[214:215], v[214:215], v[58:59]
    v_pk_mul_f32 v[216:217], v[216:217], v[72:73]
    v_pk_mul_f32 v[218:219], v[218:219], v[74:75]
    v_exp_f32 v204, v204
    v_exp_f32 v205, v205
    v_exp_f32 v206, v206
    v_exp_f32 v207, v207
    v_pk_fma_f32 v[116:117], v[164:165], v[182:183], v[116:117] op_sel_hi:[1,0,1]
    v_pk_fma_f32 v[118:119], v[166:167], v[182:183], v[118:119] op_sel_hi:[1,0,1]
    v_exp_f32 v208, v208
    v_exp_f32 v209, v209
    v_exp_f32 v210, v210
    v_exp_f32 v211, v211
    v_pk_fma_f32 v[132:133], v[168:169], v[182:183], v[132:133] op_sel_hi:[1,0,1]
    v_pk_fma_f32 v[134:135], v[170:171], v[182:183], v[134:135] op_sel_hi:[1,0,1]
    v_exp_f32 v212, v212
    v_exp_f32 v213, v213
    v_exp_f32 v214, v214
    v_exp_f32 v215, v215
    v_pk_fma_f32 v[120:121], v[164:165], v[186:187], v[120:121] op_sel_hi:[1,0,1]
    v_pk_fma_f32 v[122:123], v[166:167], v[186:187], v[122:123] op_sel_hi:[1,0,1]
    v_exp_f32 v216, v216
    v_exp_f32 v217, v217
    v_exp_f32 v218, v218
    v_exp_f32 v219, v219
    v_pk_fma_f32 v[136:137], v[168:169], v[186:187], v[136:137] op_sel_hi:[1,0,1]
    v_pk_fma_f32 v[138:139], v[170:171], v[186:187], v[138:139] op_sel_hi:[1,0,1]
    v_fma_f32 v204, v204, v181, v181
    v_fma_f32 v205, v205, v181, v181
    v_fma_f32 v206, v206, v181, v181
    v_fma_f32 v207, v207, v181, v181
    v_fma_f32 v208, v208, v181, v181
    v_fma_f32 v209, v209, v181, v181
    v_fma_f32 v210, v210, v181, v181
    v_fma_f32 v211, v211, v181, v181
    v_fma_f32 v212, v212, v185, v185
    v_fma_f32 v213, v213, v185, v185
    v_fma_f32 v214, v214, v185, v185
    v_fma_f32 v215, v215, v185, v185
    v_fma_f32 v216, v216, v185, v185
    v_fma_f32 v217, v217, v185, v185
    v_fma_f32 v218, v218, v185, v185
    v_fma_f32 v219, v219, v185, v185
    v_rcp_f32 v204, v204
    v_rcp_f32 v205, v205
    v_rcp_f32 v206, v206
    v_rcp_f32 v207, v207
    v_pk_mul_f32 v[116:117], v[116:117], v[52:53]
    v_pk_mul_f32 v[118:119], v[118:119], v[54:55]
    v_rcp_f32 v208, v208
    v_rcp_f32 v209, v209
    v_rcp_f32 v210, v210
    v_rcp_f32 v211, v211
    v_pk_mul_f32 v[132:133], v[132:133], v[68:69]
    v_pk_mul_f32 v[134:135], v[134:135], v[70:71]
    v_rcp_f32 v212, v212
    v_rcp_f32 v213, v213
    v_rcp_f32 v214, v214
    v_rcp_f32 v215, v215
    v_pk_mul_f32 v[120:121], v[120:121], v[56:57]
    v_pk_mul_f32 v[122:123], v[122:123], v[58:59]
    v_rcp_f32 v216, v216
    v_rcp_f32 v217, v217
    v_rcp_f32 v218, v218
    v_rcp_f32 v219, v219
    v_pk_mul_f32 v[136:137], v[136:137], v[72:73]
    v_pk_mul_f32 v[138:139], v[138:139], v[74:75]
    v_pk_mul_f32 v[116:117], v[116:117], v[204:205]
    v_pk_mul_f32 v[118:119], v[118:119], v[206:207]
    v_pk_mul_f32 v[132:133], v[132:133], v[208:209]
    v_pk_mul_f32 v[134:135], v[134:135], v[210:211]
    v_pk_mul_f32 v[120:121], v[120:121], v[212:213]
    v_pk_mul_f32 v[122:123], v[122:123], v[214:215]
    v_pk_mul_f32 v[136:137], v[136:137], v[216:217]
    v_pk_mul_f32 v[138:139], v[138:139], v[218:219]
    v_cvt_pk_bf16_f32 v52, v116, v117
    v_cvt_pk_bf16_f32 v53, v118, v119
    v_cvt_pk_bf16_f32 v54, v132, v133
    v_cvt_pk_bf16_f32 v55, v134, v135
    buffer_store_dwordx4 v[52:55], v2, s[28:31], s45 offen offset:2048 sc0 sc1
    v_cvt_pk_bf16_f32 v56, v120, v121
    v_cvt_pk_bf16_f32 v57, v122, v123
    v_cvt_pk_bf16_f32 v58, v136, v137
    v_cvt_pk_bf16_f32 v59, v138, v139
    buffer_store_dwordx4 v[56:59], v2, s[28:31], s45 offen offset:3072 sc0 sc1
interleave_layers__linear_kernel_hedgehog__geglu_ffn__prompt_kernel_spin343:
    ds_read_b32 v236, v3
    s_waitcnt lgkmcnt(0)
    v_readfirstlane_b32 s75, v236
    s_nop 0
    s_cmp_lt_u32 s75, 8
    s_cbranch_scc1 interleave_layers__linear_kernel_hedgehog__geglu_ffn__prompt_kernel_spin343
    s_branch mega_ph3
interleave_layers__linear_kernel_hedgehog__geglu_ffn__prompt_kernel_slowfc40:
    s_mov_b32 exec_lo, 0xffffffff
    s_mov_b32 exec_hi, 0xffffffff
    .long 0xbeca00ff, 0x0
interleave_layers__linear_kernel_hedgehog__geglu_ffn__prompt_kernel_poll44:
    buffer_load_dword v244, v236, s[56:59], 0 offen sc1
    s_add_u32 s74, s74, 1
    s_waitcnt vmcnt(0)
    v_cmp_ne_u32 vcc, s60, v244
    s_nop 0
    s_cmp_eq_u64 vcc, 0
    s_cbranch_scc1 interleave_layers__linear_kernel_hedgehog__geglu_ffn__prompt_kernel_polled45
    s_mov_b64 exec, vcc
    s_sleep 4
    s_cmp_lt_u32 s74, 50000
    s_cbranch_scc1 interleave_layers__linear_kernel_hedgehog__geglu_ffn__prompt_kernel_poll44
interleave_layers__linear_kernel_hedgehog__geglu_ffn__prompt_kernel_polled45:
    s_mov_b64 exec, -1
    s_branch interleave_layers__linear_kernel_hedgehog__geglu_ffn__prompt_kernel_backfc41
interleave_layers__linear_kernel_hedgehog__geglu_ffn__prompt_kernel_side34:
    s_lshl_b32 s41, s2, 3
    s_add_u32 s41, s41, s40
    s_lshr_b32 s42, s41, 4
    s_and_b32 s41, s41, 15
    s_and_b32 s43, s42, 7
    s_mul_i32 s44, s43, 917504
    s_lshr_b32 s43, s42, 3
    s_lshl_b32 s43, s43, 16
    s_add_u32 s44, s44, s43
    .long 0x8e2bff29, 0x7
    s_add_u32 s44, s44, s43
    s_movk_i32 s45, 16384
    s_movk_i32 s47, 2048
    s_mul_i32 s48, s41, 458752
    s_mul_i32 s43, s42, 28672
    s_add_u32 s48, s48, s43
    s_lshl_b32 s46, s40, 14
    s_mov_b32 s4, s72
    s_mov_b32 s5, s73
    s_mov_b32 s6, 0x700000
    s_mov_b32 s7, 0x00020000
    s_add_u32 s8, s68, 0x5700000
    .long 0x8209ff45, 0x0
    s_mov_b32 s10, 0x700000
    s_mov_b32 s11, 0x00020000
    v_lshrrev_b32 v3, 3, v0
    v_and_b32 v3, 6, v3
    v_xor_b32 v3, v3, v0
    v_and_b32 v3, 7, v3
    v_lshlrev_b32 v3, 4, v3
    v_lshrrev_b32 v4, 3, v0
    v_mul_u32_u24 v4, s47, v4
    v_add_u32 v2, v3, v4
    s_add_u32 m0, s46, 0
    s_nop 0
    buffer_load_dwordx4 v2, s[4:7], s44 offen nt lds
    s_add_u32 m0, s46, 1024
    s_add_u32 s44, s44, s45
    buffer_load_dwordx4 v2, s[4:7], s44 offen nt lds
    s_add_u32 m0, s46, 2048
    s_add_u32 s44, s44, s45
    buffer_load_dwordx4 v2, s[4:7], s44 offen nt lds
    s_add_u32 m0, s46, 3072
    s_add_u32 s44, s44, s45
    buffer_load_dwordx4 v2, s[4:7], s44 offen nt lds
    s_add_u32 m0, s46, 4096
    s_add_u32 s44, s44, s45
    s_add_u32 s44, s44, 65536
    buffer_load_dwordx4 v2, s[4:7], s44 offen nt lds
    s_add_u32 m0, s46, 5120
    s_add_u32 s44, s44, s45
    buffer_load_dwordx4 v2, s[4:7], s44 offen nt lds
    s_add_u32 m0, s46, 6144
    s_add_u32 s44, s44, s45
    buffer_load_dwordx4 v2, s[4:7], s44 offen nt lds
    s_add_u32 m0, s46, 7168
    s_add_u32 s44, s44, s45
    buffer_load_dwordx4 v2, s[4:7], s44 offen nt lds
    s_add_u32 m0, s46, 8192
    s_add_u32 s44, s44, s45
    s_add_u32 s44, s44, 65536
    buffer_load_dwordx4 v2, s[4:7], s44 offen nt lds
    s_add_u32 m0, s46, 9216
    s_add_u32 s44, s44, s45
    buffer_load_dwordx4 v2, s[4:7], s44 offen nt lds
    s_add_u32 m0, s46, 10240
    s_add_u32 s44, s44, s45
    buffer_load_dwordx4 v2, s[4:7], s44 offen nt lds
    s_add_u32 m0, s46, 11264
    s_add_u32 s44, s44, s45
    buffer_load_dwordx4 v2, s[4:7], s44 offen nt lds
    s_add_u32 m0, s46, 12288
    s_add_u32 s44, s44, s45
    s_add_u32 s44, s44, 65536
    buffer_load_dwordx4 v2, s[4:7], s44 offen nt lds
    s_add_u32 m0, s46, 13312
    s_add_u32 s44, s44, s45
    buffer_load_dwordx4 v2, s[4:7], s44 offen nt lds
    s_add_u32 m0, s46, 14336
    s_add_u32 s44, s44, s45
    buffer_load_dwordx4 v2, s[4:7], s44 offen nt lds
    s_add_u32 m0, s46, 15360
    s_add_u32 s44, s44, s45
    buffer_load_dwordx4 v2, s[4:7], s44 offen nt lds
    v_lshrrev_b32 v5, 2, v0
    v_lshlrev_b32 v3, 7, v5
    v_and_b32 v4, 3, v0
    v_lshl_add_u32 v3, v4, 3, v3
    v_bfe_u32 v4, v0, 3, 2
    v_add_u32 v3, s46, v3
    v_xor_b32 v5, 0, v4
    v_lshl_add_u32 v5, v5, 5, v3
    v_xor_b32_e64 v6, 1, v4
    v_lshl_add_u32 v6, v6, 5, v3
    v_xor_b32_e64 v7, 2, v4
    v_lshl_add_u32 v7, v7, 5, v3
    v_xor_b32_e64 v8, 3, v4
    v_lshl_add_u32 v8, v8, 5, v3
    v_lshlrev_b32 v3, 4, v0
    s_waitcnt vmcnt(12)
    ds_read_b64_tr_b16 v[12:13], v5 offset:0
    ds_read_b64_tr_b16 v[14:15], v5 offset:2048
    ds_read_b64_tr_b16 v[16:17], v6 offset:0
    ds_read_b64_tr_b16 v[18:19], v6 offset:2048
    ds_read_b64_tr_b16 v[20:21], v7 offset:0
    ds_read_b64_tr_b16 v[22:23], v7 offset:2048
    ds_read_b64_tr_b16 v[24:25], v8 offset:0
    ds_read_b64_tr_b16 v[26:27], v8 offset:2048
    s_waitcnt lgkmcnt(0)
    buffer_store_dwordx4 v[12:15], v3, s[8:11], s48 offen offset:0 sc0 sc1
    buffer_store_dwordx4 v[16:19], v3, s[8:11], s48 offen offset:1024 sc0 sc1
    buffer_store_dwordx4 v[20:23], v3, s[8:11], s48 offen offset:2048 sc0 sc1
    buffer_store_dwordx4 v[24:27], v3, s[8:11], s48 offen offset:3072 sc0 sc1
    s_add_u32 s48, s48, 4096
    s_waitcnt vmcnt(12)
    ds_read_b64_tr_b16 v[28:29], v5 offset:4096
    ds_read_b64_tr_b16 v[30:31], v5 offset:6144
    ds_read_b64_tr_b16 v[32:33], v6 offset:4096
    ds_read_b64_tr_b16 v[34:35], v6 offset:6144
    ds_read_b64_tr_b16 v[36:37], v7 offset:4096
    ds_read_b64_tr_b16 v[38:39], v7 offset:6144
    ds_read_b64_tr_b16 v[40:41], v8 offset:4096
    ds_read_b64_tr_b16 v[42:43], v8 offset:6144
    s_waitcnt lgkmcnt(0)
    buffer_store_dwordx4 v[28:31], v3, s[8:11], s48 offen offset:0 sc0 sc1
    buffer_store_dwordx4 v[32:35], v3, s[8:11], s48 offen offset:1024 sc0 sc1
    buffer_store_dwordx4 v[36:39], v3, s[8:11], s48 offen offset:2048 sc0 sc1
    buffer_store_dwordx4 v[40:43], v3, s[8:11], s48 offen offset:3072 sc0 sc1
    s_add_u32 s48, s48, 4096
    s_waitcnt vmcnt(12)
    ds_read_b64_tr_b16 v[44:45], v5 offset:8192
    ds_read_b64_tr_b16 v[46:47], v5 offset:10240
    ds_read_b64_tr_b16 v[48:49], v6 offset:8192
    ds_read_b64_tr_b16 v[50:51], v6 offset:10240
    ds_read_b64_tr_b16 v[52:53], v7 offset:8192
    ds_read_b64_tr_b16 v[54:55], v7 offset:10240
    ds_read_b64_tr_b16 v[56:57], v8 offset:8192
    ds_read_b64_tr_b16 v[58:59], v8 offset:10240
    s_waitcnt lgkmcnt(0)
    buffer_store_dwordx4 v[44:47], v3, s[8:11], s48 offen offset:0 sc0 sc1
    buffer_store_dwordx4 v[48:51], v3, s[8:11], s48 offen offset:1024 sc0 sc1
    buffer_store_dwordx4 v[52:55], v3, s[8:11], s48 offen offset:2048 sc0 sc1
    buffer_store_dwordx4 v[56:59], v3, s[8:11], s48 offen offset:3072 sc0 sc1
    s_add_u32 s48, s48, 4096
    s_waitcnt vmcnt(12)
    ds_read_b64_tr_b16 v[60:61], v5 offset:12288
    ds_read_b64_tr_b16 v[62:63], v5 offset:14336
    ds_read_b64_tr_b16 v[64:65], v6 offset:12288
    ds_read_b64_tr_b16 v[66:67], v6 offset:14336
    ds_read_b64_tr_b16 v[68:69], v7 offset:12288
    ds_read_b64_tr_b16 v[70:71], v7 offset:14336
    ds_read_b64_tr_b16 v[72:73], v8 offset:12288
    ds_read_b64_tr_b16 v[74:75], v8 offset:14336
    s_waitcnt lgkmcnt(0)
    s_nop 0
    buffer_store_dwordx4 v[60:63], v3, s[8:11], s48 offen offset:0 sc0 sc1
    buffer_store_dwordx4 v[64:67], v3, s[8:11], s48 offen offset:1024 sc0 sc1
    buffer_store_dwordx4 v[68:71], v3, s[8:11], s48 offen offset:2048 sc0 sc1
    buffer_store_dwordx4 v[72:75], v3, s[8:11], s48 offen offset:3072 sc0 sc1
    s_add_u32 s44, s44, 81920
    s_add_u32 s48, s48, 4096
    s_waitcnt vmcnt(0)
    v_lshrrev_b32 v3, 3, v0
    v_and_b32 v3, 6, v3
    v_xor_b32 v3, v3, v0
    v_and_b32 v3, 7, v3
    v_lshlrev_b32 v3, 4, v3
    v_lshrrev_b32 v4, 3, v0
    v_mul_u32_u24 v4, s47, v4
    v_add_u32_e64 v2, v3, v4
    s_add_u32 m0, s46, 0
    s_nop 0
    buffer_load_dwordx4 v2, s[4:7], s44 offen nt lds
    s_add_u32 m0, s46, 1024
    s_add_u32 s44, s44, s45
    buffer_load_dwordx4 v2, s[4:7], s44 offen nt lds
    s_add_u32 m0, s46, 2048
    s_add_u32 s44, s44, s45
    buffer_load_dwordx4 v2, s[4:7], s44 offen nt lds
    s_add_u32 m0, s46, 3072
    s_add_u32 s44, s44, s45
    buffer_load_dwordx4 v2, s[4:7], s44 offen nt lds
    s_add_u32 m0, s46, 4096
    s_add_u32 s44, s44, s45
    s_add_u32 s44, s44, 65536
    buffer_load_dwordx4 v2, s[4:7], s44 offen nt lds
    s_add_u32 m0, s46, 5120
    s_add_u32 s44, s44, s45
    buffer_load_dwordx4 v2, s[4:7], s44 offen nt lds
    s_add_u32 m0, s46, 6144
    s_add_u32 s44, s44, s45
    buffer_load_dwordx4 v2, s[4:7], s44 offen nt lds
    s_add_u32 m0, s46, 7168
    s_add_u32 s44, s44, s45
    buffer_load_dwordx4 v2, s[4:7], s44 offen nt lds
    s_add_u32 m0, s46, 8192
    s_add_u32 s44, s44, s45
    s_add_u32 s44, s44, 65536
    buffer_load_dwordx4 v2, s[4:7], s44 offen nt lds
    s_add_u32 m0, s46, 9216
    s_add_u32 s44, s44, s45
    buffer_load_dwordx4 v2, s[4:7], s44 offen nt lds
    s_add_u32 m0, s46, 10240
    s_add_u32 s44, s44, s45
    buffer_load_dwordx4 v2, s[4:7], s44 offen nt lds
    s_add_u32 m0, s46, 11264
    s_add_u32 s44, s44, s45
    buffer_load_dwordx4 v2, s[4:7], s44 offen nt lds
    v_lshrrev_b32 v5, 2, v0
    v_lshlrev_b32 v3, 7, v5
    v_and_b32 v4, 3, v0
    v_lshl_add_u32 v3, v4, 3, v3
    v_bfe_u32 v4, v0, 3, 2
    v_add_u32 v3, s46, v3
    v_xor_b32 v5, 0, v4
    v_lshl_add_u32 v5, v5, 5, v3
    v_xor_b32_e64 v6, 1, v4
    v_lshl_add_u32 v6, v6, 5, v3
    v_xor_b32_e64 v7, 2, v4
    v_lshl_add_u32 v7, v7, 5, v3
    v_xor_b32_e64 v8, 3, v4
    v_lshl_add_u32 v8, v8, 5, v3
    v_lshlrev_b32 v3, 4, v0
    s_waitcnt vmcnt(8)
    ds_read_b64_tr_b16 v[12:13], v5 offset:0
    ds_read_b64_tr_b16 v[14:15], v5 offset:2048
    ds_read_b64_tr_b16 v[16:17], v6 offset:0
    ds_read_b64_tr_b16 v[18:19], v6 offset:2048
    ds_read_b64_tr_b16 v[20:21], v7 offset:0
    ds_read_b64_tr_b16 v[22:23], v7 offset:2048
    ds_read_b64_tr_b16 v[24:25], v8 offset:0
    ds_read_b64_tr_b16 v[26:27], v8 offset:2048
    s_waitcnt lgkmcnt(0)
    buffer_store_dwordx4 v[12:15], v3, s[8:11], s48 offen offset:0 sc0 sc1
    buffer_store_dwordx4 v[16:19], v3, s[8:11], s48 offen offset:1024 sc0 sc1
    buffer_store_dwordx4 v[20:23], v3, s[8:11], s48 offen offset:2048 sc0 sc1
    buffer_store_dwordx4 v[24:27], v3, s[8:11], s48 offen offset:3072 sc0 sc1
    s_add_u32 s48, s48, 4096
    s_waitcnt vmcnt(8)
    ds_read_b64_tr_b16 v[28:29], v5 offset:4096
    ds_read_b64_tr_b16 v[30:31], v5 offset:6144
    ds_read_b64_tr_b16 v[32:33], v6 offset:4096
    ds_read_b64_tr_b16 v[34:35], v6 offset:6144
    ds_read_b64_tr_b16 v[36:37], v7 offset:4096
    ds_read_b64_tr_b16 v[38:39], v7 offset:6144
    ds_read_b64_tr_b16 v[40:41], v8 offset:4096
    ds_read_b64_tr_b16 v[42:43], v8 offset:6144
    s_waitcnt lgkmcnt(0)
    buffer_store_dwordx4 v[28:31], v3, s[8:11], s48 offen offset:0 sc0 sc1
    buffer_store_dwordx4 v[32:35], v3, s[8:11], s48 offen offset:1024 sc0 sc1
    buffer_store_dwordx4 v[36:39], v3, s[8:11], s48 offen offset:2048 sc0 sc1
    buffer_store_dwordx4 v[40:43], v3, s[8:11], s48 offen offset:3072 sc0 sc1
    s_add_u32 s48, s48, 4096
    s_waitcnt vmcnt(8)
    ds_read_b64_tr_b16 v[44:45], v5 offset:8192
    ds_read_b64_tr_b16 v[46:47], v5 offset:10240
    ds_read_b64_tr_b16 v[48:49], v6 offset:8192
    ds_read_b64_tr_b16 v[50:51], v6 offset:10240
    ds_read_b64_tr_b16 v[52:53], v7 offset:8192
    ds_read_b64_tr_b16 v[54:55], v7 offset:10240
    ds_read_b64_tr_b16 v[56:57], v8 offset:8192
    ds_read_b64_tr_b16 v[58:59], v8 offset:10240
    s_waitcnt lgkmcnt(0)
    buffer_store_dwordx4 v[44:47], v3, s[8:11], s48 offen offset:0 sc0 sc1
    buffer_store_dwordx4 v[48:51], v3, s[8:11], s48 offen offset:1024 sc0 sc1
    buffer_store_dwordx4 v[52:55], v3, s[8:11], s48 offen offset:2048 sc0 sc1
    buffer_store_dwordx4 v[56:59], v3, s[8:11], s48 offen offset:3072 sc0 sc1
    s_waitcnt vmcnt(0) lgkmcnt(0)
    s_barrier
    s_cmp_lg_u32 s40, 0
    s_cbranch_scc1 interleave_layers__linear_kernel_hedgehog__geglu_ffn__prompt_kernel_nf47
    s_lshl_b32 s74, s2, 7
    s_add_u32 s74, s74, 491520
    v_mov_b32 v239, 0
    v_mov_b32_e64 v240, s60
    s_mov_b64 exec, 1
    buffer_store_dword v240, v239, s[56:59], s74 offen sc0 sc1
    s_mov_b64 exec, -1
interleave_layers__linear_kernel_hedgehog__geglu_ffn__prompt_kernel_nf47:
    s_branch interleave_layers__linear_kernel_hedgehog__geglu_ffn__prompt_kernel_sidewait46
interleave_layers__linear_kernel_hedgehog__geglu_ffn__prompt_kernel_sidewait46:
    s_mov_b32 s41, 491520
    v_lshlrev_b32 v4, 7, v0
    s_mov_b32 exec_lo, 0xffffffff
    s_mov_b32 exec_hi, 0x0
    s_mov_b32 s74, 0
interleave_layers__linear_kernel_hedgehog__geglu_ffn__prompt_kernel_poll48:
    buffer_load_dword v244, v4, s[56:59], s41 offen sc1
    s_add_u32 s74, s74, 1
    s_waitcnt vmcnt(0)
    v_cmp_ne_u32 vcc, s60, v244
    s_nop 0
    s_cmp_eq_u64 vcc, 0
    s_cbranch_scc1 interleave_layers__linear_kernel_hedgehog__geglu_ffn__prompt_kernel_polled49
    s_mov_b64 exec, vcc
    s_sleep 4
    s_cmp_lt_u32 s74, 50000
    s_cbranch_scc1 interleave_layers__linear_kernel_hedgehog__geglu_ffn__prompt_kernel_poll48
interleave_layers__linear_kernel_hedgehog__geglu_ffn__prompt_kernel_polled49:
    s_mov_b64 exec, -1
    s_branch mega_ph3
mega_ph3:
    s_and_b32 s45, s2, 7
    s_lshr_b32 s49, s2, 3
    s_and_b32 s41, s45, 3
    s_lshl_b32 s41, s41, 2
    s_lshr_b32 s42, s45, 2
    s_mul_i32 s42, s42, 8
    s_and_b32 s45, s49, 3
    s_add_u32 s41, s41, s45
    s_lshr_b32 s45, s49, 2
    s_add_u32 s42, s42, s45
    s_and_b32 s52, s40, 3
    s_cmp_lt_u32 s40, 4
    s_cbranch_scc1 interleave_layers__linear_kernel_hedgehog__geglu_ffn__prompt_kernel_comp50
    s_lshl_b32 s50, s52, 11
    v_lshlrev_b32 v3, 4, v0
    v_add_u32_e64 v3, s50, v3
    s_mul_i32 s47, s42, 458752
    s_add_u32 s8, s68, 0x5700000
    .long 0x8209ff45, 0x0
    s_mov_b32 s10, 0x700000
    s_mov_b32 s11, 0x00020000
    s_add_u32 m0, s50, 0
    s_nop 0
    buffer_load_dwordx4 v3, s[8:11], s47 offen lds
    buffer_load_dwordx4 v3, s[8:11], s47 offen offset:1024 lds
    s_add_u32 s47, s47, 8192
    s_add_u32 m0, s50, 8192
    s_mov_b32 s99, 0x1000
    buffer_load_dwordx4 v3, s[8:11], s47 offen lds
    buffer_load_dwordx4 v3, s[8:11], s47 offen offset:1024 lds
    s_add_u32 s47, s47, 8192
    s_add_u32 m0, s50, 16384
    s_mov_b32 s99, 0x1000
    buffer_load_dwordx4 v3, s[8:11], s47 offen lds
    buffer_load_dwordx4 v3, s[8:11], s47 offen offset:1024 lds
    s_add_u32 s47, s47, 8192
    s_add_u32 m0, s50, 24576
    s_mov_b32 s99, 0x1000
    buffer_load_dwordx4 v3, s[8:11], s47 offen lds
    buffer_load_dwordx4 v3, s[8:11], s47 offen offset:1024 lds
    s_add_u32 s47, s47, 8192
    s_add_u32 m0, s50, 32768
    s_mov_b32 s99, 0x1000
    buffer_load_dwordx4 v3, s[8:11], s47 offen lds
    buffer_load_dwordx4 v3, s[8:11], s47 offen offset:1024 lds
    s_add_u32 s47, s47, 8192
    s_add_u32 m0, s50, 40960
    s_mov_b32 s99, 0x1000
    buffer_load_dwordx4 v3, s[8:11], s47 offen lds
    buffer_load_dwordx4 v3, s[8:11], s47 offen offset:1024 lds
    s_add_u32 s47, s47, 8192
    s_add_u32 m0, s50, 49152
    s_mov_b32 s99, 0x1000
    buffer_load_dwordx4 v3, s[8:11], s47 offen lds
    buffer_load_dwordx4 v3, s[8:11], s47 offen offset:1024 lds
    s_add_u32 s47, s47, 8192
    s_add_u32 m0, s50, 57344
    s_mov_b32 s99, 0x1000
    buffer_load_dwordx4 v3, s[8:11], s47 offen lds
    buffer_load_dwordx4 v3, s[8:11], s47 offen offset:1024 lds
    s_add_u32 s47, s47, 8192
    s_add_u32 m0, s50, 65536
    s_mov_b32 s99, 0x1000
    buffer_load_dwordx4 v3, s[8:11], s47 offen lds
    buffer_load_dwordx4 v3, s[8:11], s47 offen offset:1024 lds
    s_add_u32 s47, s47, 8192
    s_add_u32 m0, s50, 73728
    s_mov_b32 s99, 0x1000
    buffer_load_dwordx4 v3, s[8:11], s47 offen lds
    buffer_load_dwordx4 v3, s[8:11], s47 offen offset:1024 lds
    s_add_u32 s47, s47, 8192
    s_add_u32 m0, s50, 81920
    s_mov_b32 s99, 0x1000
    buffer_load_dwordx4 v3, s[8:11], s47 offen lds
    buffer_load_dwordx4 v3, s[8:11], s47 offen offset:1024 lds
    s_add_u32 s47, s47, 8192
    s_add_u32 m0, s50, 90112
    s_mov_b32 s99, 0x1000
    buffer_load_dwordx4 v3, s[8:11], s47 offen lds
    buffer_load_dwordx4 v3, s[8:11], s47 offen offset:1024 lds
    s_add_u32 s47, s47, 8192
    s_cmp_lg_u32 s40, 4
    s_cbranch_scc1 interleave_layers__linear_kernel_hedgehog__geglu_ffn__prompt_kernel_np51
    s_lshr_b32 s45, s41, 1
    s_lshl_b32 s45, s45, 12
    s_add_u32 s45, s45, 393216
    v_lshlrev_b32_e64 v6, 7, v0
    s_mov_b32 exec_lo, 0xfffffff
    s_mov_b32 exec_hi, 0x0
    s_mov_b32 s74, 0
interleave_layers__linear_kernel_hedgehog__geglu_ffn__prompt_kernel_poll52:
    buffer_load_dword v244, v6, s[56:59], s45 offen sc1
    s_add_u32 s74, s74, 1
    s_waitcnt vmcnt(0)
    v_cmp_ne_u32 vcc, s60, v244
    s_nop 0
    s_cmp_eq_u64 vcc, 0
    s_cbranch_scc1 interleave_layers__linear_kernel_hedgehog__geglu_ffn__prompt_kernel_polled53
    s_mov_b64 exec, vcc
    s_sleep 4
    s_cmp_lt_u32 s74, 50000
    s_cbranch_scc1 interleave_layers__linear_kernel_hedgehog__geglu_ffn__prompt_kernel_poll52
interleave_layers__linear_kernel_hedgehog__geglu_ffn__prompt_kernel_polled53:
    s_mov_b64 exec, -1
interleave_layers__linear_kernel_hedgehog__geglu_ffn__prompt_kernel_np51:
    s_waitcnt vmcnt(16)
    s_barrier
    s_add_u32 m0, s50, 98304
    s_mov_b32 s99, 0x1000
    buffer_load_dwordx4 v3, s[8:11], s47 offen lds
    buffer_load_dwordx4 v3, s[8:11], s47 offen offset:1024 lds
    s_add_u32 s47, s47, 8192
    s_add_u32 m0, s50, 106496
    s_mov_b32 s99, 0x1000
    buffer_load_dwordx4 v3, s[8:11], s47 offen lds
    buffer_load_dwordx4 v3, s[8:11], s47 offen offset:1024 lds
    s_add_u32 s47, s47, 8192
    s_add_u32 m0, s50, 114688
    s_mov_b32 s99, 0x1000
    buffer_load_dwordx4 v3, s[8:11], s47 offen lds
    buffer_load_dwordx4 v3, s[8:11], s47 offen offset:1024 lds
    s_add_u32 s47, s47, 8192
    s_add_u32 m0, s50, 122880
    s_mov_b32 s99, 0x1000
    buffer_load_dwordx4 v3, s[8:11], s47 offen lds
    buffer_load_dwordx4 v3, s[8:11], s47 offen offset:1024 lds
    s_add_u32 s47, s47, 8192
    s_waitcnt vmcnt(16)
    s_barrier
    s_add_u32 m0, s50, 0
    s_nop 0
    buffer_load_dwordx4 v3, s[8:11], s47 offen lds
    buffer_load_dwordx4 v3, s[8:11], s47 offen offset:1024 lds
    s_add_u32 s47, s47, 8192
    s_add_u32 m0, s50, 8192
    s_mov_b32 s99, 0x1000
    buffer_load_dwordx4 v3, s[8:11], s47 offen lds
    buffer_load_dwordx4 v3, s[8:11], s47 offen offset:1024 lds
    s_add_u32 s47, s47, 8192
    s_add_u32 m0, s50, 16384
    s_mov_b32 s99, 0x1000
    buffer_load_dwordx4 v3, s[8:11], s47 offen lds
    buffer_load_dwordx4 v3, s[8:11], s47 offen offset:1024 lds
    s_add_u32 s47, s47, 8192
    s_add_u32 m0, s50, 24576
    s_mov_b32 s99, 0x1000
    buffer_load_dwordx4 v3, s[8:11], s47 offen lds
    buffer_load_dwordx4 v3, s[8:11], s47 offen offset:1024 lds
    s_add_u32 s47, s47, 8192
    s_waitcnt vmcnt(16)
    s_barrier
    s_add_u32 m0, s50, 32768
    s_mov_b32 s99, 0x1000
    buffer_load_dwordx4 v3, s[8:11], s47 offen lds
    buffer_load_dwordx4 v3, s[8:11], s47 offen offset:1024 lds
    s_add_u32 s47, s47, 8192
    s_add_u32 m0, s50, 40960
    s_mov_b32 s99, 0x1000
    buffer_load_dwordx4 v3, s[8:11], s47 offen lds
    buffer_load_dwordx4 v3, s[8:11], s47 offen offset:1024 lds
    s_add_u32 s47, s47, 8192
    s_add_u32 m0, s50, 49152
    s_mov_b32 s99, 0x1000
    buffer_load_dwordx4 v3, s[8:11], s47 offen lds
    buffer_load_dwordx4 v3, s[8:11], s47 offen offset:1024 lds
    s_add_u32 s47, s47, 8192
    s_add_u32 m0, s50, 57344
    s_mov_b32 s99, 0x1000
    buffer_load_dwordx4 v3, s[8:11], s47 offen lds
    buffer_load_dwordx4 v3, s[8:11], s47 offen offset:1024 lds
    s_add_u32 s47, s47, 8192
    s_waitcnt vmcnt(16)
    s_barrier
    s_add_u32 m0, s50, 65536
    s_mov_b32 s99, 0x1000
    buffer_load_dwordx4 v3, s[8:11], s47 offen lds
    buffer_load_dwordx4 v3, s[8:11], s47 offen offset:1024 lds
    s_add_u32 s47, s47, 8192
    s_add_u32 m0, s50, 73728
    s_mov_b32 s99, 0x1000
    buffer_load_dwordx4 v3, s[8:11], s47 offen lds
    buffer_load_dwordx4 v3, s[8:11], s47 offen offset:1024 lds
    s_add_u32 s47, s47, 8192
    s_add_u32 m0, s50, 81920
    s_mov_b32 s99, 0x1000
    buffer_load_dwordx4 v3, s[8:11], s47 offen lds
    buffer_load_dwordx4 v3, s[8:11], s47 offen offset:1024 lds
    s_add_u32 s47, s47, 8192
    s_add_u32 m0, s50, 90112
    s_mov_b32 s99, 0x1000
    buffer_load_dwordx4 v3, s[8:11], s47 offen lds
    buffer_load_dwordx4 v3, s[8:11], s47 offen offset:1024 lds
    s_add_u32 s47, s47, 8192
    s_waitcnt vmcnt(16)
    s_barrier
    s_add_u32 m0, s50, 98304
    s_mov_b32 s99, 0x1000
    buffer_load_dwordx4 v3, s[8:11], s47 offen lds
    buffer_load_dwordx4 v3, s[8:11], s47 offen offset:1024 lds
    s_add_u32 s47, s47, 8192
    s_add_u32 m0, s50, 106496
    s_mov_b32 s99, 0x1000
    buffer_load_dwordx4 v3, s[8:11], s47 offen lds
    buffer_load_dwordx4 v3, s[8:11], s47 offen offset:1024 lds
    s_add_u32 s47, s47, 8192
    s_add_u32 m0, s50, 114688
    s_mov_b32 s99, 0x1000
    buffer_load_dwordx4 v3, s[8:11], s47 offen lds
    buffer_load_dwordx4 v3, s[8:11], s47 offen offset:1024 lds
    s_add_u32 s47, s47, 8192
    s_add_u32 m0, s50, 122880
    s_mov_b32 s99, 0x1000
    buffer_load_dwordx4 v3, s[8:11], s47 offen lds
    buffer_load_dwordx4 v3, s[8:11], s47 offen offset:1024 lds
    s_add_u32 s47, s47, 8192
    s_cmp_lg_u32 s40, 5
    s_cbranch_scc1 interleave_layers__linear_kernel_hedgehog__geglu_ffn__prompt_kernel_np54
    s_lshr_b32 s45, s41, 1
    s_lshl_b32 s45, s45, 12
    s_add_u32 s45, s45, 524288
    v_lshlrev_b32_e64 v6, 7, v0
    s_mov_b32 exec_lo, 0xfffffff
    s_mov_b32 exec_hi, 0x0
    s_mov_b32 s74, 0
interleave_layers__linear_kernel_hedgehog__geglu_ffn__prompt_kernel_poll55:
    buffer_load_dword v244, v6, s[56:59], s45 offen sc1
    s_add_u32 s74, s74, 1
    s_waitcnt vmcnt(0)
    v_cmp_ne_u32 vcc, s60, v244
    s_nop 0
    s_cmp_eq_u64 vcc, 0
    s_cbranch_scc1 interleave_layers__linear_kernel_hedgehog__geglu_ffn__prompt_kernel_polled56
    s_mov_b64 exec, vcc
    s_sleep 4
    s_cmp_lt_u32 s74, 50000
    s_cbranch_scc1 interleave_layers__linear_kernel_hedgehog__geglu_ffn__prompt_kernel_poll55
interleave_layers__linear_kernel_hedgehog__geglu_ffn__prompt_kernel_polled56:
    s_mov_b64 exec, -1
interleave_layers__linear_kernel_hedgehog__geglu_ffn__prompt_kernel_np54:
    s_waitcnt vmcnt(16)
    s_barrier
    s_add_u32 m0, s50, 0
    s_nop 0
    buffer_load_dwordx4 v3, s[8:11], s47 offen lds
    buffer_load_dwordx4 v3, s[8:11], s47 offen offset:1024 lds
    s_add_u32 s47, s47, 8192
    s_add_u32 m0, s50, 8192
    s_mov_b32 s99, 0x1000
    buffer_load_dwordx4 v3, s[8:11], s47 offen lds
    buffer_load_dwordx4 v3, s[8:11], s47 offen offset:1024 lds
    s_add_u32 s47, s47, 8192
    s_add_u32 m0, s50, 16384
    s_mov_b32 s99, 0x1000
    buffer_load_dwordx4 v3, s[8:11], s47 offen lds
    buffer_load_dwordx4 v3, s[8:11], s47 offen offset:1024 lds
    s_add_u32 s47, s47, 8192
    s_add_u32 m0, s50, 24576
    s_mov_b32 s99, 0x1000
    buffer_load_dwordx4 v3, s[8:11], s47 offen lds
    buffer_load_dwordx4 v3, s[8:11], s47 offen offset:1024 lds
    s_add_u32 s47, s47, 8192
    s_waitcnt vmcnt(16)
    s_barrier
    s_add_u32 m0, s50, 32768
    s_mov_b32 s99, 0x1000
    buffer_load_dwordx4 v3, s[8:11], s47 offen lds
    buffer_load_dwordx4 v3, s[8:11], s47 offen offset:1024 lds
    s_add_u32 s47, s47, 8192
    s_add_u32 m0, s50, 40960
    s_mov_b32 s99, 0x1000
    buffer_load_dwordx4 v3, s[8:11], s47 offen lds
    buffer_load_dwordx4 v3, s[8:11], s47 offen offset:1024 lds
    s_add_u32 s47, s47, 8192
    s_add_u32 m0, s50, 49152
    s_mov_b32 s99, 0x1000
    buffer_load_dwordx4 v3, s[8:11], s47 offen lds
    buffer_load_dwordx4 v3, s[8:11], s47 offen offset:1024 lds
    s_add_u32 s47, s47, 8192
    s_add_u32 m0, s50, 57344
    s_mov_b32 s99, 0x1000
    buffer_load_dwordx4 v3, s[8:11], s47 offen lds
    buffer_load_dwordx4 v3, s[8:11], s47 offen offset:1024 lds
    s_add_u32 s47, s47, 8192
    s_waitcnt vmcnt(16)
    s_barrier
    s_add_u32 m0, s50, 65536
    s_mov_b32 s99, 0x1000
    buffer_load_dwordx4 v3, s[8:11], s47 offen lds
    buffer_load_dwordx4 v3, s[8:11], s47 offen offset:1024 lds
    s_add_u32 s47, s47, 8192
    s_add_u32 m0, s50, 73728
    s_mov_b32 s99, 0x1000
    buffer_load_dwordx4 v3, s[8:11], s47 offen lds
    buffer_load_dwordx4 v3, s[8:11], s47 offen offset:1024 lds
    s_add_u32 s47, s47, 8192
    s_add_u32 m0, s50, 81920
    s_mov_b32 s99, 0x1000
    buffer_load_dwordx4 v3, s[8:11], s47 offen lds
    buffer_load_dwordx4 v3, s[8:11], s47 offen offset:1024 lds
    s_add_u32 s47, s47, 8192
    s_add_u32 m0, s50, 90112
    s_mov_b32 s99, 0x1000
    buffer_load_dwordx4 v3, s[8:11], s47 offen lds
    buffer_load_dwordx4 v3, s[8:11], s47 offen offset:1024 lds
    s_add_u32 s47, s47, 8192
    s_waitcnt vmcnt(16)
    s_barrier
    s_add_u32 m0, s50, 98304
    s_mov_b32 s99, 0x1000
    buffer_load_dwordx4 v3, s[8:11], s47 offen lds
    buffer_load_dwordx4 v3, s[8:11], s47 offen offset:1024 lds
    s_add_u32 s47, s47, 8192
    s_add_u32 m0, s50, 106496
    s_mov_b32 s99, 0x1000
    buffer_load_dwordx4 v3, s[8:11], s47 offen lds
    buffer_load_dwordx4 v3, s[8:11], s47 offen offset:1024 lds
    s_add_u32 s47, s47, 8192
    s_add_u32 m0, s50, 114688
    s_mov_b32 s99, 0x1000
    buffer_load_dwordx4 v3, s[8:11], s47 offen lds
    buffer_load_dwordx4 v3, s[8:11], s47 offen offset:1024 lds
    s_add_u32 s47, s47, 8192
    s_add_u32 m0, s50, 122880
    s_mov_b32 s99, 0x1000
    buffer_load_dwordx4 v3, s[8:11], s47 offen lds
    buffer_load_dwordx4 v3, s[8:11], s47 offen offset:1024 lds
    s_add_u32 s47, s47, 8192
    s_waitcnt vmcnt(16)
    s_barrier
    s_add_u32 m0, s50, 0
    s_nop 0
    buffer_load_dwordx4 v3, s[8:11], s47 offen lds
    buffer_load_dwordx4 v3, s[8:11], s47 offen offset:1024 lds
    s_add_u32 s47, s47, 8192
    s_add_u32 m0, s50, 8192
    s_mov_b32 s99, 0x1000
    buffer_load_dwordx4 v3, s[8:11], s47 offen lds
    buffer_load_dwordx4 v3, s[8:11], s47 offen offset:1024 lds
    s_add_u32 s47, s47, 8192
    s_add_u32 m0, s50, 16384
    s_mov_b32 s99, 0x1000
    buffer_load_dwordx4 v3, s[8:11], s47 offen lds
    buffer_load_dwordx4 v3, s[8:11], s47 offen offset:1024 lds
    s_add_u32 s47, s47, 8192
    s_add_u32 m0, s50, 24576
    s_mov_b32 s99, 0x1000
    buffer_load_dwordx4 v3, s[8:11], s47 offen lds
    buffer_load_dwordx4 v3, s[8:11], s47 offen offset:1024 lds
    s_add_u32 s47, s47, 8192
    s_waitcnt vmcnt(16)
    s_barrier
    s_add_u32 m0, s50, 32768
    s_mov_b32 s99, 0x1000
    buffer_load_dwordx4 v3, s[8:11], s47 offen lds
    buffer_load_dwordx4 v3, s[8:11], s47 offen offset:1024 lds
    s_add_u32 s47, s47, 8192
    s_add_u32 m0, s50, 40960
    s_mov_b32 s99, 0x1000
    buffer_load_dwordx4 v3, s[8:11], s47 offen lds
    buffer_load_dwordx4 v3, s[8:11], s47 offen offset:1024 lds
    s_add_u32 s47, s47, 8192
    s_add_u32 m0, s50, 49152
    s_mov_b32 s99, 0x1000
    buffer_load_dwordx4 v3, s[8:11], s47 offen lds
    buffer_load_dwordx4 v3, s[8:11], s47 offen offset:1024 lds
    s_add_u32 s47, s47, 8192
    s_add_u32 m0, s50, 57344
    s_mov_b32 s99, 0x1000
    buffer_load_dwordx4 v3, s[8:11], s47 offen lds
    buffer_load_dwordx4 v3, s[8:11], s47 offen offset:1024 lds
    s_add_u32 s47, s47, 8192
    s_waitcnt vmcnt(16)
    s_barrier
    s_waitcnt vmcnt(8)
    s_barrier
    s_waitcnt vmcnt(0)
    s_barrier
    s_barrier
    s_waitcnt vmcnt(0) lgkmcnt(0)
    s_barrier
    s_cmp_lg_u32 s40, 0
    s_cbranch_scc1 interleave_layers__linear_kernel_hedgehog__geglu_ffn__prompt_kernel_nf57
    s_lshl_b32 s74, s41, 11
    s_lshl_b32 s75, s42, 7
    s_add_u32 s74, s74, s75
    s_add_u32 s74, s74, 458752
    v_mov_b32 v239, 0
    v_mov_b32_e64 v240, s60
    s_mov_b64 exec, 1
    buffer_store_dword v240, v239, s[56:59], s74 offen sc0 sc1
    s_mov_b64 exec, -1
interleave_layers__linear_kernel_hedgehog__geglu_ffn__prompt_kernel_nf57:
    s_branch mega_ph4
interleave_layers__linear_kernel_hedgehog__geglu_ffn__prompt_kernel_comp50:
    v_lshlrev_b32 v5, 4, v0
    s_lshl_b32 s49, s41, 13
    s_lshl_b32 s48, s40, 11
    s_add_u32 s49, s49, s48
    s_lshl_b32 s46, s42, 18
    s_add_u32 s46, s46, s49
    s_add_u32 s47, s46, 131072
    s_add_u32 s51, s49, 131072
    v_lshlrev_b32_e64 v4, 4, v0
    s_add_u32 s4, s68, 0x2800000
    .long 0x8205ff45, 0x0
    s_mov_b32 s6, 0xe00000
    s_mov_b32 s7, 0x00020000
    s_add_u32 s12, s68, 0x400000
    .long 0x820dff45, 0x0
    s_mov_b32 s14, 0x400000
    s_mov_b32 s15, 0x00020000
    s_add_u32 s16, s68, 0x800000
    .long 0x8211ff45, 0x0
    s_mov_b32 s18, 0x400000
    s_mov_b32 s19, 0x00020000
    s_add_u32 s24, s68, 0x4cc0000
    .long 0x8219ff45, 0x0
    s_mov_b32 s26, 0x40000
    s_mov_b32 s27, 0x00020000
    s_waitcnt vmcnt(0)
    s_barrier
    buffer_load_dwordx4 v[96:99], v5, s[4:7], s49 offen offset:0
    buffer_load_dwordx4 v[100:103], v5, s[4:7], s49 offen offset:1024
    s_add_u32 s49, s49, 262144
    buffer_load_dwordx4 v[104:107], v5, s[4:7], s51 offen offset:0
    buffer_load_dwordx4 v[108:111], v5, s[4:7], s51 offen offset:1024
    s_add_u32 s51, s51, 262144
    buffer_load_dwordx4 v[112:115], v5, s[4:7], s49 offen offset:0
    buffer_load_dwordx4 v[116:119], v5, s[4:7], s49 offen offset:1024
    s_add_u32 s49, s49, 262144
    buffer_load_dwordx4 v[120:123], v5, s[4:7], s51 offen offset:0
    buffer_load_dwordx4 v[124:127], v5, s[4:7], s51 offen offset:1024
    s_add_u32 s51, s51, 262144
    buffer_load_dwordx4 v[128:131], v5, s[4:7], s49 offen offset:0
    buffer_load_dwordx4 v[132:135], v5, s[4:7], s49 offen offset:1024
    s_add_u32 s49, s49, 262144
    buffer_load_dwordx4 v[136:139], v5, s[4:7], s51 offen offset:0
    buffer_load_dwordx4 v[140:143], v5, s[4:7], s51 offen offset:1024
    s_add_u32 s51, s51, 262144
    ds_read_b128 v[40:43], v4 offset:0
    ds_read_b128 v[44:47], v4 offset:1024
    ds_read_b128 v[48:51], v4 offset:2048
    ds_read_b128 v[52:55], v4 offset:3072
    s_cmp_lg_u32 s40, 0
    s_cbranch_scc1 interleave_layers__linear_kernel_hedgehog__geglu_ffn__prompt_kernel_nfb58
    s_cmp_lt_u32 s2, 32
    s_cbranch_scc1 interleave_layers__linear_kernel_hedgehog__geglu_ffn__prompt_kernel_nfb58
    s_mov_b32 s74, s62
    v_mov_b32 v239, 0
    v_mov_b32 v240, s60
    s_mov_b64 exec, 1
    buffer_store_dword v240, v239, s[56:59], s74 offen sc0 sc1
    s_mov_b64 exec, -1
interleave_layers__linear_kernel_hedgehog__geglu_ffn__prompt_kernel_nfb58:
    s_mov_b32 s44, 0
    s_mov_b32 s43, 0
    s_waitcnt vmcnt(8) lgkmcnt(0)
    v_mfma_f32_16x16x32_bf16 v[8:11], v[40:43], v[96:99], 0
    ds_read_b128 v[56:59], v4 offset:4096
    v_mfma_f32_16x16x32_bf16 v[12:15], v[40:43], v[100:103], 0
    ds_read_b128 v[60:63], v4 offset:5120
    v_mfma_f32_16x16x32_bf16 v[16:19], v[44:47], v[96:99], 0
    ds_read_b128 v[64:67], v4 offset:6144
    v_mfma_f32_16x16x32_bf16 v[20:23], v[44:47], v[100:103], 0
    ds_read_b128 v[68:71], v4 offset:7168
    v_mfma_f32_16x16x32_bf16 v[24:27], v[48:51], v[96:99], 0
    buffer_load_dwordx4 v[144:147], v5, s[4:7], s49 offen offset:0
    v_mfma_f32_16x16x32_bf16 v[28:31], v[48:51], v[100:103], 0
    buffer_load_dwordx4 v[148:151], v5, s[4:7], s49 offen offset:1024
    s_add_u32 s49, s49, 262144
    v_mfma_f32_16x16x32_bf16 v[32:35], v[52:55], v[96:99], 0
    v_mfma_f32_16x16x32_bf16 v[36:39], v[52:55], v[100:103], 0
    s_waitcnt lgkmcnt(0)
    s_nop 0
    v_mfma_f32_16x16x32_bf16 v[8:11], v[56:59], v[104:107], v[8:11]
    ds_read_b128 v[40:43], v4 offset:8192
    v_mfma_f32_16x16x32_bf16 v[12:15], v[56:59], v[108:111], v[12:15]
    ds_read_b128 v[44:47], v4 offset:9216
    v_mfma_f32_16x16x32_bf16 v[16:19], v[60:63], v[104:107], v[16:19]
    ds_read_b128 v[48:51], v4 offset:10240
    v_mfma_f32_16x16x32_bf16 v[20:23], v[60:63], v[108:111], v[20:23]
    ds_read_b128 v[52:55], v4 offset:11264
    v_mfma_f32_16x16x32_bf16 v[24:27], v[64:67], v[104:107], v[24:27]
    buffer_load_dwordx4 v[152:155], v5, s[4:7], s51 offen offset:0
    v_mfma_f32_16x16x32_bf16 v[28:31], v[64:67], v[108:111], v[28:31]
    buffer_load_dwordx4 v[156:159], v5, s[4:7], s51 offen offset:1024
    s_add_u32 s51, s51, 262144
    v_mfma_f32_16x16x32_bf16 v[32:35], v[68:71], v[104:107], v[32:35]
    v_mfma_f32_16x16x32_bf16 v[36:39], v[68:71], v[108:111], v[36:39]
    s_waitcnt vmcnt(8) lgkmcnt(0)
    s_nop 0
    v_mfma_f32_16x16x32_bf16 v[8:11], v[40:43], v[112:115], v[8:11]
    ds_read_b128 v[56:59], v4 offset:12288
    v_mfma_f32_16x16x32_bf16 v[12:15], v[40:43], v[116:119], v[12:15]
    ds_read_b128 v[60:63], v4 offset:13312
    v_mfma_f32_16x16x32_bf16 v[16:19], v[44:47], v[112:115], v[16:19]
    ds_read_b128 v[64:67], v4 offset:14336
    v_mfma_f32_16x16x32_bf16 v[20:23], v[44:47], v[116:119], v[20:23]
    ds_read_b128 v[68:71], v4 offset:15360
    v_mfma_f32_16x16x32_bf16 v[24:27], v[48:51], v[112:115], v[24:27]
    buffer_load_dwordx4 v[96:99], v5, s[4:7], s49 offen offset:0
    v_mfma_f32_16x16x32_bf16 v[28:31], v[48:51], v[116:119], v[28:31]
    buffer_load_dwordx4 v[100:103], v5, s[4:7], s49 offen offset:1024
    s_add_u32 s49, s49, 262144
    v_mfma_f32_16x16x32_bf16 v[32:35], v[52:55], v[112:115], v[32:35]
    v_mfma_f32_16x16x32_bf16 v[36:39], v[52:55], v[116:119], v[36:39]
    s_waitcnt lgkmcnt(0)
    s_nop 0
    v_mfma_f32_16x16x32_bf16 v[8:11], v[56:59], v[120:123], v[8:11]
    ds_read_b128 v[40:43], v4 offset:16384
    v_mfma_f32_16x16x32_bf16 v[12:15], v[56:59], v[124:127], v[12:15]
    ds_read_b128 v[44:47], v4 offset:17408
    v_mfma_f32_16x16x32_bf16 v[16:19], v[60:63], v[120:123], v[16:19]
    ds_read_b128 v[48:51], v4 offset:18432
    v_mfma_f32_16x16x32_bf16 v[20:23], v[60:63], v[124:127], v[20:23]
    ds_read_b128 v[52:55], v4 offset:19456
    v_mfma_f32_16x16x32_bf16 v[24:27], v[64:67], v[120:123], v[24:27]
    buffer_load_dwordx4 v[104:107], v5, s[4:7], s51 offen offset:0
    v_mfma_f32_16x16x32_bf16 v[28:31], v[64:67], v[124:127], v[28:31]
    buffer_load_dwordx4 v[108:111], v5, s[4:7], s51 offen offset:1024
    s_add_u32 s51, s51, 262144
    v_mfma_f32_16x16x32_bf16 v[32:35], v[68:71], v[120:123], v[32:35]
    v_mfma_f32_16x16x32_bf16 v[36:39], v[68:71], v[124:127], v[36:39]
    s_waitcnt vmcnt(8) lgkmcnt(0)
    s_nop 0
    v_mfma_f32_16x16x32_bf16 v[8:11], v[40:43], v[128:131], v[8:11]
    ds_read_b128 v[56:59], v4 offset:20480
    v_mfma_f32_16x16x32_bf16 v[12:15], v[40:43], v[132:135], v[12:15]
    ds_read_b128 v[60:63], v4 offset:21504
    v_mfma_f32_16x16x32_bf16 v[16:19], v[44:47], v[128:131], v[16:19]
    ds_read_b128 v[64:67], v4 offset:22528
    v_mfma_f32_16x16x32_bf16 v[20:23], v[44:47], v[132:135], v[20:23]
    ds_read_b128 v[68:71], v4 offset:23552
    v_mfma_f32_16x16x32_bf16 v[24:27], v[48:51], v[128:131], v[24:27]
    buffer_load_dwordx4 v[112:115], v5, s[4:7], s49 offen offset:0
    v_mfma_f32_16x16x32_bf16 v[28:31], v[48:51], v[132:135], v[28:31]
    buffer_load_dwordx4 v[116:119], v5, s[4:7], s49 offen offset:1024
    s_add_u32 s49, s49, 262144
    v_mfma_f32_16x16x32_bf16 v[32:35], v[52:55], v[128:131], v[32:35]
    v_mfma_f32_16x16x32_bf16 v[36:39], v[52:55], v[132:135], v[36:39]
    s_waitcnt lgkmcnt(0)
    s_nop 0
    v_mfma_f32_16x16x32_bf16 v[8:11], v[56:59], v[136:139], v[8:11]
    ds_read_b128 v[40:43], v4 offset:24576
    v_mfma_f32_16x16x32_bf16 v[12:15], v[56:59], v[140:143], v[12:15]
    ds_read_b128 v[44:47], v4 offset:25600
    v_mfma_f32_16x16x32_bf16 v[16:19], v[60:63], v[136:139], v[16:19]
    ds_read_b128 v[48:51], v4 offset:26624
    v_mfma_f32_16x16x32_bf16 v[20:23], v[60:63], v[140:143], v[20:23]
    ds_read_b128 v[52:55], v4 offset:27648
    v_mfma_f32_16x16x32_bf16 v[24:27], v[64:67], v[136:139], v[24:27]
    buffer_load_dwordx4 v[120:123], v5, s[4:7], s51 offen offset:0
    v_mfma_f32_16x16x32_bf16 v[28:31], v[64:67], v[140:143], v[28:31]
    buffer_load_dwordx4 v[124:127], v5, s[4:7], s51 offen offset:1024
    s_add_u32 s51, s51, 262144
    v_mfma_f32_16x16x32_bf16 v[32:35], v[68:71], v[136:139], v[32:35]
    v_mfma_f32_16x16x32_bf16 v[36:39], v[68:71], v[140:143], v[36:39]
    s_waitcnt vmcnt(8) lgkmcnt(0)
    s_nop 0
    v_mfma_f32_16x16x32_bf16 v[8:11], v[40:43], v[144:147], v[8:11]
    ds_read_b128 v[56:59], v4 offset:28672
    v_mfma_f32_16x16x32_bf16 v[12:15], v[40:43], v[148:151], v[12:15]
    ds_read_b128 v[60:63], v4 offset:29696
    v_mfma_f32_16x16x32_bf16 v[16:19], v[44:47], v[144:147], v[16:19]
    ds_read_b128 v[64:67], v4 offset:30720
    v_mfma_f32_16x16x32_bf16 v[20:23], v[44:47], v[148:151], v[20:23]
    ds_read_b128 v[68:71], v4 offset:31744
    v_mfma_f32_16x16x32_bf16 v[24:27], v[48:51], v[144:147], v[24:27]
    buffer_load_dwordx4 v[128:131], v5, s[4:7], s49 offen offset:0
    v_mfma_f32_16x16x32_bf16 v[28:31], v[48:51], v[148:151], v[28:31]
    buffer_load_dwordx4 v[132:135], v5, s[4:7], s49 offen offset:1024
    s_add_u32 s49, s49, 262144
    s_add_u32 s54, s44, 32768
    s_cmp_eq_u32 s54, 131072
    .long 0x853636ff, 0x0
    s_sub_u32 s54, s54, s44
    s_add_u32 s44, s44, s54
    v_mfma_f32_16x16x32_bf16 v[32:35], v[52:55], v[144:147], v[32:35]
    v_add_u32_e64 v4, s54, v4
    v_mfma_f32_16x16x32_bf16 v[36:39], v[52:55], v[148:151], v[36:39]
    s_waitcnt lgkmcnt(0)
    s_barrier
    v_mfma_f32_16x16x32_bf16 v[8:11], v[56:59], v[152:155], v[8:11]
    ds_read_b128 v[40:43], v4 offset:0
    v_mfma_f32_16x16x32_bf16 v[12:15], v[56:59], v[156:159], v[12:15]
    ds_read_b128 v[44:47], v4 offset:1024
    v_mfma_f32_16x16x32_bf16 v[16:19], v[60:63], v[152:155], v[16:19]
    ds_read_b128 v[48:51], v4 offset:2048
    v_mfma_f32_16x16x32_bf16 v[20:23], v[60:63], v[156:159], v[20:23]
    ds_read_b128 v[52:55], v4 offset:3072
    v_mfma_f32_16x16x32_bf16 v[24:27], v[64:67], v[152:155], v[24:27]
    buffer_load_dwordx4 v[136:139], v5, s[4:7], s51 offen offset:0
    v_mfma_f32_16x16x32_bf16 v[28:31], v[64:67], v[156:159], v[28:31]
    buffer_load_dwordx4 v[140:143], v5, s[4:7], s51 offen offset:1024
    s_add_u32 s51, s51, 262144
    v_mfma_f32_16x16x32_bf16 v[32:35], v[68:71], v[152:155], v[32:35]
    v_mfma_f32_16x16x32_bf16 v[36:39], v[68:71], v[156:159], v[36:39]
interleave_layers__linear_kernel_hedgehog__geglu_ffn__prompt_kernel_loop59:
    s_waitcnt vmcnt(8) lgkmcnt(0)
    s_nop 0
    v_mfma_f32_16x16x32_bf16 v[8:11], v[40:43], v[96:99], v[8:11]
    ds_read_b128 v[56:59], v4 offset:4096
    v_mfma_f32_16x16x32_bf16 v[12:15], v[40:43], v[100:103], v[12:15]
    ds_read_b128 v[60:63], v4 offset:5120
    v_mfma_f32_16x16x32_bf16 v[16:19], v[44:47], v[96:99], v[16:19]
    ds_read_b128 v[64:67], v4 offset:6144
    v_mfma_f32_16x16x32_bf16 v[20:23], v[44:47], v[100:103], v[20:23]
    ds_read_b128 v[68:71], v4 offset:7168
    v_mfma_f32_16x16x32_bf16 v[24:27], v[48:51], v[96:99], v[24:27]
    buffer_load_dwordx4 v[144:147], v5, s[4:7], s49 offen offset:0
    v_mfma_f32_16x16x32_bf16 v[28:31], v[48:51], v[100:103], v[28:31]
    buffer_load_dwordx4 v[148:151], v5, s[4:7], s49 offen offset:1024
    s_add_u32 s49, s49, 262144
    v_mfma_f32_16x16x32_bf16 v[32:35], v[52:55], v[96:99], v[32:35]
    v_mfma_f32_16x16x32_bf16 v[36:39], v[52:55], v[100:103], v[36:39]
    s_waitcnt lgkmcnt(0)
    s_nop 0
    v_mfma_f32_16x16x32_bf16 v[8:11], v[56:59], v[104:107], v[8:11]
    ds_read_b128 v[40:43], v4 offset:8192
    v_mfma_f32_16x16x32_bf16 v[12:15], v[56:59], v[108:111], v[12:15]
    ds_read_b128 v[44:47], v4 offset:9216
    v_mfma_f32_16x16x32_bf16 v[16:19], v[60:63], v[104:107], v[16:19]
    ds_read_b128 v[48:51], v4 offset:10240
    v_mfma_f32_16x16x32_bf16 v[20:23], v[60:63], v[108:111], v[20:23]
    ds_read_b128 v[52:55], v4 offset:11264
    v_mfma_f32_16x16x32_bf16 v[24:27], v[64:67], v[104:107], v[24:27]
    buffer_load_dwordx4 v[152:155], v5, s[4:7], s51 offen offset:0
    v_mfma_f32_16x16x32_bf16 v[28:31], v[64:67], v[108:111], v[28:31]
    buffer_load_dwordx4 v[156:159], v5, s[4:7], s51 offen offset:1024
    s_add_u32 s51, s51, 262144
    v_mfma_f32_16x16x32_bf16 v[32:35], v[68:71], v[104:107], v[32:35]
    v_mfma_f32_16x16x32_bf16 v[36:39], v[68:71], v[108:111], v[36:39]
    s_waitcnt vmcnt(8) lgkmcnt(0)
    s_nop 0
    v_mfma_f32_16x16x32_bf16 v[8:11], v[40:43], v[112:115], v[8:11]
    ds_read_b128 v[56:59], v4 offset:12288
    v_mfma_f32_16x16x32_bf16 v[12:15], v[40:43], v[116:119], v[12:15]
    ds_read_b128 v[60:63], v4 offset:13312
    v_mfma_f32_16x16x32_bf16 v[16:19], v[44:47], v[112:115], v[16:19]
    ds_read_b128 v[64:67], v4 offset:14336
    v_mfma_f32_16x16x32_bf16 v[20:23], v[44:47], v[116:119], v[20:23]
    ds_read_b128 v[68:71], v4 offset:15360
    v_mfma_f32_16x16x32_bf16 v[24:27], v[48:51], v[112:115], v[24:27]
    buffer_load_dwordx4 v[96:99], v5, s[4:7], s49 offen offset:0
    v_mfma_f32_16x16x32_bf16 v[28:31], v[48:51], v[116:119], v[28:31]
    buffer_load_dwordx4 v[100:103], v5, s[4:7], s49 offen offset:1024
    s_add_u32 s49, s49, 262144
    v_mfma_f32_16x16x32_bf16 v[32:35], v[52:55], v[112:115], v[32:35]
    v_mfma_f32_16x16x32_bf16 v[36:39], v[52:55], v[116:119], v[36:39]
    s_waitcnt lgkmcnt(0)
    s_nop 0
    v_mfma_f32_16x16x32_bf16 v[8:11], v[56:59], v[120:123], v[8:11]
    ds_read_b128 v[40:43], v4 offset:16384
    v_mfma_f32_16x16x32_bf16 v[12:15], v[56:59], v[124:127], v[12:15]
    ds_read_b128 v[44:47], v4 offset:17408
    v_mfma_f32_16x16x32_bf16 v[16:19], v[60:63], v[120:123], v[16:19]
    ds_read_b128 v[48:51], v4 offset:18432
    v_mfma_f32_16x16x32_bf16 v[20:23], v[60:63], v[124:127], v[20:23]
    ds_read_b128 v[52:55], v4 offset:19456
    v_mfma_f32_16x16x32_bf16 v[24:27], v[64:67], v[120:123], v[24:27]
    buffer_load_dwordx4 v[104:107], v5, s[4:7], s51 offen offset:0
    v_mfma_f32_16x16x32_bf16 v[28:31], v[64:67], v[124:127], v[28:31]
    buffer_load_dwordx4 v[108:111], v5, s[4:7], s51 offen offset:1024
    s_add_u32 s51, s51, 262144
    v_mfma_f32_16x16x32_bf16 v[32:35], v[68:71], v[120:123], v[32:35]
    v_mfma_f32_16x16x32_bf16 v[36:39], v[68:71], v[124:127], v[36:39]
    s_waitcnt vmcnt(8) lgkmcnt(0)
    s_nop 0
    v_mfma_f32_16x16x32_bf16 v[8:11], v[40:43], v[128:131], v[8:11]
    ds_read_b128 v[56:59], v4 offset:20480
    v_mfma_f32_16x16x32_bf16 v[12:15], v[40:43], v[132:135], v[12:15]
    ds_read_b128 v[60:63], v4 offset:21504
    v_mfma_f32_16x16x32_bf16 v[16:19], v[44:47], v[128:131], v[16:19]
    ds_read_b128 v[64:67], v4 offset:22528
    v_mfma_f32_16x16x32_bf16 v[20:23], v[44:47], v[132:135], v[20:23]
    ds_read_b128 v[68:71], v4 offset:23552
    v_mfma_f32_16x16x32_bf16 v[24:27], v[48:51], v[128:131], v[24:27]
    buffer_load_dwordx4 v[112:115], v5, s[4:7], s49 offen offset:0
    v_mfma_f32_16x16x32_bf16 v[28:31], v[48:51], v[132:135], v[28:31]
    buffer_load_dwordx4 v[116:119], v5, s[4:7], s49 offen offset:1024
    s_add_u32 s49, s49, 262144
    v_mfma_f32_16x16x32_bf16 v[32:35], v[52:55], v[128:131], v[32:35]
    v_mfma_f32_16x16x32_bf16 v[36:39], v[52:55], v[132:135], v[36:39]
    s_waitcnt lgkmcnt(0)
    s_nop 0
    v_mfma_f32_16x16x32_bf16 v[8:11], v[56:59], v[136:139], v[8:11]
    ds_read_b128 v[40:43], v4 offset:24576
    v_mfma_f32_16x16x32_bf16 v[12:15], v[56:59], v[140:143], v[12:15]
    ds_read_b128 v[44:47], v4 offset:25600
    v_mfma_f32_16x16x32_bf16 v[16:19], v[60:63], v[136:139], v[16:19]
    ds_read_b128 v[48:51], v4 offset:26624
    v_mfma_f32_16x16x32_bf16 v[20:23], v[60:63], v[140:143], v[20:23]
    ds_read_b128 v[52:55], v4 offset:27648
    v_mfma_f32_16x16x32_bf16 v[24:27], v[64:67], v[136:139], v[24:27]
    buffer_load_dwordx4 v[120:123], v5, s[4:7], s51 offen offset:0
    v_mfma_f32_16x16x32_bf16 v[28:31], v[64:67], v[140:143], v[28:31]
    buffer_load_dwordx4 v[124:127], v5, s[4:7], s51 offen offset:1024
    s_add_u32 s51, s51, 262144
    v_mfma_f32_16x16x32_bf16 v[32:35], v[68:71], v[136:139], v[32:35]
    v_mfma_f32_16x16x32_bf16 v[36:39], v[68:71], v[140:143], v[36:39]
    s_waitcnt vmcnt(8) lgkmcnt(0)
    s_nop 0
    v_mfma_f32_16x16x32_bf16 v[8:11], v[40:43], v[144:147], v[8:11]
    ds_read_b128 v[56:59], v4 offset:28672
    v_mfma_f32_16x16x32_bf16 v[12:15], v[40:43], v[148:151], v[12:15]
    ds_read_b128 v[60:63], v4 offset:29696
    v_mfma_f32_16x16x32_bf16 v[16:19], v[44:47], v[144:147], v[16:19]
    ds_read_b128 v[64:67], v4 offset:30720
    v_mfma_f32_16x16x32_bf16 v[20:23], v[44:47], v[148:151], v[20:23]
    ds_read_b128 v[68:71], v4 offset:31744
    v_mfma_f32_16x16x32_bf16 v[24:27], v[48:51], v[144:147], v[24:27]
    buffer_load_dwordx4 v[128:131], v5, s[4:7], s49 offen offset:0
    v_mfma_f32_16x16x32_bf16 v[28:31], v[48:51], v[148:151], v[28:31]
    buffer_load_dwordx4 v[132:135], v5, s[4:7], s49 offen offset:1024
    s_add_u32 s49, s49, 262144
    s_add_u32 s54, s44, 32768
    s_cmp_eq_u32 s54, 131072
    .long 0x853636ff, 0x0
    s_sub_u32 s54, s54, s44
    s_add_u32 s44, s44, s54
    v_mfma_f32_16x16x32_bf16 v[32:35], v[52:55], v[144:147], v[32:35]
    v_add_u32_e64 v4, s54, v4
    v_mfma_f32_16x16x32_bf16 v[36:39], v[52:55], v[148:151], v[36:39]
    s_waitcnt lgkmcnt(0)
    s_barrier
    v_mfma_f32_16x16x32_bf16 v[8:11], v[56:59], v[152:155], v[8:11]
    ds_read_b128 v[40:43], v4 offset:0
    v_mfma_f32_16x16x32_bf16 v[12:15], v[56:59], v[156:159], v[12:15]
    ds_read_b128 v[44:47], v4 offset:1024
    v_mfma_f32_16x16x32_bf16 v[16:19], v[60:63], v[152:155], v[16:19]
    ds_read_b128 v[48:51], v4 offset:2048
    v_mfma_f32_16x16x32_bf16 v[20:23], v[60:63], v[156:159], v[20:23]
    ds_read_b128 v[52:55], v4 offset:3072
    v_mfma_f32_16x16x32_bf16 v[24:27], v[64:67], v[152:155], v[24:27]
    buffer_load_dwordx4 v[136:139], v5, s[4:7], s51 offen offset:0
    v_mfma_f32_16x16x32_bf16 v[28:31], v[64:67], v[156:159], v[28:31]
    buffer_load_dwordx4 v[140:143], v5, s[4:7], s51 offen offset:1024
    s_add_u32 s51, s51, 262144
    v_mfma_f32_16x16x32_bf16 v[32:35], v[68:71], v[152:155], v[32:35]
    v_mfma_f32_16x16x32_bf16 v[36:39], v[68:71], v[156:159], v[36:39]
    s_add_u32 s43, s43, 1
    s_cmp_lt_u32 s43, 12
    s_cbranch_scc1 interleave_layers__linear_kernel_hedgehog__geglu_ffn__prompt_kernel_loop59
    s_waitcnt vmcnt(8) lgkmcnt(0)
    v_mfma_f32_16x16x32_bf16 v[8:11], v[40:43], v[96:99], v[8:11]
    ds_read_b128 v[56:59], v4 offset:4096
    v_mfma_f32_16x16x32_bf16 v[12:15], v[40:43], v[100:103], v[12:15]
    ds_read_b128 v[60:63], v4 offset:5120
    v_mfma_f32_16x16x32_bf16 v[16:19], v[44:47], v[96:99], v[16:19]
    ds_read_b128 v[64:67], v4 offset:6144
    v_mfma_f32_16x16x32_bf16 v[20:23], v[44:47], v[100:103], v[20:23]
    ds_read_b128 v[68:71], v4 offset:7168
    v_mfma_f32_16x16x32_bf16 v[24:27], v[48:51], v[96:99], v[24:27]
    buffer_load_dwordx4 v[144:147], v5, s[4:7], s49 offen offset:0
    v_mfma_f32_16x16x32_bf16 v[28:31], v[48:51], v[100:103], v[28:31]
    buffer_load_dwordx4 v[148:151], v5, s[4:7], s49 offen offset:1024
    s_add_u32 s49, s49, 262144
    v_mfma_f32_16x16x32_bf16 v[32:35], v[52:55], v[96:99], v[32:35]
    v_mfma_f32_16x16x32_bf16 v[36:39], v[52:55], v[100:103], v[36:39]
    s_waitcnt lgkmcnt(0)
    s_nop 0
    v_mfma_f32_16x16x32_bf16 v[8:11], v[56:59], v[104:107], v[8:11]
    ds_read_b128 v[40:43], v4 offset:8192
    v_mfma_f32_16x16x32_bf16 v[12:15], v[56:59], v[108:111], v[12:15]
    ds_read_b128 v[44:47], v4 offset:9216
    v_mfma_f32_16x16x32_bf16 v[16:19], v[60:63], v[104:107], v[16:19]
    ds_read_b128 v[48:51], v4 offset:10240
    v_mfma_f32_16x16x32_bf16 v[20:23], v[60:63], v[108:111], v[20:23]
    ds_read_b128 v[52:55], v4 offset:11264
    v_mfma_f32_16x16x32_bf16 v[24:27], v[64:67], v[104:107], v[24:27]
    buffer_load_dwordx4 v[152:155], v5, s[4:7], s51 offen offset:0
    v_mfma_f32_16x16x32_bf16 v[28:31], v[64:67], v[108:111], v[28:31]
    buffer_load_dwordx4 v[156:159], v5, s[4:7], s51 offen offset:1024
    s_add_u32 s51, s51, 262144
    v_mfma_f32_16x16x32_bf16 v[32:35], v[68:71], v[104:107], v[32:35]
    buffer_load_dwordx4 v[72:75], v5, s[12:15], s46 offen offset:0
    buffer_load_dwordx4 v[76:79], v5, s[12:15], s46 offen offset:1024
    v_mfma_f32_16x16x32_bf16 v[36:39], v[68:71], v[108:111], v[36:39]
    buffer_load_dwordx4 v[80:83], v5, s[12:15], s47 offen offset:0
    buffer_load_dwordx4 v[84:87], v5, s[12:15], s47 offen offset:1024
    s_waitcnt vmcnt(12) lgkmcnt(0)
    s_nop 0
    v_mfma_f32_16x16x32_bf16 v[8:11], v[40:43], v[112:115], v[8:11]
    ds_read_b128 v[56:59], v4 offset:12288
    v_mfma_f32_16x16x32_bf16 v[12:15], v[40:43], v[116:119], v[12:15]
    ds_read_b128 v[60:63], v4 offset:13312
    v_mfma_f32_16x16x32_bf16 v[16:19], v[44:47], v[112:115], v[16:19]
    ds_read_b128 v[64:67], v4 offset:14336
    v_mfma_f32_16x16x32_bf16 v[20:23], v[44:47], v[116:119], v[20:23]
    ds_read_b128 v[68:71], v4 offset:15360
    v_mfma_f32_16x16x32_bf16 v[24:27], v[48:51], v[112:115], v[24:27]
    v_mfma_f32_16x16x32_bf16 v[28:31], v[48:51], v[116:119], v[28:31]
    v_mfma_f32_16x16x32_bf16 v[32:35], v[52:55], v[112:115], v[32:35]
    v_mfma_f32_16x16x32_bf16 v[36:39], v[52:55], v[116:119], v[36:39]
    s_waitcnt lgkmcnt(0)
    s_nop 0
    v_mfma_f32_16x16x32_bf16 v[8:11], v[56:59], v[120:123], v[8:11]
    ds_read_b128 v[40:43], v4 offset:16384
    v_mfma_f32_16x16x32_bf16 v[12:15], v[56:59], v[124:127], v[12:15]
    ds_read_b128 v[44:47], v4 offset:17408
    v_mfma_f32_16x16x32_bf16 v[16:19], v[60:63], v[120:123], v[16:19]
    ds_read_b128 v[48:51], v4 offset:18432
    v_mfma_f32_16x16x32_bf16 v[20:23], v[60:63], v[124:127], v[20:23]
    ds_read_b128 v[52:55], v4 offset:19456
    v_mfma_f32_16x16x32_bf16 v[24:27], v[64:67], v[120:123], v[24:27]
    v_mfma_f32_16x16x32_bf16 v[28:31], v[64:67], v[124:127], v[28:31]
    v_mfma_f32_16x16x32_bf16 v[32:35], v[68:71], v[120:123], v[32:35]
    v_mfma_f32_16x16x32_bf16 v[36:39], v[68:71], v[124:127], v[36:39]
    s_waitcnt vmcnt(8) lgkmcnt(0)
    s_nop 0
    v_mfma_f32_16x16x32_bf16 v[8:11], v[40:43], v[128:131], v[8:11]
    ds_read_b128 v[56:59], v4 offset:20480
    v_mfma_f32_16x16x32_bf16 v[12:15], v[40:43], v[132:135], v[12:15]
    ds_read_b128 v[60:63], v4 offset:21504
    v_mfma_f32_16x16x32_bf16 v[16:19], v[44:47], v[128:131], v[16:19]
    ds_read_b128 v[64:67], v4 offset:22528
    v_mfma_f32_16x16x32_bf16 v[20:23], v[44:47], v[132:135], v[20:23]
    ds_read_b128 v[68:71], v4 offset:23552
    v_mfma_f32_16x16x32_bf16 v[24:27], v[48:51], v[128:131], v[24:27]
    v_mfma_f32_16x16x32_bf16 v[28:31], v[48:51], v[132:135], v[28:31]
    v_mfma_f32_16x16x32_bf16 v[32:35], v[52:55], v[128:131], v[32:35]
    v_mfma_f32_16x16x32_bf16 v[36:39], v[52:55], v[132:135], v[36:39]
    s_waitcnt lgkmcnt(0)
    s_nop 0
    v_mfma_f32_16x16x32_bf16 v[8:11], v[56:59], v[136:139], v[8:11]
    ds_read_b128 v[40:43], v4 offset:24576
    v_mfma_f32_16x16x32_bf16 v[12:15], v[56:59], v[140:143], v[12:15]
    ds_read_b128 v[44:47], v4 offset:25600
    v_mfma_f32_16x16x32_bf16 v[16:19], v[60:63], v[136:139], v[16:19]
    ds_read_b128 v[48:51], v4 offset:26624
    v_mfma_f32_16x16x32_bf16 v[20:23], v[60:63], v[140:143], v[20:23]
    ds_read_b128 v[52:55], v4 offset:27648
    v_mfma_f32_16x16x32_bf16 v[24:27], v[64:67], v[136:139], v[24:27]
    v_mfma_f32_16x16x32_bf16 v[28:31], v[64:67], v[140:143], v[28:31]
    v_mfma_f32_16x16x32_bf16 v[32:35], v[68:71], v[136:139], v[32:35]
    v_mfma_f32_16x16x32_bf16 v[36:39], v[68:71], v[140:143], v[36:39]
    s_waitcnt vmcnt(4) lgkmcnt(0)
    s_nop 0
    v_mfma_f32_16x16x32_bf16 v[8:11], v[40:43], v[144:147], v[8:11]
    ds_read_b128 v[56:59], v4 offset:28672
    v_mfma_f32_16x16x32_bf16 v[12:15], v[40:43], v[148:151], v[12:15]
    ds_read_b128 v[60:63], v4 offset:29696
    v_mfma_f32_16x16x32_bf16 v[16:19], v[44:47], v[144:147], v[16:19]
    ds_read_b128 v[64:67], v4 offset:30720
    v_mfma_f32_16x16x32_bf16 v[20:23], v[44:47], v[148:151], v[20:23]
    ds_read_b128 v[68:71], v4 offset:31744
    v_mfma_f32_16x16x32_bf16 v[24:27], v[48:51], v[144:147], v[24:27]
    v_mfma_f32_16x16x32_bf16 v[28:31], v[48:51], v[148:151], v[28:31]
    s_add_u32 s54, s44, 32768
    s_cmp_eq_u32 s54, 131072
    .long 0x853636ff, 0x0
    s_sub_u32 s54, s54, s44
    s_add_u32 s44, s44, s54
    v_mfma_f32_16x16x32_bf16 v[32:35], v[52:55], v[144:147], v[32:35]
    v_add_u32_e64 v4, s54, v4
    v_mfma_f32_16x16x32_bf16 v[36:39], v[52:55], v[148:151], v[36:39]
    s_waitcnt lgkmcnt(0)
    s_barrier
    v_mfma_f32_16x16x32_bf16 v[8:11], v[56:59], v[152:155], v[8:11]
    ds_read_b128 v[40:43], v4 offset:0
    v_mfma_f32_16x16x32_bf16 v[12:15], v[56:59], v[156:159], v[12:15]
    ds_read_b128 v[44:47], v4 offset:1024
    v_mfma_f32_16x16x32_bf16 v[16:19], v[60:63], v[152:155], v[16:19]
    ds_read_b128 v[48:51], v4 offset:2048
    v_mfma_f32_16x16x32_bf16 v[20:23], v[60:63], v[156:159], v[20:23]
    ds_read_b128 v[52:55], v4 offset:3072
    v_mfma_f32_16x16x32_bf16 v[24:27], v[64:67], v[152:155], v[24:27]
    v_mfma_f32_16x16x32_bf16 v[28:31], v[64:67], v[156:159], v[28:31]
    v_mfma_f32_16x16x32_bf16 v[32:35], v[68:71], v[152:155], v[32:35]
    v_mfma_f32_16x16x32_bf16 v[36:39], v[68:71], v[156:159], v[36:39]
    s_mov_b32 s76, 0xffff0000
    s_waitcnt vmcnt(0) lgkmcnt(0)
    v_lshlrev_b32 v96, 16, v72
    v_and_b32 v97, s76, v72
    v_lshlrev_b32 v98, 16, v73
    v_and_b32_e64 v99, s76, v73
    v_pk_add_f32 v[8:9], v[8:9], v[96:97]
    v_pk_add_f32 v[10:11], v[10:11], v[98:99]
    v_lshlrev_b32 v100, 16, v74
    v_and_b32 v101, s76, v74
    v_lshlrev_b32 v102, 16, v75
    v_and_b32 v103, s76, v75
    v_pk_add_f32 v[16:17], v[16:17], v[100:101]
    v_pk_add_f32 v[18:19], v[18:19], v[102:103]
    v_cvt_pk_bf16_f32 v112, v8, v9
    v_cvt_pk_bf16_f32 v113, v10, v11
    v_cvt_pk_bf16_f32 v114, v16, v17
    v_cvt_pk_bf16_f32 v115, v18, v19
    buffer_store_dwordx4 v[112:115], v5, s[16:19], s46 offen offset:0 sc0 sc1
    v_lshlrev_b32 v104, 16, v76
    v_and_b32 v105, s76, v76
    v_lshlrev_b32 v106, 16, v77
    v_and_b32 v107, s76, v77
    v_pk_add_f32 v[12:13], v[12:13], v[104:105]
    v_pk_add_f32 v[14:15], v[14:15], v[106:107]
    v_lshlrev_b32 v108, 16, v78
    v_and_b32 v109, s76, v78
    v_lshlrev_b32 v110, 16, v79
    v_and_b32 v111, s76, v79
    v_pk_add_f32 v[20:21], v[20:21], v[108:109]
    v_pk_add_f32 v[22:23], v[22:23], v[110:111]
    v_cvt_pk_bf16_f32 v116, v12, v13
    v_cvt_pk_bf16_f32 v117, v14, v15
    v_cvt_pk_bf16_f32 v118, v20, v21
    v_cvt_pk_bf16_f32 v119, v22, v23
    buffer_store_dwordx4 v[116:119], v5, s[16:19], s46 offen offset:1024 sc0 sc1
    v_lshlrev_b32 v96, 16, v80
    v_and_b32 v97, s76, v80
    v_lshlrev_b32 v98, 16, v81
    v_and_b32 v99, s76, v81
    v_pk_add_f32 v[24:25], v[24:25], v[96:97]
    v_pk_add_f32 v[26:27], v[26:27], v[98:99]
    v_lshlrev_b32 v100, 16, v82
    v_and_b32 v101, s76, v82
    v_lshlrev_b32 v102, 16, v83
    v_and_b32 v103, s76, v83
    v_pk_add_f32 v[32:33], v[32:33], v[100:101]
    v_pk_add_f32 v[34:35], v[34:35], v[102:103]
    v_cvt_pk_bf16_f32 v120, v24, v25
    v_cvt_pk_bf16_f32 v121, v26, v27
    v_cvt_pk_bf16_f32 v122, v32, v33
    v_cvt_pk_bf16_f32 v123, v34, v35
    buffer_store_dwordx4 v[120:123], v5, s[16:19], s47 offen offset:0 sc0 sc1
    v_lshlrev_b32 v104, 16, v84
    v_and_b32 v105, s76, v84
    v_lshlrev_b32 v106, 16, v85
    v_and_b32 v107, s76, v85
    v_pk_add_f32 v[28:29], v[28:29], v[104:105]
    v_pk_add_f32 v[30:31], v[30:31], v[106:107]
    v_lshlrev_b32 v108, 16, v86
    v_and_b32 v109, s76, v86
    v_lshlrev_b32 v110, 16, v87
    v_and_b32 v111, s76, v87
    v_pk_add_f32 v[36:37], v[36:37], v[108:109]
    v_pk_add_f32 v[38:39], v[38:39], v[110:111]
    v_cvt_pk_bf16_f32 v124, v28, v29
    v_cvt_pk_bf16_f32 v125, v30, v31
    v_cvt_pk_bf16_f32 v126, v36, v37
    v_cvt_pk_bf16_f32 v127, v38, v39
    buffer_store_dwordx4 v[124:127], v5, s[16:19], s47 offen offset:1024 sc0 sc1
    s_mov_b32 s76, 0x3f803f80
    v_dot2_f32_bf16 v88, v112, s76, 0
    v_dot2_f32_bf16 v89, v112, v112, 0
    v_dot2_f32_bf16 v90, v116, s76, 0
    v_dot2_f32_bf16 v91, v116, v116, 0
    v_dot2_f32_bf16 v88, v113, s76, v88
    v_dot2_f32_bf16 v89, v113, v113, v89
    v_dot2_f32_bf16 v90, v117, s76, v90
    v_dot2_f32_bf16 v91, v117, v117, v91
    v_dot2_f32_bf16 v88, v114, s76, v88
    v_dot2_f32_bf16 v89, v114, v114, v89
    v_dot2_f32_bf16 v90, v118, s76, v90
    v_dot2_f32_bf16 v91, v118, v118, v91
    v_dot2_f32_bf16 v88, v115, s76, v88
    v_dot2_f32_bf16 v89, v115, v115, v89
    v_dot2_f32_bf16 v90, v119, s76, v90
    v_dot2_f32_bf16 v91, v119, v119, v91
    v_dot2_f32_bf16 v88, v120, s76, v88
    v_dot2_f32_bf16 v89, v120, v120, v89
    v_dot2_f32_bf16 v90, v124, s76, v90
    v_dot2_f32_bf16 v91, v124, v124, v91
    v_dot2_f32_bf16 v88, v121, s76, v88
    v_dot2_f32_bf16 v89, v121, v121, v89
    v_dot2_f32_bf16 v90, v125, s76, v90
    v_dot2_f32_bf16 v91, v125, v125, v91
    v_dot2_f32_bf16 v88, v122, s76, v88
    v_dot2_f32_bf16 v89, v122, v122, v89
    v_dot2_f32_bf16 v90, v126, s76, v90
    v_dot2_f32_bf16 v91, v126, v126, v91
    v_dot2_f32_bf16 v88, v123, s76, v88
    v_dot2_f32_bf16 v89, v123, v123, v89
    v_dot2_f32_bf16 v90, v127, s76, v90
    v_dot2_f32_bf16 v91, v127, v127, v91
    s_lshl_b32 s45, s41, 14
    s_lshl_b32 s48, s40, 12
    s_add_u32 s45, s45, s48
    s_lshl_b32 s48, s42, 7
    s_add_u32 s45, s45, s48
    v_lshlrev_b32 v1, 3, v0
    v_permlane32_swap_b32 v88, v89
    v_permlane32_swap_b32 v90, v91
    v_add_f32 v88, v88, v89
    v_add_f32 v90, v90, v91
    v_mov_b32 v92, v88
    v_mov_b32 v93, v90
    s_nop 0
    v_permlane16_swap_b32 v88, v92
    v_permlane16_swap_b32 v90, v93
    v_add_f32 v88, v88, v92
    v_add_f32 v90, v90, v93
    v_mov_b32 v89, v88
    v_mov_b32 v91, v90
    s_nop 0
    v_permlane32_swap_b32 v88, v89
    v_permlane32_swap_b32 v90, v91
    s_mov_b64 exec, 0xffff
    buffer_store_dwordx2 v[88:89], v1, s[24:27], s45 offen offset:0 sc0 sc1
    buffer_store_dwordx2 v[90:91], v1, s[24:27], s45 offen offset:2048 sc0 sc1
    s_mov_b64 exec, -1
    s_waitcnt vmcnt(0) lgkmcnt(0)
    s_barrier
    s_cmp_lg_u32 s40, 0
    s_cbranch_scc1 interleave_layers__linear_kernel_hedgehog__geglu_ffn__prompt_kernel_nf60
    s_lshl_b32 s74, s41, 11
    s_lshl_b32 s75, s42, 7
    s_add_u32 s74, s74, s75
    s_add_u32 s74, s74, 458752
    v_mov_b32 v239, 0
    v_mov_b32_e64 v240, s60
    s_mov_b64 exec, 1
    buffer_store_dword v240, v239, s[56:59], s74 offen sc0 sc1
    s_mov_b64 exec, -1
interleave_layers__linear_kernel_hedgehog__geglu_ffn__prompt_kernel_nf60:
    s_branch mega_ph4
mega_ph4:
    s_and_b32 s45, s2, 7
    s_lshr_b32 s49, s2, 3
    s_and_b32 s41, s45, 1
    s_lshl_b32 s41, s41, 2
    s_lshr_b32 s42, s45, 1
    s_mul_i32 s42, s42, 8
    s_and_b32 s45, s49, 3
    s_add_u32 s41, s41, s45
    s_lshr_b32 s45, s49, 2
    s_add_u32 s42, s42, s45
    s_and_b32 s52, s40, 3
    v_lshlrev_b32 v3, 4, v0
    s_mul_i32 s47, s42, 196608
    s_add_u32 s8, s68, 0x4f00000
    .long 0x8209ff45, 0x0
    s_mov_b32 s10, 0x600000
    s_mov_b32 s11, 0x00020000
    s_mul_i32 s51, s40, 3072
    v_add_u32_e64 v11, s51, v3
    s_add_u32 m0, s51, 0
    s_nop 0
    buffer_load_dwordx4 v11, s[8:11], s47 offen offset:0 lds
    buffer_load_dwordx4 v11, s[8:11], s47 offen offset:1024 lds
    buffer_load_dwordx4 v11, s[8:11], s47 offen offset:2048 lds
    s_add_u32 s47, s47, 24576
    s_add_u32 m0, s51, 24576
    s_mov_b32 s99, 0x1000
    buffer_load_dwordx4 v11, s[8:11], s47 offen offset:0 lds
    buffer_load_dwordx4 v11, s[8:11], s47 offen offset:1024 lds
    buffer_load_dwordx4 v11, s[8:11], s47 offen offset:2048 lds
    s_add_u32 s47, s47, 24576
    v_mov_b32 v13, v3
    s_lshl_b32 s46, s41, 14
    s_lshl_b32 s45, s40, 11
    s_add_u32 s46, s46, s45
    s_add_u32 s4, s68, 0x800000
    .long 0x8205ff45, 0x0
    s_mov_b32 s6, 0x400000
    s_mov_b32 s7, 0x00020000
    s_add_u32 s12, s68, 0x4cc0000
    .long 0x820dff45, 0x0
    s_mov_b32 s14, 0x40000
    s_mov_b32 s15, 0x00020000
    s_add_u32 s16, s68, 0x5e00000
    .long 0x8211ff45, 0x0
    s_mov_b32 s18, 0x30000
    s_mov_b32 s19, 0x00020000
    s_add_u32 s24, s68, 0x4dc0000
    .long 0x8219ff45, 0x0
    s_mov_b32 s26, 0x10000
    s_mov_b32 s27, 0x00020000
    s_lshl_b32 s45, s41, 8
    s_lshl_b32 s48, s40, 5
    s_add_u32 s45, s45, s48
    v_and_b32 v15, 15, v0
    v_lshlrev_b32 v15, 3, v15
    s_lshl_b32 s74, s45, 7
    v_add_u32 v15, s74, v15
    v_lshrrev_b32 v5, 4, v0
    v_lshl_add_u32 v15, v5, 9, v15
    v_lshrrev_b32_e64 v17, 3, v0
    v_mul_u32_u24 v17, 24576, v17
    v_and_b32_e64 v9, 7, v0
    v_lshl_add_u32 v17, v9, 4, v17
    s_min_u32 s48, s40, 2
    s_lshl_b32 s49, s48, 12
    s_lshl_b32 s53, s42, 7
    s_add_u32 s49, s49, s53
    s_add_u32 s43, s49, 12288
    s_lshl_b32 s45, s42, 11
    s_cmp_lg_u32 s40, 7
    s_cbranch_scc1 interleave_layers__linear_kernel_hedgehog__geglu_ffn__prompt_kernel_np61
    s_lshl_b32 s54, s41, 12
    s_add_u32 s54, s54, 458752
    v_lshlrev_b32 v5, 7, v0
    s_mov_b32 exec_lo, 0xffffffff
    s_mov_b32 exec_hi, 0x0
    s_mov_b32 s74, 0
interleave_layers__linear_kernel_hedgehog__geglu_ffn__prompt_kernel_poll62:
    buffer_load_dword v244, v5, s[56:59], s54 offen sc1
    s_add_u32 s74, s74, 1
    s_waitcnt vmcnt(0)
    v_cmp_ne_u32 vcc, s60, v244
    s_nop 0
    s_cmp_eq_u64 vcc, 0
    s_cbranch_scc1 interleave_layers__linear_kernel_hedgehog__geglu_ffn__prompt_kernel_polled63
    s_mov_b64 exec, vcc
    s_sleep 4
    s_cmp_lt_u32 s74, 50000
    s_cbranch_scc1 interleave_layers__linear_kernel_hedgehog__geglu_ffn__prompt_kernel_poll62
interleave_layers__linear_kernel_hedgehog__geglu_ffn__prompt_kernel_polled63:
    s_mov_b64 exec, -1
interleave_layers__linear_kernel_hedgehog__geglu_ffn__prompt_kernel_np61:
    s_waitcnt vmcnt(3)
    s_barrier
    buffer_load_dwordx4 v[116:119], v3, s[4:7], s46 offen
    buffer_load_dwordx4 v[120:123], v3, s[4:7], s46 offen offset:1024
    s_add_u32 s46, s46, 131072
    buffer_load_dwordx4 v[124:127], v3, s[4:7], s46 offen
    buffer_load_dwordx4 v[128:131], v3, s[4:7], s46 offen offset:1024
    s_add_u32 s46, s46, 131072
    buffer_load_dwordx4 v[132:135], v3, s[4:7], s46 offen
    buffer_load_dwordx4 v[136:139], v3, s[4:7], s46 offen offset:1024
    s_add_u32 s46, s46, 131072
    ds_read_b128 v[68:71], v13 offset:0
    ds_read_b128 v[72:75], v13 offset:1024
    ds_read_b128 v[76:79], v13 offset:2048
    ds_read_b128 v[80:83], v13 offset:3072
    ds_read_b128 v[84:87], v13 offset:4096
    ds_read_b128 v[88:91], v13 offset:5120
    s_waitcnt vmcnt(4) lgkmcnt(0)
    s_nop 0
    v_mfma_f32_16x16x32_bf16 v[36:39], v[76:79], v[116:119], 0
    v_mfma_f32_16x16x32_bf16 v[40:43], v[76:79], v[120:123], 0
    ds_read_b128 v[92:95], v13 offset:6144
    v_mfma_f32_16x16x32_bf16 v[44:47], v[80:83], v[116:119], 0
    ds_read_b128 v[96:99], v13 offset:7168
    buffer_load_dwordx4 v[140:143], v3, s[4:7], s46 offen
    v_mfma_f32_16x16x32_bf16 v[48:51], v[80:83], v[120:123], 0
    ds_read_b128 v[100:103], v13 offset:8192
    v_mfma_f32_16x16x32_bf16 v[52:55], v[116:119], v[84:87], 0
    ds_read_b128 v[104:107], v13 offset:9216
    v_mfma_f32_16x16x32_bf16 v[56:59], v[120:123], v[84:87], 0
    ds_read_b128 v[108:111], v13 offset:10240
    v_mfma_f32_16x16x32_bf16 v[60:63], v[116:119], v[88:91], 0
    ds_read_b128 v[112:115], v13 offset:11264
    buffer_load_dwordx4 v[144:147], v3, s[4:7], s46 offen offset:1024
    s_add_u32 s46, s46, 131072
    v_mfma_f32_16x16x32_bf16 v[64:67], v[120:123], v[88:91], 0
    s_add_u32 m0, s51, 49152
    s_mov_b32 s99, 0x1000
    buffer_load_dwordx4 v11, s[8:11], s47 offen offset:0 lds
    v_mfma_f32_16x16x32_bf16 v[20:23], v[68:71], v[116:119], 0
    buffer_load_dwordx4 v11, s[8:11], s47 offen offset:1024 lds
    v_mfma_f32_16x16x32_bf16 v[24:27], v[68:71], v[120:123], 0
    buffer_load_dwordx4 v11, s[8:11], s47 offen offset:2048 lds
    s_add_u32 s47, s47, 24576
    v_mfma_f32_16x16x32_bf16 v[28:31], v[72:75], v[116:119], 0
    v_mfma_f32_16x16x32_bf16 v[32:35], v[72:75], v[120:123], 0
    s_waitcnt vmcnt(7) lgkmcnt(0)
    s_nop 0
    v_mfma_f32_16x16x32_bf16 v[36:39], v[100:103], v[124:127], v[36:39]
    v_mfma_f32_16x16x32_bf16 v[40:43], v[100:103], v[128:131], v[40:43]
    ds_read_b128 v[68:71], v13 offset:12288
    v_mfma_f32_16x16x32_bf16 v[44:47], v[104:107], v[124:127], v[44:47]
    ds_read_b128 v[72:75], v13 offset:13312
    buffer_load_dwordx4 v[116:119], v3, s[4:7], s46 offen
    v_mfma_f32_16x16x32_bf16 v[48:51], v[104:107], v[128:131], v[48:51]
    ds_read_b128 v[76:79], v13 offset:14336
    v_mfma_f32_16x16x32_bf16 v[52:55], v[124:127], v[108:111], v[52:55]
    ds_read_b128 v[80:83], v13 offset:15360
    v_mfma_f32_16x16x32_bf16 v[56:59], v[128:131], v[108:111], v[56:59]
    ds_read_b128 v[84:87], v13 offset:16384
    v_mfma_f32_16x16x32_bf16 v[60:63], v[124:127], v[112:115], v[60:63]
    ds_read_b128 v[88:91], v13 offset:17408
    buffer_load_dwordx4 v[120:123], v3, s[4:7], s46 offen offset:1024
    s_add_u32 s46, s46, 131072
    v_mfma_f32_16x16x32_bf16 v[64:67], v[128:131], v[112:115], v[64:67]
    s_add_u32 m0, s51, 73728
    s_mov_b32 s99, 0x1000
    buffer_load_dwordx4 v11, s[8:11], s47 offen offset:0 lds
    v_mfma_f32_16x16x32_bf16 v[20:23], v[92:95], v[124:127], v[20:23]
    buffer_load_dwordx4 v11, s[8:11], s47 offen offset:1024 lds
    v_mfma_f32_16x16x32_bf16 v[24:27], v[92:95], v[128:131], v[24:27]
    buffer_load_dwordx4 v11, s[8:11], s47 offen offset:2048 lds
    s_add_u32 s47, s47, 24576
    v_mfma_f32_16x16x32_bf16 v[28:31], v[96:99], v[124:127], v[28:31]
    v_mfma_f32_16x16x32_bf16 v[32:35], v[96:99], v[128:131], v[32:35]
    s_waitcnt vmcnt(10) lgkmcnt(0)
    s_nop 0
    v_mfma_f32_16x16x32_bf16 v[36:39], v[76:79], v[132:135], v[36:39]
    v_mfma_f32_16x16x32_bf16 v[40:43], v[76:79], v[136:139], v[40:43]
    ds_read_b128 v[92:95], v13 offset:18432
    v_mfma_f32_16x16x32_bf16 v[44:47], v[80:83], v[132:135], v[44:47]
    ds_read_b128 v[96:99], v13 offset:19456
    buffer_load_dwordx4 v[124:127], v3, s[4:7], s46 offen
    v_mfma_f32_16x16x32_bf16 v[48:51], v[80:83], v[136:139], v[48:51]
    ds_read_b128 v[100:103], v13 offset:20480
    v_mfma_f32_16x16x32_bf16 v[52:55], v[132:135], v[84:87], v[52:55]
    ds_read_b128 v[104:107], v13 offset:21504
    v_mfma_f32_16x16x32_bf16 v[56:59], v[136:139], v[84:87], v[56:59]
    ds_read_b128 v[108:111], v13 offset:22528
    v_mfma_f32_16x16x32_bf16 v[60:63], v[132:135], v[88:91], v[60:63]
    ds_read_b128 v[112:115], v13 offset:23552
    buffer_load_dwordx4 v[128:131], v3, s[4:7], s46 offen offset:1024
    s_add_u32 s46, s46, 131072
    v_mfma_f32_16x16x32_bf16 v[64:67], v[136:139], v[88:91], v[64:67]
    v_mfma_f32_16x16x32_bf16 v[20:23], v[68:71], v[132:135], v[20:23]
    v_mfma_f32_16x16x32_bf16 v[24:27], v[68:71], v[136:139], v[24:27]
    v_mfma_f32_16x16x32_bf16 v[28:31], v[72:75], v[132:135], v[28:31]
    v_mfma_f32_16x16x32_bf16 v[32:35], v[72:75], v[136:139], v[32:35]
    s_waitcnt vmcnt(10) lgkmcnt(0)
    v_mfma_f32_16x16x32_bf16 v[36:39], v[100:103], v[140:143], v[36:39]
    s_barrier
    v_mfma_f32_16x16x32_bf16 v[40:43], v[100:103], v[144:147], v[40:43]
    ds_read_b128 v[68:71], v13 offset:24576
    v_mfma_f32_16x16x32_bf16 v[44:47], v[104:107], v[140:143], v[44:47]
    ds_read_b128 v[72:75], v13 offset:25600
    buffer_load_dwordx4 v[132:135], v3, s[4:7], s46 offen
    v_mfma_f32_16x16x32_bf16 v[48:51], v[104:107], v[144:147], v[48:51]
    ds_read_b128 v[76:79], v13 offset:26624
    v_mfma_f32_16x16x32_bf16 v[52:55], v[140:143], v[108:111], v[52:55]
    ds_read_b128 v[80:83], v13 offset:27648
    v_mfma_f32_16x16x32_bf16 v[56:59], v[144:147], v[108:111], v[56:59]
    ds_read_b128 v[84:87], v13 offset:28672
    v_mfma_f32_16x16x32_bf16 v[60:63], v[140:143], v[112:115], v[60:63]
    ds_read_b128 v[88:91], v13 offset:29696
    buffer_load_dwordx4 v[136:139], v3, s[4:7], s46 offen offset:1024
    s_add_u32 s46, s46, 131072
    v_mfma_f32_16x16x32_bf16 v[64:67], v[144:147], v[112:115], v[64:67]
    s_add_u32 m0, s51, 98304
    s_mov_b32 s99, 0x1000
    buffer_load_dwordx4 v11, s[8:11], s47 offen offset:0 lds
    v_mfma_f32_16x16x32_bf16 v[20:23], v[92:95], v[140:143], v[20:23]
    buffer_load_dwordx4 v11, s[8:11], s47 offen offset:1024 lds
    v_mfma_f32_16x16x32_bf16 v[24:27], v[92:95], v[144:147], v[24:27]
    buffer_load_dwordx4 v11, s[8:11], s47 offen offset:2048 lds
    s_add_u32 s47, s47, 24576
    v_mfma_f32_16x16x32_bf16 v[28:31], v[96:99], v[140:143], v[28:31]
    v_mfma_f32_16x16x32_bf16 v[32:35], v[96:99], v[144:147], v[32:35]
    s_waitcnt vmcnt(10) lgkmcnt(0)
    s_nop 0
    v_mfma_f32_16x16x32_bf16 v[36:39], v[76:79], v[116:119], v[36:39]
    v_mfma_f32_16x16x32_bf16 v[40:43], v[76:79], v[120:123], v[40:43]
    ds_read_b128 v[92:95], v13 offset:30720
    v_mfma_f32_16x16x32_bf16 v[44:47], v[80:83], v[116:119], v[44:47]
    ds_read_b128 v[96:99], v13 offset:31744
    buffer_load_dwordx4 v[140:143], v3, s[4:7], s46 offen
    v_mfma_f32_16x16x32_bf16 v[48:51], v[80:83], v[120:123], v[48:51]
    ds_read_b128 v[100:103], v13 offset:32768
    v_mfma_f32_16x16x32_bf16 v[52:55], v[116:119], v[84:87], v[52:55]
    ds_read_b128 v[104:107], v13 offset:33792
    v_mfma_f32_16x16x32_bf16 v[56:59], v[120:123], v[84:87], v[56:59]
    ds_read_b128 v[108:111], v13 offset:34816
    v_mfma_f32_16x16x32_bf16 v[60:63], v[116:119], v[88:91], v[60:63]
    ds_read_b128 v[112:115], v13 offset:35840
    buffer_load_dwordx4 v[144:147], v3, s[4:7], s46 offen offset:1024
    s_add_u32 s46, s46, 131072
    v_mfma_f32_16x16x32_bf16 v[64:67], v[120:123], v[88:91], v[64:67]
    s_add_u32 m0, s51, 0
    s_nop 0
    buffer_load_dwordx4 v11, s[8:11], s47 offen offset:0 lds
    v_mfma_f32_16x16x32_bf16 v[20:23], v[68:71], v[116:119], v[20:23]
    buffer_load_dwordx4 v11, s[8:11], s47 offen offset:1024 lds
    v_mfma_f32_16x16x32_bf16 v[24:27], v[68:71], v[120:123], v[24:27]
    buffer_load_dwordx4 v11, s[8:11], s47 offen offset:2048 lds
    s_add_u32 s47, s47, 24576
    v_mfma_f32_16x16x32_bf16 v[28:31], v[72:75], v[116:119], v[28:31]
    v_mfma_f32_16x16x32_bf16 v[32:35], v[72:75], v[120:123], v[32:35]
    s_waitcnt vmcnt(10) lgkmcnt(0)
    s_nop 0
    v_mfma_f32_16x16x32_bf16 v[36:39], v[100:103], v[124:127], v[36:39]
    v_mfma_f32_16x16x32_bf16 v[40:43], v[100:103], v[128:131], v[40:43]
    ds_read_b128 v[68:71], v13 offset:36864
    v_mfma_f32_16x16x32_bf16 v[44:47], v[104:107], v[124:127], v[44:47]
    ds_read_b128 v[72:75], v13 offset:37888
    buffer_load_dwordx4 v[116:119], v3, s[4:7], s46 offen
    v_mfma_f32_16x16x32_bf16 v[48:51], v[104:107], v[128:131], v[48:51]
    ds_read_b128 v[76:79], v13 offset:38912
    v_mfma_f32_16x16x32_bf16 v[52:55], v[124:127], v[108:111], v[52:55]
    ds_read_b128 v[80:83], v13 offset:39936
    v_mfma_f32_16x16x32_bf16 v[56:59], v[128:131], v[108:111], v[56:59]
    ds_read_b128 v[84:87], v13 offset:40960
    v_mfma_f32_16x16x32_bf16 v[60:63], v[124:127], v[112:115], v[60:63]
    ds_read_b128 v[88:91], v13 offset:41984
    buffer_load_dwordx4 v[120:123], v3, s[4:7], s46 offen offset:1024
    s_add_u32 s46, s46, 131072
    v_mfma_f32_16x16x32_bf16 v[64:67], v[128:131], v[112:115], v[64:67]
    v_mfma_f32_16x16x32_bf16 v[20:23], v[92:95], v[124:127], v[20:23]
    v_mfma_f32_16x16x32_bf16 v[24:27], v[92:95], v[128:131], v[24:27]
    v_mfma_f32_16x16x32_bf16 v[28:31], v[96:99], v[124:127], v[28:31]
    v_mfma_f32_16x16x32_bf16 v[32:35], v[96:99], v[128:131], v[32:35]
    s_waitcnt vmcnt(10) lgkmcnt(0)
    s_nop 0
    v_mfma_f32_16x16x32_bf16 v[36:39], v[76:79], v[132:135], v[36:39]
    v_mfma_f32_16x16x32_bf16 v[40:43], v[76:79], v[136:139], v[40:43]
    ds_read_b128 v[92:95], v13 offset:43008
    v_mfma_f32_16x16x32_bf16 v[44:47], v[80:83], v[132:135], v[44:47]
    ds_read_b128 v[96:99], v13 offset:44032
    buffer_load_dwordx4 v[124:127], v3, s[4:7], s46 offen
    v_mfma_f32_16x16x32_bf16 v[48:51], v[80:83], v[136:139], v[48:51]
    ds_read_b128 v[100:103], v13 offset:45056
    v_mfma_f32_16x16x32_bf16 v[52:55], v[132:135], v[84:87], v[52:55]
    ds_read_b128 v[104:107], v13 offset:46080
    v_mfma_f32_16x16x32_bf16 v[56:59], v[136:139], v[84:87], v[56:59]
    ds_read_b128 v[108:111], v13 offset:47104
    v_mfma_f32_16x16x32_bf16 v[60:63], v[132:135], v[88:91], v[60:63]
    ds_read_b128 v[112:115], v13 offset:48128
    buffer_load_dwordx4 v[128:131], v3, s[4:7], s46 offen offset:1024
    s_add_u32 s46, s46, 131072
    v_mfma_f32_16x16x32_bf16 v[64:67], v[136:139], v[88:91], v[64:67]
    buffer_load_dwordx2 v[220:221], v15, s[12:15], 0 offen offset:0
    buffer_load_dwordx2 v[222:223], v15, s[12:15], 0 offen offset:128
    v_mfma_f32_16x16x32_bf16 v[20:23], v[68:71], v[132:135], v[20:23]
    buffer_load_dwordx2 v[224:225], v15, s[12:15], 0 offen offset:256
    buffer_load_dwordx2 v[226:227], v15, s[12:15], 0 offen offset:384
    v_mfma_f32_16x16x32_bf16 v[24:27], v[68:71], v[136:139], v[24:27]
    buffer_load_dwordx2 v[228:229], v15, s[12:15], 0 offen offset:2048
    buffer_load_dwordx2 v[230:231], v15, s[12:15], 0 offen offset:2176
    v_mfma_f32_16x16x32_bf16 v[28:31], v[72:75], v[132:135], v[28:31]
    buffer_load_dwordx2 v[232:233], v15, s[12:15], 0 offen offset:2304
    buffer_load_dwordx2 v[234:235], v15, s[12:15], 0 offen offset:2432
    v_mfma_f32_16x16x32_bf16 v[32:35], v[72:75], v[136:139], v[32:35]
    s_waitcnt vmcnt(15) lgkmcnt(0)
    v_mfma_f32_16x16x32_bf16 v[36:39], v[100:103], v[140:143], v[36:39]
    s_barrier
    v_mfma_f32_16x16x32_bf16 v[40:43], v[100:103], v[144:147], v[40:43]
    ds_read_b128 v[68:71], v13 offset:49152
    v_mfma_f32_16x16x32_bf16 v[44:47], v[104:107], v[140:143], v[44:47]
    ds_read_b128 v[72:75], v13 offset:50176
    buffer_load_dwordx4 v[132:135], v3, s[4:7], s46 offen
    v_mfma_f32_16x16x32_bf16 v[48:51], v[104:107], v[144:147], v[48:51]
    ds_read_b128 v[76:79], v13 offset:51200
    v_mfma_f32_16x16x32_bf16 v[52:55], v[140:143], v[108:111], v[52:55]
    ds_read_b128 v[80:83], v13 offset:52224
    v_mfma_f32_16x16x32_bf16 v[56:59], v[144:147], v[108:111], v[56:59]
    ds_read_b128 v[84:87], v13 offset:53248
    v_mfma_f32_16x16x32_bf16 v[60:63], v[140:143], v[112:115], v[60:63]
    ds_read_b128 v[88:91], v13 offset:54272
    buffer_load_dwordx4 v[136:139], v3, s[4:7], s46 offen offset:1024
    s_add_u32 s46, s46, 131072
    v_mfma_f32_16x16x32_bf16 v[64:67], v[144:147], v[112:115], v[64:67]
    s_add_u32 m0, s51, 24576
    s_mov_b32 s99, 0x1000
    buffer_load_dwordx4 v11, s[8:11], s47 offen offset:0 lds
    v_mfma_f32_16x16x32_bf16 v[20:23], v[92:95], v[140:143], v[20:23]
    buffer_load_dwordx4 v11, s[8:11], s47 offen offset:1024 lds
    v_mfma_f32_16x16x32_bf16 v[24:27], v[92:95], v[144:147], v[24:27]
    buffer_load_dwordx4 v11, s[8:11], s47 offen offset:2048 lds
    s_add_u32 s47, s47, 24576
    v_mfma_f32_16x16x32_bf16 v[28:31], v[96:99], v[140:143], v[28:31]
    v_mfma_f32_16x16x32_bf16 v[32:35], v[96:99], v[144:147], v[32:35]
    s_waitcnt vmcnt(15) lgkmcnt(0)
    s_nop 0
    v_mfma_f32_16x16x32_bf16 v[36:39], v[76:79], v[116:119], v[36:39]
    v_mfma_f32_16x16x32_bf16 v[40:43], v[76:79], v[120:123], v[40:43]
    ds_read_b128 v[92:95], v13 offset:55296
    v_mfma_f32_16x16x32_bf16 v[44:47], v[80:83], v[116:119], v[44:47]
    ds_read_b128 v[96:99], v13 offset:56320
    buffer_load_dwordx4 v[140:143], v3, s[4:7], s46 offen
    v_mfma_f32_16x16x32_bf16 v[48:51], v[80:83], v[120:123], v[48:51]
    ds_read_b128 v[100:103], v13 offset:57344
    v_mfma_f32_16x16x32_bf16 v[52:55], v[116:119], v[84:87], v[52:55]
    ds_read_b128 v[104:107], v13 offset:58368
    v_mfma_f32_16x16x32_bf16 v[56:59], v[120:123], v[84:87], v[56:59]
    ds_read_b128 v[108:111], v13 offset:59392
    v_mfma_f32_16x16x32_bf16 v[60:63], v[116:119], v[88:91], v[60:63]
    ds_read_b128 v[112:115], v13 offset:60416
    buffer_load_dwordx4 v[144:147], v3, s[4:7], s46 offen offset:1024
    s_add_u32 s46, s46, 131072
    v_mfma_f32_16x16x32_bf16 v[64:67], v[120:123], v[88:91], v[64:67]
    v_mfma_f32_16x16x32_bf16 v[20:23], v[68:71], v[116:119], v[20:23]
    v_mfma_f32_16x16x32_bf16 v[24:27], v[68:71], v[120:123], v[24:27]
    v_mfma_f32_16x16x32_bf16 v[28:31], v[72:75], v[116:119], v[28:31]
    v_mfma_f32_16x16x32_bf16 v[32:35], v[72:75], v[120:123], v[32:35]
    s_waitcnt vmcnt(15) lgkmcnt(0)
    s_nop 0
    v_add_u32 v13, 61440, v3
    v_mfma_f32_16x16x32_bf16 v[36:39], v[100:103], v[124:127], v[36:39]
    v_mfma_f32_16x16x32_bf16 v[40:43], v[100:103], v[128:131], v[40:43]
    ds_read_b128 v[68:71], v13 offset:0
    v_mfma_f32_16x16x32_bf16 v[44:47], v[104:107], v[124:127], v[44:47]
    ds_read_b128 v[72:75], v13 offset:1024
    buffer_load_dwordx4 v[116:119], v3, s[4:7], s46 offen
    v_mfma_f32_16x16x32_bf16 v[48:51], v[104:107], v[128:131], v[48:51]
    ds_read_b128 v[76:79], v13 offset:2048
    v_mfma_f32_16x16x32_bf16 v[52:55], v[124:127], v[108:111], v[52:55]
    ds_read_b128 v[80:83], v13 offset:3072
    v_mfma_f32_16x16x32_bf16 v[56:59], v[128:131], v[108:111], v[56:59]
    ds_read_b128 v[84:87], v13 offset:4096
    v_mfma_f32_16x16x32_bf16 v[60:63], v[124:127], v[112:115], v[60:63]
    ds_read_b128 v[88:91], v13 offset:5120
    buffer_load_dwordx4 v[120:123], v3, s[4:7], s46 offen offset:1024
    s_add_u32 s46, s46, 131072
    v_mfma_f32_16x16x32_bf16 v[64:67], v[128:131], v[112:115], v[64:67]
    v_mfma_f32_16x16x32_bf16 v[20:23], v[92:95], v[124:127], v[20:23]
    v_mfma_f32_16x16x32_bf16 v[24:27], v[92:95], v[128:131], v[24:27]
    v_mfma_f32_16x16x32_bf16 v[28:31], v[96:99], v[124:127], v[28:31]
    v_mfma_f32_16x16x32_bf16 v[32:35], v[96:99], v[128:131], v[32:35]
    s_waitcnt vmcnt(7) lgkmcnt(0)
    s_nop 0
    v_mfma_f32_16x16x32_bf16 v[36:39], v[76:79], v[132:135], v[36:39]
    v_mfma_f32_16x16x32_bf16 v[40:43], v[76:79], v[136:139], v[40:43]
    ds_read_b128 v[92:95], v13 offset:6144
    v_mfma_f32_16x16x32_bf16 v[44:47], v[80:83], v[132:135], v[44:47]
    ds_read_b128 v[96:99], v13 offset:7168
    buffer_load_dwordx4 v[124:127], v3, s[4:7], s46 offen
    v_mfma_f32_16x16x32_bf16 v[48:51], v[80:83], v[136:139], v[48:51]
    ds_read_b128 v[100:103], v13 offset:8192
    v_mfma_f32_16x16x32_bf16 v[52:55], v[132:135], v[84:87], v[52:55]
    ds_read_b128 v[104:107], v13 offset:9216
    v_mfma_f32_16x16x32_bf16 v[56:59], v[136:139], v[84:87], v[56:59]
    ds_read_b128 v[108:111], v13 offset:10240
    v_mfma_f32_16x16x32_bf16 v[60:63], v[132:135], v[88:91], v[60:63]
    ds_read_b128 v[112:115], v13 offset:11264
    buffer_load_dwordx4 v[128:131], v3, s[4:7], s46 offen offset:1024
    s_add_u32 s46, s46, 131072
    v_mfma_f32_16x16x32_bf16 v[64:67], v[136:139], v[88:91], v[64:67]
    v_mfma_f32_16x16x32_bf16 v[20:23], v[68:71], v[132:135], v[20:23]
    v_mfma_f32_16x16x32_bf16 v[24:27], v[68:71], v[136:139], v[24:27]
    v_mfma_f32_16x16x32_bf16 v[28:31], v[72:75], v[132:135], v[28:31]
    buffer_load_dwordx4 v[172:175], v17, s[16:19], s49 offen
    v_mfma_f32_16x16x32_bf16 v[32:35], v[72:75], v[136:139], v[32:35]
    buffer_load_dwordx4 v[176:179], v17, s[16:19], s43 offen
    s_waitcnt vmcnt(6) lgkmcnt(0)
    v_mfma_f32_16x16x32_bf16 v[36:39], v[100:103], v[140:143], v[36:39]
    s_barrier
    v_mfma_f32_16x16x32_bf16 v[40:43], v[100:103], v[144:147], v[40:43]
    ds_read_b128 v[68:71], v13 offset:12288
    v_mfma_f32_16x16x32_bf16 v[44:47], v[104:107], v[140:143], v[44:47]
    ds_read_b128 v[72:75], v13 offset:13312
    buffer_load_dwordx4 v[132:135], v3, s[4:7], s46 offen
    v_mfma_f32_16x16x32_bf16 v[48:51], v[104:107], v[144:147], v[48:51]
    ds_read_b128 v[76:79], v13 offset:14336
    v_mfma_f32_16x16x32_bf16 v[52:55], v[140:143], v[108:111], v[52:55]
    ds_read_b128 v[80:83], v13 offset:15360
    v_mfma_f32_16x16x32_bf16 v[56:59], v[144:147], v[108:111], v[56:59]
    ds_read_b128 v[84:87], v13 offset:16384
    v_mfma_f32_16x16x32_bf16 v[60:63], v[140:143], v[112:115], v[60:63]
    ds_read_b128 v[88:91], v13 offset:17408
    buffer_load_dwordx4 v[136:139], v3, s[4:7], s46 offen offset:1024
    s_add_u32 s46, s46, 131072
    v_mfma_f32_16x16x32_bf16 v[64:67], v[144:147], v[112:115], v[64:67]
    s_add_u32 m0, s51, 49152
    s_mov_b32 s99, 0x1000
    buffer_load_dwordx4 v11, s[8:11], s47 offen offset:0 lds
    v_mfma_f32_16x16x32_bf16 v[20:23], v[92:95], v[140:143], v[20:23]
    buffer_load_dwordx4 v11, s[8:11], s47 offen offset:1024 lds
    v_mfma_f32_16x16x32_bf16 v[24:27], v[92:95], v[144:147], v[24:27]
    buffer_load_dwordx4 v11, s[8:11], s47 offen offset:2048 lds
    s_add_u32 s47, s47, 24576
    v_mfma_f32_16x16x32_bf16 v[28:31], v[96:99], v[140:143], v[28:31]
    v_mfma_f32_16x16x32_bf16 v[32:35], v[96:99], v[144:147], v[32:35]
    s_waitcnt vmcnt(5) lgkmcnt(0)
    s_nop 0
    v_mfma_f32_16x16x32_bf16 v[36:39], v[76:79], v[116:119], v[36:39]
    v_pk_add_f32 v[220:221], v[220:221], v[222:223]
    v_pk_add_f32 v[224:225], v[224:225], v[226:227]
    v_mfma_f32_16x16x32_bf16 v[40:43], v[76:79], v[120:123], v[40:43]
    ds_read_b128 v[92:95], v13 offset:18432
    v_pk_add_f32 v[228:229], v[228:229], v[230:231]
    v_pk_add_f32 v[232:233], v[232:233], v[234:235]
    v_mfma_f32_16x16x32_bf16 v[44:47], v[80:83], v[116:119], v[44:47]
    ds_read_b128 v[96:99], v13 offset:19456
    buffer_load_dwordx4 v[140:143], v3, s[4:7], s46 offen
    v_pk_add_f32 v[220:221], v[220:221], v[224:225]
    v_mfma_f32_16x16x32_bf16 v[48:51], v[80:83], v[120:123], v[48:51]
    ds_read_b128 v[100:103], v13 offset:20480
    v_pk_add_f32 v[228:229], v[228:229], v[232:233]
    v_permlane32_swap_b32 v220, v221
    v_mfma_f32_16x16x32_bf16 v[52:55], v[116:119], v[84:87], v[52:55]
    ds_read_b128 v[104:107], v13 offset:21504
    v_permlane32_swap_b32 v228, v229
    v_add_f32_e64 v220, v220, v221
    v_mfma_f32_16x16x32_bf16 v[56:59], v[120:123], v[84:87], v[56:59]
    ds_read_b128 v[108:111], v13 offset:22528
    v_add_f32_e64 v228, v228, v229
    v_mfma_f32_16x16x32_bf16 v[60:63], v[116:119], v[88:91], v[60:63]
    ds_read_b128 v[112:115], v13 offset:23552
    buffer_load_dwordx4 v[144:147], v3, s[4:7], s46 offen offset:1024
    s_add_u32 s46, s46, 131072
    v_mov_b32 v224, v220
    v_mov_b32 v232, v228
    v_mfma_f32_16x16x32_bf16 v[64:67], v[120:123], v[88:91], v[64:67]
    v_permlane16_swap_b32 v220, v224
    v_permlane16_swap_b32 v228, v232
    v_mfma_f32_16x16x32_bf16 v[20:23], v[68:71], v[116:119], v[20:23]
    v_add_f32_e64 v220, v220, v224
    v_mfma_f32_16x16x32_bf16 v[24:27], v[68:71], v[120:123], v[24:27]
    v_add_f32 v228, v228, v232
    v_mov_b32 v221, v220
    v_mfma_f32_16x16x32_bf16 v[28:31], v[72:75], v[116:119], v[28:31]
    v_mov_b32 v229, v228
    v_permlane32_swap_b32 v220, v221
    v_mfma_f32_16x16x32_bf16 v[32:35], v[72:75], v[120:123], v[32:35]
    v_permlane32_swap_b32 v228, v229
    s_waitcnt vmcnt(9) lgkmcnt(0)
    v_mfma_f32_16x16x32_bf16 v[36:39], v[100:103], v[124:127], v[36:39]
    s_mov_b32 s74, 0xba800000
    s_mov_b32 s75, 0x3727c5ac
    v_mfma_f32_16x16x32_bf16 v[40:43], v[100:103], v[128:131], v[40:43]
    ds_read_b128 v[68:71], v13 offset:24576
    v_mul_f32 v223, s74, v220
    v_mul_f32 v221, s74, v221
    v_mfma_f32_16x16x32_bf16 v[44:47], v[104:107], v[124:127], v[44:47]
    ds_read_b128 v[72:75], v13 offset:25600
    buffer_load_dwordx4 v[116:119], v3, s[4:7], s46 offen
    v_mul_f32_e64 v231, s74, v228
    v_mfma_f32_16x16x32_bf16 v[48:51], v[104:107], v[128:131], v[48:51]
    ds_read_b128 v[76:79], v13 offset:26624
    v_mul_f32_e64 v229, s74, v229
    v_fma_f32 v221, -v223, v223, -v221
    v_mfma_f32_16x16x32_bf16 v[52:55], v[124:127], v[108:111], v[52:55]
    ds_read_b128 v[80:83], v13 offset:27648
    v_fma_f32 v229, -v231, v231, -v229
    v_max_f32_e64 v221, 0, v221
    v_mfma_f32_16x16x32_bf16 v[56:59], v[128:131], v[108:111], v[56:59]
    ds_read_b128 v[84:87], v13 offset:28672
    v_max_f32_e64 v229, 0, v229
    v_mfma_f32_16x16x32_bf16 v[60:63], v[124:127], v[112:115], v[60:63]
    ds_read_b128 v[88:91], v13 offset:29696
    buffer_load_dwordx4 v[120:123], v3, s[4:7], s46 offen offset:1024
    s_add_u32 s46, s46, 131072
    v_add_f32 v221, s75, v221
    v_add_f32 v229, s75, v229
    v_mfma_f32_16x16x32_bf16 v[64:67], v[128:131], v[112:115], v[64:67]
    v_rsq_f32 v222, v221
    v_rsq_f32 v230, v229
    v_mfma_f32_16x16x32_bf16 v[20:23], v[92:95], v[124:127], v[20:23]
    v_pk_add_f32 v[172:173], v[172:173], v[176:177]
    v_mfma_f32_16x16x32_bf16 v[24:27], v[92:95], v[128:131], v[24:27]
    v_pk_add_f32 v[174:175], v[174:175], v[178:179]
    v_add_f32_dpp v172, v172, v172 row_ror:8 row_mask:0xf bank_mask:0xf
    v_mfma_f32_16x16x32_bf16 v[28:31], v[96:99], v[124:127], v[28:31]
    v_add_f32_dpp v173, v173, v173 row_ror:8 row_mask:0xf bank_mask:0xf
    v_add_f32_dpp v174, v174, v174 row_ror:8 row_mask:0xf bank_mask:0xf
    v_mfma_f32_16x16x32_bf16 v[32:35], v[96:99], v[128:131], v[32:35]
    v_add_f32_dpp v175, v175, v175 row_ror:8 row_mask:0xf bank_mask:0xf
    s_waitcnt vmcnt(7) lgkmcnt(0)
    v_mfma_f32_16x16x32_bf16 v[36:39], v[76:79], v[132:135], v[36:39]
    v_permlane32_swap_b32 v172, v173
    v_permlane32_swap_b32 v174, v175
    v_mfma_f32_16x16x32_bf16 v[40:43], v[76:79], v[136:139], v[40:43]
    ds_read_b128 v[92:95], v13 offset:30720
    v_add_f32 v172, v172, v173
    v_add_f32_e64 v174, v174, v175
    v_mfma_f32_16x16x32_bf16 v[44:47], v[80:83], v[132:135], v[44:47]
    ds_read_b128 v[96:99], v13 offset:31744
    buffer_load_dwordx4 v[124:127], v3, s[4:7], s46 offen
    v_mov_b32_e64 v176, v172
    v_mfma_f32_16x16x32_bf16 v[48:51], v[80:83], v[136:139], v[48:51]
    ds_read_b128 v[100:103], v13 offset:32768
    v_mov_b32 v177, v174
    v_permlane16_swap_b32 v172, v176
    v_mfma_f32_16x16x32_bf16 v[52:55], v[132:135], v[84:87], v[52:55]
    ds_read_b128 v[104:107], v13 offset:33792
    v_permlane16_swap_b32 v174, v177
    v_add_f32 v172, v172, v176
    v_mfma_f32_16x16x32_bf16 v[56:59], v[136:139], v[84:87], v[56:59]
    ds_read_b128 v[108:111], v13 offset:34816
    v_add_f32_e64 v174, v174, v177
    v_mfma_f32_16x16x32_bf16 v[60:63], v[132:135], v[88:91], v[60:63]
    ds_read_b128 v[112:115], v13 offset:35840
    buffer_load_dwordx4 v[128:131], v3, s[4:7], s46 offen offset:1024
    s_add_u32 s46, s46, 131072
    v_mov_b32 v173, v172
    v_mov_b32 v175, v174
    v_mfma_f32_16x16x32_bf16 v[64:67], v[136:139], v[88:91], v[64:67]
    v_permlane32_swap_b32 v172, v173
    v_permlane32_swap_b32 v174, v175
    v_mfma_f32_16x16x32_bf16 v[20:23], v[68:71], v[132:135], v[20:23]
    .long 0x8e4cff28, 0x7
    v_mfma_f32_16x16x32_bf16 v[24:27], v[68:71], v[136:139], v[24:27]
    s_add_u32 s76, s76, 135168
    v_and_b32_e64 v5, 15, v0
    v_mfma_f32_16x16x32_bf16 v[28:31], v[72:75], v[132:135], v[28:31]
    v_lshlrev_b32 v5, 2, v5
    v_add_u32 v7, s76, v5
    v_mfma_f32_16x16x32_bf16 v[32:35], v[72:75], v[136:139], v[32:35]
    ds_write_b32 v7, v222 offset:0
    s_waitcnt vmcnt(4) lgkmcnt(0)
    v_mfma_f32_16x16x32_bf16 v[36:39], v[100:103], v[140:143], v[36:39]
    s_barrier
    ds_write_b32 v7, v223 offset:1024
    v_mul_f32 v2, 0x3fb8aa3b, v222
    v_mfma_f32_16x16x32_bf16 v[40:43], v[100:103], v[144:147], v[40:43]
    ds_read_b128 v[68:71], v13 offset:36864
    v_mov_b32_e64 v4, v223
    ds_write_b32 v7, v230 offset:64
    v_mfma_f32_16x16x32_bf16 v[44:47], v[104:107], v[140:143], v[44:47]
    ds_read_b128 v[72:75], v13 offset:37888
    buffer_load_dwordx4 v[132:135], v3, s[4:7], s46 offen
    ds_write_b32 v7, v231 offset:1088
    v_mfma_f32_16x16x32_bf16 v[48:51], v[104:107], v[144:147], v[48:51]
    ds_read_b128 v[76:79], v13 offset:38912
    v_mul_f32 v6, 0x3fb8aa3b, v230
    v_mov_b32_e64 v8, v231
    v_mfma_f32_16x16x32_bf16 v[52:55], v[140:143], v[108:111], v[52:55]
    ds_read_b128 v[80:83], v13 offset:39936
    .long 0x8e4dff30, 0x7
    s_add_u32 s77, s77, 137216
    v_mfma_f32_16x16x32_bf16 v[56:59], v[144:147], v[108:111], v[56:59]
    ds_read_b128 v[84:87], v13 offset:40960
    v_lshlrev_b32_e64 v9, 4, v9
    v_mfma_f32_16x16x32_bf16 v[60:63], v[140:143], v[112:115], v[60:63]
    ds_read_b128 v[88:91], v13 offset:41984
    buffer_load_dwordx4 v[136:139], v3, s[4:7], s46 offen offset:1024
    s_add_u32 s46, s46, 131072
    v_add_u32_e64 v9, s77, v9
    ds_write_b128 v9, v[172:175]
    v_mfma_f32_16x16x32_bf16 v[64:67], v[144:147], v[112:115], v[64:67]
    v_mov_b32 v7, 137600
    v_mov_b32_e64 v9, 0
    v_mfma_f32_16x16x32_bf16 v[20:23], v[92:95], v[140:143], v[20:23]
    ds_write_b32 v7, v9
    v_mfma_f32_16x16x32_bf16 v[24:27], v[92:95], v[144:147], v[24:27]
    v_lshrrev_b32 v7, 4, v0
    v_lshlrev_b32 v7, 4, v7
    v_mfma_f32_16x16x32_bf16 v[28:31], v[96:99], v[140:143], v[28:31]
    v_add_u32_e64 v15, s76, v7
    v_add_u32 v17, 137216, v7
    v_mfma_f32_16x16x32_bf16 v[32:35], v[96:99], v[144:147], v[32:35]
    v_add_u32 v9, 137472, v5
    s_waitcnt vmcnt(4) lgkmcnt(0)
    s_nop 0
    v_mfma_f32_16x16x32_bf16 v[36:39], v[76:79], v[116:119], v[36:39]
    v_mfma_f32_16x16x32_bf16 v[40:43], v[76:79], v[120:123], v[40:43]
    ds_read_b128 v[92:95], v13 offset:43008
    v_mfma_f32_16x16x32_bf16 v[44:47], v[80:83], v[116:119], v[44:47]
    ds_read_b128 v[96:99], v13 offset:44032
    buffer_load_dwordx4 v[140:143], v3, s[4:7], s46 offen
    v_mfma_f32_16x16x32_bf16 v[48:51], v[80:83], v[120:123], v[48:51]
    ds_read_b128 v[100:103], v13 offset:45056
    v_mfma_f32_16x16x32_bf16 v[52:55], v[116:119], v[84:87], v[52:55]
    ds_read_b128 v[104:107], v13 offset:46080
    v_mfma_f32_16x16x32_bf16 v[56:59], v[120:123], v[84:87], v[56:59]
    ds_read_b128 v[108:111], v13 offset:47104
    v_mfma_f32_16x16x32_bf16 v[60:63], v[116:119], v[88:91], v[60:63]
    ds_read_b128 v[112:115], v13 offset:48128
    buffer_load_dwordx4 v[144:147], v3, s[4:7], s46 offen offset:1024
    s_add_u32 s46, s46, 131072
    v_mfma_f32_16x16x32_bf16 v[64:67], v[120:123], v[88:91], v[64:67]
    v_mfma_f32_16x16x32_bf16 v[20:23], v[68:71], v[116:119], v[20:23]
    v_mfma_f32_16x16x32_bf16 v[24:27], v[68:71], v[120:123], v[24:27]
    v_mfma_f32_16x16x32_bf16 v[28:31], v[72:75], v[116:119], v[28:31]
    v_mfma_f32_16x16x32_bf16 v[32:35], v[72:75], v[120:123], v[32:35]
    s_waitcnt vmcnt(4) lgkmcnt(0)
    s_nop 0
    v_mfma_f32_16x16x32_bf16 v[36:39], v[100:103], v[124:127], v[36:39]
    v_mfma_f32_16x16x32_bf16 v[40:43], v[100:103], v[128:131], v[40:43]
    ds_read_b128 v[68:71], v13 offset:49152
    v_mfma_f32_16x16x32_bf16 v[44:47], v[104:107], v[124:127], v[44:47]
    ds_read_b128 v[72:75], v13 offset:50176
    buffer_load_dwordx4 v[116:119], v3, s[4:7], s46 offen
    v_mfma_f32_16x16x32_bf16 v[48:51], v[104:107], v[128:131], v[48:51]
    ds_read_b128 v[76:79], v13 offset:51200
    v_mfma_f32_16x16x32_bf16 v[52:55], v[124:127], v[108:111], v[52:55]
    ds_read_b128 v[80:83], v13 offset:52224
    v_mfma_f32_16x16x32_bf16 v[56:59], v[128:131], v[108:111], v[56:59]
    ds_read_b128 v[84:87], v13 offset:53248
    v_mfma_f32_16x16x32_bf16 v[60:63], v[124:127], v[112:115], v[60:63]
    ds_read_b128 v[88:91], v13 offset:54272
    buffer_load_dwordx4 v[120:123], v3, s[4:7], s46 offen offset:1024
    s_add_u32 s46, s46, 131072
    v_mfma_f32_16x16x32_bf16 v[64:67], v[128:131], v[112:115], v[64:67]
    v_mfma_f32_16x16x32_bf16 v[20:23], v[92:95], v[124:127], v[20:23]
    v_mfma_f32_16x16x32_bf16 v[24:27], v[92:95], v[128:131], v[24:27]
    v_mfma_f32_16x16x32_bf16 v[28:31], v[96:99], v[124:127], v[28:31]
    v_mfma_f32_16x16x32_bf16 v[32:35], v[96:99], v[128:131], v[32:35]
    s_waitcnt vmcnt(4) lgkmcnt(0)
    s_nop 0
    v_mfma_f32_16x16x32_bf16 v[36:39], v[76:79], v[132:135], v[36:39]
    v_mfma_f32_16x16x32_bf16 v[40:43], v[76:79], v[136:139], v[40:43]
    ds_read_b128 v[92:95], v13 offset:55296
    v_mfma_f32_16x16x32_bf16 v[44:47], v[80:83], v[132:135], v[44:47]
    ds_read_b128 v[96:99], v13 offset:56320
    buffer_load_dwordx4 v[124:127], v3, s[4:7], s46 offen
    v_mfma_f32_16x16x32_bf16 v[48:51], v[80:83], v[136:139], v[48:51]
    ds_read_b128 v[100:103], v13 offset:57344
    v_mfma_f32_16x16x32_bf16 v[52:55], v[132:135], v[84:87], v[52:55]
    ds_read_b128 v[104:107], v13 offset:58368
    v_mfma_f32_16x16x32_bf16 v[56:59], v[136:139], v[84:87], v[56:59]
    ds_read_b128 v[108:111], v13 offset:59392
    v_mfma_f32_16x16x32_bf16 v[60:63], v[132:135], v[88:91], v[60:63]
    ds_read_b128 v[112:115], v13 offset:60416
    buffer_load_dwordx4 v[128:131], v3, s[4:7], s46 offen offset:1024
    s_add_u32 s46, s46, 131072
    v_mfma_f32_16x16x32_bf16 v[64:67], v[136:139], v[88:91], v[64:67]
    v_mfma_f32_16x16x32_bf16 v[20:23], v[68:71], v[132:135], v[20:23]
    v_mfma_f32_16x16x32_bf16 v[24:27], v[68:71], v[136:139], v[24:27]
    v_mfma_f32_16x16x32_bf16 v[28:31], v[72:75], v[132:135], v[28:31]
    v_mfma_f32_16x16x32_bf16 v[32:35], v[72:75], v[136:139], v[32:35]
    s_waitcnt vmcnt(4) lgkmcnt(0)
    v_add_u32 v13, 0, v3
    v_mfma_f32_16x16x32_bf16 v[36:39], v[100:103], v[140:143], v[36:39]
    s_barrier
    s_nop 0
    v_mfma_f32_16x16x32_bf16 v[40:43], v[100:103], v[144:147], v[40:43]
    ds_read_b128 v[68:71], v13 offset:0
    v_mfma_f32_16x16x32_bf16 v[44:47], v[104:107], v[140:143], v[44:47]
    ds_read_b128 v[72:75], v13 offset:1024
    buffer_load_dwordx4 v[132:135], v3, s[4:7], s46 offen
    v_mfma_f32_16x16x32_bf16 v[48:51], v[104:107], v[144:147], v[48:51]
    ds_read_b128 v[76:79], v13 offset:2048
    v_mfma_f32_16x16x32_bf16 v[52:55], v[140:143], v[108:111], v[52:55]
    ds_read_b128 v[80:83], v13 offset:3072
    v_mfma_f32_16x16x32_bf16 v[56:59], v[144:147], v[108:111], v[56:59]
    ds_read_b128 v[84:87], v13 offset:4096
    v_mfma_f32_16x16x32_bf16 v[60:63], v[140:143], v[112:115], v[60:63]
    ds_read_b128 v[88:91], v13 offset:5120
    buffer_load_dwordx4 v[136:139], v3, s[4:7], s46 offen offset:1024
    s_add_u32 s46, s46, 131072
    v_mfma_f32_16x16x32_bf16 v[64:67], v[144:147], v[112:115], v[64:67]
    v_mfma_f32_16x16x32_bf16 v[20:23], v[92:95], v[140:143], v[20:23]
    v_mfma_f32_16x16x32_bf16 v[24:27], v[92:95], v[144:147], v[24:27]
    v_mfma_f32_16x16x32_bf16 v[28:31], v[96:99], v[140:143], v[28:31]
    v_mfma_f32_16x16x32_bf16 v[32:35], v[96:99], v[144:147], v[32:35]
    s_waitcnt vmcnt(4) lgkmcnt(0)
    s_nop 0
    v_mfma_f32_16x16x32_bf16 v[36:39], v[76:79], v[116:119], v[36:39]
    v_mfma_f32_16x16x32_bf16 v[40:43], v[76:79], v[120:123], v[40:43]
    ds_read_b128 v[92:95], v13 offset:6144
    v_mfma_f32_16x16x32_bf16 v[44:47], v[80:83], v[116:119], v[44:47]
    ds_read_b128 v[96:99], v13 offset:7168
    buffer_load_dwordx4 v[140:143], v3, s[4:7], s46 offen
    v_mfma_f32_16x16x32_bf16 v[48:51], v[80:83], v[120:123], v[48:51]
    ds_read_b128 v[100:103], v13 offset:8192
    v_mfma_f32_16x16x32_bf16 v[52:55], v[116:119], v[84:87], v[52:55]
    ds_read_b128 v[104:107], v13 offset:9216
    v_mfma_f32_16x16x32_bf16 v[56:59], v[120:123], v[84:87], v[56:59]
    ds_read_b128 v[108:111], v13 offset:10240
    v_mfma_f32_16x16x32_bf16 v[60:63], v[116:119], v[88:91], v[60:63]
    ds_read_b128 v[112:115], v13 offset:11264
    buffer_load_dwordx4 v[144:147], v3, s[4:7], s46 offen offset:1024
    s_add_u32 s46, s46, 131072
    v_mfma_f32_16x16x32_bf16 v[64:67], v[120:123], v[88:91], v[64:67]
    v_mfma_f32_16x16x32_bf16 v[20:23], v[68:71], v[116:119], v[20:23]
    v_mfma_f32_16x16x32_bf16 v[24:27], v[68:71], v[120:123], v[24:27]
    v_mfma_f32_16x16x32_bf16 v[28:31], v[72:75], v[116:119], v[28:31]
    v_mfma_f32_16x16x32_bf16 v[32:35], v[72:75], v[120:123], v[32:35]
    s_waitcnt vmcnt(4) lgkmcnt(0)
    s_nop 0
    v_mfma_f32_16x16x32_bf16 v[36:39], v[100:103], v[124:127], v[36:39]
    v_mfma_f32_16x16x32_bf16 v[40:43], v[100:103], v[128:131], v[40:43]
    ds_read_b128 v[68:71], v13 offset:12288
    v_mfma_f32_16x16x32_bf16 v[44:47], v[104:107], v[124:127], v[44:47]
    ds_read_b128 v[72:75], v13 offset:13312
    buffer_load_dwordx4 v[116:119], v3, s[4:7], s46 offen
    v_mfma_f32_16x16x32_bf16 v[48:51], v[104:107], v[128:131], v[48:51]
    ds_read_b128 v[76:79], v13 offset:14336
    v_mfma_f32_16x16x32_bf16 v[52:55], v[124:127], v[108:111], v[52:55]
    ds_read_b128 v[80:83], v13 offset:15360
    v_mfma_f32_16x16x32_bf16 v[56:59], v[128:131], v[108:111], v[56:59]
    ds_read_b128 v[84:87], v13 offset:16384
    v_mfma_f32_16x16x32_bf16 v[60:63], v[124:127], v[112:115], v[60:63]
    ds_read_b128 v[88:91], v13 offset:17408
    buffer_load_dwordx4 v[120:123], v3, s[4:7], s46 offen offset:1024
    s_add_u32 s46, s46, 131072
    v_mfma_f32_16x16x32_bf16 v[64:67], v[128:131], v[112:115], v[64:67]
    v_mfma_f32_16x16x32_bf16 v[20:23], v[92:95], v[124:127], v[20:23]
    v_mfma_f32_16x16x32_bf16 v[24:27], v[92:95], v[128:131], v[24:27]
    v_mfma_f32_16x16x32_bf16 v[28:31], v[96:99], v[124:127], v[28:31]
    v_mfma_f32_16x16x32_bf16 v[32:35], v[96:99], v[128:131], v[32:35]
    s_waitcnt vmcnt(4) lgkmcnt(0)
    s_nop 0
    v_mfma_f32_16x16x32_bf16 v[36:39], v[76:79], v[132:135], v[36:39]
    v_mfma_f32_16x16x32_bf16 v[40:43], v[76:79], v[136:139], v[40:43]
    ds_read_b128 v[92:95], v13 offset:18432
    v_mfma_f32_16x16x32_bf16 v[44:47], v[80:83], v[132:135], v[44:47]
    ds_read_b128 v[96:99], v13 offset:19456
    buffer_load_dwordx4 v[124:127], v3, s[4:7], s46 offen
    v_mfma_f32_16x16x32_bf16 v[48:51], v[80:83], v[136:139], v[48:51]
    ds_read_b128 v[100:103], v13 offset:20480
    v_mfma_f32_16x16x32_bf16 v[52:55], v[132:135], v[84:87], v[52:55]
    ds_read_b128 v[104:107], v13 offset:21504
    v_mfma_f32_16x16x32_bf16 v[56:59], v[136:139], v[84:87], v[56:59]
    ds_read_b128 v[108:111], v13 offset:22528
    v_mfma_f32_16x16x32_bf16 v[60:63], v[132:135], v[88:91], v[60:63]
    ds_read_b128 v[112:115], v13 offset:23552
    buffer_load_dwordx4 v[128:131], v3, s[4:7], s46 offen offset:1024
    s_add_u32 s46, s46, 131072
    v_mfma_f32_16x16x32_bf16 v[64:67], v[136:139], v[88:91], v[64:67]
    v_mfma_f32_16x16x32_bf16 v[20:23], v[68:71], v[132:135], v[20:23]
    v_mfma_f32_16x16x32_bf16 v[24:27], v[68:71], v[136:139], v[24:27]
    v_mfma_f32_16x16x32_bf16 v[28:31], v[72:75], v[132:135], v[28:31]
    v_mfma_f32_16x16x32_bf16 v[32:35], v[72:75], v[136:139], v[32:35]
    s_waitcnt vmcnt(4) lgkmcnt(0)
    v_mfma_f32_16x16x32_bf16 v[36:39], v[100:103], v[140:143], v[36:39]
    s_barrier
    v_mfma_f32_16x16x32_bf16 v[40:43], v[100:103], v[144:147], v[40:43]
    ds_read_b128 v[68:71], v13 offset:24576
    v_mfma_f32_16x16x32_bf16 v[44:47], v[104:107], v[140:143], v[44:47]
    ds_read_b128 v[72:75], v13 offset:25600
    buffer_load_dwordx4 v[132:135], v3, s[4:7], s46 offen
    v_mfma_f32_16x16x32_bf16 v[48:51], v[104:107], v[144:147], v[48:51]
    ds_read_b128 v[76:79], v13 offset:26624
    v_mfma_f32_16x16x32_bf16 v[52:55], v[140:143], v[108:111], v[52:55]
    ds_read_b128 v[80:83], v13 offset:27648
    v_mfma_f32_16x16x32_bf16 v[56:59], v[144:147], v[108:111], v[56:59]
    ds_read_b128 v[84:87], v13 offset:28672
    v_mfma_f32_16x16x32_bf16 v[60:63], v[140:143], v[112:115], v[60:63]
    ds_read_b128 v[88:91], v13 offset:29696
    buffer_load_dwordx4 v[136:139], v3, s[4:7], s46 offen offset:1024
    s_add_u32 s46, s46, 131072
    v_mfma_f32_16x16x32_bf16 v[64:67], v[144:147], v[112:115], v[64:67]
    v_mfma_f32_16x16x32_bf16 v[20:23], v[92:95], v[140:143], v[20:23]
    v_mfma_f32_16x16x32_bf16 v[24:27], v[92:95], v[144:147], v[24:27]
    v_mfma_f32_16x16x32_bf16 v[28:31], v[96:99], v[140:143], v[28:31]
    v_mfma_f32_16x16x32_bf16 v[32:35], v[96:99], v[144:147], v[32:35]
    s_waitcnt vmcnt(4) lgkmcnt(0)
    s_nop 0
    v_mfma_f32_16x16x32_bf16 v[36:39], v[76:79], v[116:119], v[36:39]
    v_mfma_f32_16x16x32_bf16 v[40:43], v[76:79], v[120:123], v[40:43]
    ds_read_b128 v[92:95], v13 offset:30720
    v_mfma_f32_16x16x32_bf16 v[44:47], v[80:83], v[116:119], v[44:47]
    ds_read_b128 v[96:99], v13 offset:31744
    buffer_load_dwordx4 v[140:143], v3, s[4:7], s46 offen
    v_mfma_f32_16x16x32_bf16 v[48:51], v[80:83], v[120:123], v[48:51]
    ds_read_b128 v[100:103], v13 offset:32768
    v_mfma_f32_16x16x32_bf16 v[52:55], v[116:119], v[84:87], v[52:55]
    ds_read_b128 v[104:107], v13 offset:33792
    v_mfma_f32_16x16x32_bf16 v[56:59], v[120:123], v[84:87], v[56:59]
    ds_read_b128 v[108:111], v13 offset:34816
    v_mfma_f32_16x16x32_bf16 v[60:63], v[116:119], v[88:91], v[60:63]
    ds_read_b128 v[112:115], v13 offset:35840
    buffer_load_dwordx4 v[144:147], v3, s[4:7], s46 offen offset:1024
    s_add_u32 s46, s46, 131072
    v_mfma_f32_16x16x32_bf16 v[64:67], v[120:123], v[88:91], v[64:67]
    v_mfma_f32_16x16x32_bf16 v[20:23], v[68:71], v[116:119], v[20:23]
    v_mfma_f32_16x16x32_bf16 v[24:27], v[68:71], v[120:123], v[24:27]
    v_mfma_f32_16x16x32_bf16 v[28:31], v[72:75], v[116:119], v[28:31]
    v_mfma_f32_16x16x32_bf16 v[32:35], v[72:75], v[120:123], v[32:35]
    s_waitcnt vmcnt(4) lgkmcnt(0)
    s_nop 0
    v_mfma_f32_16x16x32_bf16 v[36:39], v[100:103], v[124:127], v[36:39]
    v_mfma_f32_16x16x32_bf16 v[40:43], v[100:103], v[128:131], v[40:43]
    ds_read_b128 v[68:71], v13 offset:36864
    v_mfma_f32_16x16x32_bf16 v[44:47], v[104:107], v[124:127], v[44:47]
    ds_read_b128 v[72:75], v13 offset:37888
    buffer_load_dwordx4 v[116:119], v3, s[4:7], s46 offen
    v_mfma_f32_16x16x32_bf16 v[48:51], v[104:107], v[128:131], v[48:51]
    ds_read_b128 v[76:79], v13 offset:38912
    v_mfma_f32_16x16x32_bf16 v[52:55], v[124:127], v[108:111], v[52:55]
    ds_read_b128 v[80:83], v13 offset:39936
    v_mfma_f32_16x16x32_bf16 v[56:59], v[128:131], v[108:111], v[56:59]
    ds_read_b128 v[84:87], v13 offset:40960
    v_mfma_f32_16x16x32_bf16 v[60:63], v[124:127], v[112:115], v[60:63]
    ds_read_b128 v[88:91], v13 offset:41984
    buffer_load_dwordx4 v[120:123], v3, s[4:7], s46 offen offset:1024
    s_add_u32 s46, s46, 131072
    v_mfma_f32_16x16x32_bf16 v[64:67], v[128:131], v[112:115], v[64:67]
    v_mfma_f32_16x16x32_bf16 v[20:23], v[92:95], v[124:127], v[20:23]
    v_mfma_f32_16x16x32_bf16 v[24:27], v[92:95], v[128:131], v[24:27]
    v_mfma_f32_16x16x32_bf16 v[28:31], v[96:99], v[124:127], v[28:31]
    v_mfma_f32_16x16x32_bf16 v[32:35], v[96:99], v[128:131], v[32:35]
    s_waitcnt vmcnt(4) lgkmcnt(0)
    s_nop 0
    v_mfma_f32_16x16x32_bf16 v[36:39], v[76:79], v[132:135], v[36:39]
    v_mfma_f32_16x16x32_bf16 v[40:43], v[76:79], v[136:139], v[40:43]
    ds_read_b128 v[92:95], v13 offset:43008
    v_mfma_f32_16x16x32_bf16 v[44:47], v[80:83], v[132:135], v[44:47]
    ds_read_b128 v[96:99], v13 offset:44032
    buffer_load_dwordx4 v[124:127], v3, s[4:7], s46 offen
    v_mfma_f32_16x16x32_bf16 v[48:51], v[80:83], v[136:139], v[48:51]
    ds_read_b128 v[100:103], v13 offset:45056
    v_mfma_f32_16x16x32_bf16 v[52:55], v[132:135], v[84:87], v[52:55]
    ds_read_b128 v[104:107], v13 offset:46080
    v_mfma_f32_16x16x32_bf16 v[56:59], v[136:139], v[84:87], v[56:59]
    ds_read_b128 v[108:111], v13 offset:47104
    v_mfma_f32_16x16x32_bf16 v[60:63], v[132:135], v[88:91], v[60:63]
    ds_read_b128 v[112:115], v13 offset:48128
    buffer_load_dwordx4 v[128:131], v3, s[4:7], s46 offen offset:1024
    s_add_u32 s46, s46, 131072
    v_mfma_f32_16x16x32_bf16 v[64:67], v[136:139], v[88:91], v[64:67]
    v_mfma_f32_16x16x32_bf16 v[20:23], v[68:71], v[132:135], v[20:23]
    v_mfma_f32_16x16x32_bf16 v[24:27], v[68:71], v[136:139], v[24:27]
    v_mfma_f32_16x16x32_bf16 v[28:31], v[72:75], v[132:135], v[28:31]
    v_mfma_f32_16x16x32_bf16 v[32:35], v[72:75], v[136:139], v[32:35]
    s_waitcnt vmcnt(4) lgkmcnt(0)
    v_mfma_f32_16x16x32_bf16 v[36:39], v[100:103], v[140:143], v[36:39]
    s_barrier
    v_mfma_f32_16x16x32_bf16 v[40:43], v[100:103], v[144:147], v[40:43]
    ds_read_b128 v[68:71], v13 offset:49152
    v_mfma_f32_16x16x32_bf16 v[44:47], v[104:107], v[140:143], v[44:47]
    ds_read_b128 v[72:75], v13 offset:50176
    buffer_load_dwordx4 v[132:135], v3, s[4:7], s46 offen
    v_mfma_f32_16x16x32_bf16 v[48:51], v[104:107], v[144:147], v[48:51]
    ds_read_b128 v[76:79], v13 offset:51200
    v_mfma_f32_16x16x32_bf16 v[52:55], v[140:143], v[108:111], v[52:55]
    ds_read_b128 v[80:83], v13 offset:52224
    v_mfma_f32_16x16x32_bf16 v[56:59], v[144:147], v[108:111], v[56:59]
    ds_read_b128 v[84:87], v13 offset:53248
    v_mfma_f32_16x16x32_bf16 v[60:63], v[140:143], v[112:115], v[60:63]
    ds_read_b128 v[88:91], v13 offset:54272
    buffer_load_dwordx4 v[136:139], v3, s[4:7], s46 offen offset:1024
    s_add_u32 s46, s46, 131072
    v_mfma_f32_16x16x32_bf16 v[64:67], v[144:147], v[112:115], v[64:67]
    v_mfma_f32_16x16x32_bf16 v[20:23], v[92:95], v[140:143], v[20:23]
    v_mfma_f32_16x16x32_bf16 v[24:27], v[92:95], v[144:147], v[24:27]
    v_mfma_f32_16x16x32_bf16 v[28:31], v[96:99], v[140:143], v[28:31]
    v_mfma_f32_16x16x32_bf16 v[32:35], v[96:99], v[144:147], v[32:35]
    s_waitcnt vmcnt(4) lgkmcnt(0)
    s_nop 0
    v_mfma_f32_16x16x32_bf16 v[36:39], v[76:79], v[116:119], v[36:39]
    v_mfma_f32_16x16x32_bf16 v[40:43], v[76:79], v[120:123], v[40:43]
    ds_read_b128 v[92:95], v13 offset:55296
    v_mfma_f32_16x16x32_bf16 v[44:47], v[80:83], v[116:119], v[44:47]
    ds_read_b128 v[96:99], v13 offset:56320
    buffer_load_dwordx4 v[140:143], v3, s[4:7], s46 offen
    v_mfma_f32_16x16x32_bf16 v[48:51], v[80:83], v[120:123], v[48:51]
    ds_read_b128 v[100:103], v13 offset:57344
    v_mfma_f32_16x16x32_bf16 v[52:55], v[116:119], v[84:87], v[52:55]
    ds_read_b128 v[104:107], v13 offset:58368
    v_mfma_f32_16x16x32_bf16 v[56:59], v[120:123], v[84:87], v[56:59]
    ds_read_b128 v[108:111], v13 offset:59392
    v_mfma_f32_16x16x32_bf16 v[60:63], v[116:119], v[88:91], v[60:63]
    ds_read_b128 v[112:115], v13 offset:60416
    buffer_load_dwordx4 v[144:147], v3, s[4:7], s46 offen offset:1024
    s_add_u32 s46, s46, 131072
    v_mfma_f32_16x16x32_bf16 v[64:67], v[120:123], v[88:91], v[64:67]
    v_mfma_f32_16x16x32_bf16 v[20:23], v[68:71], v[116:119], v[20:23]
    v_mfma_f32_16x16x32_bf16 v[24:27], v[68:71], v[120:123], v[24:27]
    v_mfma_f32_16x16x32_bf16 v[28:31], v[72:75], v[116:119], v[28:31]
    buffer_load_dwordx4 v[148:151], v3, s[24:27], s45 offen
    v_mfma_f32_16x16x32_bf16 v[32:35], v[72:75], v[120:123], v[32:35]
    buffer_load_dwordx4 v[152:155], v3, s[24:27], s45 offen offset:1024
    s_waitcnt vmcnt(6) lgkmcnt(0)
    s_nop 0
    v_add_u32 v13, 61440, v3
    v_mfma_f32_16x16x32_bf16 v[36:39], v[100:103], v[124:127], v[36:39]
    v_mfma_f32_16x16x32_bf16 v[40:43], v[100:103], v[128:131], v[40:43]
    ds_read_b128 v[68:71], v13 offset:0
    v_mfma_f32_16x16x32_bf16 v[44:47], v[104:107], v[124:127], v[44:47]
    ds_read_b128 v[72:75], v13 offset:1024
    v_mfma_f32_16x16x32_bf16 v[48:51], v[104:107], v[128:131], v[48:51]
    ds_read_b128 v[76:79], v13 offset:2048
    v_mfma_f32_16x16x32_bf16 v[52:55], v[124:127], v[108:111], v[52:55]
    ds_read_b128 v[80:83], v13 offset:3072
    v_mfma_f32_16x16x32_bf16 v[56:59], v[128:131], v[108:111], v[56:59]
    ds_read_b128 v[84:87], v13 offset:4096
    v_mfma_f32_16x16x32_bf16 v[60:63], v[124:127], v[112:115], v[60:63]
    ds_read_b128 v[88:91], v13 offset:5120
    v_mfma_f32_16x16x32_bf16 v[64:67], v[128:131], v[112:115], v[64:67]
    v_mfma_f32_16x16x32_bf16 v[20:23], v[92:95], v[124:127], v[20:23]
    v_mfma_f32_16x16x32_bf16 v[24:27], v[92:95], v[128:131], v[24:27]
    v_mfma_f32_16x16x32_bf16 v[28:31], v[96:99], v[124:127], v[28:31]
    v_mfma_f32_16x16x32_bf16 v[32:35], v[96:99], v[128:131], v[32:35]
    s_waitcnt vmcnt(4) lgkmcnt(0)
    s_nop 0
    v_mfma_f32_16x16x32_bf16 v[36:39], v[76:79], v[132:135], v[36:39]
    v_mfma_f32_16x16x32_bf16 v[40:43], v[76:79], v[136:139], v[40:43]
    ds_read_b128 v[92:95], v13 offset:6144
    v_mfma_f32_16x16x32_bf16 v[44:47], v[80:83], v[132:135], v[44:47]
    ds_read_b128 v[96:99], v13 offset:7168
    v_mfma_f32_16x16x32_bf16 v[48:51], v[80:83], v[136:139], v[48:51]
    ds_read_b128 v[100:103], v13 offset:8192
    v_mfma_f32_16x16x32_bf16 v[52:55], v[132:135], v[84:87], v[52:55]
    ds_read_b128 v[104:107], v13 offset:9216
    v_mfma_f32_16x16x32_bf16 v[56:59], v[136:139], v[84:87], v[56:59]
    ds_read_b128 v[108:111], v13 offset:10240
    v_mfma_f32_16x16x32_bf16 v[60:63], v[132:135], v[88:91], v[60:63]
    ds_read_b128 v[112:115], v13 offset:11264
    v_mfma_f32_16x16x32_bf16 v[64:67], v[136:139], v[88:91], v[64:67]
    v_mfma_f32_16x16x32_bf16 v[20:23], v[68:71], v[132:135], v[20:23]
    v_mfma_f32_16x16x32_bf16 v[24:27], v[68:71], v[136:139], v[24:27]
    v_mfma_f32_16x16x32_bf16 v[28:31], v[72:75], v[132:135], v[28:31]
    v_mfma_f32_16x16x32_bf16 v[32:35], v[72:75], v[136:139], v[32:35]
    s_waitcnt vmcnt(2) lgkmcnt(0)
    v_mfma_f32_16x16x32_bf16 v[36:39], v[100:103], v[140:143], v[36:39]
    s_barrier
    v_mfma_f32_16x16x32_bf16 v[40:43], v[100:103], v[144:147], v[40:43]
    ds_read_b128 v[164:167], v17 offset:128
    ds_read_b128 v[168:171], v17 offset:192
    v_mfma_f32_16x16x32_bf16 v[44:47], v[104:107], v[140:143], v[44:47]
    ds_read_b32 v10, v9
    ds_read_b32 v12, v9 offset:64
    v_mfma_f32_16x16x32_bf16 v[48:51], v[104:107], v[144:147], v[48:51]
    ds_read_b128 v[220:223], v15
    ds_read_b128 v[224:227], v15 offset:1024
    v_mfma_f32_16x16x32_bf16 v[52:55], v[140:143], v[108:111], v[52:55]
    ds_read_b128 v[228:231], v15 offset:64
    ds_read_b128 v[232:235], v15 offset:1088
    v_mfma_f32_16x16x32_bf16 v[56:59], v[144:147], v[108:111], v[56:59]
    ds_read_b128 v[156:159], v17
    ds_read_b128 v[160:163], v17 offset:64
    v_mfma_f32_16x16x32_bf16 v[60:63], v[140:143], v[112:115], v[60:63]
    v_mfma_f32_16x16x32_bf16 v[64:67], v[144:147], v[112:115], v[64:67]
    v_mfma_f32_16x16x32_bf16 v[20:23], v[92:95], v[140:143], v[20:23]
    v_mfma_f32_16x16x32_bf16 v[24:27], v[92:95], v[144:147], v[24:27]
    v_mfma_f32_16x16x32_bf16 v[28:31], v[96:99], v[140:143], v[28:31]
    v_mfma_f32_16x16x32_bf16 v[32:35], v[96:99], v[144:147], v[32:35]
    s_add_u32 s28, s68, 0x4800000
    .long 0x821dff45, 0x0
    s_mov_b32 s30, 0x200000
    s_mov_b32 s31, 0x00020000
    s_add_u32 s32, s68, 0x4c20000
    .long 0x8221ff45, 0x0
    s_mov_b32 s34, 0x10000
    s_mov_b32 s35, 0x00020000
    s_waitcnt vmcnt(0) lgkmcnt(0)
    s_nop 0
    v_pk_fma_f32 v[36:37], v[164:165], v[4:5], v[36:37] op_sel_hi:[1,0,1]
    v_pk_fma_f32 v[38:39], v[166:167], v[4:5], v[38:39] op_sel_hi:[1,0,1]
    v_pk_fma_f32 v[44:45], v[168:169], v[4:5], v[44:45] op_sel_hi:[1,0,1]
    v_pk_fma_f32 v[46:47], v[170:171], v[4:5], v[46:47] op_sel_hi:[1,0,1]
    v_pk_fma_f32 v[40:41], v[164:165], v[8:9], v[40:41] op_sel_hi:[1,0,1]
    v_pk_fma_f32 v[42:43], v[166:167], v[8:9], v[42:43] op_sel_hi:[1,0,1]
    v_pk_fma_f32 v[48:49], v[168:169], v[8:9], v[48:49] op_sel_hi:[1,0,1]
    v_pk_fma_f32 v[50:51], v[170:171], v[8:9], v[50:51] op_sel_hi:[1,0,1]
    v_cvt_pk_bf16_f32 v68, v36, v37
    v_cvt_pk_bf16_f32 v69, v38, v39
    v_cvt_pk_bf16_f32 v70, v44, v45
    v_cvt_pk_bf16_f32 v71, v46, v47
    v_cvt_pk_bf16_f32 v72, v40, v41
    v_cvt_pk_bf16_f32 v73, v42, v43
    v_cvt_pk_bf16_f32 v74, v48, v49
    v_cvt_pk_bf16_f32 v75, v50, v51
    v_mfma_f32_16x16x32_bf16 v[104:107], v[148:151], v[68:71], 0
    v_mfma_f32_16x16x32_bf16 v[108:111], v[152:155], v[68:71], 0
    v_mfma_f32_16x16x32_bf16 v[112:115], v[148:151], v[72:75], 0
    v_mfma_f32_16x16x32_bf16 v[116:119], v[152:155], v[72:75], 0
    v_pk_fma_f32 v[52:53], v[224:225], v[10:11], v[52:53] op_sel_hi:[1,0,1]
    v_pk_fma_f32 v[54:55], v[226:227], v[10:11], v[54:55] op_sel_hi:[1,0,1]
    v_pk_fma_f32 v[56:57], v[232:233], v[10:11], v[56:57] op_sel_hi:[1,0,1]
    v_pk_fma_f32 v[58:59], v[234:235], v[10:11], v[58:59] op_sel_hi:[1,0,1]
    v_pk_fma_f32 v[60:61], v[224:225], v[12:13], v[60:61] op_sel_hi:[1,0,1]
    v_pk_fma_f32 v[62:63], v[226:227], v[12:13], v[62:63] op_sel_hi:[1,0,1]
    v_pk_fma_f32 v[64:65], v[232:233], v[12:13], v[64:65] op_sel_hi:[1,0,1]
    v_pk_fma_f32 v[66:67], v[234:235], v[12:13], v[66:67] op_sel_hi:[1,0,1]
    v_pk_mul_f32 v[52:53], v[52:53], v[220:221]
    v_pk_mul_f32 v[54:55], v[54:55], v[222:223]
    v_pk_mul_f32 v[56:57], v[56:57], v[228:229]
    v_pk_mul_f32 v[58:59], v[58:59], v[230:231]
    v_pk_mul_f32 v[60:61], v[60:61], v[220:221]
    v_pk_mul_f32 v[62:63], v[62:63], v[222:223]
    v_pk_mul_f32 v[64:65], v[64:65], v[228:229]
    v_pk_mul_f32 v[66:67], v[66:67], v[230:231]
    v_cvt_pk_bf16_f32 v76, v52, v53
    v_cvt_pk_bf16_f32 v77, v54, v55
    v_cvt_pk_bf16_f32 v78, v56, v57
    v_cvt_pk_bf16_f32 v79, v58, v59
    v_cvt_pk_bf16_f32 v80, v60, v61
    v_cvt_pk_bf16_f32 v81, v62, v63
    v_cvt_pk_bf16_f32 v82, v64, v65
    v_cvt_pk_bf16_f32 v83, v66, v67
    s_lshl_b32 s45, s40, 11
    v_add_u32 v11, s45, v3
    ds_write_b128 v11, v[76:79] offset:0
    ds_write_b128 v11, v[80:83] offset:1024
    v_and_b32 v5, 15, v0
    v_lshrrev_b32 v9, 2, v7
    v_sub_u32_e64 v5, v5, v9
    v_mov_b32 v92, 0x3f80
    v_mov_b32 v93, 1.0
    v_cmp_eq_u32 vcc, 0, v5
    s_nop 1
    v_cndmask_b32 v84, 0, v92, vcc
    v_cmp_eq_u32 vcc, 1, v5
    s_nop 1
    v_cndmask_b32 v84, v84, v93, vcc
    v_cmp_eq_u32 vcc, 2, v5
    s_nop 1
    v_cndmask_b32 v85, 0, v92, vcc
    v_cmp_eq_u32 vcc, 3, v5
    s_nop 1
    v_cndmask_b32 v85, v85, v93, vcc
    v_mov_b32 v86, 0
    v_mov_b32 v87, 0
    v_mov_b32 v88, 0
    v_mov_b32 v89, 0
    v_mov_b32 v90, v84
    v_mov_b32_e64 v91, v85
    v_mov_b32 v92, 0x3f803f80
    v_mov_b32 v93, 0x3f803f80
    v_mov_b32 v94, 0x3f803f80
    v_mov_b32 v95, 0x3f803f80
    v_max3_f32 v96, v104, v105, v106
    v_max3_f32 v98, -v104, -v105, -v106
    v_max3_f32 v100, v112, v113, v114
    v_max3_f32 v102, -v112, -v113, -v114
    v_max3_f32 v96, v96, v107, v108
    v_max3_f32 v98, v98, -v107, -v108
    v_max3_f32 v100, v100, v115, v116
    v_max3_f32 v102, v102, -v115, -v116
    v_max3_f32 v96, v96, v109, v110
    v_max3_f32 v98, v98, -v109, -v110
    v_max3_f32 v100, v100, v117, v118
    v_max3_f32 v102, v102, -v117, -v118
    v_max_f32_e64 v96, v96, v111
    v_max_f32_e64 v98, v98, -v111
    v_max_f32_e64 v100, v100, v119
    v_max_f32_e64 v102, v102, -v119
    v_permlane32_swap_b32 v96, v98
    s_nop 0
    v_permlane32_swap_b32 v100, v102
    v_max_f32 v96, v96, v98
    v_max_f32 v100, v100, v102
    v_mov_b32 v97, v96
    v_mov_b32 v101, v100
    s_nop 0
    v_permlane16_swap_b32 v96, v97
    v_permlane16_swap_b32 v100, v101
    v_max_f32 v96, v96, v97
    v_max_f32 v100, v100, v101
    v_mov_b32 v98, v96
    v_mov_b32 v102, v100
    s_nop 0
    v_permlane32_swap_b32 v96, v98
    v_permlane32_swap_b32 v100, v102
    v_mul_f32 v96, v2, v96
    v_mul_f32 v98, v2, v98
    v_mul_f32 v100, v6, v100
    v_mul_f32_e64 v102, v6, v102
    v_pk_fma_f32 v[120:121], v[104:105], v[2:3], v[98:99] op_sel_hi:[1,0,0] neg_lo:[1,0,1] neg_hi:[1,0,1]
    v_pk_fma_f32 v[122:123], v[106:107], v[2:3], v[98:99] op_sel_hi:[1,0,0] neg_lo:[1,0,1] neg_hi:[1,0,1]
    v_pk_fma_f32 v[124:125], v[108:109], v[2:3], v[98:99] op_sel_hi:[1,0,0] neg_lo:[1,0,1] neg_hi:[1,0,1]
    v_pk_fma_f32 v[126:127], v[110:111], v[2:3], v[98:99] op_sel_hi:[1,0,0] neg_lo:[1,0,1] neg_hi:[1,0,1]
    v_pk_fma_f32 v[104:105], v[104:105], v[2:3], v[96:97] op_sel_hi:[1,0,0] neg_lo:[0,0,1] neg_hi:[0,0,1]
    v_pk_fma_f32 v[106:107], v[106:107], v[2:3], v[96:97] op_sel_hi:[1,0,0] neg_lo:[0,0,1] neg_hi:[0,0,1]
    v_pk_fma_f32 v[108:109], v[108:109], v[2:3], v[96:97] op_sel_hi:[1,0,0] neg_lo:[0,0,1] neg_hi:[0,0,1]
    v_pk_fma_f32 v[110:111], v[110:111], v[2:3], v[96:97] op_sel_hi:[1,0,0] neg_lo:[0,0,1] neg_hi:[0,0,1]
    v_pk_fma_f32 v[128:129], v[112:113], v[6:7], v[102:103] op_sel_hi:[1,0,0] neg_lo:[1,0,1] neg_hi:[1,0,1]
    v_pk_fma_f32 v[130:131], v[114:115], v[6:7], v[102:103] op_sel_hi:[1,0,0] neg_lo:[1,0,1] neg_hi:[1,0,1]
    v_pk_fma_f32 v[132:133], v[116:117], v[6:7], v[102:103] op_sel_hi:[1,0,0] neg_lo:[1,0,1] neg_hi:[1,0,1]
    v_pk_fma_f32 v[134:135], v[118:119], v[6:7], v[102:103] op_sel_hi:[1,0,0] neg_lo:[1,0,1] neg_hi:[1,0,1]
    v_pk_fma_f32 v[112:113], v[112:113], v[6:7], v[100:101] op_sel_hi:[1,0,0] neg_lo:[0,0,1] neg_hi:[0,0,1]
    v_pk_fma_f32 v[114:115], v[114:115], v[6:7], v[100:101] op_sel_hi:[1,0,0] neg_lo:[0,0,1] neg_hi:[0,0,1]
    v_pk_fma_f32 v[116:117], v[116:117], v[6:7], v[100:101] op_sel_hi:[1,0,0] neg_lo:[0,0,1] neg_hi:[0,0,1]
    v_pk_fma_f32 v[118:119], v[118:119], v[6:7], v[100:101] op_sel_hi:[1,0,0] neg_lo:[0,0,1] neg_hi:[0,0,1]
    v_exp_f32 v104, v104
    v_exp_f32 v105, v105
    v_exp_f32 v106, v106
    v_exp_f32 v107, v107
    v_exp_f32 v108, v108
    v_exp_f32 v109, v109
    v_exp_f32 v110, v110
    v_exp_f32 v111, v111
    v_exp_f32 v120, v120
    v_exp_f32 v121, v121
    v_exp_f32 v122, v122
    v_exp_f32 v123, v123
    v_exp_f32 v124, v124
    v_exp_f32 v125, v125
    v_exp_f32 v126, v126
    v_exp_f32 v127, v127
    v_exp_f32 v112, v112
    v_exp_f32 v113, v113
    v_exp_f32 v114, v114
    v_exp_f32 v115, v115
    v_exp_f32 v116, v116
    v_exp_f32 v117, v117
    v_exp_f32 v118, v118
    v_exp_f32 v119, v119
    v_exp_f32 v128, v128
    v_exp_f32 v129, v129
    v_exp_f32 v130, v130
    v_exp_f32 v131, v131
    v_exp_f32 v132, v132
    v_exp_f32 v133, v133
    v_exp_f32 v134, v134
    v_exp_f32 v135, v135
    v_pk_add_f32 v[96:97], v[104:105], v[106:107]
    v_pk_add_f32 v[98:99], v[120:121], v[122:123]
    v_pk_add_f32 v[100:101], v[112:113], v[114:115]
    v_pk_add_f32 v[102:103], v[128:129], v[130:131]
    v_pk_add_f32 v[96:97], v[96:97], v[108:109]
    v_pk_add_f32 v[98:99], v[98:99], v[124:125]
    v_pk_add_f32 v[100:101], v[100:101], v[116:117]
    v_pk_add_f32 v[102:103], v[102:103], v[132:133]
    v_pk_add_f32 v[96:97], v[96:97], v[110:111]
    v_pk_add_f32 v[98:99], v[98:99], v[126:127]
    v_pk_add_f32 v[100:101], v[100:101], v[118:119]
    v_pk_add_f32 v[102:103], v[102:103], v[134:135]
    v_add_f32 v96, v96, v97
    v_add_f32 v98, v98, v99
    v_add_f32 v100, v100, v101
    v_add_f32 v102, v102, v103
    v_permlane32_swap_b32 v96, v98
    s_nop 0
    v_permlane32_swap_b32 v100, v102
    v_add_f32 v96, v96, v98
    v_add_f32 v100, v100, v102
    v_mov_b32 v97, v96
    v_mov_b32 v101, v100
    s_nop 0
    v_permlane16_swap_b32 v96, v97
    v_permlane16_swap_b32 v100, v101
    v_add_f32 v96, v96, v97
    v_add_f32 v100, v100, v101
    v_mov_b32 v98, v96
    v_mov_b32 v102, v100
    s_nop 0
    v_permlane32_swap_b32 v96, v98
    v_permlane32_swap_b32 v100, v102
    v_rcp_f32 v96, v96
    v_rcp_f32 v98, v98
    v_rcp_f32 v100, v100
    v_rcp_f32_e64 v102, v102
    v_pk_mul_f32 v[104:105], v[104:105], v[96:97] op_sel_hi:[1,0]
    v_pk_mul_f32 v[106:107], v[106:107], v[96:97] op_sel_hi:[1,0]
    v_pk_mul_f32 v[108:109], v[108:109], v[96:97] op_sel_hi:[1,0]
    v_pk_mul_f32 v[110:111], v[110:111], v[96:97] op_sel_hi:[1,0]
    v_pk_mul_f32 v[120:121], v[120:121], v[98:99] op_sel_hi:[1,0]
    v_pk_mul_f32 v[122:123], v[122:123], v[98:99] op_sel_hi:[1,0]
    v_pk_mul_f32 v[124:125], v[124:125], v[98:99] op_sel_hi:[1,0]
    v_pk_mul_f32 v[126:127], v[126:127], v[98:99] op_sel_hi:[1,0]
    v_cvt_pk_bf16_f32 v104, v104, v105
    v_cvt_pk_bf16_f32 v105, v106, v107
    v_cvt_pk_bf16_f32 v106, v108, v109
    v_cvt_pk_bf16_f32 v107, v110, v111
    v_cvt_pk_bf16_f32 v120, v120, v121
    v_cvt_pk_bf16_f32 v121, v122, v123
    v_cvt_pk_bf16_f32 v122, v124, v125
    v_cvt_pk_bf16_f32 v123, v126, v127
    v_mfma_f32_16x16x32_bf16 v[172:175], v[104:107], v[84:87], 0
    s_mov_b32 s99, 0x1000
    v_mfma_f32_16x16x32_bf16 v[188:191], v[120:123], v[84:87], 0
    v_mfma_f32_16x16x32_bf16 v[180:183], v[104:107], v[88:91], 0
    v_mfma_f32_16x16x32_bf16 v[196:199], v[120:123], v[88:91], 0
    v_pk_mul_f32 v[112:113], v[112:113], v[100:101] op_sel_hi:[1,0]
    v_pk_mul_f32 v[114:115], v[114:115], v[100:101] op_sel_hi:[1,0]
    v_pk_mul_f32 v[116:117], v[116:117], v[100:101] op_sel_hi:[1,0]
    v_pk_mul_f32 v[118:119], v[118:119], v[100:101] op_sel_hi:[1,0]
    v_pk_mul_f32 v[128:129], v[128:129], v[102:103] op_sel_hi:[1,0]
    v_pk_mul_f32 v[130:131], v[130:131], v[102:103] op_sel_hi:[1,0]
    v_pk_mul_f32 v[132:133], v[132:133], v[102:103] op_sel_hi:[1,0]
    v_pk_mul_f32 v[134:135], v[134:135], v[102:103] op_sel_hi:[1,0]
    v_cvt_pk_bf16_f32 v112, v112, v113
    v_cvt_pk_bf16_f32 v113, v114, v115
    v_cvt_pk_bf16_f32 v114, v116, v117
    v_cvt_pk_bf16_f32 v115, v118, v119
    v_cvt_pk_bf16_f32 v128, v128, v129
    v_cvt_pk_bf16_f32 v129, v130, v131
    v_cvt_pk_bf16_f32 v130, v132, v133
    v_cvt_pk_bf16_f32 v131, v134, v135
    v_mfma_f32_16x16x32_bf16 v[176:179], v[112:115], v[84:87], 0
    s_mov_b32 s99, 0x1000
    v_mfma_f32_16x16x32_bf16 v[192:195], v[128:131], v[84:87], 0
    v_mfma_f32_16x16x32_bf16 v[184:187], v[112:115], v[88:91], 0
    v_mfma_f32_16x16x32_bf16 v[200:203], v[128:131], v[88:91], 0
    s_lshl_b32 s45, s40, 10
    v_add_u32 v11, s45, v3
    v_mov_b32 v13, 137600
    v_mov_b32_e64 v9, 1
    v_cvt_pk_bf16_f32 v204, v172, v173
    v_cvt_pk_bf16_f32 v205, v174, v175
    v_cvt_pk_bf16_f32 v206, v176, v177
    v_cvt_pk_bf16_f32 v207, v178, v179
    ds_write_b128 v11, v[204:207] offset:16384
    v_cvt_pk_bf16_f32 v208, v180, v181
    v_cvt_pk_bf16_f32 v209, v182, v183
    v_cvt_pk_bf16_f32 v210, v184, v185
    v_cvt_pk_bf16_f32 v211, v186, v187
    ds_write_b128 v11, v[208:211] offset:24576
    v_cvt_pk_bf16_f32 v212, v188, v189
    v_cvt_pk_bf16_f32 v213, v190, v191
    v_cvt_pk_bf16_f32 v214, v192, v193
    v_cvt_pk_bf16_f32 v215, v194, v195
    ds_write_b128 v11, v[212:215] offset:32768
    v_cvt_pk_bf16_f32 v216, v196, v197
    v_cvt_pk_bf16_f32 v217, v198, v199
    v_cvt_pk_bf16_f32 v218, v200, v201
    v_cvt_pk_bf16_f32 v219, v202, v203
    ds_write_b128 v11, v[216:219] offset:40960
    s_waitcnt lgkmcnt(0)
    s_mov_b64 exec, 1
    ds_add_u32 v13, v9
    s_mov_b64 exec, -1
    s_cmp_ge_u32 s40, 4
    s_cbranch_scc1 interleave_layers__linear_kernel_hedgehog__geglu_ffn__prompt_kernel_hi64
    s_lshl_b32 s45, s40, 13
    v_add_u32_e64 v11, s45, v3
    s_lshl_b32 s53, s42, 3
    s_add_u32 s48, s53, s41
    s_lshl_b32 s49, s48, 13
    s_lshl_b32 s54, s40, 11
    s_add_u32 s49, s49, s54
    s_lshl_b32 s48, s48, 8
    s_lshl_b32 s43, s40, 6
    s_add_u32 s48, s48, s43
interleave_layers__linear_kernel_hedgehog__geglu_ffn__prompt_kernel_spin66:
    ds_read_b32 v9, v13
    s_waitcnt lgkmcnt(0)
    v_readfirstlane_b32 s74, v9
    s_nop 0
    .long 0xbf0aff4a, 0x8
    s_cbranch_scc1 interleave_layers__linear_kernel_hedgehog__geglu_ffn__prompt_kernel_spin66
    ds_read_b128 v[104:107], v11 offset:16384
    ds_read_b128 v[172:175], v3 offset:0
    ds_read_b128 v[176:179], v3 offset:1024
    ds_read_b128 v[108:111], v11 offset:17408
    ds_read_b128 v[180:183], v3 offset:2048
    ds_read_b128 v[184:187], v3 offset:3072
    ds_read_b128 v[112:115], v11 offset:18432
    ds_read_b128 v[188:191], v3 offset:4096
    ds_read_b128 v[192:195], v3 offset:5120
    ds_read_b128 v[116:119], v11 offset:19456
    ds_read_b128 v[196:199], v3 offset:6144
    ds_read_b128 v[200:203], v3 offset:7168
    s_waitcnt lgkmcnt(9)
    v_mfma_f32_16x16x32_bf16 v[136:139], v[104:107], v[172:175], 0
    v_mfma_f32_16x16x32_bf16 v[140:143], v[104:107], v[176:179], 0
    v_mfma_f32_16x16x32_bf16 v[144:147], v[104:107], v[92:95], 0
    ds_read_b128 v[120:123], v11 offset:20480
    ds_read_b128 v[204:207], v3 offset:8192
    ds_read_b128 v[208:211], v3 offset:9216
    s_waitcnt lgkmcnt(9)
    v_mfma_f32_16x16x32_bf16 v[136:139], v[108:111], v[180:183], v[136:139]
    v_mfma_f32_16x16x32_bf16 v[140:143], v[108:111], v[184:187], v[140:143]
    v_mfma_f32_16x16x32_bf16 v[144:147], v[108:111], v[92:95], v[144:147]
    ds_read_b128 v[124:127], v11 offset:21504
    ds_read_b128 v[212:215], v3 offset:10240
    ds_read_b128 v[216:219], v3 offset:11264
    s_waitcnt lgkmcnt(9)
    v_mfma_f32_16x16x32_bf16 v[136:139], v[112:115], v[188:191], v[136:139]
    v_mfma_f32_16x16x32_bf16 v[140:143], v[112:115], v[192:195], v[140:143]
    v_mfma_f32_16x16x32_bf16 v[144:147], v[112:115], v[92:95], v[144:147]
    ds_read_b128 v[128:131], v11 offset:22528
    ds_read_b128 v[220:223], v3 offset:12288
    ds_read_b128 v[224:227], v3 offset:13312
    s_waitcnt lgkmcnt(9)
    v_mfma_f32_16x16x32_bf16 v[136:139], v[116:119], v[196:199], v[136:139]
    v_mfma_f32_16x16x32_bf16 v[140:143], v[116:119], v[200:203], v[140:143]
    v_mfma_f32_16x16x32_bf16 v[144:147], v[116:119], v[92:95], v[144:147]
    ds_read_b128 v[132:135], v11 offset:23552
    ds_read_b128 v[228:231], v3 offset:14336
    ds_read_b128 v[232:235], v3 offset:15360
    s_waitcnt lgkmcnt(9)
    v_mfma_f32_16x16x32_bf16 v[136:139], v[120:123], v[204:207], v[136:139]
    v_mfma_f32_16x16x32_bf16 v[140:143], v[120:123], v[208:211], v[140:143]
    v_mfma_f32_16x16x32_bf16 v[144:147], v[120:123], v[92:95], v[144:147]
    s_waitcnt lgkmcnt(6)
    v_mfma_f32_16x16x32_bf16 v[136:139], v[124:127], v[212:215], v[136:139]
    v_mfma_f32_16x16x32_bf16 v[140:143], v[124:127], v[216:219], v[140:143]
    v_mfma_f32_16x16x32_bf16 v[144:147], v[124:127], v[92:95], v[144:147]
    s_waitcnt lgkmcnt(3)
    v_mfma_f32_16x16x32_bf16 v[136:139], v[128:131], v[220:223], v[136:139]
    v_mfma_f32_16x16x32_bf16 v[140:143], v[128:131], v[224:227], v[140:143]
    v_mfma_f32_16x16x32_bf16 v[144:147], v[128:131], v[92:95], v[144:147]
    s_waitcnt lgkmcnt(0)
    v_mfma_f32_16x16x32_bf16 v[136:139], v[132:135], v[228:231], v[136:139]
    v_mfma_f32_16x16x32_bf16 v[140:143], v[132:135], v[232:235], v[140:143]
    v_mfma_f32_16x16x32_bf16 v[144:147], v[132:135], v[92:95], v[144:147]
    .long 0x8e4aff2a, 0xc
    s_add_u32 s74, s74, 131072
    s_lshl_b32 s75, s40, 7
    s_add_u32 s74, s74, s75
    s_lshl_b32 s75, s41, 9
    s_add_u32 s74, s74, s75
    buffer_store_dwordx4 v[136:139], v3, s[28:31], s49 offen offset:0 sc0 sc1
    buffer_store_dwordx4 v[140:143], v3, s[28:31], s49 offen offset:1024 sc0 sc1
    s_mov_b32 exec_lo, 0x00010001
    s_mov_b32 exec_hi, 0x00010001
    buffer_store_dwordx4 v[144:147], v7, s[32:35], s48 offen sc0 sc1
    s_mov_b64 exec, -1
    s_nop 0
    v_pk_fma_f32 v[20:21], v[156:157], v[4:5], v[20:21] op_sel_hi:[1,0,1]
    v_pk_fma_f32 v[22:23], v[158:159], v[4:5], v[22:23] op_sel_hi:[1,0,1]
    v_pk_fma_f32 v[28:29], v[160:161], v[4:5], v[28:29] op_sel_hi:[1,0,1]
    v_pk_fma_f32 v[30:31], v[162:163], v[4:5], v[30:31] op_sel_hi:[1,0,1]
    v_pk_fma_f32 v[24:25], v[156:157], v[8:9], v[24:25] op_sel_hi:[1,0,1]
    v_pk_fma_f32 v[26:27], v[158:159], v[8:9], v[26:27] op_sel_hi:[1,0,1]
    v_pk_fma_f32 v[32:33], v[160:161], v[8:9], v[32:33] op_sel_hi:[1,0,1]
    v_pk_fma_f32 v[34:35], v[162:163], v[8:9], v[34:35] op_sel_hi:[1,0,1]
    v_cvt_pk_bf16_f32 v68, v20, v21
    v_cvt_pk_bf16_f32 v69, v22, v23
    v_cvt_pk_bf16_f32 v70, v28, v29
    v_cvt_pk_bf16_f32 v71, v30, v31
    v_cvt_pk_bf16_f32 v72, v24, v25
    v_cvt_pk_bf16_f32 v73, v26, v27
    v_cvt_pk_bf16_f32 v74, v32, v33
    v_cvt_pk_bf16_f32 v75, v34, v35
    v_mfma_f32_16x16x32_bf16 v[36:39], v[148:151], v[68:71], 0
    v_mfma_f32_16x16x32_bf16 v[40:43], v[152:155], v[68:71], 0
    v_mfma_f32_16x16x32_bf16 v[44:47], v[148:151], v[72:75], 0
    v_mfma_f32_16x16x32_bf16 v[48:51], v[152:155], v[72:75], 0
    s_waitcnt vmcnt(0)
    v_mov_b32 v239, 0
    v_mov_b32 v240, s60
    s_mov_b64 exec, 1
    buffer_store_dword v240, v239, s[56:59], s74 offen sc0 sc1
    s_mov_b64 exec, -1
    s_nop 0
    v_max3_f32 v96, v36, v37, v38
    v_max3_f32 v98, -v36, -v37, -v38
    v_max3_f32 v100, v44, v45, v46
    v_max3_f32 v102, -v44, -v45, -v46
    v_max3_f32 v96, v96, v39, v40
    v_max3_f32 v98, v98, -v39, -v40
    v_max3_f32 v100, v100, v47, v48
    v_max3_f32 v102, v102, -v47, -v48
    v_max3_f32 v96, v96, v41, v42
    v_max3_f32 v98, v98, -v41, -v42
    v_max3_f32 v100, v100, v49, v50
    v_max3_f32 v102, v102, -v49, -v50
    v_max_f32_e64 v96, v96, v43
    v_max_f32_e64 v98, v98, -v43
    v_max_f32_e64 v100, v100, v51
    v_max_f32_e64 v102, v102, -v51
    v_permlane32_swap_b32 v96, v98
    s_nop 0
    v_permlane32_swap_b32 v100, v102
    v_max_f32 v96, v96, v98
    v_max_f32 v100, v100, v102
    v_mov_b32 v97, v96
    v_mov_b32 v101, v100
    s_nop 0
    v_permlane16_swap_b32 v96, v97
    v_permlane16_swap_b32 v100, v101
    v_max_f32 v96, v96, v97
    v_max_f32 v100, v100, v101
    v_mov_b32 v98, v96
    v_mov_b32 v102, v100
    s_nop 0
    v_permlane32_swap_b32 v96, v98
    v_permlane32_swap_b32 v100, v102
    v_mul_f32 v96, v2, v96
    v_mul_f32 v98, v2, v98
    v_mul_f32 v100, v6, v100
    v_mul_f32_e64 v102, v6, v102
    v_pk_fma_f32 v[52:53], v[36:37], v[2:3], v[98:99] op_sel_hi:[1,0,0] neg_lo:[1,0,1] neg_hi:[1,0,1]
    v_pk_fma_f32 v[54:55], v[38:39], v[2:3], v[98:99] op_sel_hi:[1,0,0] neg_lo:[1,0,1] neg_hi:[1,0,1]
    v_pk_fma_f32 v[56:57], v[40:41], v[2:3], v[98:99] op_sel_hi:[1,0,0] neg_lo:[1,0,1] neg_hi:[1,0,1]
    v_pk_fma_f32 v[58:59], v[42:43], v[2:3], v[98:99] op_sel_hi:[1,0,0] neg_lo:[1,0,1] neg_hi:[1,0,1]
    v_pk_fma_f32 v[36:37], v[36:37], v[2:3], v[96:97] op_sel_hi:[1,0,0] neg_lo:[0,0,1] neg_hi:[0,0,1]
    v_pk_fma_f32 v[38:39], v[38:39], v[2:3], v[96:97] op_sel_hi:[1,0,0] neg_lo:[0,0,1] neg_hi:[0,0,1]
    v_pk_fma_f32 v[40:41], v[40:41], v[2:3], v[96:97] op_sel_hi:[1,0,0] neg_lo:[0,0,1] neg_hi:[0,0,1]
    v_pk_fma_f32 v[42:43], v[42:43], v[2:3], v[96:97] op_sel_hi:[1,0,0] neg_lo:[0,0,1] neg_hi:[0,0,1]
    v_pk_fma_f32 v[60:61], v[44:45], v[6:7], v[102:103] op_sel_hi:[1,0,0] neg_lo:[1,0,1] neg_hi:[1,0,1]
    v_pk_fma_f32 v[62:63], v[46:47], v[6:7], v[102:103] op_sel_hi:[1,0,0] neg_lo:[1,0,1] neg_hi:[1,0,1]
    v_pk_fma_f32 v[64:65], v[48:49], v[6:7], v[102:103] op_sel_hi:[1,0,0] neg_lo:[1,0,1] neg_hi:[1,0,1]
    v_pk_fma_f32 v[66:67], v[50:51], v[6:7], v[102:103] op_sel_hi:[1,0,0] neg_lo:[1,0,1] neg_hi:[1,0,1]
    v_pk_fma_f32 v[44:45], v[44:45], v[6:7], v[100:101] op_sel_hi:[1,0,0] neg_lo:[0,0,1] neg_hi:[0,0,1]
    v_pk_fma_f32 v[46:47], v[46:47], v[6:7], v[100:101] op_sel_hi:[1,0,0] neg_lo:[0,0,1] neg_hi:[0,0,1]
    v_pk_fma_f32 v[48:49], v[48:49], v[6:7], v[100:101] op_sel_hi:[1,0,0] neg_lo:[0,0,1] neg_hi:[0,0,1]
    v_pk_fma_f32 v[50:51], v[50:51], v[6:7], v[100:101] op_sel_hi:[1,0,0] neg_lo:[0,0,1] neg_hi:[0,0,1]
    v_exp_f32 v36, v36
    v_exp_f32 v37, v37
    v_exp_f32 v38, v38
    v_exp_f32 v39, v39
    v_exp_f32 v40, v40
    v_exp_f32 v41, v41
    v_exp_f32 v42, v42
    v_exp_f32 v43, v43
    v_exp_f32 v52, v52
    v_exp_f32 v53, v53
    v_exp_f32 v54, v54
    v_exp_f32 v55, v55
    v_exp_f32 v56, v56
    v_exp_f32 v57, v57
    v_exp_f32 v58, v58
    v_exp_f32 v59, v59
    v_exp_f32 v44, v44
    v_exp_f32 v45, v45
    v_exp_f32 v46, v46
    v_exp_f32 v47, v47
    v_exp_f32 v48, v48
    v_exp_f32 v49, v49
    v_exp_f32 v50, v50
    v_exp_f32 v51, v51
    v_exp_f32 v60, v60
    v_exp_f32 v61, v61
    v_exp_f32 v62, v62
    v_exp_f32 v63, v63
    v_exp_f32 v64, v64
    v_exp_f32 v65, v65
    v_exp_f32 v66, v66
    v_exp_f32 v67, v67
    v_pk_add_f32 v[96:97], v[36:37], v[38:39]
    v_pk_add_f32 v[98:99], v[52:53], v[54:55]
    v_pk_add_f32 v[100:101], v[44:45], v[46:47]
    v_pk_add_f32 v[102:103], v[60:61], v[62:63]
    v_pk_add_f32 v[96:97], v[96:97], v[40:41]
    v_pk_add_f32 v[98:99], v[98:99], v[56:57]
    v_pk_add_f32 v[100:101], v[100:101], v[48:49]
    v_pk_add_f32 v[102:103], v[102:103], v[64:65]
    v_pk_add_f32 v[96:97], v[96:97], v[42:43]
    v_pk_add_f32 v[98:99], v[98:99], v[58:59]
    v_pk_add_f32 v[100:101], v[100:101], v[50:51]
    v_pk_add_f32 v[102:103], v[102:103], v[66:67]
    v_add_f32 v96, v96, v97
    v_add_f32 v98, v98, v99
    v_add_f32 v100, v100, v101
    v_add_f32 v102, v102, v103
    v_permlane32_swap_b32 v96, v98
    s_nop 0
    v_permlane32_swap_b32 v100, v102
    v_add_f32 v96, v96, v98
    v_add_f32 v100, v100, v102
    v_mov_b32 v97, v96
    v_mov_b32 v101, v100
    s_nop 0
    v_permlane16_swap_b32 v96, v97
    v_permlane16_swap_b32 v100, v101
    v_add_f32 v96, v96, v97
    v_add_f32 v100, v100, v101
    v_mov_b32 v98, v96
    v_mov_b32 v102, v100
    s_nop 0
    v_permlane32_swap_b32 v96, v98
    v_permlane32_swap_b32 v100, v102
    v_rcp_f32 v96, v96
    v_rcp_f32 v98, v98
    v_rcp_f32 v100, v100
    v_rcp_f32_e64 v102, v102
    v_pk_mul_f32 v[36:37], v[36:37], v[96:97] op_sel_hi:[1,0]
    v_pk_mul_f32 v[38:39], v[38:39], v[96:97] op_sel_hi:[1,0]
    v_pk_mul_f32 v[40:41], v[40:41], v[96:97] op_sel_hi:[1,0]
    v_pk_mul_f32 v[42:43], v[42:43], v[96:97] op_sel_hi:[1,0]
    v_pk_mul_f32 v[52:53], v[52:53], v[98:99] op_sel_hi:[1,0]
    v_pk_mul_f32 v[54:55], v[54:55], v[98:99] op_sel_hi:[1,0]
    v_pk_mul_f32 v[56:57], v[56:57], v[98:99] op_sel_hi:[1,0]
    v_pk_mul_f32 v[58:59], v[58:59], v[98:99] op_sel_hi:[1,0]
    v_cvt_pk_bf16_f32 v36, v36, v37
    v_cvt_pk_bf16_f32 v37, v38, v39
    v_cvt_pk_bf16_f32 v38, v40, v41
    v_cvt_pk_bf16_f32 v39, v42, v43
    v_cvt_pk_bf16_f32 v52, v52, v53
    v_cvt_pk_bf16_f32 v53, v54, v55
    v_cvt_pk_bf16_f32 v54, v56, v57
    v_cvt_pk_bf16_f32 v55, v58, v59
    v_pk_mul_f32 v[44:45], v[44:45], v[100:101] op_sel_hi:[1,0]
    v_pk_mul_f32 v[46:47], v[46:47], v[100:101] op_sel_hi:[1,0]
    v_pk_mul_f32 v[48:49], v[48:49], v[100:101] op_sel_hi:[1,0]
    v_pk_mul_f32 v[50:51], v[50:51], v[100:101] op_sel_hi:[1,0]
    v_pk_mul_f32 v[60:61], v[60:61], v[102:103] op_sel_hi:[1,0]
    v_pk_mul_f32 v[62:63], v[62:63], v[102:103] op_sel_hi:[1,0]
    v_pk_mul_f32 v[64:65], v[64:65], v[102:103] op_sel_hi:[1,0]
    v_pk_mul_f32 v[66:67], v[66:67], v[102:103] op_sel_hi:[1,0]
    v_cvt_pk_bf16_f32 v44, v44, v45
    v_cvt_pk_bf16_f32 v45, v46, v47
    v_cvt_pk_bf16_f32 v46, v48, v49
    v_cvt_pk_bf16_f32 v47, v50, v51
    v_cvt_pk_bf16_f32 v60, v60, v61
    v_cvt_pk_bf16_f32 v61, v62, v63
    v_cvt_pk_bf16_f32 v62, v64, v65
    v_cvt_pk_bf16_f32 v63, v66, v67
    s_branch interleave_layers__linear_kernel_hedgehog__geglu_ffn__prompt_kernel_jn65
interleave_layers__linear_kernel_hedgehog__geglu_ffn__prompt_kernel_hi64:
    s_nop 0
    v_pk_fma_f32 v[20:21], v[156:157], v[4:5], v[20:21] op_sel_hi:[1,0,1]
    v_pk_fma_f32 v[22:23], v[158:159], v[4:5], v[22:23] op_sel_hi:[1,0,1]
    v_pk_fma_f32 v[28:29], v[160:161], v[4:5], v[28:29] op_sel_hi:[1,0,1]
    v_pk_fma_f32 v[30:31], v[162:163], v[4:5], v[30:31] op_sel_hi:[1,0,1]
    v_pk_fma_f32 v[24:25], v[156:157], v[8:9], v[24:25] op_sel_hi:[1,0,1]
    v_pk_fma_f32 v[26:27], v[158:159], v[8:9], v[26:27] op_sel_hi:[1,0,1]
    v_pk_fma_f32 v[32:33], v[160:161], v[8:9], v[32:33] op_sel_hi:[1,0,1]
    v_pk_fma_f32 v[34:35], v[162:163], v[8:9], v[34:35] op_sel_hi:[1,0,1]
    v_cvt_pk_bf16_f32 v68, v20, v21
    v_cvt_pk_bf16_f32 v69, v22, v23
    v_cvt_pk_bf16_f32 v70, v28, v29
    v_cvt_pk_bf16_f32 v71, v30, v31
    v_cvt_pk_bf16_f32 v72, v24, v25
    v_cvt_pk_bf16_f32 v73, v26, v27
    v_cvt_pk_bf16_f32 v74, v32, v33
    v_cvt_pk_bf16_f32 v75, v34, v35
    v_mfma_f32_16x16x32_bf16 v[36:39], v[148:151], v[68:71], 0
    v_mfma_f32_16x16x32_bf16 v[40:43], v[152:155], v[68:71], 0
    v_mfma_f32_16x16x32_bf16 v[44:47], v[148:151], v[72:75], 0
    v_mfma_f32_16x16x32_bf16 v[48:51], v[152:155], v[72:75], 0
    s_nop 4
    s_nop 0
    v_max3_f32 v96, v36, v37, v38
    v_max3_f32 v98, -v36, -v37, -v38
    v_max3_f32 v100, v44, v45, v46
    v_max3_f32 v102, -v44, -v45, -v46
    v_max3_f32 v96, v96, v39, v40
    v_max3_f32 v98, v98, -v39, -v40
    v_max3_f32 v100, v100, v47, v48
    v_max3_f32 v102, v102, -v47, -v48
    v_max3_f32 v96, v96, v41, v42
    v_max3_f32 v98, v98, -v41, -v42
    v_max3_f32 v100, v100, v49, v50
    v_max3_f32 v102, v102, -v49, -v50
    v_max_f32_e64 v96, v96, v43
    v_max_f32_e64 v98, v98, -v43
    v_max_f32_e64 v100, v100, v51
    v_max_f32_e64 v102, v102, -v51
    v_permlane32_swap_b32 v96, v98
    s_nop 0
    v_permlane32_swap_b32 v100, v102
    v_max_f32 v96, v96, v98
    v_max_f32 v100, v100, v102
    v_mov_b32 v97, v96
    v_mov_b32 v101, v100
    s_nop 0
    v_permlane16_swap_b32 v96, v97
    v_permlane16_swap_b32 v100, v101
    v_max_f32 v96, v96, v97
    v_max_f32 v100, v100, v101
    v_mov_b32 v98, v96
    v_mov_b32 v102, v100
    s_nop 0
    v_permlane32_swap_b32 v96, v98
    v_permlane32_swap_b32 v100, v102
    v_mul_f32 v96, v2, v96
    v_mul_f32 v98, v2, v98
    v_mul_f32 v100, v6, v100
    v_mul_f32_e64 v102, v6, v102
    v_pk_fma_f32 v[52:53], v[36:37], v[2:3], v[98:99] op_sel_hi:[1,0,0] neg_lo:[1,0,1] neg_hi:[1,0,1]
    v_pk_fma_f32 v[54:55], v[38:39], v[2:3], v[98:99] op_sel_hi:[1,0,0] neg_lo:[1,0,1] neg_hi:[1,0,1]
    v_pk_fma_f32 v[56:57], v[40:41], v[2:3], v[98:99] op_sel_hi:[1,0,0] neg_lo:[1,0,1] neg_hi:[1,0,1]
    v_pk_fma_f32 v[58:59], v[42:43], v[2:3], v[98:99] op_sel_hi:[1,0,0] neg_lo:[1,0,1] neg_hi:[1,0,1]
    v_pk_fma_f32 v[36:37], v[36:37], v[2:3], v[96:97] op_sel_hi:[1,0,0] neg_lo:[0,0,1] neg_hi:[0,0,1]
    v_pk_fma_f32 v[38:39], v[38:39], v[2:3], v[96:97] op_sel_hi:[1,0,0] neg_lo:[0,0,1] neg_hi:[0,0,1]
    v_pk_fma_f32 v[40:41], v[40:41], v[2:3], v[96:97] op_sel_hi:[1,0,0] neg_lo:[0,0,1] neg_hi:[0,0,1]
    v_pk_fma_f32 v[42:43], v[42:43], v[2:3], v[96:97] op_sel_hi:[1,0,0] neg_lo:[0,0,1] neg_hi:[0,0,1]
    v_pk_fma_f32 v[60:61], v[44:45], v[6:7], v[102:103] op_sel_hi:[1,0,0] neg_lo:[1,0,1] neg_hi:[1,0,1]
    v_pk_fma_f32 v[62:63], v[46:47], v[6:7], v[102:103] op_sel_hi:[1,0,0] neg_lo:[1,0,1] neg_hi:[1,0,1]
    v_pk_fma_f32 v[64:65], v[48:49], v[6:7], v[102:103] op_sel_hi:[1,0,0] neg_lo:[1,0,1] neg_hi:[1,0,1]
    v_pk_fma_f32 v[66:67], v[50:51], v[6:7], v[102:103] op_sel_hi:[1,0,0] neg_lo:[1,0,1] neg_hi:[1,0,1]
    v_pk_fma_f32 v[44:45], v[44:45], v[6:7], v[100:101] op_sel_hi:[1,0,0] neg_lo:[0,0,1] neg_hi:[0,0,1]
    v_pk_fma_f32 v[46:47], v[46:47], v[6:7], v[100:101] op_sel_hi:[1,0,0] neg_lo:[0,0,1] neg_hi:[0,0,1]
    v_pk_fma_f32 v[48:49], v[48:49], v[6:7], v[100:101] op_sel_hi:[1,0,0] neg_lo:[0,0,1] neg_hi:[0,0,1]
    v_pk_fma_f32 v[50:51], v[50:51], v[6:7], v[100:101] op_sel_hi:[1,0,0] neg_lo:[0,0,1] neg_hi:[0,0,1]
    v_exp_f32 v36, v36
    v_exp_f32 v37, v37
    v_exp_f32 v38, v38
    v_exp_f32 v39, v39
    v_exp_f32 v40, v40
    v_exp_f32 v41, v41
    v_exp_f32 v42, v42
    v_exp_f32 v43, v43
    v_exp_f32 v52, v52
    v_exp_f32 v53, v53
    v_exp_f32 v54, v54
    v_exp_f32 v55, v55
    v_exp_f32 v56, v56
    v_exp_f32 v57, v57
    v_exp_f32 v58, v58
    v_exp_f32 v59, v59
    v_exp_f32 v44, v44
    v_exp_f32 v45, v45
    v_exp_f32 v46, v46
    v_exp_f32 v47, v47
    v_exp_f32 v48, v48
    v_exp_f32 v49, v49
    v_exp_f32 v50, v50
    v_exp_f32 v51, v51
    v_exp_f32 v60, v60
    v_exp_f32 v61, v61
    v_exp_f32 v62, v62
    v_exp_f32 v63, v63
    v_exp_f32 v64, v64
    v_exp_f32 v65, v65
    v_exp_f32 v66, v66
    v_exp_f32 v67, v67
    v_pk_add_f32 v[96:97], v[36:37], v[38:39]
    v_pk_add_f32 v[98:99], v[52:53], v[54:55]
    v_pk_add_f32 v[100:101], v[44:45], v[46:47]
    v_pk_add_f32 v[102:103], v[60:61], v[62:63]
    v_pk_add_f32 v[96:97], v[96:97], v[40:41]
    v_pk_add_f32 v[98:99], v[98:99], v[56:57]
    v_pk_add_f32 v[100:101], v[100:101], v[48:49]
    v_pk_add_f32 v[102:103], v[102:103], v[64:65]
    v_pk_add_f32 v[96:97], v[96:97], v[42:43]
    v_pk_add_f32 v[98:99], v[98:99], v[58:59]
    v_pk_add_f32 v[100:101], v[100:101], v[50:51]
    v_pk_add_f32 v[102:103], v[102:103], v[66:67]
    v_add_f32 v96, v96, v97
    v_add_f32 v98, v98, v99
    v_add_f32 v100, v100, v101
    v_add_f32 v102, v102, v103
    v_permlane32_swap_b32 v96, v98
    s_nop 0
    v_permlane32_swap_b32 v100, v102
    v_add_f32 v96, v96, v98
    v_add_f32 v100, v100, v102
    v_mov_b32 v97, v96
    v_mov_b32 v101, v100
    s_nop 0
    v_permlane16_swap_b32 v96, v97
    v_permlane16_swap_b32 v100, v101
    v_add_f32 v96, v96, v97
    v_add_f32 v100, v100, v101
    v_mov_b32 v98, v96
    v_mov_b32 v102, v100
    s_nop 0
    v_permlane32_swap_b32 v96, v98
    v_permlane32_swap_b32 v100, v102
    v_rcp_f32 v96, v96
    v_rcp_f32 v98, v98
    v_rcp_f32 v100, v100
    v_rcp_f32_e64 v102, v102
    v_pk_mul_f32 v[36:37], v[36:37], v[96:97] op_sel_hi:[1,0]
    v_pk_mul_f32 v[38:39], v[38:39], v[96:97] op_sel_hi:[1,0]
    v_pk_mul_f32 v[40:41], v[40:41], v[96:97] op_sel_hi:[1,0]
    v_pk_mul_f32 v[42:43], v[42:43], v[96:97] op_sel_hi:[1,0]
    v_pk_mul_f32 v[52:53], v[52:53], v[98:99] op_sel_hi:[1,0]
    v_pk_mul_f32 v[54:55], v[54:55], v[98:99] op_sel_hi:[1,0]
    v_pk_mul_f32 v[56:57], v[56:57], v[98:99] op_sel_hi:[1,0]
    v_pk_mul_f32 v[58:59], v[58:59], v[98:99] op_sel_hi:[1,0]
    v_cvt_pk_bf16_f32 v36, v36, v37
    v_cvt_pk_bf16_f32 v37, v38, v39
    v_cvt_pk_bf16_f32 v38, v40, v41
    v_cvt_pk_bf16_f32 v39, v42, v43
    v_cvt_pk_bf16_f32 v52, v52, v53
    v_cvt_pk_bf16_f32 v53, v54, v55
    v_cvt_pk_bf16_f32 v54, v56, v57
    v_cvt_pk_bf16_f32 v55, v58, v59
    v_pk_mul_f32 v[44:45], v[44:45], v[100:101] op_sel_hi:[1,0]
    v_pk_mul_f32 v[46:47], v[46:47], v[100:101] op_sel_hi:[1,0]
    v_pk_mul_f32 v[48:49], v[48:49], v[100:101] op_sel_hi:[1,0]
    v_pk_mul_f32 v[50:51], v[50:51], v[100:101] op_sel_hi:[1,0]
    v_pk_mul_f32 v[60:61], v[60:61], v[102:103] op_sel_hi:[1,0]
    v_pk_mul_f32 v[62:63], v[62:63], v[102:103] op_sel_hi:[1,0]
    v_pk_mul_f32 v[64:65], v[64:65], v[102:103] op_sel_hi:[1,0]
    v_pk_mul_f32 v[66:67], v[66:67], v[102:103] op_sel_hi:[1,0]
    v_cvt_pk_bf16_f32 v44, v44, v45
    v_cvt_pk_bf16_f32 v45, v46, v47
    v_cvt_pk_bf16_f32 v46, v48, v49
    v_cvt_pk_bf16_f32 v47, v50, v51
    v_cvt_pk_bf16_f32 v60, v60, v61
    v_cvt_pk_bf16_f32 v61, v62, v63
    v_cvt_pk_bf16_f32 v62, v64, v65
    v_cvt_pk_bf16_f32 v63, v66, v67
    s_add_u32 s12, s68, 0x4800000
    .long 0x820dff45, 0x0
    s_mov_b32 s14, 0x200000
    s_mov_b32 s15, 0x00020000
    s_add_u32 s16, s68, 0x4c20000
    .long 0x8211ff45, 0x0
    s_mov_b32 s18, 0x10000
    s_mov_b32 s19, 0x00020000
    .long 0x8e35ff2a, 0xc
    s_add_u32 s53, s53, 131072
    s_lshl_b32 s74, s52, 7
    s_add_u32 s53, s53, s74
    s_lshl_b32 s49, s42, 16
    s_lshl_b32 s74, s52, 11
    s_add_u32 s49, s49, s74
    s_lshl_b32 s48, s42, 11
    s_lshl_b32 s74, s52, 6
    s_add_u32 s48, s48, s74
    v_and_b32_e64 v5, 7, v0
    v_lshl_add_u32 v5, v5, 8, v7
    v_lshlrev_b32_e64 v9, 9, v0
    s_mov_b32 exec_lo, 0xff
    s_mov_b32 exec_hi, 0x0
    s_mov_b32 s74, 0
interleave_layers__linear_kernel_hedgehog__geglu_ffn__prompt_kernel_poll67:
    buffer_load_dword v244, v9, s[56:59], s53 offen sc1
    s_add_u32 s74, s74, 1
    s_waitcnt vmcnt(0)
    v_cmp_ne_u32 vcc, s60, v244
    s_nop 0
    s_cmp_eq_u64 vcc, 0
    s_cbranch_scc1 interleave_layers__linear_kernel_hedgehog__geglu_ffn__prompt_kernel_polled68
    s_mov_b64 exec, vcc
    s_sleep 4
    s_cmp_lt_u32 s74, 50000
    s_cbranch_scc1 interleave_layers__linear_kernel_hedgehog__geglu_ffn__prompt_kernel_poll67
interleave_layers__linear_kernel_hedgehog__geglu_ffn__prompt_kernel_polled68:
    s_mov_b64 exec, -1
    buffer_load_dwordx4 v[68:71], v3, s[12:15], s49 offen offset:0
    buffer_load_dwordx4 v[72:75], v3, s[12:15], s49 offen offset:1024
    s_add_u32 s49, s49, 8192
    buffer_load_dwordx4 v[76:79], v3, s[12:15], s49 offen offset:0
    buffer_load_dwordx4 v[80:83], v3, s[12:15], s49 offen offset:1024
    s_add_u32 s49, s49, 8192
    buffer_load_dwordx4 v[84:87], v3, s[12:15], s49 offen offset:0
    buffer_load_dwordx4 v[88:91], v3, s[12:15], s49 offen offset:1024
    s_add_u32 s49, s49, 8192
    buffer_load_dwordx4 v[92:95], v3, s[12:15], s49 offen offset:0
    buffer_load_dwordx4 v[96:99], v3, s[12:15], s49 offen offset:1024
    s_add_u32 s49, s49, 8192
    buffer_load_dwordx4 v[100:103], v3, s[12:15], s49 offen offset:0
    buffer_load_dwordx4 v[104:107], v3, s[12:15], s49 offen offset:1024
    s_add_u32 s49, s49, 8192
    buffer_load_dwordx4 v[108:111], v3, s[12:15], s49 offen offset:0
    buffer_load_dwordx4 v[112:115], v3, s[12:15], s49 offen offset:1024
    s_add_u32 s49, s49, 8192
    buffer_load_dwordx4 v[116:119], v3, s[12:15], s49 offen offset:0
    buffer_load_dwordx4 v[120:123], v3, s[12:15], s49 offen offset:1024
    s_add_u32 s49, s49, 8192
    buffer_load_dwordx4 v[124:127], v3, s[12:15], s49 offen offset:0
    buffer_load_dwordx4 v[128:131], v3, s[12:15], s49 offen offset:1024
    buffer_load_dwordx4 v[132:135], v5, s[16:19], s48 offen
    .long 0x8f35ff34, 0x1
    s_mul_i32 s53, s53, 3072
    s_and_b32 s74, s52, 1
    .long 0x8e4aff4a, 0x3
    s_add_u32 s53, s53, s74
    s_add_u32 s53, s53, 81920
    v_add_u32 v9, s53, v3
    s_waitcnt vmcnt(13)
    v_pk_add_f32 v[68:69], v[68:69], v[76:77]
    v_pk_add_f32 v[70:71], v[70:71], v[78:79]
    v_pk_add_f32 v[72:73], v[72:73], v[80:81]
    v_pk_add_f32 v[74:75], v[74:75], v[82:83]
    s_waitcnt vmcnt(11)
    v_pk_add_f32 v[68:69], v[68:69], v[84:85]
    v_pk_add_f32 v[70:71], v[70:71], v[86:87]
    v_pk_add_f32 v[72:73], v[72:73], v[88:89]
    v_pk_add_f32 v[74:75], v[74:75], v[90:91]
    s_waitcnt vmcnt(9)
    v_pk_add_f32 v[68:69], v[68:69], v[92:93]
    v_pk_add_f32 v[70:71], v[70:71], v[94:95]
    v_pk_add_f32 v[72:73], v[72:73], v[96:97]
    v_pk_add_f32 v[74:75], v[74:75], v[98:99]
    s_waitcnt vmcnt(7)
    v_pk_add_f32 v[68:69], v[68:69], v[100:101]
    v_pk_add_f32 v[70:71], v[70:71], v[102:103]
    v_pk_add_f32 v[72:73], v[72:73], v[104:105]
    v_pk_add_f32 v[74:75], v[74:75], v[106:107]
    s_waitcnt vmcnt(5)
    v_pk_add_f32 v[68:69], v[68:69], v[108:109]
    v_pk_add_f32 v[70:71], v[70:71], v[110:111]
    v_pk_add_f32 v[72:73], v[72:73], v[112:113]
    v_pk_add_f32 v[74:75], v[74:75], v[114:115]
    s_waitcnt vmcnt(3)
    v_pk_add_f32 v[68:69], v[68:69], v[116:117]
    v_pk_add_f32 v[70:71], v[70:71], v[118:119]
    v_pk_add_f32 v[72:73], v[72:73], v[120:121]
    v_pk_add_f32 v[74:75], v[74:75], v[122:123]
    s_waitcnt vmcnt(1)
    v_pk_add_f32 v[68:69], v[68:69], v[124:125]
    v_pk_add_f32 v[70:71], v[70:71], v[126:127]
    v_pk_add_f32 v[72:73], v[72:73], v[128:129]
    v_pk_add_f32 v[74:75], v[74:75], v[130:131]
    v_cvt_pk_bf16_f32 v76, v68, v69
    v_cvt_pk_bf16_f32 v77, v70, v71
    v_cvt_pk_bf16_f32 v78, v72, v73
    v_cvt_pk_bf16_f32 v79, v74, v75
    ds_write_b64 v9, v[76:77]
    ds_write_b64 v9, v[78:79] offset:1024
    s_waitcnt vmcnt(0)
    s_nop 0
    v_add_f32_dpp v132, v132, v132 row_ror:4 row_mask:0xf bank_mask:0xf
    v_add_f32_dpp v133, v133, v133 row_ror:4 row_mask:0xf bank_mask:0xf
    v_add_f32_dpp v134, v134, v134 row_ror:4 row_mask:0xf bank_mask:0xf
    v_add_f32_dpp v135, v135, v135 row_ror:4 row_mask:0xf bank_mask:0xf
    v_add_f32_dpp v132, v132, v132 row_ror:2 row_mask:0xf bank_mask:0xf
    v_add_f32_dpp v133, v133, v133 row_ror:2 row_mask:0xf bank_mask:0xf
    v_add_f32_dpp v134, v134, v134 row_ror:2 row_mask:0xf bank_mask:0xf
    v_add_f32_dpp v135, v135, v135 row_ror:2 row_mask:0xf bank_mask:0xf
    v_add_f32_dpp v132, v132, v132 row_ror:1 row_mask:0xf bank_mask:0xf
    v_add_f32_dpp v133, v133, v133 row_ror:1 row_mask:0xf bank_mask:0xf
    v_add_f32_dpp v134, v134, v134 row_ror:1 row_mask:0xf bank_mask:0xf
    v_add_f32_dpp v135, v135, v135 row_ror:1 row_mask:0xf bank_mask:0xf
    v_cvt_pk_bf16_f32 v136, v132, v133
    v_cvt_pk_bf16_f32 v137, v134, v135
    ds_write_b64 v9, v[136:137] offset:2048
    s_waitcnt lgkmcnt(0)
interleave_layers__linear_kernel_hedgehog__geglu_ffn__prompt_kernel_jn65:
    s_add_u32 s28, s68, 0x1400000
    s_addc_u32 s29, s69, 0
    s_mov_b32 s30, 0x400000
    s_mov_b32 s31, 0x00020000
    s_lshl_b32 s45, s42, 17
    s_lshl_b32 s48, s41, 14
    s_add_u32 s45, s45, s48
    .long 0x8e30ff28, 0xb
    s_add_u32 s45, s45, s48
    s_mov_b32 s76, 0x358637bd
    v_add_u32 v5, 81920, v3
    s_barrier
    s_nop 0
    ds_read_b128 v[180:183], v5 offset:2048
    ds_read_b128 v[172:175], v5 offset:0
    ds_read_b128 v[176:179], v5 offset:1024
    ds_read_b128 v[192:195], v5 offset:5120
    ds_read_b128 v[184:187], v5 offset:3072
    ds_read_b128 v[188:191], v5 offset:4096
    s_waitcnt lgkmcnt(3)
    v_mfma_f32_16x16x32_bf16 v[204:207], v[180:183], v[36:39], 0
    v_mfma_f32_16x16x32_bf16 v[216:219], v[180:183], v[44:47], 0
    v_mfma_f32_16x16x32_bf16 v[196:199], v[172:175], v[36:39], 0
    v_mfma_f32_16x16x32_bf16 v[208:211], v[172:175], v[44:47], 0
    v_mfma_f32_16x16x32_bf16 v[200:203], v[176:179], v[36:39], 0
    v_mfma_f32_16x16x32_bf16 v[212:215], v[176:179], v[44:47], 0
    s_waitcnt lgkmcnt(0)
    v_mfma_f32_16x16x32_bf16 v[204:207], v[192:195], v[52:55], v[204:207]
    v_mfma_f32_16x16x32_bf16 v[216:219], v[192:195], v[60:63], v[216:219]
    v_mfma_f32_16x16x32_bf16 v[196:199], v[184:187], v[52:55], v[196:199]
    v_mfma_f32_16x16x32_bf16 v[208:211], v[184:187], v[60:63], v[208:211]
    v_mfma_f32_16x16x32_bf16 v[200:203], v[188:191], v[52:55], v[200:203]
    v_mfma_f32_16x16x32_bf16 v[212:215], v[188:191], v[60:63], v[212:215]
    s_nop 2
    v_add_f32 v204, s76, v204
    v_add_f32 v216, s76, v216
    v_rcp_f32 v204, v204
    v_rcp_f32_e64 v216, v216
    v_pk_mul_f32 v[196:197], v[196:197], v[204:205] op_sel_hi:[1,0]
    v_pk_mul_f32 v[198:199], v[198:199], v[204:205] op_sel_hi:[1,0]
    v_pk_mul_f32 v[200:201], v[200:201], v[204:205] op_sel_hi:[1,0]
    v_pk_mul_f32 v[202:203], v[202:203], v[204:205] op_sel_hi:[1,0]
    v_cvt_pk_bf16_f32 v20, v196, v197
    v_cvt_pk_bf16_f32 v21, v198, v199
    v_cvt_pk_bf16_f32 v22, v200, v201
    v_cvt_pk_bf16_f32 v23, v202, v203
    buffer_store_dwordx4 v[20:23], v3, s[28:31], s45 offen offset:0 sc0 sc1
    v_pk_mul_f32 v[208:209], v[208:209], v[216:217] op_sel_hi:[1,0]
    v_pk_mul_f32 v[210:211], v[210:211], v[216:217] op_sel_hi:[1,0]
    v_pk_mul_f32 v[212:213], v[212:213], v[216:217] op_sel_hi:[1,0]
    v_pk_mul_f32 v[214:215], v[214:215], v[216:217] op_sel_hi:[1,0]
    v_cvt_pk_bf16_f32 v24, v208, v209
    v_cvt_pk_bf16_f32 v25, v210, v211
    v_cvt_pk_bf16_f32 v26, v212, v213
    v_cvt_pk_bf16_f32 v27, v214, v215
    buffer_store_dwordx4 v[24:27], v3, s[28:31], s45 offen offset:1024 sc0 sc1
    s_waitcnt vmcnt(0) lgkmcnt(0)
    s_barrier
    s_cmp_lg_u32 s40, 0
    s_cbranch_scc1 interleave_layers__linear_kernel_hedgehog__geglu_ffn__prompt_kernel_nf69
    s_lshl_b32 s74, s41, 12
    .long 0x8e4bff2a, 0x7
    s_add_u32 s74, s74, s75
    s_add_u32 s74, s74, 294912
    v_mov_b32 v239, 0
    v_mov_b32_e64 v240, s60
    s_mov_b64 exec, 1
    buffer_store_dword v240, v239, s[56:59], s74 offen sc0 sc1
    s_mov_b64 exec, -1
interleave_layers__linear_kernel_hedgehog__geglu_ffn__prompt_kernel_nf69:
    s_branch mega_ph5
mega_ph5:
    s_and_b32 s45, s2, 7
    s_lshr_b32 s49, s2, 3
    s_and_b32 s41, s45, 3
    s_lshl_b32 s41, s41, 2
    s_lshr_b32 s42, s45, 2
    s_mul_i32 s42, s42, 8
    s_and_b32 s45, s49, 3
    s_add_u32 s41, s41, s45
    s_lshr_b32 s45, s49, 2
    s_add_u32 s42, s42, s45
    s_and_b32 s52, s40, 3
    s_cmp_lt_u32 s40, 4
    s_cbranch_scc1 interleave_layers__linear_kernel_hedgehog__geglu_ffn__prompt_kernel_comp70
    s_lshl_b32 s50, s52, 11
    v_lshlrev_b32 v3, 4, v0
    v_add_u32 v3, s50, v3
    s_mul_i32 s47, s42, 131072
    s_add_u32 s8, s68, 0x5500000
    .long 0x8209ff45, 0x0
    s_mov_b32 s10, 0x200000
    s_mov_b32 s11, 0x00020000
    s_add_u32 m0, s50, 0
    s_nop 0
    buffer_load_dwordx4 v3, s[8:11], s47 offen lds
    buffer_load_dwordx4 v3, s[8:11], s47 offen offset:1024 lds
    s_add_u32 s47, s47, 8192
    s_add_u32 m0, s50, 8192
    s_mov_b32 s99, 0x1000
    buffer_load_dwordx4 v3, s[8:11], s47 offen lds
    buffer_load_dwordx4 v3, s[8:11], s47 offen offset:1024 lds
    s_add_u32 s47, s47, 8192
    s_add_u32 m0, s50, 16384
    s_mov_b32 s99, 0x1000
    buffer_load_dwordx4 v3, s[8:11], s47 offen lds
    buffer_load_dwordx4 v3, s[8:11], s47 offen offset:1024 lds
    s_add_u32 s47, s47, 8192
    s_add_u32 m0, s50, 24576
    s_mov_b32 s99, 0x1000
    buffer_load_dwordx4 v3, s[8:11], s47 offen lds
    buffer_load_dwordx4 v3, s[8:11], s47 offen offset:1024 lds
    s_add_u32 s47, s47, 8192
    s_add_u32 m0, s50, 32768
    s_mov_b32 s99, 0x1000
    buffer_load_dwordx4 v3, s[8:11], s47 offen lds
    buffer_load_dwordx4 v3, s[8:11], s47 offen offset:1024 lds
    s_add_u32 s47, s47, 8192
    s_add_u32 m0, s50, 40960
    s_mov_b32 s99, 0x1000
    buffer_load_dwordx4 v3, s[8:11], s47 offen lds
    buffer_load_dwordx4 v3, s[8:11], s47 offen offset:1024 lds
    s_add_u32 s47, s47, 8192
    s_add_u32 m0, s50, 49152
    s_mov_b32 s99, 0x1000
    buffer_load_dwordx4 v3, s[8:11], s47 offen lds
    buffer_load_dwordx4 v3, s[8:11], s47 offen offset:1024 lds
    s_add_u32 s47, s47, 8192
    s_add_u32 m0, s50, 57344
    s_mov_b32 s99, 0x1000
    buffer_load_dwordx4 v3, s[8:11], s47 offen lds
    buffer_load_dwordx4 v3, s[8:11], s47 offen offset:1024 lds
    s_add_u32 s47, s47, 8192
    s_add_u32 m0, s50, 65536
    s_mov_b32 s99, 0x1000
    buffer_load_dwordx4 v3, s[8:11], s47 offen lds
    buffer_load_dwordx4 v3, s[8:11], s47 offen offset:1024 lds
    s_add_u32 s47, s47, 8192
    s_add_u32 m0, s50, 73728
    s_mov_b32 s99, 0x1000
    buffer_load_dwordx4 v3, s[8:11], s47 offen lds
    buffer_load_dwordx4 v3, s[8:11], s47 offen offset:1024 lds
    s_add_u32 s47, s47, 8192
    s_add_u32 m0, s50, 81920
    s_mov_b32 s99, 0x1000
    buffer_load_dwordx4 v3, s[8:11], s47 offen lds
    buffer_load_dwordx4 v3, s[8:11], s47 offen offset:1024 lds
    s_add_u32 s47, s47, 8192
    s_add_u32 m0, s50, 90112
    s_mov_b32 s99, 0x1000
    buffer_load_dwordx4 v3, s[8:11], s47 offen lds
    buffer_load_dwordx4 v3, s[8:11], s47 offen offset:1024 lds
    s_add_u32 s47, s47, 8192
    s_cmp_lg_u32 s40, 4
    s_cbranch_scc1 interleave_layers__linear_kernel_hedgehog__geglu_ffn__prompt_kernel_np71
    s_lshr_b32 s45, s41, 1
    s_lshl_b32 s45, s45, 12
    s_add_u32 s45, s45, 294912
    v_lshlrev_b32 v6, 7, v0
    s_mov_b32 exec_lo, 0xffffffff
    s_mov_b32 exec_hi, 0x0
    s_mov_b32 s74, 0
interleave_layers__linear_kernel_hedgehog__geglu_ffn__prompt_kernel_poll72:
    buffer_load_dword v244, v6, s[56:59], s45 offen sc1
    s_add_u32 s74, s74, 1
    s_waitcnt vmcnt(0)
    v_cmp_ne_u32 vcc, s60, v244
    s_nop 0
    s_cmp_eq_u64 vcc, 0
    s_cbranch_scc1 interleave_layers__linear_kernel_hedgehog__geglu_ffn__prompt_kernel_polled73
    s_mov_b64 exec, vcc
    s_sleep 4
    s_cmp_lt_u32 s74, 50000
    s_cbranch_scc1 interleave_layers__linear_kernel_hedgehog__geglu_ffn__prompt_kernel_poll72
interleave_layers__linear_kernel_hedgehog__geglu_ffn__prompt_kernel_polled73:
    s_mov_b64 exec, -1
interleave_layers__linear_kernel_hedgehog__geglu_ffn__prompt_kernel_np71:
    s_waitcnt vmcnt(16)
    s_barrier
    s_add_u32 m0, s50, 98304
    s_mov_b32 s99, 0x1000
    buffer_load_dwordx4 v3, s[8:11], s47 offen lds
    buffer_load_dwordx4 v3, s[8:11], s47 offen offset:1024 lds
    s_add_u32 s47, s47, 8192
    s_add_u32 m0, s50, 106496
    s_mov_b32 s99, 0x1000
    buffer_load_dwordx4 v3, s[8:11], s47 offen lds
    buffer_load_dwordx4 v3, s[8:11], s47 offen offset:1024 lds
    s_add_u32 s47, s47, 8192
    s_add_u32 m0, s50, 114688
    s_mov_b32 s99, 0x1000
    buffer_load_dwordx4 v3, s[8:11], s47 offen lds
    buffer_load_dwordx4 v3, s[8:11], s47 offen offset:1024 lds
    s_add_u32 s47, s47, 8192
    s_add_u32 m0, s50, 122880
    s_mov_b32 s99, 0x1000
    buffer_load_dwordx4 v3, s[8:11], s47 offen lds
    buffer_load_dwordx4 v3, s[8:11], s47 offen offset:1024 lds
    s_add_u32 s47, s47, 8192
    s_waitcnt vmcnt(16)
    s_barrier
    s_waitcnt vmcnt(8)
    s_barrier
    s_waitcnt vmcnt(0)
    s_barrier
    s_barrier
    s_waitcnt vmcnt(0) lgkmcnt(0)
    s_barrier
    s_cmp_lg_u32 s40, 0
    s_cbranch_scc1 interleave_layers__linear_kernel_hedgehog__geglu_ffn__prompt_kernel_nf74
    s_lshl_b32 s74, s41, 11
    s_lshl_b32 s75, s42, 7
    s_add_u32 s74, s74, s75
    s_add_u32 s74, s74, 360448
    v_mov_b32 v239, 0
    v_mov_b32_e64 v240, s60
    s_mov_b64 exec, 1
    buffer_store_dword v240, v239, s[56:59], s74 offen sc0 sc1
    s_mov_b64 exec, -1
interleave_layers__linear_kernel_hedgehog__geglu_ffn__prompt_kernel_nf74:
    s_branch mega_ph6
interleave_layers__linear_kernel_hedgehog__geglu_ffn__prompt_kernel_comp70:
    v_lshlrev_b32 v5, 4, v0
    s_lshl_b32 s49, s41, 13
    s_lshl_b32 s48, s40, 11
    s_add_u32 s49, s49, s48
    s_lshl_b32 s46, s42, 18
    s_add_u32 s46, s46, s49
    s_add_u32 s47, s46, 131072
    s_add_u32 s51, s49, 131072
    v_lshlrev_b32_e64 v4, 4, v0
    s_add_u32 s4, s68, 0x1400000
    .long 0x8205ff45, 0x0
    s_mov_b32 s6, 0x400000
    s_mov_b32 s7, 0x00020000
    s_add_u32 s12, s68, 0x800000
    .long 0x820dff45, 0x0
    s_mov_b32 s14, 0x400000
    s_mov_b32 s15, 0x00020000
    s_add_u32 s16, s68, 0xc00000
    .long 0x8211ff45, 0x0
    s_mov_b32 s18, 0x400000
    s_mov_b32 s19, 0x00020000
    s_add_u32 s24, s68, 0x4d00000
    .long 0x8219ff45, 0x0
    s_mov_b32 s26, 0x40000
    s_mov_b32 s27, 0x00020000
    s_barrier
    s_nop 0
    buffer_load_dwordx4 v[96:99], v5, s[4:7], s49 offen offset:0
    buffer_load_dwordx4 v[100:103], v5, s[4:7], s49 offen offset:1024
    s_add_u32 s49, s49, 262144
    buffer_load_dwordx4 v[104:107], v5, s[4:7], s51 offen offset:0
    buffer_load_dwordx4 v[108:111], v5, s[4:7], s51 offen offset:1024
    s_add_u32 s51, s51, 262144
    buffer_load_dwordx4 v[112:115], v5, s[4:7], s49 offen offset:0
    buffer_load_dwordx4 v[116:119], v5, s[4:7], s49 offen offset:1024
    s_add_u32 s49, s49, 262144
    buffer_load_dwordx4 v[120:123], v5, s[4:7], s51 offen offset:0
    buffer_load_dwordx4 v[124:127], v5, s[4:7], s51 offen offset:1024
    s_add_u32 s51, s51, 262144
    buffer_load_dwordx4 v[128:131], v5, s[4:7], s49 offen offset:0
    buffer_load_dwordx4 v[132:135], v5, s[4:7], s49 offen offset:1024
    s_add_u32 s49, s49, 262144
    buffer_load_dwordx4 v[136:139], v5, s[4:7], s51 offen offset:0
    buffer_load_dwordx4 v[140:143], v5, s[4:7], s51 offen offset:1024
    s_add_u32 s51, s51, 262144
    ds_read_b128 v[40:43], v4 offset:0
    ds_read_b128 v[44:47], v4 offset:1024
    ds_read_b128 v[48:51], v4 offset:2048
    ds_read_b128 v[52:55], v4 offset:3072
    s_mov_b32 s44, 0
    .long 0xbeab00ff, 0x0
    s_waitcnt vmcnt(8) lgkmcnt(0)
    v_mfma_f32_16x16x32_bf16 v[8:11], v[40:43], v[96:99], 0
    ds_read_b128 v[56:59], v4 offset:4096
    v_mfma_f32_16x16x32_bf16 v[12:15], v[40:43], v[100:103], 0
    ds_read_b128 v[60:63], v4 offset:5120
    v_mfma_f32_16x16x32_bf16 v[16:19], v[44:47], v[96:99], 0
    ds_read_b128 v[64:67], v4 offset:6144
    v_mfma_f32_16x16x32_bf16 v[20:23], v[44:47], v[100:103], 0
    ds_read_b128 v[68:71], v4 offset:7168
    v_mfma_f32_16x16x32_bf16 v[24:27], v[48:51], v[96:99], 0
    buffer_load_dwordx4 v[144:147], v5, s[4:7], s49 offen offset:0
    v_mfma_f32_16x16x32_bf16 v[28:31], v[48:51], v[100:103], 0
    buffer_load_dwordx4 v[148:151], v5, s[4:7], s49 offen offset:1024
    s_add_u32 s49, s49, 262144
    v_mfma_f32_16x16x32_bf16 v[32:35], v[52:55], v[96:99], 0
    v_mfma_f32_16x16x32_bf16 v[36:39], v[52:55], v[100:103], 0
    s_waitcnt lgkmcnt(0)
    s_nop 0
    v_mfma_f32_16x16x32_bf16 v[8:11], v[56:59], v[104:107], v[8:11]
    ds_read_b128 v[40:43], v4 offset:8192
    v_mfma_f32_16x16x32_bf16 v[12:15], v[56:59], v[108:111], v[12:15]
    ds_read_b128 v[44:47], v4 offset:9216
    v_mfma_f32_16x16x32_bf16 v[16:19], v[60:63], v[104:107], v[16:19]
    ds_read_b128 v[48:51], v4 offset:10240
    v_mfma_f32_16x16x32_bf16 v[20:23], v[60:63], v[108:111], v[20:23]
    ds_read_b128 v[52:55], v4 offset:11264
    v_mfma_f32_16x16x32_bf16 v[24:27], v[64:67], v[104:107], v[24:27]
    buffer_load_dwordx4 v[152:155], v5, s[4:7], s51 offen offset:0
    v_mfma_f32_16x16x32_bf16 v[28:31], v[64:67], v[108:111], v[28:31]
    buffer_load_dwordx4 v[156:159], v5, s[4:7], s51 offen offset:1024
    s_add_u32 s51, s51, 262144
    v_mfma_f32_16x16x32_bf16 v[32:35], v[68:71], v[104:107], v[32:35]
    v_mfma_f32_16x16x32_bf16 v[36:39], v[68:71], v[108:111], v[36:39]
    s_waitcnt vmcnt(8) lgkmcnt(0)
    s_nop 0
    v_mfma_f32_16x16x32_bf16 v[8:11], v[40:43], v[112:115], v[8:11]
    ds_read_b128 v[56:59], v4 offset:12288
    v_mfma_f32_16x16x32_bf16 v[12:15], v[40:43], v[116:119], v[12:15]
    ds_read_b128 v[60:63], v4 offset:13312
    v_mfma_f32_16x16x32_bf16 v[16:19], v[44:47], v[112:115], v[16:19]
    ds_read_b128 v[64:67], v4 offset:14336
    v_mfma_f32_16x16x32_bf16 v[20:23], v[44:47], v[116:119], v[20:23]
    ds_read_b128 v[68:71], v4 offset:15360
    v_mfma_f32_16x16x32_bf16 v[24:27], v[48:51], v[112:115], v[24:27]
    buffer_load_dwordx4 v[96:99], v5, s[4:7], s49 offen offset:0
    v_mfma_f32_16x16x32_bf16 v[28:31], v[48:51], v[116:119], v[28:31]
    buffer_load_dwordx4 v[100:103], v5, s[4:7], s49 offen offset:1024
    s_add_u32 s49, s49, 262144
    v_mfma_f32_16x16x32_bf16 v[32:35], v[52:55], v[112:115], v[32:35]
    v_mfma_f32_16x16x32_bf16 v[36:39], v[52:55], v[116:119], v[36:39]
    s_waitcnt lgkmcnt(0)
    s_nop 0
    v_mfma_f32_16x16x32_bf16 v[8:11], v[56:59], v[120:123], v[8:11]
    ds_read_b128 v[40:43], v4 offset:16384
    v_mfma_f32_16x16x32_bf16 v[12:15], v[56:59], v[124:127], v[12:15]
    ds_read_b128 v[44:47], v4 offset:17408
    v_mfma_f32_16x16x32_bf16 v[16:19], v[60:63], v[120:123], v[16:19]
    ds_read_b128 v[48:51], v4 offset:18432
    v_mfma_f32_16x16x32_bf16 v[20:23], v[60:63], v[124:127], v[20:23]
    ds_read_b128 v[52:55], v4 offset:19456
    v_mfma_f32_16x16x32_bf16 v[24:27], v[64:67], v[120:123], v[24:27]
    buffer_load_dwordx4 v[104:107], v5, s[4:7], s51 offen offset:0
    v_mfma_f32_16x16x32_bf16 v[28:31], v[64:67], v[124:127], v[28:31]
    buffer_load_dwordx4 v[108:111], v5, s[4:7], s51 offen offset:1024
    s_add_u32 s51, s51, 262144
    v_mfma_f32_16x16x32_bf16 v[32:35], v[68:71], v[120:123], v[32:35]
    v_mfma_f32_16x16x32_bf16 v[36:39], v[68:71], v[124:127], v[36:39]
    s_waitcnt vmcnt(8) lgkmcnt(0)
    s_nop 0
    v_mfma_f32_16x16x32_bf16 v[8:11], v[40:43], v[128:131], v[8:11]
    ds_read_b128 v[56:59], v4 offset:20480
    v_mfma_f32_16x16x32_bf16 v[12:15], v[40:43], v[132:135], v[12:15]
    ds_read_b128 v[60:63], v4 offset:21504
    v_mfma_f32_16x16x32_bf16 v[16:19], v[44:47], v[128:131], v[16:19]
    ds_read_b128 v[64:67], v4 offset:22528
    v_mfma_f32_16x16x32_bf16 v[20:23], v[44:47], v[132:135], v[20:23]
    ds_read_b128 v[68:71], v4 offset:23552
    v_mfma_f32_16x16x32_bf16 v[24:27], v[48:51], v[128:131], v[24:27]
    buffer_load_dwordx4 v[112:115], v5, s[4:7], s49 offen offset:0
    v_mfma_f32_16x16x32_bf16 v[28:31], v[48:51], v[132:135], v[28:31]
    buffer_load_dwordx4 v[116:119], v5, s[4:7], s49 offen offset:1024
    s_add_u32 s49, s49, 262144
    v_mfma_f32_16x16x32_bf16 v[32:35], v[52:55], v[128:131], v[32:35]
    v_mfma_f32_16x16x32_bf16 v[36:39], v[52:55], v[132:135], v[36:39]
    s_waitcnt lgkmcnt(0)
    s_nop 0
    v_mfma_f32_16x16x32_bf16 v[8:11], v[56:59], v[136:139], v[8:11]
    ds_read_b128 v[40:43], v4 offset:24576
    v_mfma_f32_16x16x32_bf16 v[12:15], v[56:59], v[140:143], v[12:15]
    ds_read_b128 v[44:47], v4 offset:25600
    v_mfma_f32_16x16x32_bf16 v[16:19], v[60:63], v[136:139], v[16:19]
    ds_read_b128 v[48:51], v4 offset:26624
    v_mfma_f32_16x16x32_bf16 v[20:23], v[60:63], v[140:143], v[20:23]
    ds_read_b128 v[52:55], v4 offset:27648
    v_mfma_f32_16x16x32_bf16 v[24:27], v[64:67], v[136:139], v[24:27]
    buffer_load_dwordx4 v[120:123], v5, s[4:7], s51 offen offset:0
    v_mfma_f32_16x16x32_bf16 v[28:31], v[64:67], v[140:143], v[28:31]
    buffer_load_dwordx4 v[124:127], v5, s[4:7], s51 offen offset:1024
    s_add_u32 s51, s51, 262144
    v_mfma_f32_16x16x32_bf16 v[32:35], v[68:71], v[136:139], v[32:35]
    v_mfma_f32_16x16x32_bf16 v[36:39], v[68:71], v[140:143], v[36:39]
    s_waitcnt vmcnt(8) lgkmcnt(0)
    s_nop 0
    v_mfma_f32_16x16x32_bf16 v[8:11], v[40:43], v[144:147], v[8:11]
    ds_read_b128 v[56:59], v4 offset:28672
    v_mfma_f32_16x16x32_bf16 v[12:15], v[40:43], v[148:151], v[12:15]
    ds_read_b128 v[60:63], v4 offset:29696
    v_mfma_f32_16x16x32_bf16 v[16:19], v[44:47], v[144:147], v[16:19]
    ds_read_b128 v[64:67], v4 offset:30720
    v_mfma_f32_16x16x32_bf16 v[20:23], v[44:47], v[148:151], v[20:23]
    ds_read_b128 v[68:71], v4 offset:31744
    v_mfma_f32_16x16x32_bf16 v[24:27], v[48:51], v[144:147], v[24:27]
    buffer_load_dwordx4 v[128:131], v5, s[4:7], s49 offen offset:0
    v_mfma_f32_16x16x32_bf16 v[28:31], v[48:51], v[148:151], v[28:31]
    buffer_load_dwordx4 v[132:135], v5, s[4:7], s49 offen offset:1024
    s_add_u32 s49, s49, 262144
    s_add_u32 s54, s44, 32768
    s_cmp_eq_u32 s54, 131072
    .long 0x853636ff, 0x0
    s_sub_u32 s54, s54, s44
    s_add_u32 s44, s44, s54
    v_mfma_f32_16x16x32_bf16 v[32:35], v[52:55], v[144:147], v[32:35]
    v_add_u32_e64 v4, s54, v4
    v_mfma_f32_16x16x32_bf16 v[36:39], v[52:55], v[148:151], v[36:39]
    s_waitcnt lgkmcnt(0)
    s_barrier
    v_mfma_f32_16x16x32_bf16 v[8:11], v[56:59], v[152:155], v[8:11]
    ds_read_b128 v[40:43], v4 offset:0
    v_mfma_f32_16x16x32_bf16 v[12:15], v[56:59], v[156:159], v[12:15]
    ds_read_b128 v[44:47], v4 offset:1024
    v_mfma_f32_16x16x32_bf16 v[16:19], v[60:63], v[152:155], v[16:19]
    ds_read_b128 v[48:51], v4 offset:2048
    v_mfma_f32_16x16x32_bf16 v[20:23], v[60:63], v[156:159], v[20:23]
    ds_read_b128 v[52:55], v4 offset:3072
    v_mfma_f32_16x16x32_bf16 v[24:27], v[64:67], v[152:155], v[24:27]
    buffer_load_dwordx4 v[136:139], v5, s[4:7], s51 offen offset:0
    v_mfma_f32_16x16x32_bf16 v[28:31], v[64:67], v[156:159], v[28:31]
    buffer_load_dwordx4 v[140:143], v5, s[4:7], s51 offen offset:1024
    s_add_u32 s51, s51, 262144
    v_mfma_f32_16x16x32_bf16 v[32:35], v[68:71], v[152:155], v[32:35]
    v_mfma_f32_16x16x32_bf16 v[36:39], v[68:71], v[156:159], v[36:39]
interleave_layers__linear_kernel_hedgehog__geglu_ffn__prompt_kernel_loop75:
    s_waitcnt vmcnt(8) lgkmcnt(0)
    s_nop 0
    v_mfma_f32_16x16x32_bf16 v[8:11], v[40:43], v[96:99], v[8:11]
    ds_read_b128 v[56:59], v4 offset:4096
    v_mfma_f32_16x16x32_bf16 v[12:15], v[40:43], v[100:103], v[12:15]
    ds_read_b128 v[60:63], v4 offset:5120
    v_mfma_f32_16x16x32_bf16 v[16:19], v[44:47], v[96:99], v[16:19]
    ds_read_b128 v[64:67], v4 offset:6144
    v_mfma_f32_16x16x32_bf16 v[20:23], v[44:47], v[100:103], v[20:23]
    ds_read_b128 v[68:71], v4 offset:7168
    v_mfma_f32_16x16x32_bf16 v[24:27], v[48:51], v[96:99], v[24:27]
    buffer_load_dwordx4 v[144:147], v5, s[4:7], s49 offen offset:0
    v_mfma_f32_16x16x32_bf16 v[28:31], v[48:51], v[100:103], v[28:31]
    buffer_load_dwordx4 v[148:151], v5, s[4:7], s49 offen offset:1024
    s_add_u32 s49, s49, 262144
    v_mfma_f32_16x16x32_bf16 v[32:35], v[52:55], v[96:99], v[32:35]
    v_mfma_f32_16x16x32_bf16 v[36:39], v[52:55], v[100:103], v[36:39]
    s_waitcnt lgkmcnt(0)
    s_nop 0
    v_mfma_f32_16x16x32_bf16 v[8:11], v[56:59], v[104:107], v[8:11]
    ds_read_b128 v[40:43], v4 offset:8192
    v_mfma_f32_16x16x32_bf16 v[12:15], v[56:59], v[108:111], v[12:15]
    ds_read_b128 v[44:47], v4 offset:9216
    v_mfma_f32_16x16x32_bf16 v[16:19], v[60:63], v[104:107], v[16:19]
    ds_read_b128 v[48:51], v4 offset:10240
    v_mfma_f32_16x16x32_bf16 v[20:23], v[60:63], v[108:111], v[20:23]
    ds_read_b128 v[52:55], v4 offset:11264
    v_mfma_f32_16x16x32_bf16 v[24:27], v[64:67], v[104:107], v[24:27]
    buffer_load_dwordx4 v[152:155], v5, s[4:7], s51 offen offset:0
    v_mfma_f32_16x16x32_bf16 v[28:31], v[64:67], v[108:111], v[28:31]
    buffer_load_dwordx4 v[156:159], v5, s[4:7], s51 offen offset:1024
    s_add_u32 s51, s51, 262144
    v_mfma_f32_16x16x32_bf16 v[32:35], v[68:71], v[104:107], v[32:35]
    v_mfma_f32_16x16x32_bf16 v[36:39], v[68:71], v[108:111], v[36:39]
    s_waitcnt vmcnt(8) lgkmcnt(0)
    s_nop 0
    v_mfma_f32_16x16x32_bf16 v[8:11], v[40:43], v[112:115], v[8:11]
    ds_read_b128 v[56:59], v4 offset:12288
    v_mfma_f32_16x16x32_bf16 v[12:15], v[40:43], v[116:119], v[12:15]
    ds_read_b128 v[60:63], v4 offset:13312
    v_mfma_f32_16x16x32_bf16 v[16:19], v[44:47], v[112:115], v[16:19]
    ds_read_b128 v[64:67], v4 offset:14336
    v_mfma_f32_16x16x32_bf16 v[20:23], v[44:47], v[116:119], v[20:23]
    ds_read_b128 v[68:71], v4 offset:15360
    v_mfma_f32_16x16x32_bf16 v[24:27], v[48:51], v[112:115], v[24:27]
    buffer_load_dwordx4 v[96:99], v5, s[4:7], s49 offen offset:0
    v_mfma_f32_16x16x32_bf16 v[28:31], v[48:51], v[116:119], v[28:31]
    buffer_load_dwordx4 v[100:103], v5, s[4:7], s49 offen offset:1024
    s_add_u32 s49, s49, 262144
    v_mfma_f32_16x16x32_bf16 v[32:35], v[52:55], v[112:115], v[32:35]
    v_mfma_f32_16x16x32_bf16 v[36:39], v[52:55], v[116:119], v[36:39]
    s_waitcnt lgkmcnt(0)
    s_nop 0
    v_mfma_f32_16x16x32_bf16 v[8:11], v[56:59], v[120:123], v[8:11]
    ds_read_b128 v[40:43], v4 offset:16384
    v_mfma_f32_16x16x32_bf16 v[12:15], v[56:59], v[124:127], v[12:15]
    ds_read_b128 v[44:47], v4 offset:17408
    v_mfma_f32_16x16x32_bf16 v[16:19], v[60:63], v[120:123], v[16:19]
    ds_read_b128 v[48:51], v4 offset:18432
    v_mfma_f32_16x16x32_bf16 v[20:23], v[60:63], v[124:127], v[20:23]
    ds_read_b128 v[52:55], v4 offset:19456
    v_mfma_f32_16x16x32_bf16 v[24:27], v[64:67], v[120:123], v[24:27]
    buffer_load_dwordx4 v[104:107], v5, s[4:7], s51 offen offset:0
    v_mfma_f32_16x16x32_bf16 v[28:31], v[64:67], v[124:127], v[28:31]
    buffer_load_dwordx4 v[108:111], v5, s[4:7], s51 offen offset:1024
    s_add_u32 s51, s51, 262144
    v_mfma_f32_16x16x32_bf16 v[32:35], v[68:71], v[120:123], v[32:35]
    v_mfma_f32_16x16x32_bf16 v[36:39], v[68:71], v[124:127], v[36:39]
    s_waitcnt vmcnt(8) lgkmcnt(0)
    s_nop 0
    v_mfma_f32_16x16x32_bf16 v[8:11], v[40:43], v[128:131], v[8:11]
    ds_read_b128 v[56:59], v4 offset:20480
    v_mfma_f32_16x16x32_bf16 v[12:15], v[40:43], v[132:135], v[12:15]
    ds_read_b128 v[60:63], v4 offset:21504
    v_mfma_f32_16x16x32_bf16 v[16:19], v[44:47], v[128:131], v[16:19]
    ds_read_b128 v[64:67], v4 offset:22528
    v_mfma_f32_16x16x32_bf16 v[20:23], v[44:47], v[132:135], v[20:23]
    ds_read_b128 v[68:71], v4 offset:23552
    v_mfma_f32_16x16x32_bf16 v[24:27], v[48:51], v[128:131], v[24:27]
    buffer_load_dwordx4 v[112:115], v5, s[4:7], s49 offen offset:0
    v_mfma_f32_16x16x32_bf16 v[28:31], v[48:51], v[132:135], v[28:31]
    buffer_load_dwordx4 v[116:119], v5, s[4:7], s49 offen offset:1024
    s_add_u32 s49, s49, 262144
    v_mfma_f32_16x16x32_bf16 v[32:35], v[52:55], v[128:131], v[32:35]
    v_mfma_f32_16x16x32_bf16 v[36:39], v[52:55], v[132:135], v[36:39]
    s_waitcnt lgkmcnt(0)
    s_nop 0
    v_mfma_f32_16x16x32_bf16 v[8:11], v[56:59], v[136:139], v[8:11]
    ds_read_b128 v[40:43], v4 offset:24576
    v_mfma_f32_16x16x32_bf16 v[12:15], v[56:59], v[140:143], v[12:15]
    ds_read_b128 v[44:47], v4 offset:25600
    v_mfma_f32_16x16x32_bf16 v[16:19], v[60:63], v[136:139], v[16:19]
    ds_read_b128 v[48:51], v4 offset:26624
    v_mfma_f32_16x16x32_bf16 v[20:23], v[60:63], v[140:143], v[20:23]
    ds_read_b128 v[52:55], v4 offset:27648
    v_mfma_f32_16x16x32_bf16 v[24:27], v[64:67], v[136:139], v[24:27]
    buffer_load_dwordx4 v[120:123], v5, s[4:7], s51 offen offset:0
    v_mfma_f32_16x16x32_bf16 v[28:31], v[64:67], v[140:143], v[28:31]
    buffer_load_dwordx4 v[124:127], v5, s[4:7], s51 offen offset:1024
    s_add_u32 s51, s51, 262144
    v_mfma_f32_16x16x32_bf16 v[32:35], v[68:71], v[136:139], v[32:35]
    v_mfma_f32_16x16x32_bf16 v[36:39], v[68:71], v[140:143], v[36:39]
    s_waitcnt vmcnt(8) lgkmcnt(0)
    s_nop 0
    v_mfma_f32_16x16x32_bf16 v[8:11], v[40:43], v[144:147], v[8:11]
    ds_read_b128 v[56:59], v4 offset:28672
    v_mfma_f32_16x16x32_bf16 v[12:15], v[40:43], v[148:151], v[12:15]
    ds_read_b128 v[60:63], v4 offset:29696
    v_mfma_f32_16x16x32_bf16 v[16:19], v[44:47], v[144:147], v[16:19]
    ds_read_b128 v[64:67], v4 offset:30720
    v_mfma_f32_16x16x32_bf16 v[20:23], v[44:47], v[148:151], v[20:23]
    ds_read_b128 v[68:71], v4 offset:31744
    v_mfma_f32_16x16x32_bf16 v[24:27], v[48:51], v[144:147], v[24:27]
    buffer_load_dwordx4 v[128:131], v5, s[4:7], s49 offen offset:0
    v_mfma_f32_16x16x32_bf16 v[28:31], v[48:51], v[148:151], v[28:31]
    buffer_load_dwordx4 v[132:135], v5, s[4:7], s49 offen offset:1024
    s_add_u32 s49, s49, 262144
    s_add_u32 s54, s44, 32768
    s_cmp_eq_u32 s54, 131072
    .long 0x853636ff, 0x0
    s_sub_u32 s54, s54, s44
    s_add_u32 s44, s44, s54
    v_mfma_f32_16x16x32_bf16 v[32:35], v[52:55], v[144:147], v[32:35]
    v_add_u32_e64 v4, s54, v4
    v_mfma_f32_16x16x32_bf16 v[36:39], v[52:55], v[148:151], v[36:39]
    s_waitcnt lgkmcnt(0)
    s_barrier
    v_mfma_f32_16x16x32_bf16 v[8:11], v[56:59], v[152:155], v[8:11]
    ds_read_b128 v[40:43], v4 offset:0
    v_mfma_f32_16x16x32_bf16 v[12:15], v[56:59], v[156:159], v[12:15]
    ds_read_b128 v[44:47], v4 offset:1024
    v_mfma_f32_16x16x32_bf16 v[16:19], v[60:63], v[152:155], v[16:19]
    ds_read_b128 v[48:51], v4 offset:2048
    v_mfma_f32_16x16x32_bf16 v[20:23], v[60:63], v[156:159], v[20:23]
    ds_read_b128 v[52:55], v4 offset:3072
    v_mfma_f32_16x16x32_bf16 v[24:27], v[64:67], v[152:155], v[24:27]
    buffer_load_dwordx4 v[136:139], v5, s[4:7], s51 offen offset:0
    v_mfma_f32_16x16x32_bf16 v[28:31], v[64:67], v[156:159], v[28:31]
    buffer_load_dwordx4 v[140:143], v5, s[4:7], s51 offen offset:1024
    s_add_u32 s51, s51, 262144
    v_mfma_f32_16x16x32_bf16 v[32:35], v[68:71], v[152:155], v[32:35]
    v_mfma_f32_16x16x32_bf16 v[36:39], v[68:71], v[156:159], v[36:39]
    s_add_u32 s43, s43, 1
    s_cmp_lt_u32 s43, 2
    s_cbranch_scc1 interleave_layers__linear_kernel_hedgehog__geglu_ffn__prompt_kernel_loop75
    s_waitcnt vmcnt(8) lgkmcnt(0)
    v_mfma_f32_16x16x32_bf16 v[8:11], v[40:43], v[96:99], v[8:11]
    ds_read_b128 v[56:59], v4 offset:4096
    v_mfma_f32_16x16x32_bf16 v[12:15], v[40:43], v[100:103], v[12:15]
    ds_read_b128 v[60:63], v4 offset:5120
    v_mfma_f32_16x16x32_bf16 v[16:19], v[44:47], v[96:99], v[16:19]
    ds_read_b128 v[64:67], v4 offset:6144
    v_mfma_f32_16x16x32_bf16 v[20:23], v[44:47], v[100:103], v[20:23]
    ds_read_b128 v[68:71], v4 offset:7168
    v_mfma_f32_16x16x32_bf16 v[24:27], v[48:51], v[96:99], v[24:27]
    buffer_load_dwordx4 v[144:147], v5, s[4:7], s49 offen offset:0
    v_mfma_f32_16x16x32_bf16 v[28:31], v[48:51], v[100:103], v[28:31]
    buffer_load_dwordx4 v[148:151], v5, s[4:7], s49 offen offset:1024
    s_add_u32 s49, s49, 262144
    v_mfma_f32_16x16x32_bf16 v[32:35], v[52:55], v[96:99], v[32:35]
    v_mfma_f32_16x16x32_bf16 v[36:39], v[52:55], v[100:103], v[36:39]
    s_waitcnt lgkmcnt(0)
    s_nop 0
    v_mfma_f32_16x16x32_bf16 v[8:11], v[56:59], v[104:107], v[8:11]
    ds_read_b128 v[40:43], v4 offset:8192
    v_mfma_f32_16x16x32_bf16 v[12:15], v[56:59], v[108:111], v[12:15]
    ds_read_b128 v[44:47], v4 offset:9216
    v_mfma_f32_16x16x32_bf16 v[16:19], v[60:63], v[104:107], v[16:19]
    ds_read_b128 v[48:51], v4 offset:10240
    v_mfma_f32_16x16x32_bf16 v[20:23], v[60:63], v[108:111], v[20:23]
    ds_read_b128 v[52:55], v4 offset:11264
    v_mfma_f32_16x16x32_bf16 v[24:27], v[64:67], v[104:107], v[24:27]
    buffer_load_dwordx4 v[152:155], v5, s[4:7], s51 offen offset:0
    v_mfma_f32_16x16x32_bf16 v[28:31], v[64:67], v[108:111], v[28:31]
    buffer_load_dwordx4 v[156:159], v5, s[4:7], s51 offen offset:1024
    s_add_u32 s51, s51, 262144
    v_mfma_f32_16x16x32_bf16 v[32:35], v[68:71], v[104:107], v[32:35]
    buffer_load_dwordx4 v[72:75], v5, s[12:15], s46 offen offset:0
    buffer_load_dwordx4 v[76:79], v5, s[12:15], s46 offen offset:1024
    v_mfma_f32_16x16x32_bf16 v[36:39], v[68:71], v[108:111], v[36:39]
    buffer_load_dwordx4 v[80:83], v5, s[12:15], s47 offen offset:0
    buffer_load_dwordx4 v[84:87], v5, s[12:15], s47 offen offset:1024
    s_waitcnt vmcnt(12) lgkmcnt(0)
    s_nop 0
    v_mfma_f32_16x16x32_bf16 v[8:11], v[40:43], v[112:115], v[8:11]
    ds_read_b128 v[56:59], v4 offset:12288
    v_mfma_f32_16x16x32_bf16 v[12:15], v[40:43], v[116:119], v[12:15]
    ds_read_b128 v[60:63], v4 offset:13312
    v_mfma_f32_16x16x32_bf16 v[16:19], v[44:47], v[112:115], v[16:19]
    ds_read_b128 v[64:67], v4 offset:14336
    v_mfma_f32_16x16x32_bf16 v[20:23], v[44:47], v[116:119], v[20:23]
    ds_read_b128 v[68:71], v4 offset:15360
    v_mfma_f32_16x16x32_bf16 v[24:27], v[48:51], v[112:115], v[24:27]
    v_mfma_f32_16x16x32_bf16 v[28:31], v[48:51], v[116:119], v[28:31]
    v_mfma_f32_16x16x32_bf16 v[32:35], v[52:55], v[112:115], v[32:35]
    v_mfma_f32_16x16x32_bf16 v[36:39], v[52:55], v[116:119], v[36:39]
    s_waitcnt lgkmcnt(0)
    s_nop 0
    v_mfma_f32_16x16x32_bf16 v[8:11], v[56:59], v[120:123], v[8:11]
    ds_read_b128 v[40:43], v4 offset:16384
    v_mfma_f32_16x16x32_bf16 v[12:15], v[56:59], v[124:127], v[12:15]
    ds_read_b128 v[44:47], v4 offset:17408
    v_mfma_f32_16x16x32_bf16 v[16:19], v[60:63], v[120:123], v[16:19]
    ds_read_b128 v[48:51], v4 offset:18432
    v_mfma_f32_16x16x32_bf16 v[20:23], v[60:63], v[124:127], v[20:23]
    ds_read_b128 v[52:55], v4 offset:19456
    v_mfma_f32_16x16x32_bf16 v[24:27], v[64:67], v[120:123], v[24:27]
    v_mfma_f32_16x16x32_bf16 v[28:31], v[64:67], v[124:127], v[28:31]
    v_mfma_f32_16x16x32_bf16 v[32:35], v[68:71], v[120:123], v[32:35]
    v_mfma_f32_16x16x32_bf16 v[36:39], v[68:71], v[124:127], v[36:39]
    s_waitcnt vmcnt(8) lgkmcnt(0)
    s_nop 0
    v_mfma_f32_16x16x32_bf16 v[8:11], v[40:43], v[128:131], v[8:11]
    ds_read_b128 v[56:59], v4 offset:20480
    v_mfma_f32_16x16x32_bf16 v[12:15], v[40:43], v[132:135], v[12:15]
    ds_read_b128 v[60:63], v4 offset:21504
    v_mfma_f32_16x16x32_bf16 v[16:19], v[44:47], v[128:131], v[16:19]
    ds_read_b128 v[64:67], v4 offset:22528
    v_mfma_f32_16x16x32_bf16 v[20:23], v[44:47], v[132:135], v[20:23]
    ds_read_b128 v[68:71], v4 offset:23552
    v_mfma_f32_16x16x32_bf16 v[24:27], v[48:51], v[128:131], v[24:27]
    v_mfma_f32_16x16x32_bf16 v[28:31], v[48:51], v[132:135], v[28:31]
    v_mfma_f32_16x16x32_bf16 v[32:35], v[52:55], v[128:131], v[32:35]
    v_mfma_f32_16x16x32_bf16 v[36:39], v[52:55], v[132:135], v[36:39]
    s_waitcnt lgkmcnt(0)
    s_nop 0
    v_mfma_f32_16x16x32_bf16 v[8:11], v[56:59], v[136:139], v[8:11]
    ds_read_b128 v[40:43], v4 offset:24576
    v_mfma_f32_16x16x32_bf16 v[12:15], v[56:59], v[140:143], v[12:15]
    ds_read_b128 v[44:47], v4 offset:25600
    v_mfma_f32_16x16x32_bf16 v[16:19], v[60:63], v[136:139], v[16:19]
    ds_read_b128 v[48:51], v4 offset:26624
    v_mfma_f32_16x16x32_bf16 v[20:23], v[60:63], v[140:143], v[20:23]
    ds_read_b128 v[52:55], v4 offset:27648
    v_mfma_f32_16x16x32_bf16 v[24:27], v[64:67], v[136:139], v[24:27]
    v_mfma_f32_16x16x32_bf16 v[28:31], v[64:67], v[140:143], v[28:31]
    v_mfma_f32_16x16x32_bf16 v[32:35], v[68:71], v[136:139], v[32:35]
    v_mfma_f32_16x16x32_bf16 v[36:39], v[68:71], v[140:143], v[36:39]
    s_waitcnt vmcnt(4) lgkmcnt(0)
    s_nop 0
    v_mfma_f32_16x16x32_bf16 v[8:11], v[40:43], v[144:147], v[8:11]
    ds_read_b128 v[56:59], v4 offset:28672
    v_mfma_f32_16x16x32_bf16 v[12:15], v[40:43], v[148:151], v[12:15]
    ds_read_b128 v[60:63], v4 offset:29696
    v_mfma_f32_16x16x32_bf16 v[16:19], v[44:47], v[144:147], v[16:19]
    ds_read_b128 v[64:67], v4 offset:30720
    v_mfma_f32_16x16x32_bf16 v[20:23], v[44:47], v[148:151], v[20:23]
    ds_read_b128 v[68:71], v4 offset:31744
    v_mfma_f32_16x16x32_bf16 v[24:27], v[48:51], v[144:147], v[24:27]
    v_mfma_f32_16x16x32_bf16 v[28:31], v[48:51], v[148:151], v[28:31]
    s_add_u32 s54, s44, 32768
    s_cmp_eq_u32 s54, 131072
    .long 0x853636ff, 0x0
    s_sub_u32 s54, s54, s44
    s_add_u32 s44, s44, s54
    v_mfma_f32_16x16x32_bf16 v[32:35], v[52:55], v[144:147], v[32:35]
    v_add_u32_e64 v4, s54, v4
    v_mfma_f32_16x16x32_bf16 v[36:39], v[52:55], v[148:151], v[36:39]
    s_waitcnt lgkmcnt(0)
    s_barrier
    v_mfma_f32_16x16x32_bf16 v[8:11], v[56:59], v[152:155], v[8:11]
    ds_read_b128 v[40:43], v4 offset:0
    v_mfma_f32_16x16x32_bf16 v[12:15], v[56:59], v[156:159], v[12:15]
    ds_read_b128 v[44:47], v4 offset:1024
    v_mfma_f32_16x16x32_bf16 v[16:19], v[60:63], v[152:155], v[16:19]
    ds_read_b128 v[48:51], v4 offset:2048
    v_mfma_f32_16x16x32_bf16 v[20:23], v[60:63], v[156:159], v[20:23]
    ds_read_b128 v[52:55], v4 offset:3072
    v_mfma_f32_16x16x32_bf16 v[24:27], v[64:67], v[152:155], v[24:27]
    v_mfma_f32_16x16x32_bf16 v[28:31], v[64:67], v[156:159], v[28:31]
    v_mfma_f32_16x16x32_bf16 v[32:35], v[68:71], v[152:155], v[32:35]
    v_mfma_f32_16x16x32_bf16 v[36:39], v[68:71], v[156:159], v[36:39]
    s_mov_b32 s76, 0xffff0000
    s_waitcnt vmcnt(0) lgkmcnt(0)
    v_lshlrev_b32 v96, 16, v72
    v_and_b32 v97, s76, v72
    v_lshlrev_b32 v98, 16, v73
    v_and_b32_e64 v99, s76, v73
    v_pk_add_f32 v[8:9], v[8:9], v[96:97]
    v_pk_add_f32 v[10:11], v[10:11], v[98:99]
    v_lshlrev_b32 v100, 16, v74
    v_and_b32 v101, s76, v74
    v_lshlrev_b32 v102, 16, v75
    v_and_b32 v103, s76, v75
    v_pk_add_f32 v[16:17], v[16:17], v[100:101]
    v_pk_add_f32 v[18:19], v[18:19], v[102:103]
    v_cvt_pk_bf16_f32 v112, v8, v9
    v_cvt_pk_bf16_f32 v113, v10, v11
    v_cvt_pk_bf16_f32 v114, v16, v17
    v_cvt_pk_bf16_f32 v115, v18, v19
    buffer_store_dwordx4 v[112:115], v5, s[16:19], s46 offen offset:0 sc0 sc1
    v_lshlrev_b32 v104, 16, v76
    v_and_b32 v105, s76, v76
    v_lshlrev_b32 v106, 16, v77
    v_and_b32 v107, s76, v77
    v_pk_add_f32 v[12:13], v[12:13], v[104:105]
    v_pk_add_f32 v[14:15], v[14:15], v[106:107]
    v_lshlrev_b32 v108, 16, v78
    v_and_b32 v109, s76, v78
    v_lshlrev_b32 v110, 16, v79
    v_and_b32 v111, s76, v79
    v_pk_add_f32 v[20:21], v[20:21], v[108:109]
    v_pk_add_f32 v[22:23], v[22:23], v[110:111]
    v_cvt_pk_bf16_f32 v116, v12, v13
    v_cvt_pk_bf16_f32 v117, v14, v15
    v_cvt_pk_bf16_f32 v118, v20, v21
    v_cvt_pk_bf16_f32 v119, v22, v23
    buffer_store_dwordx4 v[116:119], v5, s[16:19], s46 offen offset:1024 sc0 sc1
    v_lshlrev_b32 v96, 16, v80
    v_and_b32 v97, s76, v80
    v_lshlrev_b32 v98, 16, v81
    v_and_b32 v99, s76, v81
    v_pk_add_f32 v[24:25], v[24:25], v[96:97]
    v_pk_add_f32 v[26:27], v[26:27], v[98:99]
    v_lshlrev_b32 v100, 16, v82
    v_and_b32 v101, s76, v82
    v_lshlrev_b32 v102, 16, v83
    v_and_b32 v103, s76, v83
    v_pk_add_f32 v[32:33], v[32:33], v[100:101]
    v_pk_add_f32 v[34:35], v[34:35], v[102:103]
    v_cvt_pk_bf16_f32 v120, v24, v25
    v_cvt_pk_bf16_f32 v121, v26, v27
    v_cvt_pk_bf16_f32 v122, v32, v33
    v_cvt_pk_bf16_f32 v123, v34, v35
    buffer_store_dwordx4 v[120:123], v5, s[16:19], s47 offen offset:0 sc0 sc1
    v_lshlrev_b32 v104, 16, v84
    v_and_b32 v105, s76, v84
    v_lshlrev_b32 v106, 16, v85
    v_and_b32 v107, s76, v85
    v_pk_add_f32 v[28:29], v[28:29], v[104:105]
    v_pk_add_f32 v[30:31], v[30:31], v[106:107]
    v_lshlrev_b32 v108, 16, v86
    v_and_b32 v109, s76, v86
    v_lshlrev_b32 v110, 16, v87
    v_and_b32 v111, s76, v87
    v_pk_add_f32 v[36:37], v[36:37], v[108:109]
    v_pk_add_f32 v[38:39], v[38:39], v[110:111]
    v_cvt_pk_bf16_f32 v124, v28, v29
    v_cvt_pk_bf16_f32 v125, v30, v31
    v_cvt_pk_bf16_f32 v126, v36, v37
    v_cvt_pk_bf16_f32 v127, v38, v39
    buffer_store_dwordx4 v[124:127], v5, s[16:19], s47 offen offset:1024 sc0 sc1
    s_mov_b32 s76, 0x3f803f80
    v_dot2_f32_bf16 v88, v112, s76, 0
    v_dot2_f32_bf16 v89, v112, v112, 0
    v_dot2_f32_bf16 v90, v116, s76, 0
    v_dot2_f32_bf16 v91, v116, v116, 0
    v_dot2_f32_bf16 v88, v113, s76, v88
    v_dot2_f32_bf16 v89, v113, v113, v89
    v_dot2_f32_bf16 v90, v117, s76, v90
    v_dot2_f32_bf16 v91, v117, v117, v91
    v_dot2_f32_bf16 v88, v114, s76, v88
    v_dot2_f32_bf16 v89, v114, v114, v89
    v_dot2_f32_bf16 v90, v118, s76, v90
    v_dot2_f32_bf16 v91, v118, v118, v91
    v_dot2_f32_bf16 v88, v115, s76, v88
    v_dot2_f32_bf16 v89, v115, v115, v89
    v_dot2_f32_bf16 v90, v119, s76, v90
    v_dot2_f32_bf16 v91, v119, v119, v91
    v_dot2_f32_bf16 v88, v120, s76, v88
    v_dot2_f32_bf16 v89, v120, v120, v89
    v_dot2_f32_bf16 v90, v124, s76, v90
    v_dot2_f32_bf16 v91, v124, v124, v91
    v_dot2_f32_bf16 v88, v121, s76, v88
    v_dot2_f32_bf16 v89, v121, v121, v89
    v_dot2_f32_bf16 v90, v125, s76, v90
    v_dot2_f32_bf16 v91, v125, v125, v91
    v_dot2_f32_bf16 v88, v122, s76, v88
    v_dot2_f32_bf16 v89, v122, v122, v89
    v_dot2_f32_bf16 v90, v126, s76, v90
    v_dot2_f32_bf16 v91, v126, v126, v91
    v_dot2_f32_bf16 v88, v123, s76, v88
    v_dot2_f32_bf16 v89, v123, v123, v89
    v_dot2_f32_bf16 v90, v127, s76, v90
    v_dot2_f32_bf16 v91, v127, v127, v91
    s_lshl_b32 s45, s41, 14
    s_lshl_b32 s48, s40, 12
    s_add_u32 s45, s45, s48
    s_lshl_b32 s48, s42, 7
    s_add_u32 s45, s45, s48
    v_lshlrev_b32 v1, 3, v0
    v_permlane32_swap_b32 v88, v89
    v_permlane32_swap_b32 v90, v91
    v_add_f32 v88, v88, v89
    v_add_f32 v90, v90, v91
    v_mov_b32 v92, v88
    v_mov_b32 v93, v90
    s_nop 0
    v_permlane16_swap_b32 v88, v92
    v_permlane16_swap_b32 v90, v93
    v_add_f32 v88, v88, v92
    v_add_f32 v90, v90, v93
    v_mov_b32 v89, v88
    v_mov_b32 v91, v90
    s_nop 0
    v_permlane32_swap_b32 v88, v89
    v_permlane32_swap_b32 v90, v91
    s_mov_b64 exec, 0xffff
    buffer_store_dwordx2 v[88:89], v1, s[24:27], s45 offen offset:0 sc0 sc1
    buffer_store_dwordx2 v[90:91], v1, s[24:27], s45 offen offset:2048 sc0 sc1
    s_mov_b64 exec, -1
    s_waitcnt vmcnt(0) lgkmcnt(0)
    s_barrier
    s_cmp_lg_u32 s40, 0
    s_cbranch_scc1 interleave_layers__linear_kernel_hedgehog__geglu_ffn__prompt_kernel_nf76
    s_lshl_b32 s74, s41, 11
    s_lshl_b32 s75, s42, 7
    s_add_u32 s74, s74, s75
    s_add_u32 s74, s74, 360448
    v_mov_b32 v239, 0
    v_mov_b32_e64 v240, s60
    s_mov_b64 exec, 1
    buffer_store_dword v240, v239, s[56:59], s74 offen sc0 sc1
    s_mov_b64 exec, -1
interleave_layers__linear_kernel_hedgehog__geglu_ffn__prompt_kernel_nf76:
    s_branch mega_ph6
mega_ph6:
    s_cmp_lt_u32 s2, 32
    s_cbranch_scc1 mega_ph7
    s_sub_u32 s55, s2, 32
    s_and_b32 s45, s55, 7
    s_lshr_b32 s49, s55, 3
    s_and_b32 s41, s45, 1
    s_lshl_b32 s41, s41, 2
    s_and_b32 s48, s49, 3
    s_add_u32 s41, s41, s48
    s_lshr_b32 s42, s45, 1
    s_mul_i32 s42, s42, 7
    s_lshr_b32 s48, s49, 2
    s_add_u32 s42, s42, s48
    v_lshlrev_b32 v5, 4, v0
    s_lshl_b32 s50, s40, 11
    v_add_u32 v5, s50, v5
    v_lshrrev_b32 v1, 4, v0
    s_lshl_b32 s45, s40, 2
    v_add_u32 v1, s45, v1
    v_lshlrev_b32 v2, 1, v1
    v_xor_b32 v2, v2, v0
    v_and_b32 v2, 15, v2
    v_lshlrev_b32_e64 v2, 4, v2
    v_mul_u32_u24 v1, 7168, v1
    v_add_u32 v6, v1, v2
    s_lshl_b32 s51, s40, 10
    s_add_u32 s51, s51, 16384
    s_lshl_b32 s46, s41, 14
    s_lshl_b32 s47, s42, 8
    s_add_u32 s4, s68, 0xc00000
    .long 0x8205ff45, 0x0
    s_mov_b32 s6, 0x400000
    s_mov_b32 s7, 0x00020000
    s_mov_b32 s8, s64
    s_mov_b32 s9, s65
    s_mov_b32 s10, 0x700000
    s_mov_b32 s11, 0x00020000
    s_mov_b32 s12, s66
    s_mov_b32 s13, s67
    s_mov_b32 s14, 0x700000
    s_mov_b32 s15, 0x00020000
    s_lshl_b32 s45, s41, 8
    s_lshl_b32 s48, s40, 5
    s_add_u32 s45, s45, s48
    .long 0x807cff33, 0x0
    s_nop 0
    buffer_load_dwordx4 v6, s[8:11], s47 offen lds
    s_add_u32 m0, s51, 8192
    s_mov_b32 s99, 0x1000
    buffer_load_dwordx4 v6, s[12:15], s47 offen lds
    s_add_u32 s47, s47, 229376
    s_add_u32 m0, s51, 32768
    s_mov_b32 s99, 0x1000
    buffer_load_dwordx4 v6, s[8:11], s47 offen lds
    s_add_u32 m0, s51, 40960
    s_mov_b32 s99, 0x1000
    buffer_load_dwordx4 v6, s[12:15], s47 offen lds
    s_add_u32 s47, s47, 229376
    s_add_u32 m0, s51, 65536
    s_mov_b32 s99, 0x1000
    buffer_load_dwordx4 v6, s[8:11], s47 offen lds
    s_add_u32 m0, s51, 73728
    s_mov_b32 s99, 0x1000
    buffer_load_dwordx4 v6, s[12:15], s47 offen lds
    s_add_u32 s47, s47, 229376
    s_add_u32 s16, s68, 0x4d00000
    .long 0x8211ff45, 0x0
    s_mov_b32 s18, 0x40000
    s_mov_b32 s19, 0x00020000
    s_add_u32 s24, s68, 0x4d40000
    .long 0x8219ff45, 0x0
    s_mov_b32 s26, 0x7000
    s_mov_b32 s27, 0x00020000
    s_add_u32 s28, s68, 0x3600000
    .long 0x821dff45, 0x0
    s_mov_b32 s30, 0xe00000
    s_mov_b32 s31, 0x00020000
    v_and_b32 v236, 15, v0
    v_lshlrev_b32 v236, 3, v236
    s_lshl_b32 s74, s45, 7
    v_add_u32 v236, s74, v236
    v_lshrrev_b32_e64 v3, 4, v0
    v_lshl_add_u32 v236, v3, 9, v236
    v_lshlrev_b32 v7, 4, v0
    s_and_b32 s48, s40, 3
    s_lshl_b32 s48, s48, 12
    v_add_u32 v7, s48, v7
    v_lshrrev_b32 v1, 2, v0
    v_lshlrev_b32 v3, 8, v1
    v_and_b32_e64 v4, 3, v0
    v_lshl_add_u32 v3, v4, 3, v3
    v_bfe_u32 v4, v0, 2, 3
    s_and_b32 s48, s40, 4
    s_add_u32 s53, s48, 0
    v_xor_b32_e64 v2, s53, v4
    v_lshl_add_u32 v8, v2, 5, v3
    v_add_u32 v8, 16384, v8
    s_add_u32 s53, s48, 1
    v_xor_b32 v2, s53, v4
    v_lshl_add_u32 v9, v2, 5, v3
    v_add_u32 v9, 16384, v9
    s_add_u32 s53, s48, 2
    v_xor_b32 v2, s53, v4
    v_lshl_add_u32 v10, v2, 5, v3
    v_add_u32 v10, 16384, v10
    s_add_u32 s53, s48, 3
    v_xor_b32 v2, s53, v4
    v_lshl_add_u32 v11, v2, 5, v3
    v_add_u32 v11, 16384, v11
    s_cmp_lg_u32 s40, 7
    s_cbranch_scc1 interleave_layers__linear_kernel_hedgehog__geglu_ffn__prompt_kernel_np78
    .long 0x8e31ff29, 0xc
    s_add_u32 s49, s49, 360448
    v_lshlrev_b32 v188, 7, v0
    s_mov_b32 exec_lo, 0xffffffff
    s_mov_b32 exec_hi, 0x0
    s_mov_b32 s74, 0
interleave_layers__linear_kernel_hedgehog__geglu_ffn__prompt_kernel_poll79:
    buffer_load_dword v244, v188, s[56:59], s49 offen sc1
    s_add_u32 s74, s74, 1
    s_waitcnt vmcnt(0)
    v_cmp_ne_u32 vcc, s60, v244
    s_nop 0
    s_cmp_eq_u64 vcc, 0
    s_cbranch_scc1 interleave_layers__linear_kernel_hedgehog__geglu_ffn__prompt_kernel_polled80
    s_mov_b64 exec, vcc
    s_sleep 4
    s_cmp_lt_u32 s74, 50000
    s_cbranch_scc1 interleave_layers__linear_kernel_hedgehog__geglu_ffn__prompt_kernel_poll79
interleave_layers__linear_kernel_hedgehog__geglu_ffn__prompt_kernel_polled80:
    s_mov_b64 exec, -1
interleave_layers__linear_kernel_hedgehog__geglu_ffn__prompt_kernel_np78:
    s_barrier
    .long 0x807cff32, 0x0
    s_nop 0
    buffer_load_dwordx4 v5, s[4:7], s46 offen lds
    buffer_load_dwordx4 v5, s[4:7], s46 offen offset:1024 lds
    s_add_u32 s46, s46, 131072
    s_add_u32 m0, s50, 32768
    s_mov_b32 s99, 0x1000
    buffer_load_dwordx4 v5, s[4:7], s46 offen lds
    buffer_load_dwordx4 v5, s[4:7], s46 offen offset:1024 lds
    s_add_u32 s46, s46, 131072
    buffer_load_dwordx2 v[124:125], v236, s[16:19], 0 offen offset:0
    buffer_load_dwordx2 v[126:127], v236, s[16:19], 0 offen offset:128
    buffer_load_dwordx2 v[128:129], v236, s[16:19], 0 offen offset:256
    buffer_load_dwordx2 v[130:131], v236, s[16:19], 0 offen offset:384
    buffer_load_dwordx2 v[132:133], v236, s[16:19], 0 offen offset:2048
    buffer_load_dwordx2 v[134:135], v236, s[16:19], 0 offen offset:2176
    buffer_load_dwordx2 v[136:137], v236, s[16:19], 0 offen offset:2304
    buffer_load_dwordx2 v[138:139], v236, s[16:19], 0 offen offset:2432
    .long 0xbeac00ff, 0x0
    s_waitcnt vmcnt(10)
    s_barrier
    ds_read_b64_tr_b16 v[156:157], v8 offset:0
    ds_read_b64_tr_b16 v[158:159], v8 offset:4096
    ds_read_b128 v[140:143], v7 offset:0
    ds_read_b128 v[144:147], v7 offset:1024
    ds_read_b128 v[148:151], v7 offset:2048
    ds_read_b128 v[152:155], v7 offset:3072
    ds_read_b64_tr_b16 v[160:161], v9 offset:0
    ds_read_b64_tr_b16 v[162:163], v9 offset:4096
    ds_read_b64_tr_b16 v[164:165], v10 offset:0
    ds_read_b64_tr_b16 v[166:167], v10 offset:4096
    ds_read_b64_tr_b16 v[168:169], v11 offset:0
    ds_read_b64_tr_b16 v[170:171], v11 offset:4096
    ds_read_b64_tr_b16 v[172:173], v8 offset:8192
    ds_read_b64_tr_b16 v[174:175], v8 offset:12288
    ds_read_b64_tr_b16 v[176:177], v9 offset:8192
    ds_read_b64_tr_b16 v[178:179], v9 offset:12288
    ds_read_b64_tr_b16 v[180:181], v10 offset:8192
    ds_read_b64_tr_b16 v[182:183], v10 offset:12288
    ds_read_b64_tr_b16 v[184:185], v11 offset:8192
    ds_read_b64_tr_b16 v[186:187], v11 offset:12288
    s_add_u32 s54, s44, 32768
    s_cmp_eq_u32 s54, 131072
    s_cselect_b32 s54, 0, s54
    s_sub_u32 s54, s54, s44
    s_add_u32 s44, s44, s54
    v_add_u32 v7, s54, v7
    v_add_u32 v8, s54, v8
    v_add_u32 v9, s54, v9
    v_add_u32 v10, s54, v10
    v_add_u32 v11, s54, v11
    s_add_u32 m0, s50, 65536
    s_mov_b32 s99, 0x1000
    buffer_load_dwordx4 v5, s[4:7], s46 offen lds
    buffer_load_dwordx4 v5, s[4:7], s46 offen offset:1024 lds
    s_add_u32 s46, s46, 131072
    s_mov_b32 s52, 98304
    s_waitcnt vmcnt(2)
    s_nop 0
    v_pk_add_f32 v[124:125], v[124:125], v[126:127]
    v_pk_add_f32 v[128:129], v[128:129], v[130:131]
    v_pk_add_f32 v[132:133], v[132:133], v[134:135]
    v_pk_add_f32 v[136:137], v[136:137], v[138:139]
    v_pk_add_f32 v[124:125], v[124:125], v[128:129]
    v_pk_add_f32 v[132:133], v[132:133], v[136:137]
    s_nop 0
    v_permlane32_swap_b32 v124, v125
    v_permlane32_swap_b32 v132, v133
    v_add_f32 v124, v124, v125
    v_add_f32 v132, v132, v133
    v_mov_b32 v128, v124
    v_mov_b32 v136, v132
    s_nop 0
    v_permlane16_swap_b32 v124, v128
    v_permlane16_swap_b32 v132, v136
    v_add_f32 v124, v124, v128
    v_add_f32 v132, v132, v136
    v_mov_b32 v125, v124
    v_mov_b32_e64 v133, v132
    s_nop 0
    v_permlane32_swap_b32 v124, v125
    v_permlane32_swap_b32 v132, v133
    s_mov_b32 s74, 0xba800000
    s_mov_b32 s75, 0x3727c5ac
    v_mul_f32 v127, s74, v124
    v_mul_f32 v125, s74, v125
    v_mul_f32 v135, s74, v132
    v_mul_f32 v133, s74, v133
    v_fma_f32 v125, -v127, v127, -v125
    v_fma_f32 v133, -v135, v135, -v133
    v_max_f32 v125, 0, v125
    v_max_f32 v133, 0, v133
    v_add_f32 v125, s75, v125
    v_add_f32 v133, s75, v133
    v_rsq_f32 v126, v125
    v_rsq_f32_e64 v134, v133
    s_lshl_b32 s45, s40, 7
    s_add_u32 s45, s45, 131072
    v_and_b32 v1, 15, v0
    v_lshlrev_b32 v1, 2, v1
    v_add_u32_e64 v1, s45, v1
    ds_write_b32 v1, v126 offset:0
    ds_write_b32 v1, v127 offset:1024
    ds_write_b32 v1, v134 offset:64
    ds_write_b32 v1, v135 offset:1088
    v_mov_b32 v1, 147456
    v_mov_b32_e64 v2, 0
    ds_write_b32 v1, v2
    s_waitcnt lgkmcnt(0)
    s_barrier
    v_mfma_f32_16x16x32_bf16 v[12:15], v[156:159], v[140:143], 0
    ds_read_b64_tr_b16 v[204:205], v8 offset:0
    v_mfma_f32_16x16x32_bf16 v[16:19], v[156:159], v[144:147], 0
    ds_read_b64_tr_b16 v[206:207], v8 offset:4096
    v_mfma_f32_16x16x32_bf16 v[20:23], v[156:159], v[148:151], 0
    ds_read_b128 v[188:191], v7 offset:0
    s_add_u32 m0, s52, s50
    s_nop 0
    buffer_load_dwordx4 v5, s[4:7], s46 offen lds
    v_mfma_f32_16x16x32_bf16 v[24:27], v[156:159], v[152:155], 0
    ds_read_b128 v[192:195], v7 offset:1024
    v_mfma_f32_16x16x32_bf16 v[28:31], v[160:163], v[140:143], 0
    ds_read_b128 v[196:199], v7 offset:2048
    buffer_load_dwordx4 v5, s[4:7], s46 offen offset:1024 lds
    s_add_u32 s46, s46, 131072
    v_mfma_f32_16x16x32_bf16 v[32:35], v[160:163], v[144:147], 0
    ds_read_b128 v[200:203], v7 offset:3072
    v_mfma_f32_16x16x32_bf16 v[36:39], v[160:163], v[148:151], 0
    ds_read_b64_tr_b16 v[208:209], v9 offset:0
    s_add_u32 m0, s52, s51
    s_nop 0
    buffer_load_dwordx4 v6, s[8:11], s47 offen lds
    v_mfma_f32_16x16x32_bf16 v[40:43], v[160:163], v[152:155], 0
    ds_read_b64_tr_b16 v[210:211], v9 offset:4096
    v_mfma_f32_16x16x32_bf16 v[44:47], v[164:167], v[140:143], 0
    ds_read_b64_tr_b16 v[212:213], v10 offset:0
    s_add_u32 m0, m0, 8192
    s_mov_b32 s99, 0x1000
    buffer_load_dwordx4 v6, s[12:15], s47 offen lds
    s_add_u32 s47, s47, 229376
    v_mfma_f32_16x16x32_bf16 v[48:51], v[164:167], v[144:147], 0
    ds_read_b64_tr_b16 v[214:215], v10 offset:4096
    v_mfma_f32_16x16x32_bf16 v[52:55], v[164:167], v[148:151], 0
    ds_read_b64_tr_b16 v[216:217], v11 offset:0
    s_add_u32 s52, s52, 32768
    s_cmp_eq_u32 s52, 131072
    .long 0x853434ff, 0x0
    v_mfma_f32_16x16x32_bf16 v[56:59], v[164:167], v[152:155], 0
    ds_read_b64_tr_b16 v[218:219], v11 offset:4096
    v_mfma_f32_16x16x32_bf16 v[60:63], v[168:171], v[140:143], 0
    ds_read_b64_tr_b16 v[220:221], v8 offset:8192
    s_add_u32 m0, s52, s50
    s_nop 0
    buffer_load_dwordx4 v5, s[4:7], s46 offen lds
    v_mfma_f32_16x16x32_bf16 v[64:67], v[168:171], v[144:147], 0
    ds_read_b64_tr_b16 v[222:223], v8 offset:12288
    v_mfma_f32_16x16x32_bf16 v[68:71], v[168:171], v[148:151], 0
    ds_read_b64_tr_b16 v[224:225], v9 offset:8192
    buffer_load_dwordx4 v5, s[4:7], s46 offen offset:1024 lds
    s_add_u32 s46, s46, 131072
    v_mfma_f32_16x16x32_bf16 v[72:75], v[168:171], v[152:155], 0
    ds_read_b64_tr_b16 v[226:227], v9 offset:12288
    v_mfma_f32_16x16x32_bf16 v[76:79], v[172:175], v[140:143], 0
    ds_read_b64_tr_b16 v[228:229], v10 offset:8192
    s_add_u32 m0, s52, s51
    s_nop 0
    buffer_load_dwordx4 v6, s[8:11], s47 offen lds
    v_mfma_f32_16x16x32_bf16 v[80:83], v[172:175], v[144:147], 0
    ds_read_b64_tr_b16 v[230:231], v10 offset:12288
    v_mfma_f32_16x16x32_bf16 v[84:87], v[172:175], v[148:151], 0
    ds_read_b64_tr_b16 v[232:233], v11 offset:8192
    s_add_u32 m0, m0, 8192
    s_mov_b32 s99, 0x1000
    buffer_load_dwordx4 v6, s[12:15], s47 offen lds
    s_add_u32 s47, s47, 229376
    v_mfma_f32_16x16x32_bf16 v[88:91], v[172:175], v[152:155], 0
    ds_read_b64_tr_b16 v[234:235], v11 offset:12288
    v_mfma_f32_16x16x32_bf16 v[92:95], v[176:179], v[140:143], 0
    s_add_u32 s54, s44, 32768
    s_cmp_eq_u32 s54, 131072
    s_cselect_b32 s54, 0, s54
    s_sub_u32 s54, s54, s44
    s_add_u32 s44, s44, s54
    v_add_u32 v7, s54, v7
    s_add_u32 s52, s52, 32768
    s_cmp_eq_u32 s52, 131072
    .long 0x853434ff, 0x0
    v_mfma_f32_16x16x32_bf16 v[96:99], v[176:179], v[144:147], 0
    v_add_u32 v8, s54, v8
    v_add_u32 v9, s54, v9
    v_mfma_f32_16x16x32_bf16 v[100:103], v[176:179], v[148:151], 0
    v_add_u32 v10, s54, v10
    v_add_u32 v11, s54, v11
    v_mfma_f32_16x16x32_bf16 v[104:107], v[176:179], v[152:155], 0
    v_mfma_f32_16x16x32_bf16 v[108:111], v[180:183], v[140:143], 0
    v_mfma_f32_16x16x32_bf16 v[112:115], v[180:183], v[144:147], 0
    v_mfma_f32_16x16x32_bf16 v[116:119], v[180:183], v[148:151], 0
    s_waitcnt vmcnt(8) lgkmcnt(0)
    s_barrier
    v_mfma_f32_16x16x32_bf16 v[120:123], v[180:183], v[152:155], 0
    v_mfma_f32_16x16x32_bf16 v[124:127], v[184:187], v[140:143], 0
    v_mfma_f32_16x16x32_bf16 v[128:131], v[184:187], v[144:147], 0
    v_mfma_f32_16x16x32_bf16 v[132:135], v[184:187], v[148:151], 0
    v_mfma_f32_16x16x32_bf16 v[136:139], v[184:187], v[152:155], 0
    v_mfma_f32_16x16x32_bf16 v[12:15], v[204:207], v[188:191], v[12:15]
    ds_read_b64_tr_b16 v[156:157], v8 offset:0
    v_mfma_f32_16x16x32_bf16 v[16:19], v[204:207], v[192:195], v[16:19]
    ds_read_b64_tr_b16 v[158:159], v8 offset:4096
    v_mfma_f32_16x16x32_bf16 v[20:23], v[204:207], v[196:199], v[20:23]
    ds_read_b128 v[140:143], v7 offset:0
    s_add_u32 m0, s52, s50
    s_nop 0
    buffer_load_dwordx4 v5, s[4:7], s46 offen lds
    v_mfma_f32_16x16x32_bf16 v[24:27], v[204:207], v[200:203], v[24:27]
    ds_read_b128 v[144:147], v7 offset:1024
    v_mfma_f32_16x16x32_bf16 v[28:31], v[208:211], v[188:191], v[28:31]
    ds_read_b128 v[148:151], v7 offset:2048
    v_mfma_f32_16x16x32_bf16 v[32:35], v[208:211], v[192:195], v[32:35]
    ds_read_b128 v[152:155], v7 offset:3072
    v_mfma_f32_16x16x32_bf16 v[36:39], v[208:211], v[196:199], v[36:39]
    ds_read_b64_tr_b16 v[160:161], v9 offset:0
    v_mfma_f32_16x16x32_bf16 v[40:43], v[208:211], v[200:203], v[40:43]
    ds_read_b64_tr_b16 v[162:163], v9 offset:4096
    buffer_load_dwordx4 v5, s[4:7], s46 offen offset:1024 lds
    s_add_u32 s46, s46, 131072
    v_mfma_f32_16x16x32_bf16 v[44:47], v[212:215], v[188:191], v[44:47]
    ds_read_b64_tr_b16 v[164:165], v10 offset:0
    v_mfma_f32_16x16x32_bf16 v[48:51], v[212:215], v[192:195], v[48:51]
    ds_read_b64_tr_b16 v[166:167], v10 offset:4096
    v_mfma_f32_16x16x32_bf16 v[52:55], v[212:215], v[196:199], v[52:55]
    ds_read_b64_tr_b16 v[168:169], v11 offset:0
    v_mfma_f32_16x16x32_bf16 v[56:59], v[212:215], v[200:203], v[56:59]
    ds_read_b64_tr_b16 v[170:171], v11 offset:4096
    v_mfma_f32_16x16x32_bf16 v[60:63], v[216:219], v[188:191], v[60:63]
    ds_read_b64_tr_b16 v[172:173], v8 offset:8192
    s_add_u32 m0, s52, s51
    s_nop 0
    buffer_load_dwordx4 v6, s[8:11], s47 offen lds
    v_mfma_f32_16x16x32_bf16 v[64:67], v[216:219], v[192:195], v[64:67]
    ds_read_b64_tr_b16 v[174:175], v8 offset:12288
    v_mfma_f32_16x16x32_bf16 v[68:71], v[216:219], v[196:199], v[68:71]
    ds_read_b64_tr_b16 v[176:177], v9 offset:8192
    v_mfma_f32_16x16x32_bf16 v[72:75], v[216:219], v[200:203], v[72:75]
    ds_read_b64_tr_b16 v[178:179], v9 offset:12288
    v_mfma_f32_16x16x32_bf16 v[76:79], v[220:223], v[188:191], v[76:79]
    ds_read_b64_tr_b16 v[180:181], v10 offset:8192
    v_mfma_f32_16x16x32_bf16 v[80:83], v[220:223], v[192:195], v[80:83]
    ds_read_b64_tr_b16 v[182:183], v10 offset:12288
    s_add_u32 m0, m0, 8192
    s_mov_b32 s99, 0x1000
    buffer_load_dwordx4 v6, s[12:15], s47 offen lds
    s_add_u32 s47, s47, 229376
    v_mfma_f32_16x16x32_bf16 v[84:87], v[220:223], v[196:199], v[84:87]
    ds_read_b64_tr_b16 v[184:185], v11 offset:8192
    v_mfma_f32_16x16x32_bf16 v[88:91], v[220:223], v[200:203], v[88:91]
    ds_read_b64_tr_b16 v[186:187], v11 offset:12288
    v_mfma_f32_16x16x32_bf16 v[92:95], v[224:227], v[188:191], v[92:95]
    s_add_u32 s54, s44, 32768
    s_cmp_eq_u32 s54, 131072
    s_cselect_b32 s54, 0, s54
    s_sub_u32 s54, s54, s44
    s_add_u32 s44, s44, s54
    v_add_u32 v7, s54, v7
    v_mfma_f32_16x16x32_bf16 v[96:99], v[224:227], v[192:195], v[96:99]
    v_add_u32 v8, s54, v8
    v_add_u32 v9, s54, v9
    v_mfma_f32_16x16x32_bf16 v[100:103], v[224:227], v[196:199], v[100:103]
    v_add_u32 v10, s54, v10
    v_add_u32 v11, s54, v11
    s_add_u32 s52, s52, 32768
    s_cmp_eq_u32 s52, 131072
    .long 0x853434ff, 0x0
    v_mfma_f32_16x16x32_bf16 v[104:107], v[224:227], v[200:203], v[104:107]
    v_mfma_f32_16x16x32_bf16 v[108:111], v[228:231], v[188:191], v[108:111]
    v_mfma_f32_16x16x32_bf16 v[112:115], v[228:231], v[192:195], v[112:115]
    v_mfma_f32_16x16x32_bf16 v[116:119], v[228:231], v[196:199], v[116:119]
    s_waitcnt vmcnt(8) lgkmcnt(0)
    s_barrier
    v_mfma_f32_16x16x32_bf16 v[120:123], v[228:231], v[200:203], v[120:123]
    v_mfma_f32_16x16x32_bf16 v[124:127], v[232:235], v[188:191], v[124:127]
    v_mfma_f32_16x16x32_bf16 v[128:131], v[232:235], v[192:195], v[128:131]
    v_mfma_f32_16x16x32_bf16 v[132:135], v[232:235], v[196:199], v[132:135]
    v_mfma_f32_16x16x32_bf16 v[136:139], v[232:235], v[200:203], v[136:139]
    .long 0xbeab00ff, 0x0
interleave_layers__linear_kernel_hedgehog__geglu_ffn__prompt_kernel_loop81:
    v_mfma_f32_16x16x32_bf16 v[12:15], v[156:159], v[140:143], v[12:15]
    ds_read_b64_tr_b16 v[204:205], v8 offset:0
    v_mfma_f32_16x16x32_bf16 v[16:19], v[156:159], v[144:147], v[16:19]
    ds_read_b64_tr_b16 v[206:207], v8 offset:4096
    v_mfma_f32_16x16x32_bf16 v[20:23], v[156:159], v[148:151], v[20:23]
    ds_read_b128 v[188:191], v7 offset:0
    s_add_u32 m0, s52, s50
    s_nop 0
    buffer_load_dwordx4 v5, s[4:7], s46 offen lds
    v_mfma_f32_16x16x32_bf16 v[24:27], v[156:159], v[152:155], v[24:27]
    ds_read_b128 v[192:195], v7 offset:1024
    v_mfma_f32_16x16x32_bf16 v[28:31], v[160:163], v[140:143], v[28:31]
    ds_read_b128 v[196:199], v7 offset:2048
    v_mfma_f32_16x16x32_bf16 v[32:35], v[160:163], v[144:147], v[32:35]
    ds_read_b128 v[200:203], v7 offset:3072
    v_mfma_f32_16x16x32_bf16 v[36:39], v[160:163], v[148:151], v[36:39]
    ds_read_b64_tr_b16 v[208:209], v9 offset:0
    v_mfma_f32_16x16x32_bf16 v[40:43], v[160:163], v[152:155], v[40:43]
    ds_read_b64_tr_b16 v[210:211], v9 offset:4096
    buffer_load_dwordx4 v5, s[4:7], s46 offen offset:1024 lds
    s_add_u32 s46, s46, 131072
    v_mfma_f32_16x16x32_bf16 v[44:47], v[164:167], v[140:143], v[44:47]
    ds_read_b64_tr_b16 v[212:213], v10 offset:0
    v_mfma_f32_16x16x32_bf16 v[48:51], v[164:167], v[144:147], v[48:51]
    ds_read_b64_tr_b16 v[214:215], v10 offset:4096
    v_mfma_f32_16x16x32_bf16 v[52:55], v[164:167], v[148:151], v[52:55]
    ds_read_b64_tr_b16 v[216:217], v11 offset:0
    v_mfma_f32_16x16x32_bf16 v[56:59], v[164:167], v[152:155], v[56:59]
    ds_read_b64_tr_b16 v[218:219], v11 offset:4096
    v_mfma_f32_16x16x32_bf16 v[60:63], v[168:171], v[140:143], v[60:63]
    ds_read_b64_tr_b16 v[220:221], v8 offset:8192
    s_add_u32 m0, s52, s51
    s_nop 0
    buffer_load_dwordx4 v6, s[8:11], s47 offen lds
    v_mfma_f32_16x16x32_bf16 v[64:67], v[168:171], v[144:147], v[64:67]
    ds_read_b64_tr_b16 v[222:223], v8 offset:12288
    v_mfma_f32_16x16x32_bf16 v[68:71], v[168:171], v[148:151], v[68:71]
    ds_read_b64_tr_b16 v[224:225], v9 offset:8192
    v_mfma_f32_16x16x32_bf16 v[72:75], v[168:171], v[152:155], v[72:75]
    ds_read_b64_tr_b16 v[226:227], v9 offset:12288
    v_mfma_f32_16x16x32_bf16 v[76:79], v[172:175], v[140:143], v[76:79]
    ds_read_b64_tr_b16 v[228:229], v10 offset:8192
    v_mfma_f32_16x16x32_bf16 v[80:83], v[172:175], v[144:147], v[80:83]
    ds_read_b64_tr_b16 v[230:231], v10 offset:12288
    s_add_u32 m0, m0, 8192
    s_mov_b32 s99, 0x1000
    buffer_load_dwordx4 v6, s[12:15], s47 offen lds
    s_add_u32 s47, s47, 229376
    v_mfma_f32_16x16x32_bf16 v[84:87], v[172:175], v[148:151], v[84:87]
    ds_read_b64_tr_b16 v[232:233], v11 offset:8192
    v_mfma_f32_16x16x32_bf16 v[88:91], v[172:175], v[152:155], v[88:91]
    ds_read_b64_tr_b16 v[234:235], v11 offset:12288
    v_mfma_f32_16x16x32_bf16 v[92:95], v[176:179], v[140:143], v[92:95]
    s_add_u32 s54, s44, 32768
    s_cmp_eq_u32 s54, 131072
    s_cselect_b32 s54, 0, s54
    s_sub_u32 s54, s54, s44
    s_add_u32 s44, s44, s54
    v_add_u32 v7, s54, v7
    v_mfma_f32_16x16x32_bf16 v[96:99], v[176:179], v[144:147], v[96:99]
    v_add_u32 v8, s54, v8
    v_add_u32 v9, s54, v9
    v_mfma_f32_16x16x32_bf16 v[100:103], v[176:179], v[148:151], v[100:103]
    v_add_u32 v10, s54, v10
    v_add_u32 v11, s54, v11
    s_add_u32 s52, s52, 32768
    s_cmp_eq_u32 s52, 131072
    .long 0x853434ff, 0x0
    v_mfma_f32_16x16x32_bf16 v[104:107], v[176:179], v[152:155], v[104:107]
    v_mfma_f32_16x16x32_bf16 v[108:111], v[180:183], v[140:143], v[108:111]
    v_mfma_f32_16x16x32_bf16 v[112:115], v[180:183], v[144:147], v[112:115]
    v_mfma_f32_16x16x32_bf16 v[116:119], v[180:183], v[148:151], v[116:119]
    s_waitcnt vmcnt(8) lgkmcnt(0)
    s_barrier
    v_mfma_f32_16x16x32_bf16 v[120:123], v[180:183], v[152:155], v[120:123]
    v_mfma_f32_16x16x32_bf16 v[124:127], v[184:187], v[140:143], v[124:127]
    v_mfma_f32_16x16x32_bf16 v[128:131], v[184:187], v[144:147], v[128:131]
    v_mfma_f32_16x16x32_bf16 v[132:135], v[184:187], v[148:151], v[132:135]
    v_mfma_f32_16x16x32_bf16 v[136:139], v[184:187], v[152:155], v[136:139]
    v_mfma_f32_16x16x32_bf16 v[12:15], v[204:207], v[188:191], v[12:15]
    ds_read_b64_tr_b16 v[156:157], v8 offset:0
    v_mfma_f32_16x16x32_bf16 v[16:19], v[204:207], v[192:195], v[16:19]
    ds_read_b64_tr_b16 v[158:159], v8 offset:4096
    v_mfma_f32_16x16x32_bf16 v[20:23], v[204:207], v[196:199], v[20:23]
    ds_read_b128 v[140:143], v7 offset:0
    s_add_u32 m0, s52, s50
    s_nop 0
    buffer_load_dwordx4 v5, s[4:7], s46 offen lds
    v_mfma_f32_16x16x32_bf16 v[24:27], v[204:207], v[200:203], v[24:27]
    ds_read_b128 v[144:147], v7 offset:1024
    v_mfma_f32_16x16x32_bf16 v[28:31], v[208:211], v[188:191], v[28:31]
    ds_read_b128 v[148:151], v7 offset:2048
    v_mfma_f32_16x16x32_bf16 v[32:35], v[208:211], v[192:195], v[32:35]
    ds_read_b128 v[152:155], v7 offset:3072
    v_mfma_f32_16x16x32_bf16 v[36:39], v[208:211], v[196:199], v[36:39]
    ds_read_b64_tr_b16 v[160:161], v9 offset:0
    v_mfma_f32_16x16x32_bf16 v[40:43], v[208:211], v[200:203], v[40:43]
    ds_read_b64_tr_b16 v[162:163], v9 offset:4096
    buffer_load_dwordx4 v5, s[4:7], s46 offen offset:1024 lds
    s_add_u32 s46, s46, 131072
    v_mfma_f32_16x16x32_bf16 v[44:47], v[212:215], v[188:191], v[44:47]
    ds_read_b64_tr_b16 v[164:165], v10 offset:0
    v_mfma_f32_16x16x32_bf16 v[48:51], v[212:215], v[192:195], v[48:51]
    ds_read_b64_tr_b16 v[166:167], v10 offset:4096
    v_mfma_f32_16x16x32_bf16 v[52:55], v[212:215], v[196:199], v[52:55]
    ds_read_b64_tr_b16 v[168:169], v11 offset:0
    v_mfma_f32_16x16x32_bf16 v[56:59], v[212:215], v[200:203], v[56:59]
    ds_read_b64_tr_b16 v[170:171], v11 offset:4096
    v_mfma_f32_16x16x32_bf16 v[60:63], v[216:219], v[188:191], v[60:63]
    ds_read_b64_tr_b16 v[172:173], v8 offset:8192
    s_add_u32 m0, s52, s51
    s_nop 0
    buffer_load_dwordx4 v6, s[8:11], s47 offen lds
    v_mfma_f32_16x16x32_bf16 v[64:67], v[216:219], v[192:195], v[64:67]
    ds_read_b64_tr_b16 v[174:175], v8 offset:12288
    v_mfma_f32_16x16x32_bf16 v[68:71], v[216:219], v[196:199], v[68:71]
    ds_read_b64_tr_b16 v[176:177], v9 offset:8192
    v_mfma_f32_16x16x32_bf16 v[72:75], v[216:219], v[200:203], v[72:75]
    ds_read_b64_tr_b16 v[178:179], v9 offset:12288
    v_mfma_f32_16x16x32_bf16 v[76:79], v[220:223], v[188:191], v[76:79]
    ds_read_b64_tr_b16 v[180:181], v10 offset:8192
    v_mfma_f32_16x16x32_bf16 v[80:83], v[220:223], v[192:195], v[80:83]
    ds_read_b64_tr_b16 v[182:183], v10 offset:12288
    s_add_u32 m0, m0, 8192
    s_mov_b32 s99, 0x1000
    buffer_load_dwordx4 v6, s[12:15], s47 offen lds
    s_add_u32 s47, s47, 229376
    v_mfma_f32_16x16x32_bf16 v[84:87], v[220:223], v[196:199], v[84:87]
    ds_read_b64_tr_b16 v[184:185], v11 offset:8192
    v_mfma_f32_16x16x32_bf16 v[88:91], v[220:223], v[200:203], v[88:91]
    ds_read_b64_tr_b16 v[186:187], v11 offset:12288
    v_mfma_f32_16x16x32_bf16 v[92:95], v[224:227], v[188:191], v[92:95]
    s_add_u32 s54, s44, 32768
    s_cmp_eq_u32 s54, 131072
    s_cselect_b32 s54, 0, s54
    s_sub_u32 s54, s54, s44
    s_add_u32 s44, s44, s54
    v_add_u32 v7, s54, v7
    v_mfma_f32_16x16x32_bf16 v[96:99], v[224:227], v[192:195], v[96:99]
    v_add_u32 v8, s54, v8
    v_add_u32 v9, s54, v9
    v_mfma_f32_16x16x32_bf16 v[100:103], v[224:227], v[196:199], v[100:103]
    v_add_u32 v10, s54, v10
    v_add_u32 v11, s54, v11
    s_add_u32 s52, s52, 32768
    s_cmp_eq_u32 s52, 131072
    .long 0x853434ff, 0x0
    v_mfma_f32_16x16x32_bf16 v[104:107], v[224:227], v[200:203], v[104:107]
    v_mfma_f32_16x16x32_bf16 v[108:111], v[228:231], v[188:191], v[108:111]
    v_mfma_f32_16x16x32_bf16 v[112:115], v[228:231], v[192:195], v[112:115]
    v_mfma_f32_16x16x32_bf16 v[116:119], v[228:231], v[196:199], v[116:119]
    s_waitcnt vmcnt(8) lgkmcnt(0)
    s_barrier
    v_mfma_f32_16x16x32_bf16 v[120:123], v[228:231], v[200:203], v[120:123]
    v_mfma_f32_16x16x32_bf16 v[124:127], v[232:235], v[188:191], v[124:127]
    v_mfma_f32_16x16x32_bf16 v[128:131], v[232:235], v[192:195], v[128:131]
    v_mfma_f32_16x16x32_bf16 v[132:135], v[232:235], v[196:199], v[132:135]
    v_mfma_f32_16x16x32_bf16 v[136:139], v[232:235], v[200:203], v[136:139]
    s_add_u32 s43, s43, 2
    .long 0xbf0aff2b, 0x1a
    s_cbranch_scc1 interleave_layers__linear_kernel_hedgehog__geglu_ffn__prompt_kernel_loop81
    v_mfma_f32_16x16x32_bf16 v[12:15], v[156:159], v[140:143], v[12:15]
    ds_read_b64_tr_b16 v[204:205], v8 offset:0
    v_mfma_f32_16x16x32_bf16 v[16:19], v[156:159], v[144:147], v[16:19]
    ds_read_b64_tr_b16 v[206:207], v8 offset:4096
    v_mfma_f32_16x16x32_bf16 v[20:23], v[156:159], v[148:151], v[20:23]
    ds_read_b128 v[188:191], v7 offset:0
    v_mfma_f32_16x16x32_bf16 v[24:27], v[156:159], v[152:155], v[24:27]
    ds_read_b128 v[192:195], v7 offset:1024
    v_mfma_f32_16x16x32_bf16 v[28:31], v[160:163], v[140:143], v[28:31]
    ds_read_b128 v[196:199], v7 offset:2048
    v_mfma_f32_16x16x32_bf16 v[32:35], v[160:163], v[144:147], v[32:35]
    ds_read_b128 v[200:203], v7 offset:3072
    v_mfma_f32_16x16x32_bf16 v[36:39], v[160:163], v[148:151], v[36:39]
    ds_read_b64_tr_b16 v[208:209], v9 offset:0
    v_mfma_f32_16x16x32_bf16 v[40:43], v[160:163], v[152:155], v[40:43]
    ds_read_b64_tr_b16 v[210:211], v9 offset:4096
    v_mfma_f32_16x16x32_bf16 v[44:47], v[164:167], v[140:143], v[44:47]
    ds_read_b64_tr_b16 v[212:213], v10 offset:0
    v_mfma_f32_16x16x32_bf16 v[48:51], v[164:167], v[144:147], v[48:51]
    ds_read_b64_tr_b16 v[214:215], v10 offset:4096
    v_mfma_f32_16x16x32_bf16 v[52:55], v[164:167], v[148:151], v[52:55]
    ds_read_b64_tr_b16 v[216:217], v11 offset:0
    v_mfma_f32_16x16x32_bf16 v[56:59], v[164:167], v[152:155], v[56:59]
    ds_read_b64_tr_b16 v[218:219], v11 offset:4096
    v_mfma_f32_16x16x32_bf16 v[60:63], v[168:171], v[140:143], v[60:63]
    ds_read_b64_tr_b16 v[220:221], v8 offset:8192
    v_mfma_f32_16x16x32_bf16 v[64:67], v[168:171], v[144:147], v[64:67]
    ds_read_b64_tr_b16 v[222:223], v8 offset:12288
    v_mfma_f32_16x16x32_bf16 v[68:71], v[168:171], v[148:151], v[68:71]
    ds_read_b64_tr_b16 v[224:225], v9 offset:8192
    v_mfma_f32_16x16x32_bf16 v[72:75], v[168:171], v[152:155], v[72:75]
    ds_read_b64_tr_b16 v[226:227], v9 offset:12288
    v_mfma_f32_16x16x32_bf16 v[76:79], v[172:175], v[140:143], v[76:79]
    ds_read_b64_tr_b16 v[228:229], v10 offset:8192
    v_mfma_f32_16x16x32_bf16 v[80:83], v[172:175], v[144:147], v[80:83]
    ds_read_b64_tr_b16 v[230:231], v10 offset:12288
    v_mfma_f32_16x16x32_bf16 v[84:87], v[172:175], v[148:151], v[84:87]
    ds_read_b64_tr_b16 v[232:233], v11 offset:8192
    v_mfma_f32_16x16x32_bf16 v[88:91], v[172:175], v[152:155], v[88:91]
    ds_read_b64_tr_b16 v[234:235], v11 offset:12288
    v_mfma_f32_16x16x32_bf16 v[92:95], v[176:179], v[140:143], v[92:95]
    s_add_u32 s54, s44, 32768
    s_cmp_eq_u32 s54, 131072
    s_cselect_b32 s54, 0, s54
    s_sub_u32 s54, s54, s44
    s_add_u32 s44, s44, s54
    v_add_u32 v7, s54, v7
    v_mfma_f32_16x16x32_bf16 v[96:99], v[176:179], v[144:147], v[96:99]
    v_add_u32 v8, s54, v8
    v_add_u32 v9, s54, v9
    v_mfma_f32_16x16x32_bf16 v[100:103], v[176:179], v[148:151], v[100:103]
    v_add_u32 v10, s54, v10
    v_add_u32 v11, s54, v11
    v_mfma_f32_16x16x32_bf16 v[104:107], v[176:179], v[152:155], v[104:107]
    v_mfma_f32_16x16x32_bf16 v[108:111], v[180:183], v[140:143], v[108:111]
    v_mfma_f32_16x16x32_bf16 v[112:115], v[180:183], v[144:147], v[112:115]
    v_mfma_f32_16x16x32_bf16 v[116:119], v[180:183], v[148:151], v[116:119]
    s_waitcnt vmcnt(0) lgkmcnt(0)
    s_barrier
    v_mfma_f32_16x16x32_bf16 v[120:123], v[180:183], v[152:155], v[120:123]
    .long 0xbf09ff28, 0x4
    s_cbranch_scc1 interleave_layers__linear_kernel_hedgehog__geglu_ffn__prompt_kernel_pr82
    s_setprio 2
interleave_layers__linear_kernel_hedgehog__geglu_ffn__prompt_kernel_pr82:
    v_mfma_f32_16x16x32_bf16 v[124:127], v[184:187], v[140:143], v[124:127]
    v_mfma_f32_16x16x32_bf16 v[128:131], v[184:187], v[144:147], v[128:131]
    v_mfma_f32_16x16x32_bf16 v[132:135], v[184:187], v[148:151], v[132:135]
    v_mfma_f32_16x16x32_bf16 v[136:139], v[184:187], v[152:155], v[136:139]
    v_mfma_f32_16x16x32_bf16 v[12:15], v[204:207], v[188:191], v[12:15]
    ds_read_b64_tr_b16 v[156:157], v8 offset:0
    v_mfma_f32_16x16x32_bf16 v[16:19], v[204:207], v[192:195], v[16:19]
    ds_read_b64_tr_b16 v[158:159], v8 offset:4096
    v_mfma_f32_16x16x32_bf16 v[20:23], v[204:207], v[196:199], v[20:23]
    ds_read_b128 v[140:143], v7 offset:0
    v_mfma_f32_16x16x32_bf16 v[24:27], v[204:207], v[200:203], v[24:27]
    ds_read_b128 v[144:147], v7 offset:1024
    v_mfma_f32_16x16x32_bf16 v[28:31], v[208:211], v[188:191], v[28:31]
    ds_read_b128 v[148:151], v7 offset:2048
    v_mfma_f32_16x16x32_bf16 v[32:35], v[208:211], v[192:195], v[32:35]
    ds_read_b128 v[152:155], v7 offset:3072
    v_mfma_f32_16x16x32_bf16 v[36:39], v[208:211], v[196:199], v[36:39]
    ds_read_b64_tr_b16 v[160:161], v9 offset:0
    v_mfma_f32_16x16x32_bf16 v[40:43], v[208:211], v[200:203], v[40:43]
    ds_read_b64_tr_b16 v[162:163], v9 offset:4096
    v_mfma_f32_16x16x32_bf16 v[44:47], v[212:215], v[188:191], v[44:47]
    ds_read_b64_tr_b16 v[164:165], v10 offset:0
    v_mfma_f32_16x16x32_bf16 v[48:51], v[212:215], v[192:195], v[48:51]
    ds_read_b64_tr_b16 v[166:167], v10 offset:4096
    v_mfma_f32_16x16x32_bf16 v[52:55], v[212:215], v[196:199], v[52:55]
    ds_read_b64_tr_b16 v[168:169], v11 offset:0
    v_mfma_f32_16x16x32_bf16 v[56:59], v[212:215], v[200:203], v[56:59]
    ds_read_b64_tr_b16 v[170:171], v11 offset:4096
    v_mfma_f32_16x16x32_bf16 v[60:63], v[216:219], v[188:191], v[60:63]
    ds_read_b64_tr_b16 v[172:173], v8 offset:8192
    v_mfma_f32_16x16x32_bf16 v[64:67], v[216:219], v[192:195], v[64:67]
    ds_read_b64_tr_b16 v[174:175], v8 offset:12288
    v_mfma_f32_16x16x32_bf16 v[68:71], v[216:219], v[196:199], v[68:71]
    ds_read_b64_tr_b16 v[176:177], v9 offset:8192
    v_mfma_f32_16x16x32_bf16 v[72:75], v[216:219], v[200:203], v[72:75]
    ds_read_b64_tr_b16 v[178:179], v9 offset:12288
    v_mfma_f32_16x16x32_bf16 v[76:79], v[220:223], v[188:191], v[76:79]
    ds_read_b64_tr_b16 v[180:181], v10 offset:8192
    v_mfma_f32_16x16x32_bf16 v[80:83], v[220:223], v[192:195], v[80:83]
    ds_read_b64_tr_b16 v[182:183], v10 offset:12288
    v_mfma_f32_16x16x32_bf16 v[84:87], v[220:223], v[196:199], v[84:87]
    ds_read_b64_tr_b16 v[184:185], v11 offset:8192
    v_mfma_f32_16x16x32_bf16 v[88:91], v[220:223], v[200:203], v[88:91]
    ds_read_b64_tr_b16 v[186:187], v11 offset:12288
    v_mfma_f32_16x16x32_bf16 v[92:95], v[224:227], v[188:191], v[92:95]
    s_add_u32 s54, s44, 32768
    s_cmp_eq_u32 s54, 131072
    s_cselect_b32 s54, 0, s54
    s_sub_u32 s54, s54, s44
    s_add_u32 s44, s44, s54
    v_add_u32 v7, s54, v7
    v_mfma_f32_16x16x32_bf16 v[96:99], v[224:227], v[192:195], v[96:99]
    v_add_u32 v8, s54, v8
    v_add_u32 v9, s54, v9
    v_mfma_f32_16x16x32_bf16 v[100:103], v[224:227], v[196:199], v[100:103]
    v_add_u32 v10, s54, v10
    v_add_u32 v11, s54, v11
    v_mfma_f32_16x16x32_bf16 v[104:107], v[224:227], v[200:203], v[104:107]
    v_mfma_f32_16x16x32_bf16 v[108:111], v[228:231], v[188:191], v[108:111]
    v_mfma_f32_16x16x32_bf16 v[112:115], v[228:231], v[192:195], v[112:115]
    v_mfma_f32_16x16x32_bf16 v[116:119], v[228:231], v[196:199], v[116:119]
    v_mfma_f32_16x16x32_bf16 v[120:123], v[228:231], v[200:203], v[120:123]
    v_mfma_f32_16x16x32_bf16 v[124:127], v[232:235], v[188:191], v[124:127]
    v_mfma_f32_16x16x32_bf16 v[128:131], v[232:235], v[192:195], v[128:131]
    v_mfma_f32_16x16x32_bf16 v[132:135], v[232:235], v[196:199], v[132:135]
    v_mfma_f32_16x16x32_bf16 v[136:139], v[232:235], v[200:203], v[136:139]
    s_waitcnt lgkmcnt(0)
    s_nop 0
    v_mfma_f32_16x16x32_bf16 v[12:15], v[156:159], v[140:143], v[12:15]
    ds_read_b64_tr_b16 v[204:205], v8 offset:0
    v_mfma_f32_16x16x32_bf16 v[16:19], v[156:159], v[144:147], v[16:19]
    ds_read_b64_tr_b16 v[206:207], v8 offset:4096
    v_mfma_f32_16x16x32_bf16 v[20:23], v[156:159], v[148:151], v[20:23]
    ds_read_b128 v[188:191], v7 offset:0
    v_mfma_f32_16x16x32_bf16 v[24:27], v[156:159], v[152:155], v[24:27]
    ds_read_b128 v[192:195], v7 offset:1024
    v_mfma_f32_16x16x32_bf16 v[28:31], v[160:163], v[140:143], v[28:31]
    ds_read_b128 v[196:199], v7 offset:2048
    v_mfma_f32_16x16x32_bf16 v[32:35], v[160:163], v[144:147], v[32:35]
    ds_read_b128 v[200:203], v7 offset:3072
    v_mfma_f32_16x16x32_bf16 v[36:39], v[160:163], v[148:151], v[36:39]
    ds_read_b64_tr_b16 v[208:209], v9 offset:0
    v_mfma_f32_16x16x32_bf16 v[40:43], v[160:163], v[152:155], v[40:43]
    ds_read_b64_tr_b16 v[210:211], v9 offset:4096
    v_mfma_f32_16x16x32_bf16 v[44:47], v[164:167], v[140:143], v[44:47]
    ds_read_b64_tr_b16 v[212:213], v10 offset:0
    v_mfma_f32_16x16x32_bf16 v[48:51], v[164:167], v[144:147], v[48:51]
    ds_read_b64_tr_b16 v[214:215], v10 offset:4096
    v_mfma_f32_16x16x32_bf16 v[52:55], v[164:167], v[148:151], v[52:55]
    ds_read_b64_tr_b16 v[216:217], v11 offset:0
    v_mfma_f32_16x16x32_bf16 v[56:59], v[164:167], v[152:155], v[56:59]
    ds_read_b64_tr_b16 v[218:219], v11 offset:4096
    v_mfma_f32_16x16x32_bf16 v[60:63], v[168:171], v[140:143], v[60:63]
    ds_read_b64_tr_b16 v[220:221], v8 offset:8192
    v_mfma_f32_16x16x32_bf16 v[64:67], v[168:171], v[144:147], v[64:67]
    ds_read_b64_tr_b16 v[222:223], v8 offset:12288
    v_mfma_f32_16x16x32_bf16 v[68:71], v[168:171], v[148:151], v[68:71]
    ds_read_b64_tr_b16 v[224:225], v9 offset:8192
    v_mfma_f32_16x16x32_bf16 v[72:75], v[168:171], v[152:155], v[72:75]
    ds_read_b64_tr_b16 v[226:227], v9 offset:12288
    v_mfma_f32_16x16x32_bf16 v[76:79], v[172:175], v[140:143], v[76:79]
    ds_read_b64_tr_b16 v[228:229], v10 offset:8192
    v_mfma_f32_16x16x32_bf16 v[80:83], v[172:175], v[144:147], v[80:83]
    ds_read_b64_tr_b16 v[230:231], v10 offset:12288
    v_mfma_f32_16x16x32_bf16 v[84:87], v[172:175], v[148:151], v[84:87]
    ds_read_b64_tr_b16 v[232:233], v11 offset:8192
    v_mfma_f32_16x16x32_bf16 v[88:91], v[172:175], v[152:155], v[88:91]
    ds_read_b64_tr_b16 v[234:235], v11 offset:12288
    v_mfma_f32_16x16x32_bf16 v[92:95], v[176:179], v[140:143], v[92:95]
    s_add_u32 s54, s44, 32768
    s_cmp_eq_u32 s54, 131072
    s_cselect_b32 s54, 0, s54
    s_sub_u32 s54, s54, s44
    s_add_u32 s44, s44, s54
    v_add_u32 v7, s54, v7
    v_mfma_f32_16x16x32_bf16 v[96:99], v[176:179], v[144:147], v[96:99]
    v_add_u32 v8, s54, v8
    v_add_u32 v9, s54, v9
    v_mfma_f32_16x16x32_bf16 v[100:103], v[176:179], v[148:151], v[100:103]
    v_add_u32 v10, s54, v10
    v_add_u32 v11, s54, v11
    v_mfma_f32_16x16x32_bf16 v[104:107], v[176:179], v[152:155], v[104:107]
    v_mfma_f32_16x16x32_bf16 v[108:111], v[180:183], v[140:143], v[108:111]
    v_mfma_f32_16x16x32_bf16 v[112:115], v[180:183], v[144:147], v[112:115]
    v_mfma_f32_16x16x32_bf16 v[116:119], v[180:183], v[148:151], v[116:119]
    v_mfma_f32_16x16x32_bf16 v[120:123], v[180:183], v[152:155], v[120:123]
    v_mfma_f32_16x16x32_bf16 v[124:127], v[184:187], v[140:143], v[124:127]
    v_mfma_f32_16x16x32_bf16 v[128:131], v[184:187], v[144:147], v[128:131]
    v_mfma_f32_16x16x32_bf16 v[132:135], v[184:187], v[148:151], v[132:135]
    v_mfma_f32_16x16x32_bf16 v[136:139], v[184:187], v[152:155], v[136:139]
    s_waitcnt lgkmcnt(0)
    v_mfma_f32_16x16x32_bf16 v[12:15], v[204:207], v[188:191], v[12:15]
    v_lshrrev_b32 v1, 4, v0
    v_lshlrev_b32_e64 v1, 4, v1
    s_lshl_b32 s45, s42, 9
    s_and_b32 s48, s40, 4
    s_lshl_b32 s48, s48, 6
    s_add_u32 s45, s45, s48
    s_add_u32 s48, s45, 14336
    v_mfma_f32_16x16x32_bf16 v[16:19], v[204:207], v[192:195], v[16:19]
    buffer_load_dwordx4 v[140:143], v1, s[24:27], s45 offen offset:0
    v_mfma_f32_16x16x32_bf16 v[20:23], v[204:207], v[196:199], v[20:23]
    buffer_load_dwordx4 v[144:147], v1, s[24:27], s45 offen offset:64
    v_mfma_f32_16x16x32_bf16 v[24:27], v[204:207], v[200:203], v[24:27]
    buffer_load_dwordx4 v[148:151], v1, s[24:27], s45 offen offset:128
    v_mfma_f32_16x16x32_bf16 v[28:31], v[208:211], v[188:191], v[28:31]
    buffer_load_dwordx4 v[152:155], v1, s[24:27], s45 offen offset:192
    v_mfma_f32_16x16x32_bf16 v[32:35], v[208:211], v[192:195], v[32:35]
    buffer_load_dwordx4 v[156:159], v1, s[24:27], s48 offen offset:0
    v_mfma_f32_16x16x32_bf16 v[36:39], v[208:211], v[196:199], v[36:39]
    buffer_load_dwordx4 v[160:163], v1, s[24:27], s48 offen offset:64
    v_mfma_f32_16x16x32_bf16 v[40:43], v[208:211], v[200:203], v[40:43]
    buffer_load_dwordx4 v[164:167], v1, s[24:27], s48 offen offset:128
    v_mfma_f32_16x16x32_bf16 v[44:47], v[212:215], v[188:191], v[44:47]
    buffer_load_dwordx4 v[168:171], v1, s[24:27], s48 offen offset:192
    v_mfma_f32_16x16x32_bf16 v[48:51], v[212:215], v[192:195], v[48:51]
    v_mfma_f32_16x16x32_bf16 v[52:55], v[212:215], v[196:199], v[52:55]
    s_and_b32 s49, s40, 3
    s_lshl_b32 s49, s49, 8
    s_add_u32 s49, s49, 131072
    v_and_b32 v2, 15, v0
    v_lshlrev_b32 v3, 2, v2
    v_add_u32_e64 v3, s49, v3
    v_mfma_f32_16x16x32_bf16 v[56:59], v[212:215], v[200:203], v[56:59]
    ds_read_b32 v172, v3 offset:0
    ds_read_b32 v174, v3 offset:1024
    v_mfma_f32_16x16x32_bf16 v[60:63], v[216:219], v[188:191], v[60:63]
    ds_read_b32 v176, v3 offset:64
    ds_read_b32 v178, v3 offset:1088
    v_mfma_f32_16x16x32_bf16 v[64:67], v[216:219], v[192:195], v[64:67]
    ds_read_b32 v180, v3 offset:128
    ds_read_b32 v182, v3 offset:1152
    v_mfma_f32_16x16x32_bf16 v[68:71], v[216:219], v[196:199], v[68:71]
    ds_read_b32 v184, v3 offset:192
    ds_read_b32 v186, v3 offset:1216
    v_mfma_f32_16x16x32_bf16 v[72:75], v[216:219], v[200:203], v[72:75]
    v_mfma_f32_16x16x32_bf16 v[76:79], v[220:223], v[188:191], v[76:79]
    v_mfma_f32_16x16x32_bf16 v[80:83], v[220:223], v[192:195], v[80:83]
    v_mfma_f32_16x16x32_bf16 v[84:87], v[220:223], v[196:199], v[84:87]
    v_mfma_f32_16x16x32_bf16 v[88:91], v[220:223], v[200:203], v[88:91]
    v_mfma_f32_16x16x32_bf16 v[92:95], v[224:227], v[188:191], v[92:95]
    v_mfma_f32_16x16x32_bf16 v[96:99], v[224:227], v[192:195], v[96:99]
    v_mfma_f32_16x16x32_bf16 v[100:103], v[224:227], v[196:199], v[100:103]
    v_mfma_f32_16x16x32_bf16 v[104:107], v[224:227], v[200:203], v[104:107]
    v_mfma_f32_16x16x32_bf16 v[108:111], v[228:231], v[188:191], v[108:111]
    v_mfma_f32_16x16x32_bf16 v[112:115], v[228:231], v[192:195], v[112:115]
    v_mfma_f32_16x16x32_bf16 v[116:119], v[228:231], v[196:199], v[116:119]
    v_mfma_f32_16x16x32_bf16 v[120:123], v[228:231], v[200:203], v[120:123]
    v_mfma_f32_16x16x32_bf16 v[124:127], v[232:235], v[188:191], v[124:127]
    v_mfma_f32_16x16x32_bf16 v[128:131], v[232:235], v[192:195], v[128:131]
    v_mfma_f32_16x16x32_bf16 v[132:135], v[232:235], v[196:199], v[132:135]
    v_mfma_f32_16x16x32_bf16 v[136:139], v[232:235], v[200:203], v[136:139]
    s_setprio 0
    v_lshlrev_b32_e64 v2, 4, v0
    s_lshl_b32 s45, s42, 18
    s_lshl_b32 s48, s41, 14
    s_add_u32 s45, s45, s48
    s_and_b32 s48, s40, 3
    s_lshl_b32 s48, s48, 12
    s_add_u32 s45, s45, s48
    s_and_b32 s48, s40, 4
    s_lshl_b32 s48, s48, 15
    s_add_u32 s45, s45, s48
    v_mov_b32 v3, 147456
    v_mov_b32 v4, 1
    s_waitcnt vmcnt(0) lgkmcnt(0)
    v_mul_f32 v173, v172, v172
    v_mul_f32 v177, v176, v176
    v_mul_f32 v181, v180, v180
    v_mul_f32 v185, v184, v184
    v_mul_f32 v172, 0xc0135761, v172
    v_mul_f32 v176, 0xc0135761, v176
    v_mul_f32 v180, 0xc0135761, v180
    v_mul_f32 v184, 0xc0135761, v184
    v_mul_f32 v220, 0x3d372713, v173
    v_mul_f32 v222, 0x3d372713, v177
    v_mul_f32 v224, 0x3d372713, v181
    v_mul_f32 v226, 0x3d372713, v185
    v_rcp_f32 v173, v173
    v_rcp_f32 v177, v177
    v_rcp_f32 v181, v181
    v_rcp_f32 v185, v185
    v_mul_f32 v220, v220, v172
    v_mul_f32 v222, v222, v176
    v_mul_f32 v224, v224, v180
    v_mul_f32 v226, v226, v184
    v_pk_fma_f32 v[12:13], v[140:141], v[174:175], v[12:13] op_sel_hi:[1,0,1]
    v_pk_fma_f32 v[14:15], v[142:143], v[174:175], v[14:15] op_sel_hi:[1,0,1]
    v_pk_fma_f32 v[28:29], v[144:145], v[174:175], v[28:29] op_sel_hi:[1,0,1]
    v_pk_fma_f32 v[30:31], v[146:147], v[174:175], v[30:31] op_sel_hi:[1,0,1]
    v_pk_fma_f32 v[16:17], v[140:141], v[178:179], v[16:17] op_sel_hi:[1,0,1]
    v_pk_fma_f32 v[18:19], v[142:143], v[178:179], v[18:19] op_sel_hi:[1,0,1]
    v_pk_fma_f32 v[32:33], v[144:145], v[178:179], v[32:33] op_sel_hi:[1,0,1]
    v_pk_fma_f32 v[34:35], v[146:147], v[178:179], v[34:35] op_sel_hi:[1,0,1]
    v_pk_mul_f32 v[188:189], v[12:13], v[12:13]
    v_pk_mul_f32 v[190:191], v[14:15], v[14:15]
    v_pk_mul_f32 v[192:193], v[28:29], v[28:29]
    v_pk_mul_f32 v[194:195], v[30:31], v[30:31]
    v_pk_mul_f32 v[196:197], v[16:17], v[16:17]
    v_pk_mul_f32 v[198:199], v[18:19], v[18:19]
    v_pk_mul_f32 v[200:201], v[32:33], v[32:33]
    v_pk_mul_f32 v[202:203], v[34:35], v[34:35]
    v_pk_fma_f32 v[188:189], v[188:189], v[220:221], v[172:173] op_sel_hi:[1,0,0]
    v_pk_fma_f32 v[190:191], v[190:191], v[220:221], v[172:173] op_sel_hi:[1,0,0]
    v_pk_fma_f32 v[192:193], v[192:193], v[220:221], v[172:173] op_sel_hi:[1,0,0]
    v_pk_fma_f32 v[194:195], v[194:195], v[220:221], v[172:173] op_sel_hi:[1,0,0]
    v_pk_fma_f32 v[196:197], v[196:197], v[222:223], v[176:177] op_sel_hi:[1,0,0]
    v_pk_fma_f32 v[198:199], v[198:199], v[222:223], v[176:177] op_sel_hi:[1,0,0]
    v_pk_fma_f32 v[200:201], v[200:201], v[222:223], v[176:177] op_sel_hi:[1,0,0]
    v_pk_fma_f32 v[202:203], v[202:203], v[222:223], v[176:177] op_sel_hi:[1,0,0]
    v_pk_mul_f32 v[188:189], v[188:189], v[12:13]
    v_pk_mul_f32 v[190:191], v[190:191], v[14:15]
    v_pk_mul_f32 v[192:193], v[192:193], v[28:29]
    v_pk_mul_f32 v[194:195], v[194:195], v[30:31]
    v_pk_mul_f32 v[196:197], v[196:197], v[16:17]
    v_pk_mul_f32 v[198:199], v[198:199], v[18:19]
    v_pk_mul_f32 v[200:201], v[200:201], v[32:33]
    v_pk_mul_f32 v[202:203], v[202:203], v[34:35]
    v_exp_f32 v188, v188
    v_exp_f32 v189, v189
    v_exp_f32 v190, v190
    v_exp_f32 v191, v191
    v_pk_fma_f32 v[76:77], v[156:157], v[174:175], v[76:77] op_sel_hi:[1,0,1]
    v_pk_fma_f32 v[78:79], v[158:159], v[174:175], v[78:79] op_sel_hi:[1,0,1]
    v_exp_f32 v192, v192
    v_exp_f32 v193, v193
    v_exp_f32 v194, v194
    v_exp_f32 v195, v195
    v_pk_fma_f32 v[92:93], v[160:161], v[174:175], v[92:93] op_sel_hi:[1,0,1]
    v_pk_fma_f32 v[94:95], v[162:163], v[174:175], v[94:95] op_sel_hi:[1,0,1]
    v_exp_f32 v196, v196
    v_exp_f32 v197, v197
    v_exp_f32 v198, v198
    v_exp_f32 v199, v199
    v_pk_fma_f32 v[80:81], v[156:157], v[178:179], v[80:81] op_sel_hi:[1,0,1]
    v_pk_fma_f32 v[82:83], v[158:159], v[178:179], v[82:83] op_sel_hi:[1,0,1]
    v_exp_f32 v200, v200
    v_exp_f32 v201, v201
    v_exp_f32 v202, v202
    v_exp_f32 v203, v203
    v_pk_fma_f32 v[96:97], v[160:161], v[178:179], v[96:97] op_sel_hi:[1,0,1]
    v_pk_fma_f32 v[98:99], v[162:163], v[178:179], v[98:99] op_sel_hi:[1,0,1]
    v_fma_f32 v188, v188, v173, v173
    v_fma_f32 v189, v189, v173, v173
    v_fma_f32 v190, v190, v173, v173
    v_fma_f32 v191, v191, v173, v173
    v_fma_f32 v192, v192, v173, v173
    v_fma_f32 v193, v193, v173, v173
    v_fma_f32 v194, v194, v173, v173
    v_fma_f32 v195, v195, v173, v173
    v_fma_f32 v196, v196, v177, v177
    v_fma_f32 v197, v197, v177, v177
    v_fma_f32 v198, v198, v177, v177
    v_fma_f32 v199, v199, v177, v177
    v_fma_f32 v200, v200, v177, v177
    v_fma_f32 v201, v201, v177, v177
    v_fma_f32 v202, v202, v177, v177
    v_fma_f32 v203, v203, v177, v177
    v_rcp_f32 v188, v188
    v_rcp_f32 v189, v189
    v_rcp_f32 v190, v190
    v_rcp_f32 v191, v191
    v_pk_mul_f32 v[76:77], v[76:77], v[12:13]
    v_pk_mul_f32 v[78:79], v[78:79], v[14:15]
    v_rcp_f32 v192, v192
    v_rcp_f32 v193, v193
    v_rcp_f32 v194, v194
    v_rcp_f32 v195, v195
    v_pk_mul_f32 v[92:93], v[92:93], v[28:29]
    v_pk_mul_f32 v[94:95], v[94:95], v[30:31]
    v_rcp_f32 v196, v196
    v_rcp_f32 v197, v197
    v_rcp_f32 v198, v198
    v_rcp_f32 v199, v199
    v_pk_mul_f32 v[80:81], v[80:81], v[16:17]
    v_pk_mul_f32 v[82:83], v[82:83], v[18:19]
    v_rcp_f32 v200, v200
    v_rcp_f32 v201, v201
    v_rcp_f32 v202, v202
    v_rcp_f32 v203, v203
    v_pk_mul_f32 v[96:97], v[96:97], v[32:33]
    v_pk_mul_f32 v[98:99], v[98:99], v[34:35]
    v_pk_mul_f32 v[76:77], v[76:77], v[188:189]
    v_pk_mul_f32 v[78:79], v[78:79], v[190:191]
    v_pk_mul_f32 v[92:93], v[92:93], v[192:193]
    v_pk_mul_f32 v[94:95], v[94:95], v[194:195]
    v_pk_mul_f32 v[80:81], v[80:81], v[196:197]
    v_pk_mul_f32 v[82:83], v[82:83], v[198:199]
    v_pk_mul_f32 v[96:97], v[96:97], v[200:201]
    v_pk_mul_f32 v[98:99], v[98:99], v[202:203]
    v_cvt_pk_bf16_f32 v12, v76, v77
    v_cvt_pk_bf16_f32 v13, v78, v79
    v_cvt_pk_bf16_f32 v14, v92, v93
    v_cvt_pk_bf16_f32 v15, v94, v95
    buffer_store_dwordx4 v[12:15], v2, s[28:31], s45 offen offset:0 sc0 sc1
    v_cvt_pk_bf16_f32 v16, v80, v81
    v_cvt_pk_bf16_f32 v17, v82, v83
    v_cvt_pk_bf16_f32 v18, v96, v97
    v_cvt_pk_bf16_f32 v19, v98, v99
    buffer_store_dwordx4 v[16:19], v2, s[28:31], s45 offen offset:1024 sc0 sc1
    v_pk_fma_f32 v[20:21], v[140:141], v[182:183], v[20:21] op_sel_hi:[1,0,1]
    v_pk_fma_f32 v[22:23], v[142:143], v[182:183], v[22:23] op_sel_hi:[1,0,1]
    v_pk_fma_f32 v[36:37], v[144:145], v[182:183], v[36:37] op_sel_hi:[1,0,1]
    v_pk_fma_f32 v[38:39], v[146:147], v[182:183], v[38:39] op_sel_hi:[1,0,1]
    v_pk_fma_f32 v[24:25], v[140:141], v[186:187], v[24:25] op_sel_hi:[1,0,1]
    v_pk_fma_f32 v[26:27], v[142:143], v[186:187], v[26:27] op_sel_hi:[1,0,1]
    v_pk_fma_f32 v[40:41], v[144:145], v[186:187], v[40:41] op_sel_hi:[1,0,1]
    v_pk_fma_f32 v[42:43], v[146:147], v[186:187], v[42:43] op_sel_hi:[1,0,1]
    v_pk_mul_f32 v[204:205], v[20:21], v[20:21]
    v_pk_mul_f32 v[206:207], v[22:23], v[22:23]
    v_pk_mul_f32 v[208:209], v[36:37], v[36:37]
    v_pk_mul_f32 v[210:211], v[38:39], v[38:39]
    v_pk_mul_f32 v[212:213], v[24:25], v[24:25]
    v_pk_mul_f32 v[214:215], v[26:27], v[26:27]
    v_pk_mul_f32 v[216:217], v[40:41], v[40:41]
    v_pk_mul_f32 v[218:219], v[42:43], v[42:43]
    v_pk_fma_f32 v[204:205], v[204:205], v[224:225], v[180:181] op_sel_hi:[1,0,0]
    v_pk_fma_f32 v[206:207], v[206:207], v[224:225], v[180:181] op_sel_hi:[1,0,0]
    v_pk_fma_f32 v[208:209], v[208:209], v[224:225], v[180:181] op_sel_hi:[1,0,0]
    v_pk_fma_f32 v[210:211], v[210:211], v[224:225], v[180:181] op_sel_hi:[1,0,0]
    v_pk_fma_f32 v[212:213], v[212:213], v[226:227], v[184:185] op_sel_hi:[1,0,0]
    v_pk_fma_f32 v[214:215], v[214:215], v[226:227], v[184:185] op_sel_hi:[1,0,0]
    v_pk_fma_f32 v[216:217], v[216:217], v[226:227], v[184:185] op_sel_hi:[1,0,0]
    v_pk_fma_f32 v[218:219], v[218:219], v[226:227], v[184:185] op_sel_hi:[1,0,0]
    v_pk_mul_f32 v[204:205], v[204:205], v[20:21]
    v_pk_mul_f32 v[206:207], v[206:207], v[22:23]
    v_pk_mul_f32 v[208:209], v[208:209], v[36:37]
    v_pk_mul_f32 v[210:211], v[210:211], v[38:39]
    v_pk_mul_f32 v[212:213], v[212:213], v[24:25]
    v_pk_mul_f32 v[214:215], v[214:215], v[26:27]
    v_pk_mul_f32 v[216:217], v[216:217], v[40:41]
    v_pk_mul_f32 v[218:219], v[218:219], v[42:43]
    v_exp_f32 v204, v204
    v_exp_f32 v205, v205
    v_exp_f32 v206, v206
    v_exp_f32 v207, v207
    v_pk_fma_f32 v[84:85], v[156:157], v[182:183], v[84:85] op_sel_hi:[1,0,1]
    v_pk_fma_f32 v[86:87], v[158:159], v[182:183], v[86:87] op_sel_hi:[1,0,1]
    v_exp_f32 v208, v208
    v_exp_f32 v209, v209
    v_exp_f32 v210, v210
    v_exp_f32 v211, v211
    v_pk_fma_f32 v[100:101], v[160:161], v[182:183], v[100:101] op_sel_hi:[1,0,1]
    v_pk_fma_f32 v[102:103], v[162:163], v[182:183], v[102:103] op_sel_hi:[1,0,1]
    v_exp_f32 v212, v212
    v_exp_f32 v213, v213
    v_exp_f32 v214, v214
    v_exp_f32 v215, v215
    v_pk_fma_f32 v[88:89], v[156:157], v[186:187], v[88:89] op_sel_hi:[1,0,1]
    v_pk_fma_f32 v[90:91], v[158:159], v[186:187], v[90:91] op_sel_hi:[1,0,1]
    v_exp_f32 v216, v216
    v_exp_f32 v217, v217
    v_exp_f32 v218, v218
    v_exp_f32 v219, v219
    v_pk_fma_f32 v[104:105], v[160:161], v[186:187], v[104:105] op_sel_hi:[1,0,1]
    v_pk_fma_f32 v[106:107], v[162:163], v[186:187], v[106:107] op_sel_hi:[1,0,1]
    v_fma_f32 v204, v204, v181, v181
    v_fma_f32 v205, v205, v181, v181
    v_fma_f32 v206, v206, v181, v181
    v_fma_f32 v207, v207, v181, v181
    v_fma_f32 v208, v208, v181, v181
    v_fma_f32 v209, v209, v181, v181
    v_fma_f32 v210, v210, v181, v181
    v_fma_f32 v211, v211, v181, v181
    v_fma_f32 v212, v212, v185, v185
    v_fma_f32 v213, v213, v185, v185
    v_fma_f32 v214, v214, v185, v185
    v_fma_f32 v215, v215, v185, v185
    v_fma_f32 v216, v216, v185, v185
    v_fma_f32 v217, v217, v185, v185
    v_fma_f32 v218, v218, v185, v185
    v_fma_f32 v219, v219, v185, v185
    v_rcp_f32 v204, v204
    v_rcp_f32 v205, v205
    v_rcp_f32 v206, v206
    v_rcp_f32 v207, v207
    v_pk_mul_f32 v[84:85], v[84:85], v[20:21]
    v_pk_mul_f32 v[86:87], v[86:87], v[22:23]
    v_rcp_f32 v208, v208
    v_rcp_f32 v209, v209
    v_rcp_f32 v210, v210
    v_rcp_f32 v211, v211
    v_pk_mul_f32 v[100:101], v[100:101], v[36:37]
    v_pk_mul_f32 v[102:103], v[102:103], v[38:39]
    v_rcp_f32 v212, v212
    v_rcp_f32 v213, v213
    v_rcp_f32 v214, v214
    v_rcp_f32 v215, v215
    v_pk_mul_f32 v[88:89], v[88:89], v[24:25]
    v_pk_mul_f32 v[90:91], v[90:91], v[26:27]
    v_rcp_f32 v216, v216
    v_rcp_f32 v217, v217
    v_rcp_f32 v218, v218
    v_rcp_f32 v219, v219
    v_pk_mul_f32 v[104:105], v[104:105], v[40:41]
    v_pk_mul_f32 v[106:107], v[106:107], v[42:43]
    v_pk_mul_f32 v[84:85], v[84:85], v[204:205]
    v_pk_mul_f32 v[86:87], v[86:87], v[206:207]
    v_pk_mul_f32 v[100:101], v[100:101], v[208:209]
    v_pk_mul_f32 v[102:103], v[102:103], v[210:211]
    v_pk_mul_f32 v[88:89], v[88:89], v[212:213]
    v_pk_mul_f32 v[90:91], v[90:91], v[214:215]
    v_pk_mul_f32 v[104:105], v[104:105], v[216:217]
    v_pk_mul_f32 v[106:107], v[106:107], v[218:219]
    v_cvt_pk_bf16_f32 v20, v84, v85
    v_cvt_pk_bf16_f32 v21, v86, v87
    v_cvt_pk_bf16_f32 v22, v100, v101
    v_cvt_pk_bf16_f32 v23, v102, v103
    buffer_store_dwordx4 v[20:23], v2, s[28:31], s45 offen offset:2048 sc0 sc1
    v_cvt_pk_bf16_f32 v24, v88, v89
    v_cvt_pk_bf16_f32 v25, v90, v91
    v_cvt_pk_bf16_f32 v26, v104, v105
    v_cvt_pk_bf16_f32 v27, v106, v107
    buffer_store_dwordx4 v[24:27], v2, s[28:31], s45 offen offset:3072 sc0 sc1
    s_add_u32 s45, s45, 7340032
    v_pk_fma_f32 v[44:45], v[148:149], v[174:175], v[44:45] op_sel_hi:[1,0,1]
    v_pk_fma_f32 v[46:47], v[150:151], v[174:175], v[46:47] op_sel_hi:[1,0,1]
    v_pk_fma_f32 v[60:61], v[152:153], v[174:175], v[60:61] op_sel_hi:[1,0,1]
    v_pk_fma_f32 v[62:63], v[154:155], v[174:175], v[62:63] op_sel_hi:[1,0,1]
    v_pk_fma_f32 v[48:49], v[148:149], v[178:179], v[48:49] op_sel_hi:[1,0,1]
    v_pk_fma_f32 v[50:51], v[150:151], v[178:179], v[50:51] op_sel_hi:[1,0,1]
    v_pk_fma_f32 v[64:65], v[152:153], v[178:179], v[64:65] op_sel_hi:[1,0,1]
    v_pk_fma_f32 v[66:67], v[154:155], v[178:179], v[66:67] op_sel_hi:[1,0,1]
    v_pk_mul_f32 v[188:189], v[44:45], v[44:45]
    v_pk_mul_f32 v[190:191], v[46:47], v[46:47]
    v_pk_mul_f32 v[192:193], v[60:61], v[60:61]
    v_pk_mul_f32 v[194:195], v[62:63], v[62:63]
    v_pk_mul_f32 v[196:197], v[48:49], v[48:49]
    v_pk_mul_f32 v[198:199], v[50:51], v[50:51]
    v_pk_mul_f32 v[200:201], v[64:65], v[64:65]
    v_pk_mul_f32 v[202:203], v[66:67], v[66:67]
    v_pk_fma_f32 v[188:189], v[188:189], v[220:221], v[172:173] op_sel_hi:[1,0,0]
    v_pk_fma_f32 v[190:191], v[190:191], v[220:221], v[172:173] op_sel_hi:[1,0,0]
    v_pk_fma_f32 v[192:193], v[192:193], v[220:221], v[172:173] op_sel_hi:[1,0,0]
    v_pk_fma_f32 v[194:195], v[194:195], v[220:221], v[172:173] op_sel_hi:[1,0,0]
    v_pk_fma_f32 v[196:197], v[196:197], v[222:223], v[176:177] op_sel_hi:[1,0,0]
    v_pk_fma_f32 v[198:199], v[198:199], v[222:223], v[176:177] op_sel_hi:[1,0,0]
    v_pk_fma_f32 v[200:201], v[200:201], v[222:223], v[176:177] op_sel_hi:[1,0,0]
    v_pk_fma_f32 v[202:203], v[202:203], v[222:223], v[176:177] op_sel_hi:[1,0,0]
    v_pk_mul_f32 v[188:189], v[188:189], v[44:45]
    v_pk_mul_f32 v[190:191], v[190:191], v[46:47]
    v_pk_mul_f32 v[192:193], v[192:193], v[60:61]
    v_pk_mul_f32 v[194:195], v[194:195], v[62:63]
    v_pk_mul_f32 v[196:197], v[196:197], v[48:49]
    v_pk_mul_f32 v[198:199], v[198:199], v[50:51]
    v_pk_mul_f32 v[200:201], v[200:201], v[64:65]
    v_pk_mul_f32 v[202:203], v[202:203], v[66:67]
    v_exp_f32 v188, v188
    v_exp_f32 v189, v189
    v_exp_f32 v190, v190
    v_exp_f32 v191, v191
    v_pk_fma_f32 v[108:109], v[164:165], v[174:175], v[108:109] op_sel_hi:[1,0,1]
    v_pk_fma_f32 v[110:111], v[166:167], v[174:175], v[110:111] op_sel_hi:[1,0,1]
    v_exp_f32 v192, v192
    v_exp_f32 v193, v193
    v_exp_f32 v194, v194
    v_exp_f32 v195, v195
    v_pk_fma_f32 v[124:125], v[168:169], v[174:175], v[124:125] op_sel_hi:[1,0,1]
    v_pk_fma_f32 v[126:127], v[170:171], v[174:175], v[126:127] op_sel_hi:[1,0,1]
    v_exp_f32 v196, v196
    v_exp_f32 v197, v197
    v_exp_f32 v198, v198
    v_exp_f32 v199, v199
    v_pk_fma_f32 v[112:113], v[164:165], v[178:179], v[112:113] op_sel_hi:[1,0,1]
    v_pk_fma_f32 v[114:115], v[166:167], v[178:179], v[114:115] op_sel_hi:[1,0,1]
    v_exp_f32 v200, v200
    v_exp_f32 v201, v201
    v_exp_f32 v202, v202
    v_exp_f32 v203, v203
    v_pk_fma_f32 v[128:129], v[168:169], v[178:179], v[128:129] op_sel_hi:[1,0,1]
    v_pk_fma_f32 v[130:131], v[170:171], v[178:179], v[130:131] op_sel_hi:[1,0,1]
    v_fma_f32 v188, v188, v173, v173
    v_fma_f32 v189, v189, v173, v173
    v_fma_f32 v190, v190, v173, v173
    v_fma_f32 v191, v191, v173, v173
    v_fma_f32 v192, v192, v173, v173
    v_fma_f32 v193, v193, v173, v173
    v_fma_f32 v194, v194, v173, v173
    v_fma_f32 v195, v195, v173, v173
    v_fma_f32 v196, v196, v177, v177
    v_fma_f32 v197, v197, v177, v177
    v_fma_f32 v198, v198, v177, v177
    v_fma_f32 v199, v199, v177, v177
    v_fma_f32 v200, v200, v177, v177
    v_fma_f32 v201, v201, v177, v177
    v_fma_f32 v202, v202, v177, v177
    v_fma_f32 v203, v203, v177, v177
    v_rcp_f32 v188, v188
    v_rcp_f32 v189, v189
    v_rcp_f32 v190, v190
    v_rcp_f32 v191, v191
    v_pk_mul_f32 v[108:109], v[108:109], v[44:45]
    v_pk_mul_f32 v[110:111], v[110:111], v[46:47]
    v_rcp_f32 v192, v192
    v_rcp_f32 v193, v193
    v_rcp_f32 v194, v194
    v_rcp_f32 v195, v195
    v_pk_mul_f32 v[124:125], v[124:125], v[60:61]
    v_pk_mul_f32 v[126:127], v[126:127], v[62:63]
    v_rcp_f32 v196, v196
    v_rcp_f32 v197, v197
    v_rcp_f32 v198, v198
    v_rcp_f32 v199, v199
    v_pk_mul_f32 v[112:113], v[112:113], v[48:49]
    v_pk_mul_f32 v[114:115], v[114:115], v[50:51]
    v_rcp_f32 v200, v200
    v_rcp_f32 v201, v201
    v_rcp_f32 v202, v202
    v_rcp_f32 v203, v203
    v_pk_mul_f32 v[128:129], v[128:129], v[64:65]
    v_pk_mul_f32 v[130:131], v[130:131], v[66:67]
    v_pk_mul_f32 v[108:109], v[108:109], v[188:189]
    v_pk_mul_f32 v[110:111], v[110:111], v[190:191]
    v_pk_mul_f32 v[124:125], v[124:125], v[192:193]
    v_pk_mul_f32 v[126:127], v[126:127], v[194:195]
    v_pk_mul_f32 v[112:113], v[112:113], v[196:197]
    v_pk_mul_f32 v[114:115], v[114:115], v[198:199]
    v_pk_mul_f32 v[128:129], v[128:129], v[200:201]
    v_pk_mul_f32 v[130:131], v[130:131], v[202:203]
    v_cvt_pk_bf16_f32 v44, v108, v109
    v_cvt_pk_bf16_f32 v45, v110, v111
    v_cvt_pk_bf16_f32 v46, v124, v125
    v_cvt_pk_bf16_f32 v47, v126, v127
    buffer_store_dwordx4 v[44:47], v2, s[28:31], s45 offen offset:0 sc0 sc1
    v_cvt_pk_bf16_f32 v48, v112, v113
    v_cvt_pk_bf16_f32 v49, v114, v115
    v_cvt_pk_bf16_f32 v50, v128, v129
    v_cvt_pk_bf16_f32 v51, v130, v131
    buffer_store_dwordx4 v[48:51], v2, s[28:31], s45 offen offset:1024 sc0 sc1
    s_waitcnt vmcnt(2)
    s_mov_b64 exec, 1
    ds_add_rtn_u32 v236, v3, v4
    s_mov_b64 exec, -1
    s_lshl_b32 s62, s41, 12
    s_lshl_b32 s75, s42, 7
    s_add_u32 s62, s62, s75
    s_add_u32 s74, s62, 425984
    s_add_u32 s62, s62, 557056
    s_waitcnt lgkmcnt(0)
    v_readfirstlane_b32 s75, v236
    s_nop 0
    s_cmp_lg_u32 s75, 7
    s_cbranch_scc1 interleave_layers__linear_kernel_hedgehog__geglu_ffn__prompt_kernel_nfa83
    v_mov_b32 v239, 0
    v_mov_b32 v240, s60
    s_mov_b64 exec, 1
    buffer_store_dword v240, v239, s[56:59], s74 offen sc0 sc1
    s_mov_b64 exec, -1
interleave_layers__linear_kernel_hedgehog__geglu_ffn__prompt_kernel_nfa83:
    s_nop 0
    v_pk_fma_f32 v[52:53], v[148:149], v[182:183], v[52:53] op_sel_hi:[1,0,1]
    v_pk_fma_f32 v[54:55], v[150:151], v[182:183], v[54:55] op_sel_hi:[1,0,1]
    v_pk_fma_f32 v[68:69], v[152:153], v[182:183], v[68:69] op_sel_hi:[1,0,1]
    v_pk_fma_f32 v[70:71], v[154:155], v[182:183], v[70:71] op_sel_hi:[1,0,1]
    v_pk_fma_f32 v[56:57], v[148:149], v[186:187], v[56:57] op_sel_hi:[1,0,1]
    v_pk_fma_f32 v[58:59], v[150:151], v[186:187], v[58:59] op_sel_hi:[1,0,1]
    v_pk_fma_f32 v[72:73], v[152:153], v[186:187], v[72:73] op_sel_hi:[1,0,1]
    v_pk_fma_f32 v[74:75], v[154:155], v[186:187], v[74:75] op_sel_hi:[1,0,1]
    v_pk_mul_f32 v[204:205], v[52:53], v[52:53]
    v_pk_mul_f32 v[206:207], v[54:55], v[54:55]
    v_pk_mul_f32 v[208:209], v[68:69], v[68:69]
    v_pk_mul_f32 v[210:211], v[70:71], v[70:71]
    v_pk_mul_f32 v[212:213], v[56:57], v[56:57]
    v_pk_mul_f32 v[214:215], v[58:59], v[58:59]
    v_pk_mul_f32 v[216:217], v[72:73], v[72:73]
    v_pk_mul_f32 v[218:219], v[74:75], v[74:75]
    v_pk_fma_f32 v[204:205], v[204:205], v[224:225], v[180:181] op_sel_hi:[1,0,0]
    v_pk_fma_f32 v[206:207], v[206:207], v[224:225], v[180:181] op_sel_hi:[1,0,0]
    v_pk_fma_f32 v[208:209], v[208:209], v[224:225], v[180:181] op_sel_hi:[1,0,0]
    v_pk_fma_f32 v[210:211], v[210:211], v[224:225], v[180:181] op_sel_hi:[1,0,0]
    v_pk_fma_f32 v[212:213], v[212:213], v[226:227], v[184:185] op_sel_hi:[1,0,0]
    v_pk_fma_f32 v[214:215], v[214:215], v[226:227], v[184:185] op_sel_hi:[1,0,0]
    v_pk_fma_f32 v[216:217], v[216:217], v[226:227], v[184:185] op_sel_hi:[1,0,0]
    v_pk_fma_f32 v[218:219], v[218:219], v[226:227], v[184:185] op_sel_hi:[1,0,0]
    v_pk_mul_f32 v[204:205], v[204:205], v[52:53]
    v_pk_mul_f32 v[206:207], v[206:207], v[54:55]
    v_pk_mul_f32 v[208:209], v[208:209], v[68:69]
    v_pk_mul_f32 v[210:211], v[210:211], v[70:71]
    v_pk_mul_f32 v[212:213], v[212:213], v[56:57]
    v_pk_mul_f32 v[214:215], v[214:215], v[58:59]
    v_pk_mul_f32 v[216:217], v[216:217], v[72:73]
    v_pk_mul_f32 v[218:219], v[218:219], v[74:75]
    v_exp_f32 v204, v204
    v_exp_f32 v205, v205
    v_exp_f32 v206, v206
    v_exp_f32 v207, v207
    v_pk_fma_f32 v[116:117], v[164:165], v[182:183], v[116:117] op_sel_hi:[1,0,1]
    v_pk_fma_f32 v[118:119], v[166:167], v[182:183], v[118:119] op_sel_hi:[1,0,1]
    v_exp_f32 v208, v208
    v_exp_f32 v209, v209
    v_exp_f32 v210, v210
    v_exp_f32 v211, v211
    v_pk_fma_f32 v[132:133], v[168:169], v[182:183], v[132:133] op_sel_hi:[1,0,1]
    v_pk_fma_f32 v[134:135], v[170:171], v[182:183], v[134:135] op_sel_hi:[1,0,1]
    v_exp_f32 v212, v212
    v_exp_f32 v213, v213
    v_exp_f32 v214, v214
    v_exp_f32 v215, v215
    v_pk_fma_f32 v[120:121], v[164:165], v[186:187], v[120:121] op_sel_hi:[1,0,1]
    v_pk_fma_f32 v[122:123], v[166:167], v[186:187], v[122:123] op_sel_hi:[1,0,1]
    v_exp_f32 v216, v216
    v_exp_f32 v217, v217
    v_exp_f32 v218, v218
    v_exp_f32 v219, v219
    v_pk_fma_f32 v[136:137], v[168:169], v[186:187], v[136:137] op_sel_hi:[1,0,1]
    v_pk_fma_f32 v[138:139], v[170:171], v[186:187], v[138:139] op_sel_hi:[1,0,1]
    v_fma_f32 v204, v204, v181, v181
    v_fma_f32 v205, v205, v181, v181
    v_fma_f32 v206, v206, v181, v181
    v_fma_f32 v207, v207, v181, v181
    v_fma_f32 v208, v208, v181, v181
    v_fma_f32 v209, v209, v181, v181
    v_fma_f32 v210, v210, v181, v181
    v_fma_f32 v211, v211, v181, v181
    v_fma_f32 v212, v212, v185, v185
    v_fma_f32 v213, v213, v185, v185
    v_fma_f32 v214, v214, v185, v185
    v_fma_f32 v215, v215, v185, v185
    v_fma_f32 v216, v216, v185, v185
    v_fma_f32 v217, v217, v185, v185
    v_fma_f32 v218, v218, v185, v185
    v_fma_f32 v219, v219, v185, v185
    v_rcp_f32 v204, v204
    v_rcp_f32 v205, v205
    v_rcp_f32 v206, v206
    v_rcp_f32 v207, v207
    v_pk_mul_f32 v[116:117], v[116:117], v[52:53]
    v_pk_mul_f32 v[118:119], v[118:119], v[54:55]
    v_rcp_f32 v208, v208
    v_rcp_f32 v209, v209
    v_rcp_f32 v210, v210
    v_rcp_f32 v211, v211
    v_pk_mul_f32 v[132:133], v[132:133], v[68:69]
    v_pk_mul_f32 v[134:135], v[134:135], v[70:71]
    v_rcp_f32 v212, v212
    v_rcp_f32 v213, v213
    v_rcp_f32 v214, v214
    v_rcp_f32 v215, v215
    v_pk_mul_f32 v[120:121], v[120:121], v[56:57]
    v_pk_mul_f32 v[122:123], v[122:123], v[58:59]
    v_rcp_f32 v216, v216
    v_rcp_f32 v217, v217
    v_rcp_f32 v218, v218
    v_rcp_f32 v219, v219
    v_pk_mul_f32 v[136:137], v[136:137], v[72:73]
    v_pk_mul_f32 v[138:139], v[138:139], v[74:75]
    v_pk_mul_f32 v[116:117], v[116:117], v[204:205]
    v_pk_mul_f32 v[118:119], v[118:119], v[206:207]
    v_pk_mul_f32 v[132:133], v[132:133], v[208:209]
    v_pk_mul_f32 v[134:135], v[134:135], v[210:211]
    v_pk_mul_f32 v[120:121], v[120:121], v[212:213]
    v_pk_mul_f32 v[122:123], v[122:123], v[214:215]
    v_pk_mul_f32 v[136:137], v[136:137], v[216:217]
    v_pk_mul_f32 v[138:139], v[138:139], v[218:219]
    v_cvt_pk_bf16_f32 v52, v116, v117
    v_cvt_pk_bf16_f32 v53, v118, v119
    v_cvt_pk_bf16_f32 v54, v132, v133
    v_cvt_pk_bf16_f32 v55, v134, v135
    buffer_store_dwordx4 v[52:55], v2, s[28:31], s45 offen offset:2048 sc0 sc1
    v_cvt_pk_bf16_f32 v56, v120, v121
    v_cvt_pk_bf16_f32 v57, v122, v123
    v_cvt_pk_bf16_f32 v58, v136, v137
    v_cvt_pk_bf16_f32 v59, v138, v139
    buffer_store_dwordx4 v[56:59], v2, s[28:31], s45 offen offset:3072 sc0 sc1
interleave_layers__linear_kernel_hedgehog__geglu_ffn__prompt_kernel_spin384:
    ds_read_b32 v236, v3
    s_waitcnt lgkmcnt(0)
    v_readfirstlane_b32 s75, v236
    s_nop 0
    s_cmp_lt_u32 s75, 8
    s_cbranch_scc1 interleave_layers__linear_kernel_hedgehog__geglu_ffn__prompt_kernel_spin384
    s_branch mega_ph7
mega_ph7:
    s_and_b32 s45, s2, 7
    s_lshr_b32 s49, s2, 3
    s_and_b32 s41, s45, 3
    s_lshl_b32 s41, s41, 2
    s_lshr_b32 s42, s45, 2
    s_mul_i32 s42, s42, 8
    s_and_b32 s45, s49, 3
    s_add_u32 s41, s41, s45
    s_lshr_b32 s45, s49, 2
    s_add_u32 s42, s42, s45
    s_and_b32 s52, s40, 3
    s_cmp_lt_u32 s40, 4
    s_cbranch_scc1 interleave_layers__linear_kernel_hedgehog__geglu_ffn__prompt_kernel_comp85
    s_lshl_b32 s50, s52, 11
    v_lshlrev_b32 v3, 4, v0
    v_add_u32 v3, s50, v3
    s_mul_i32 s47, s42, 458752
    s_add_u32 s8, s68, 0x5700000
    .long 0x8209ff45, 0x0
    s_mov_b32 s10, 0x700000
    s_mov_b32 s11, 0x00020000
    s_add_u32 m0, s50, 0
    s_nop 0
    buffer_load_dwordx4 v3, s[8:11], s47 offen lds
    buffer_load_dwordx4 v3, s[8:11], s47 offen offset:1024 lds
    s_add_u32 s47, s47, 8192
    s_add_u32 m0, s50, 8192
    s_mov_b32 s99, 0x1000
    buffer_load_dwordx4 v3, s[8:11], s47 offen lds
    buffer_load_dwordx4 v3, s[8:11], s47 offen offset:1024 lds
    s_add_u32 s47, s47, 8192
    s_add_u32 m0, s50, 16384
    s_mov_b32 s99, 0x1000
    buffer_load_dwordx4 v3, s[8:11], s47 offen lds
    buffer_load_dwordx4 v3, s[8:11], s47 offen offset:1024 lds
    s_add_u32 s47, s47, 8192
    s_add_u32 m0, s50, 24576
    s_mov_b32 s99, 0x1000
    buffer_load_dwordx4 v3, s[8:11], s47 offen lds
    buffer_load_dwordx4 v3, s[8:11], s47 offen offset:1024 lds
    s_add_u32 s47, s47, 8192
    s_add_u32 m0, s50, 32768
    s_mov_b32 s99, 0x1000
    buffer_load_dwordx4 v3, s[8:11], s47 offen lds
    buffer_load_dwordx4 v3, s[8:11], s47 offen offset:1024 lds
    s_add_u32 s47, s47, 8192
    s_add_u32 m0, s50, 40960
    s_mov_b32 s99, 0x1000
    buffer_load_dwordx4 v3, s[8:11], s47 offen lds
    buffer_load_dwordx4 v3, s[8:11], s47 offen offset:1024 lds
    s_add_u32 s47, s47, 8192
    s_add_u32 m0, s50, 49152
    s_mov_b32 s99, 0x1000
    buffer_load_dwordx4 v3, s[8:11], s47 offen lds
    buffer_load_dwordx4 v3, s[8:11], s47 offen offset:1024 lds
    s_add_u32 s47, s47, 8192
    s_add_u32 m0, s50, 57344
    s_mov_b32 s99, 0x1000
    buffer_load_dwordx4 v3, s[8:11], s47 offen lds
    buffer_load_dwordx4 v3, s[8:11], s47 offen offset:1024 lds
    s_add_u32 s47, s47, 8192
    s_add_u32 m0, s50, 65536
    s_mov_b32 s99, 0x1000
    buffer_load_dwordx4 v3, s[8:11], s47 offen lds
    buffer_load_dwordx4 v3, s[8:11], s47 offen offset:1024 lds
    s_add_u32 s47, s47, 8192
    s_add_u32 m0, s50, 73728
    s_mov_b32 s99, 0x1000
    buffer_load_dwordx4 v3, s[8:11], s47 offen lds
    buffer_load_dwordx4 v3, s[8:11], s47 offen offset:1024 lds
    s_add_u32 s47, s47, 8192
    s_add_u32 m0, s50, 81920
    s_mov_b32 s99, 0x1000
    buffer_load_dwordx4 v3, s[8:11], s47 offen lds
    buffer_load_dwordx4 v3, s[8:11], s47 offen offset:1024 lds
    s_add_u32 s47, s47, 8192
    s_add_u32 m0, s50, 90112
    s_mov_b32 s99, 0x1000
    buffer_load_dwordx4 v3, s[8:11], s47 offen lds
    buffer_load_dwordx4 v3, s[8:11], s47 offen offset:1024 lds
    s_add_u32 s47, s47, 8192
    s_cmp_lg_u32 s40, 4
    s_cbranch_scc1 interleave_layers__linear_kernel_hedgehog__geglu_ffn__prompt_kernel_np86
    s_lshr_b32 s45, s41, 1
    s_lshl_b32 s45, s45, 12
    s_add_u32 s45, s45, 425984
    v_lshlrev_b32_e64 v6, 7, v0
    s_mov_b32 exec_lo, 0xfffffff
    s_mov_b32 exec_hi, 0x0
    s_mov_b32 s74, 0
interleave_layers__linear_kernel_hedgehog__geglu_ffn__prompt_kernel_poll87:
    buffer_load_dword v244, v6, s[56:59], s45 offen sc1
    s_add_u32 s74, s74, 1
    s_waitcnt vmcnt(0)
    v_cmp_ne_u32 vcc, s60, v244
    s_nop 0
    s_cmp_eq_u64 vcc, 0
    s_cbranch_scc1 interleave_layers__linear_kernel_hedgehog__geglu_ffn__prompt_kernel_polled88
    s_mov_b64 exec, vcc
    s_sleep 4
    s_cmp_lt_u32 s74, 50000
    s_cbranch_scc1 interleave_layers__linear_kernel_hedgehog__geglu_ffn__prompt_kernel_poll87
interleave_layers__linear_kernel_hedgehog__geglu_ffn__prompt_kernel_polled88:
    s_mov_b64 exec, -1
interleave_layers__linear_kernel_hedgehog__geglu_ffn__prompt_kernel_np86:
    s_waitcnt vmcnt(16)
    s_barrier
    s_add_u32 m0, s50, 98304
    s_mov_b32 s99, 0x1000
    buffer_load_dwordx4 v3, s[8:11], s47 offen lds
    buffer_load_dwordx4 v3, s[8:11], s47 offen offset:1024 lds
    s_add_u32 s47, s47, 8192
    s_add_u32 m0, s50, 106496
    s_mov_b32 s99, 0x1000
    buffer_load_dwordx4 v3, s[8:11], s47 offen lds
    buffer_load_dwordx4 v3, s[8:11], s47 offen offset:1024 lds
    s_add_u32 s47, s47, 8192
    s_add_u32 m0, s50, 114688
    s_mov_b32 s99, 0x1000
    buffer_load_dwordx4 v3, s[8:11], s47 offen lds
    buffer_load_dwordx4 v3, s[8:11], s47 offen offset:1024 lds
    s_add_u32 s47, s47, 8192
    s_add_u32 m0, s50, 122880
    s_mov_b32 s99, 0x1000
    buffer_load_dwordx4 v3, s[8:11], s47 offen lds
    buffer_load_dwordx4 v3, s[8:11], s47 offen offset:1024 lds
    s_add_u32 s47, s47, 8192
    s_waitcnt vmcnt(16)
    s_barrier
    s_add_u32 m0, s50, 0
    s_nop 0
    buffer_load_dwordx4 v3, s[8:11], s47 offen lds
    buffer_load_dwordx4 v3, s[8:11], s47 offen offset:1024 lds
    s_add_u32 s47, s47, 8192
    s_add_u32 m0, s50, 8192
    s_mov_b32 s99, 0x1000
    buffer_load_dwordx4 v3, s[8:11], s47 offen lds
    buffer_load_dwordx4 v3, s[8:11], s47 offen offset:1024 lds
    s_add_u32 s47, s47, 8192
    s_add_u32 m0, s50, 16384
    s_mov_b32 s99, 0x1000
    buffer_load_dwordx4 v3, s[8:11], s47 offen lds
    buffer_load_dwordx4 v3, s[8:11], s47 offen offset:1024 lds
    s_add_u32 s47, s47, 8192
    s_add_u32 m0, s50, 24576
    s_mov_b32 s99, 0x1000
    buffer_load_dwordx4 v3, s[8:11], s47 offen lds
    buffer_load_dwordx4 v3, s[8:11], s47 offen offset:1024 lds
    s_add_u32 s47, s47, 8192
    s_waitcnt vmcnt(16)
    s_barrier
    s_add_u32 m0, s50, 32768
    s_mov_b32 s99, 0x1000
    buffer_load_dwordx4 v3, s[8:11], s47 offen lds
    buffer_load_dwordx4 v3, s[8:11], s47 offen offset:1024 lds
    s_add_u32 s47, s47, 8192
    s_add_u32 m0, s50, 40960
    s_mov_b32 s99, 0x1000
    buffer_load_dwordx4 v3, s[8:11], s47 offen lds
    buffer_load_dwordx4 v3, s[8:11], s47 offen offset:1024 lds
    s_add_u32 s47, s47, 8192
    s_add_u32 m0, s50, 49152
    s_mov_b32 s99, 0x1000
    buffer_load_dwordx4 v3, s[8:11], s47 offen lds
    buffer_load_dwordx4 v3, s[8:11], s47 offen offset:1024 lds
    s_add_u32 s47, s47, 8192
    s_add_u32 m0, s50, 57344
    s_mov_b32 s99, 0x1000
    buffer_load_dwordx4 v3, s[8:11], s47 offen lds
    buffer_load_dwordx4 v3, s[8:11], s47 offen offset:1024 lds
    s_add_u32 s47, s47, 8192
    s_waitcnt vmcnt(16)
    s_barrier
    s_add_u32 m0, s50, 65536
    s_mov_b32 s99, 0x1000
    buffer_load_dwordx4 v3, s[8:11], s47 offen lds
    buffer_load_dwordx4 v3, s[8:11], s47 offen offset:1024 lds
    s_add_u32 s47, s47, 8192
    s_add_u32 m0, s50, 73728
    s_mov_b32 s99, 0x1000
    buffer_load_dwordx4 v3, s[8:11], s47 offen lds
    buffer_load_dwordx4 v3, s[8:11], s47 offen offset:1024 lds
    s_add_u32 s47, s47, 8192
    s_add_u32 m0, s50, 81920
    s_mov_b32 s99, 0x1000
    buffer_load_dwordx4 v3, s[8:11], s47 offen lds
    buffer_load_dwordx4 v3, s[8:11], s47 offen offset:1024 lds
    s_add_u32 s47, s47, 8192
    s_add_u32 m0, s50, 90112
    s_mov_b32 s99, 0x1000
    buffer_load_dwordx4 v3, s[8:11], s47 offen lds
    buffer_load_dwordx4 v3, s[8:11], s47 offen offset:1024 lds
    s_add_u32 s47, s47, 8192
    s_waitcnt vmcnt(16)
    s_barrier
    s_add_u32 m0, s50, 98304
    s_mov_b32 s99, 0x1000
    buffer_load_dwordx4 v3, s[8:11], s47 offen lds
    buffer_load_dwordx4 v3, s[8:11], s47 offen offset:1024 lds
    s_add_u32 s47, s47, 8192
    s_add_u32 m0, s50, 106496
    s_mov_b32 s99, 0x1000
    buffer_load_dwordx4 v3, s[8:11], s47 offen lds
    buffer_load_dwordx4 v3, s[8:11], s47 offen offset:1024 lds
    s_add_u32 s47, s47, 8192
    s_add_u32 m0, s50, 114688
    s_mov_b32 s99, 0x1000
    buffer_load_dwordx4 v3, s[8:11], s47 offen lds
    buffer_load_dwordx4 v3, s[8:11], s47 offen offset:1024 lds
    s_add_u32 s47, s47, 8192
    s_add_u32 m0, s50, 122880
    s_mov_b32 s99, 0x1000
    buffer_load_dwordx4 v3, s[8:11], s47 offen lds
    buffer_load_dwordx4 v3, s[8:11], s47 offen offset:1024 lds
    s_add_u32 s47, s47, 8192
    s_cmp_lg_u32 s40, 5
    s_cbranch_scc1 interleave_layers__linear_kernel_hedgehog__geglu_ffn__prompt_kernel_np89
    s_lshr_b32 s45, s41, 1
    s_lshl_b32 s45, s45, 12
    s_add_u32 s45, s45, 557056
    v_lshlrev_b32_e64 v6, 7, v0
    s_mov_b32 exec_lo, 0xfffffff
    s_mov_b32 exec_hi, 0x0
    s_mov_b32 s74, 0
interleave_layers__linear_kernel_hedgehog__geglu_ffn__prompt_kernel_poll90:
    buffer_load_dword v244, v6, s[56:59], s45 offen sc1
    s_add_u32 s74, s74, 1
    s_waitcnt vmcnt(0)
    v_cmp_ne_u32 vcc, s60, v244
    s_nop 0
    s_cmp_eq_u64 vcc, 0
    s_cbranch_scc1 interleave_layers__linear_kernel_hedgehog__geglu_ffn__prompt_kernel_polled91
    s_mov_b64 exec, vcc
    s_sleep 4
    s_cmp_lt_u32 s74, 50000
    s_cbranch_scc1 interleave_layers__linear_kernel_hedgehog__geglu_ffn__prompt_kernel_poll90
interleave_layers__linear_kernel_hedgehog__geglu_ffn__prompt_kernel_polled91:
    s_mov_b64 exec, -1
interleave_layers__linear_kernel_hedgehog__geglu_ffn__prompt_kernel_np89:
    s_waitcnt vmcnt(16)
    s_barrier
    s_add_u32 m0, s50, 0
    s_nop 0
    buffer_load_dwordx4 v3, s[8:11], s47 offen lds
    buffer_load_dwordx4 v3, s[8:11], s47 offen offset:1024 lds
    s_add_u32 s47, s47, 8192
    s_add_u32 m0, s50, 8192
    s_mov_b32 s99, 0x1000
    buffer_load_dwordx4 v3, s[8:11], s47 offen lds
    buffer_load_dwordx4 v3, s[8:11], s47 offen offset:1024 lds
    s_add_u32 s47, s47, 8192
    s_add_u32 m0, s50, 16384
    s_mov_b32 s99, 0x1000
    buffer_load_dwordx4 v3, s[8:11], s47 offen lds
    buffer_load_dwordx4 v3, s[8:11], s47 offen offset:1024 lds
    s_add_u32 s47, s47, 8192
    s_add_u32 m0, s50, 24576
    s_mov_b32 s99, 0x1000
    buffer_load_dwordx4 v3, s[8:11], s47 offen lds
    buffer_load_dwordx4 v3, s[8:11], s47 offen offset:1024 lds
    s_add_u32 s47, s47, 8192
    s_waitcnt vmcnt(16)
    s_barrier
    s_add_u32 m0, s50, 32768
    s_mov_b32 s99, 0x1000
    buffer_load_dwordx4 v3, s[8:11], s47 offen lds
    buffer_load_dwordx4 v3, s[8:11], s47 offen offset:1024 lds
    s_add_u32 s47, s47, 8192
    s_add_u32 m0, s50, 40960
    s_mov_b32 s99, 0x1000
    buffer_load_dwordx4 v3, s[8:11], s47 offen lds
    buffer_load_dwordx4 v3, s[8:11], s47 offen offset:1024 lds
    s_add_u32 s47, s47, 8192
    s_add_u32 m0, s50, 49152
    s_mov_b32 s99, 0x1000
    buffer_load_dwordx4 v3, s[8:11], s47 offen lds
    buffer_load_dwordx4 v3, s[8:11], s47 offen offset:1024 lds
    s_add_u32 s47, s47, 8192
    s_add_u32 m0, s50, 57344
    s_mov_b32 s99, 0x1000
    buffer_load_dwordx4 v3, s[8:11], s47 offen lds
    buffer_load_dwordx4 v3, s[8:11], s47 offen offset:1024 lds
    s_add_u32 s47, s47, 8192
    s_waitcnt vmcnt(16)
    s_barrier
    s_add_u32 m0, s50, 65536
    s_mov_b32 s99, 0x1000
    buffer_load_dwordx4 v3, s[8:11], s47 offen lds
    buffer_load_dwordx4 v3, s[8:11], s47 offen offset:1024 lds
    s_add_u32 s47, s47, 8192
    s_add_u32 m0, s50, 73728
    s_mov_b32 s99, 0x1000
    buffer_load_dwordx4 v3, s[8:11], s47 offen lds
    buffer_load_dwordx4 v3, s[8:11], s47 offen offset:1024 lds
    s_add_u32 s47, s47, 8192
    s_add_u32 m0, s50, 81920
    s_mov_b32 s99, 0x1000
    buffer_load_dwordx4 v3, s[8:11], s47 offen lds
    buffer_load_dwordx4 v3, s[8:11], s47 offen offset:1024 lds
    s_add_u32 s47, s47, 8192
    s_add_u32 m0, s50, 90112
    s_mov_b32 s99, 0x1000
    buffer_load_dwordx4 v3, s[8:11], s47 offen lds
    buffer_load_dwordx4 v3, s[8:11], s47 offen offset:1024 lds
    s_add_u32 s47, s47, 8192
    s_waitcnt vmcnt(16)
    s_barrier
    s_add_u32 m0, s50, 98304
    s_mov_b32 s99, 0x1000
    buffer_load_dwordx4 v3, s[8:11], s47 offen lds
    buffer_load_dwordx4 v3, s[8:11], s47 offen offset:1024 lds
    s_add_u32 s47, s47, 8192
    s_add_u32 m0, s50, 106496
    s_mov_b32 s99, 0x1000
    buffer_load_dwordx4 v3, s[8:11], s47 offen lds
    buffer_load_dwordx4 v3, s[8:11], s47 offen offset:1024 lds
    s_add_u32 s47, s47, 8192
    s_add_u32 m0, s50, 114688
    s_mov_b32 s99, 0x1000
    buffer_load_dwordx4 v3, s[8:11], s47 offen lds
    buffer_load_dwordx4 v3, s[8:11], s47 offen offset:1024 lds
    s_add_u32 s47, s47, 8192
    s_add_u32 m0, s50, 122880
    s_mov_b32 s99, 0x1000
    buffer_load_dwordx4 v3, s[8:11], s47 offen lds
    buffer_load_dwordx4 v3, s[8:11], s47 offen offset:1024 lds
    s_add_u32 s47, s47, 8192
    s_waitcnt vmcnt(16)
    s_barrier
    s_add_u32 m0, s50, 0
    s_nop 0
    buffer_load_dwordx4 v3, s[8:11], s47 offen lds
    buffer_load_dwordx4 v3, s[8:11], s47 offen offset:1024 lds
    s_add_u32 s47, s47, 8192
    s_add_u32 m0, s50, 8192
    s_mov_b32 s99, 0x1000
    buffer_load_dwordx4 v3, s[8:11], s47 offen lds
    buffer_load_dwordx4 v3, s[8:11], s47 offen offset:1024 lds
    s_add_u32 s47, s47, 8192
    s_add_u32 m0, s50, 16384
    s_mov_b32 s99, 0x1000
    buffer_load_dwordx4 v3, s[8:11], s47 offen lds
    buffer_load_dwordx4 v3, s[8:11], s47 offen offset:1024 lds
    s_add_u32 s47, s47, 8192
    s_add_u32 m0, s50, 24576
    s_mov_b32 s99, 0x1000
    buffer_load_dwordx4 v3, s[8:11], s47 offen lds
    buffer_load_dwordx4 v3, s[8:11], s47 offen offset:1024 lds
    s_add_u32 s47, s47, 8192
    s_waitcnt vmcnt(16)
    s_barrier
    s_add_u32 m0, s50, 32768
    s_mov_b32 s99, 0x1000
    buffer_load_dwordx4 v3, s[8:11], s47 offen lds
    buffer_load_dwordx4 v3, s[8:11], s47 offen offset:1024 lds
    s_add_u32 s47, s47, 8192
    s_add_u32 m0, s50, 40960
    s_mov_b32 s99, 0x1000
    buffer_load_dwordx4 v3, s[8:11], s47 offen lds
    buffer_load_dwordx4 v3, s[8:11], s47 offen offset:1024 lds
    s_add_u32 s47, s47, 8192
    s_add_u32 m0, s50, 49152
    s_mov_b32 s99, 0x1000
    buffer_load_dwordx4 v3, s[8:11], s47 offen lds
    buffer_load_dwordx4 v3, s[8:11], s47 offen offset:1024 lds
    s_add_u32 s47, s47, 8192
    s_add_u32 m0, s50, 57344
    s_mov_b32 s99, 0x1000
    buffer_load_dwordx4 v3, s[8:11], s47 offen lds
    buffer_load_dwordx4 v3, s[8:11], s47 offen offset:1024 lds
    s_add_u32 s47, s47, 8192
    s_waitcnt vmcnt(16)
    s_barrier
    s_waitcnt vmcnt(8)
    s_barrier
    s_waitcnt vmcnt(0)
    s_barrier
    s_barrier
    s_waitcnt vmcnt(0) lgkmcnt(0)
    s_endpgm
interleave_layers__linear_kernel_hedgehog__geglu_ffn__prompt_kernel_comp85:
    v_lshlrev_b32_e64 v5, 4, v0
    s_lshl_b32 s49, s41, 13
    s_lshl_b32 s48, s40, 11
    s_add_u32 s49, s49, s48
    s_lshl_b32 s46, s42, 18
    s_add_u32 s46, s46, s49
    s_add_u32 s47, s46, 131072
    s_add_u32 s51, s49, 131072
    v_lshlrev_b32_e64 v4, 4, v0
    s_add_u32 s4, s68, 0x3600000
    .long 0x8205ff45, 0x0
    s_mov_b32 s6, 0xe00000
    s_mov_b32 s7, 0x00020000
    s_add_u32 s12, s68, 0xc00000
    .long 0x820dff45, 0x0
    s_mov_b32 s14, 0x400000
    s_mov_b32 s15, 0x00020000
    s_mov_b32 s16, s70
    s_mov_b32 s17, s71
    s_mov_b32 s18, 0x400000
    s_mov_b32 s19, 0x00020000
    s_waitcnt vmcnt(0)
    s_barrier
    buffer_load_dwordx4 v[96:99], v5, s[4:7], s49 offen offset:0
    buffer_load_dwordx4 v[100:103], v5, s[4:7], s49 offen offset:1024
    s_add_u32 s49, s49, 262144
    buffer_load_dwordx4 v[104:107], v5, s[4:7], s51 offen offset:0
    buffer_load_dwordx4 v[108:111], v5, s[4:7], s51 offen offset:1024
    s_add_u32 s51, s51, 262144
    buffer_load_dwordx4 v[112:115], v5, s[4:7], s49 offen offset:0
    buffer_load_dwordx4 v[116:119], v5, s[4:7], s49 offen offset:1024
    s_add_u32 s49, s49, 262144
    buffer_load_dwordx4 v[120:123], v5, s[4:7], s51 offen offset:0
    buffer_load_dwordx4 v[124:127], v5, s[4:7], s51 offen offset:1024
    s_add_u32 s51, s51, 262144
    buffer_load_dwordx4 v[128:131], v5, s[4:7], s49 offen offset:0
    buffer_load_dwordx4 v[132:135], v5, s[4:7], s49 offen offset:1024
    s_add_u32 s49, s49, 262144
    buffer_load_dwordx4 v[136:139], v5, s[4:7], s51 offen offset:0
    buffer_load_dwordx4 v[140:143], v5, s[4:7], s51 offen offset:1024
    s_add_u32 s51, s51, 262144
    ds_read_b128 v[40:43], v4 offset:0
    ds_read_b128 v[44:47], v4 offset:1024
    ds_read_b128 v[48:51], v4 offset:2048
    ds_read_b128 v[52:55], v4 offset:3072
    s_cmp_lg_u32 s40, 0
    s_cbranch_scc1 interleave_layers__linear_kernel_hedgehog__geglu_ffn__prompt_kernel_nfb92
    s_cmp_lt_u32 s2, 32
    s_cbranch_scc1 interleave_layers__linear_kernel_hedgehog__geglu_ffn__prompt_kernel_nfb92
    s_mov_b32 s74, s62
    v_mov_b32 v239, 0
    v_mov_b32 v240, s60
    s_mov_b64 exec, 1
    buffer_store_dword v240, v239, s[56:59], s74 offen sc0 sc1
    s_mov_b64 exec, -1
interleave_layers__linear_kernel_hedgehog__geglu_ffn__prompt_kernel_nfb92:
    s_mov_b32 s44, 0
    s_mov_b32 s43, 0
    s_waitcnt vmcnt(8) lgkmcnt(0)
    v_mfma_f32_16x16x32_bf16 v[8:11], v[40:43], v[96:99], 0
    ds_read_b128 v[56:59], v4 offset:4096
    v_mfma_f32_16x16x32_bf16 v[12:15], v[40:43], v[100:103], 0
    ds_read_b128 v[60:63], v4 offset:5120
    v_mfma_f32_16x16x32_bf16 v[16:19], v[44:47], v[96:99], 0
    ds_read_b128 v[64:67], v4 offset:6144
    v_mfma_f32_16x16x32_bf16 v[20:23], v[44:47], v[100:103], 0
    ds_read_b128 v[68:71], v4 offset:7168
    v_mfma_f32_16x16x32_bf16 v[24:27], v[48:51], v[96:99], 0
    buffer_load_dwordx4 v[144:147], v5, s[4:7], s49 offen offset:0
    v_mfma_f32_16x16x32_bf16 v[28:31], v[48:51], v[100:103], 0
    buffer_load_dwordx4 v[148:151], v5, s[4:7], s49 offen offset:1024
    s_add_u32 s49, s49, 262144
    v_mfma_f32_16x16x32_bf16 v[32:35], v[52:55], v[96:99], 0
    v_mfma_f32_16x16x32_bf16 v[36:39], v[52:55], v[100:103], 0
    s_waitcnt lgkmcnt(0)
    s_nop 0
    v_mfma_f32_16x16x32_bf16 v[8:11], v[56:59], v[104:107], v[8:11]
    ds_read_b128 v[40:43], v4 offset:8192
    v_mfma_f32_16x16x32_bf16 v[12:15], v[56:59], v[108:111], v[12:15]
    ds_read_b128 v[44:47], v4 offset:9216
    v_mfma_f32_16x16x32_bf16 v[16:19], v[60:63], v[104:107], v[16:19]
    ds_read_b128 v[48:51], v4 offset:10240
    v_mfma_f32_16x16x32_bf16 v[20:23], v[60:63], v[108:111], v[20:23]
    ds_read_b128 v[52:55], v4 offset:11264
    v_mfma_f32_16x16x32_bf16 v[24:27], v[64:67], v[104:107], v[24:27]
    buffer_load_dwordx4 v[152:155], v5, s[4:7], s51 offen offset:0
    v_mfma_f32_16x16x32_bf16 v[28:31], v[64:67], v[108:111], v[28:31]
    buffer_load_dwordx4 v[156:159], v5, s[4:7], s51 offen offset:1024
    s_add_u32 s51, s51, 262144
    v_mfma_f32_16x16x32_bf16 v[32:35], v[68:71], v[104:107], v[32:35]
    v_mfma_f32_16x16x32_bf16 v[36:39], v[68:71], v[108:111], v[36:39]
    s_waitcnt vmcnt(8) lgkmcnt(0)
    s_nop 0
    v_mfma_f32_16x16x32_bf16 v[8:11], v[40:43], v[112:115], v[8:11]
    ds_read_b128 v[56:59], v4 offset:12288
    v_mfma_f32_16x16x32_bf16 v[12:15], v[40:43], v[116:119], v[12:15]
    ds_read_b128 v[60:63], v4 offset:13312
    v_mfma_f32_16x16x32_bf16 v[16:19], v[44:47], v[112:115], v[16:19]
    ds_read_b128 v[64:67], v4 offset:14336
    v_mfma_f32_16x16x32_bf16 v[20:23], v[44:47], v[116:119], v[20:23]
    ds_read_b128 v[68:71], v4 offset:15360
    v_mfma_f32_16x16x32_bf16 v[24:27], v[48:51], v[112:115], v[24:27]
    buffer_load_dwordx4 v[96:99], v5, s[4:7], s49 offen offset:0
    v_mfma_f32_16x16x32_bf16 v[28:31], v[48:51], v[116:119], v[28:31]
    buffer_load_dwordx4 v[100:103], v5, s[4:7], s49 offen offset:1024
    s_add_u32 s49, s49, 262144
    v_mfma_f32_16x16x32_bf16 v[32:35], v[52:55], v[112:115], v[32:35]
    v_mfma_f32_16x16x32_bf16 v[36:39], v[52:55], v[116:119], v[36:39]
    s_waitcnt lgkmcnt(0)
    s_nop 0
    v_mfma_f32_16x16x32_bf16 v[8:11], v[56:59], v[120:123], v[8:11]
    ds_read_b128 v[40:43], v4 offset:16384
    v_mfma_f32_16x16x32_bf16 v[12:15], v[56:59], v[124:127], v[12:15]
    ds_read_b128 v[44:47], v4 offset:17408
    v_mfma_f32_16x16x32_bf16 v[16:19], v[60:63], v[120:123], v[16:19]
    ds_read_b128 v[48:51], v4 offset:18432
    v_mfma_f32_16x16x32_bf16 v[20:23], v[60:63], v[124:127], v[20:23]
    ds_read_b128 v[52:55], v4 offset:19456
    v_mfma_f32_16x16x32_bf16 v[24:27], v[64:67], v[120:123], v[24:27]
    buffer_load_dwordx4 v[104:107], v5, s[4:7], s51 offen offset:0
    v_mfma_f32_16x16x32_bf16 v[28:31], v[64:67], v[124:127], v[28:31]
    buffer_load_dwordx4 v[108:111], v5, s[4:7], s51 offen offset:1024
    s_add_u32 s51, s51, 262144
    v_mfma_f32_16x16x32_bf16 v[32:35], v[68:71], v[120:123], v[32:35]
    v_mfma_f32_16x16x32_bf16 v[36:39], v[68:71], v[124:127], v[36:39]
    s_waitcnt vmcnt(8) lgkmcnt(0)
    s_nop 0
    v_mfma_f32_16x16x32_bf16 v[8:11], v[40:43], v[128:131], v[8:11]
    ds_read_b128 v[56:59], v4 offset:20480
    v_mfma_f32_16x16x32_bf16 v[12:15], v[40:43], v[132:135], v[12:15]
    ds_read_b128 v[60:63], v4 offset:21504
    v_mfma_f32_16x16x32_bf16 v[16:19], v[44:47], v[128:131], v[16:19]
    ds_read_b128 v[64:67], v4 offset:22528
    v_mfma_f32_16x16x32_bf16 v[20:23], v[44:47], v[132:135], v[20:23]
    ds_read_b128 v[68:71], v4 offset:23552
    v_mfma_f32_16x16x32_bf16 v[24:27], v[48:51], v[128:131], v[24:27]
    buffer_load_dwordx4 v[112:115], v5, s[4:7], s49 offen offset:0
    v_mfma_f32_16x16x32_bf16 v[28:31], v[48:51], v[132:135], v[28:31]
    buffer_load_dwordx4 v[116:119], v5, s[4:7], s49 offen offset:1024
    s_add_u32 s49, s49, 262144
    v_mfma_f32_16x16x32_bf16 v[32:35], v[52:55], v[128:131], v[32:35]
    v_mfma_f32_16x16x32_bf16 v[36:39], v[52:55], v[132:135], v[36:39]
    s_waitcnt lgkmcnt(0)
    s_nop 0
    v_mfma_f32_16x16x32_bf16 v[8:11], v[56:59], v[136:139], v[8:11]
    ds_read_b128 v[40:43], v4 offset:24576
    v_mfma_f32_16x16x32_bf16 v[12:15], v[56:59], v[140:143], v[12:15]
    ds_read_b128 v[44:47], v4 offset:25600
    v_mfma_f32_16x16x32_bf16 v[16:19], v[60:63], v[136:139], v[16:19]
    ds_read_b128 v[48:51], v4 offset:26624
    v_mfma_f32_16x16x32_bf16 v[20:23], v[60:63], v[140:143], v[20:23]
    ds_read_b128 v[52:55], v4 offset:27648
    v_mfma_f32_16x16x32_bf16 v[24:27], v[64:67], v[136:139], v[24:27]
    buffer_load_dwordx4 v[120:123], v5, s[4:7], s51 offen offset:0
    v_mfma_f32_16x16x32_bf16 v[28:31], v[64:67], v[140:143], v[28:31]
    buffer_load_dwordx4 v[124:127], v5, s[4:7], s51 offen offset:1024
    s_add_u32 s51, s51, 262144
    v_mfma_f32_16x16x32_bf16 v[32:35], v[68:71], v[136:139], v[32:35]
    v_mfma_f32_16x16x32_bf16 v[36:39], v[68:71], v[140:143], v[36:39]
    s_waitcnt vmcnt(8) lgkmcnt(0)
    s_nop 0
    v_mfma_f32_16x16x32_bf16 v[8:11], v[40:43], v[144:147], v[8:11]
    ds_read_b128 v[56:59], v4 offset:28672
    v_mfma_f32_16x16x32_bf16 v[12:15], v[40:43], v[148:151], v[12:15]
    ds_read_b128 v[60:63], v4 offset:29696
    v_mfma_f32_16x16x32_bf16 v[16:19], v[44:47], v[144:147], v[16:19]
    ds_read_b128 v[64:67], v4 offset:30720
    v_mfma_f32_16x16x32_bf16 v[20:23], v[44:47], v[148:151], v[20:23]
    ds_read_b128 v[68:71], v4 offset:31744
    v_mfma_f32_16x16x32_bf16 v[24:27], v[48:51], v[144:147], v[24:27]
    buffer_load_dwordx4 v[128:131], v5, s[4:7], s49 offen offset:0
    v_mfma_f32_16x16x32_bf16 v[28:31], v[48:51], v[148:151], v[28:31]
    buffer_load_dwordx4 v[132:135], v5, s[4:7], s49 offen offset:1024
    s_add_u32 s49, s49, 262144
    s_add_u32 s54, s44, 32768
    s_cmp_eq_u32 s54, 131072
    .long 0x853636ff, 0x0
    s_sub_u32 s54, s54, s44
    s_add_u32 s44, s44, s54
    v_mfma_f32_16x16x32_bf16 v[32:35], v[52:55], v[144:147], v[32:35]
    v_add_u32_e64 v4, s54, v4
    v_mfma_f32_16x16x32_bf16 v[36:39], v[52:55], v[148:151], v[36:39]
    s_waitcnt lgkmcnt(0)
    s_barrier
    v_mfma_f32_16x16x32_bf16 v[8:11], v[56:59], v[152:155], v[8:11]
    ds_read_b128 v[40:43], v4 offset:0
    v_mfma_f32_16x16x32_bf16 v[12:15], v[56:59], v[156:159], v[12:15]
    ds_read_b128 v[44:47], v4 offset:1024
    v_mfma_f32_16x16x32_bf16 v[16:19], v[60:63], v[152:155], v[16:19]
    ds_read_b128 v[48:51], v4 offset:2048
    v_mfma_f32_16x16x32_bf16 v[20:23], v[60:63], v[156:159], v[20:23]
    ds_read_b128 v[52:55], v4 offset:3072
    v_mfma_f32_16x16x32_bf16 v[24:27], v[64:67], v[152:155], v[24:27]
    buffer_load_dwordx4 v[136:139], v5, s[4:7], s51 offen offset:0
    v_mfma_f32_16x16x32_bf16 v[28:31], v[64:67], v[156:159], v[28:31]
    buffer_load_dwordx4 v[140:143], v5, s[4:7], s51 offen offset:1024
    s_add_u32 s51, s51, 262144
    v_mfma_f32_16x16x32_bf16 v[32:35], v[68:71], v[152:155], v[32:35]
    v_mfma_f32_16x16x32_bf16 v[36:39], v[68:71], v[156:159], v[36:39]
interleave_layers__linear_kernel_hedgehog__geglu_ffn__prompt_kernel_loop93:
    s_waitcnt vmcnt(8) lgkmcnt(0)
    s_nop 0
    v_mfma_f32_16x16x32_bf16 v[8:11], v[40:43], v[96:99], v[8:11]
    ds_read_b128 v[56:59], v4 offset:4096
    v_mfma_f32_16x16x32_bf16 v[12:15], v[40:43], v[100:103], v[12:15]
    ds_read_b128 v[60:63], v4 offset:5120
    v_mfma_f32_16x16x32_bf16 v[16:19], v[44:47], v[96:99], v[16:19]
    ds_read_b128 v[64:67], v4 offset:6144
    v_mfma_f32_16x16x32_bf16 v[20:23], v[44:47], v[100:103], v[20:23]
    ds_read_b128 v[68:71], v4 offset:7168
    v_mfma_f32_16x16x32_bf16 v[24:27], v[48:51], v[96:99], v[24:27]
    buffer_load_dwordx4 v[144:147], v5, s[4:7], s49 offen offset:0
    v_mfma_f32_16x16x32_bf16 v[28:31], v[48:51], v[100:103], v[28:31]
    buffer_load_dwordx4 v[148:151], v5, s[4:7], s49 offen offset:1024
    s_add_u32 s49, s49, 262144
    v_mfma_f32_16x16x32_bf16 v[32:35], v[52:55], v[96:99], v[32:35]
    v_mfma_f32_16x16x32_bf16 v[36:39], v[52:55], v[100:103], v[36:39]
    s_waitcnt lgkmcnt(0)
    s_nop 0
    v_mfma_f32_16x16x32_bf16 v[8:11], v[56:59], v[104:107], v[8:11]
    ds_read_b128 v[40:43], v4 offset:8192
    v_mfma_f32_16x16x32_bf16 v[12:15], v[56:59], v[108:111], v[12:15]
    ds_read_b128 v[44:47], v4 offset:9216
    v_mfma_f32_16x16x32_bf16 v[16:19], v[60:63], v[104:107], v[16:19]
    ds_read_b128 v[48:51], v4 offset:10240
    v_mfma_f32_16x16x32_bf16 v[20:23], v[60:63], v[108:111], v[20:23]
    ds_read_b128 v[52:55], v4 offset:11264
    v_mfma_f32_16x16x32_bf16 v[24:27], v[64:67], v[104:107], v[24:27]
    buffer_load_dwordx4 v[152:155], v5, s[4:7], s51 offen offset:0
    v_mfma_f32_16x16x32_bf16 v[28:31], v[64:67], v[108:111], v[28:31]
    buffer_load_dwordx4 v[156:159], v5, s[4:7], s51 offen offset:1024
    s_add_u32 s51, s51, 262144
    v_mfma_f32_16x16x32_bf16 v[32:35], v[68:71], v[104:107], v[32:35]
    v_mfma_f32_16x16x32_bf16 v[36:39], v[68:71], v[108:111], v[36:39]
    s_waitcnt vmcnt(8) lgkmcnt(0)
    s_nop 0
    v_mfma_f32_16x16x32_bf16 v[8:11], v[40:43], v[112:115], v[8:11]
    ds_read_b128 v[56:59], v4 offset:12288
    v_mfma_f32_16x16x32_bf16 v[12:15], v[40:43], v[116:119], v[12:15]
    ds_read_b128 v[60:63], v4 offset:13312
    v_mfma_f32_16x16x32_bf16 v[16:19], v[44:47], v[112:115], v[16:19]
    ds_read_b128 v[64:67], v4 offset:14336
    v_mfma_f32_16x16x32_bf16 v[20:23], v[44:47], v[116:119], v[20:23]
    ds_read_b128 v[68:71], v4 offset:15360
    v_mfma_f32_16x16x32_bf16 v[24:27], v[48:51], v[112:115], v[24:27]
    buffer_load_dwordx4 v[96:99], v5, s[4:7], s49 offen offset:0
    v_mfma_f32_16x16x32_bf16 v[28:31], v[48:51], v[116:119], v[28:31]
    buffer_load_dwordx4 v[100:103], v5, s[4:7], s49 offen offset:1024
    s_add_u32 s49, s49, 262144
    v_mfma_f32_16x16x32_bf16 v[32:35], v[52:55], v[112:115], v[32:35]
    v_mfma_f32_16x16x32_bf16 v[36:39], v[52:55], v[116:119], v[36:39]
    s_waitcnt lgkmcnt(0)
    s_nop 0
    v_mfma_f32_16x16x32_bf16 v[8:11], v[56:59], v[120:123], v[8:11]
    ds_read_b128 v[40:43], v4 offset:16384
    v_mfma_f32_16x16x32_bf16 v[12:15], v[56:59], v[124:127], v[12:15]
    ds_read_b128 v[44:47], v4 offset:17408
    v_mfma_f32_16x16x32_bf16 v[16:19], v[60:63], v[120:123], v[16:19]
    ds_read_b128 v[48:51], v4 offset:18432
    v_mfma_f32_16x16x32_bf16 v[20:23], v[60:63], v[124:127], v[20:23]
    ds_read_b128 v[52:55], v4 offset:19456
    v_mfma_f32_16x16x32_bf16 v[24:27], v[64:67], v[120:123], v[24:27]
    buffer_load_dwordx4 v[104:107], v5, s[4:7], s51 offen offset:0
    v_mfma_f32_16x16x32_bf16 v[28:31], v[64:67], v[124:127], v[28:31]
    buffer_load_dwordx4 v[108:111], v5, s[4:7], s51 offen offset:1024
    s_add_u32 s51, s51, 262144
    v_mfma_f32_16x16x32_bf16 v[32:35], v[68:71], v[120:123], v[32:35]
    v_mfma_f32_16x16x32_bf16 v[36:39], v[68:71], v[124:127], v[36:39]
    s_waitcnt vmcnt(8) lgkmcnt(0)
    s_nop 0
    v_mfma_f32_16x16x32_bf16 v[8:11], v[40:43], v[128:131], v[8:11]
    ds_read_b128 v[56:59], v4 offset:20480
    v_mfma_f32_16x16x32_bf16 v[12:15], v[40:43], v[132:135], v[12:15]
    ds_read_b128 v[60:63], v4 offset:21504
    v_mfma_f32_16x16x32_bf16 v[16:19], v[44:47], v[128:131], v[16:19]
    ds_read_b128 v[64:67], v4 offset:22528
    v_mfma_f32_16x16x32_bf16 v[20:23], v[44:47], v[132:135], v[20:23]
    ds_read_b128 v[68:71], v4 offset:23552
    v_mfma_f32_16x16x32_bf16 v[24:27], v[48:51], v[128:131], v[24:27]
    buffer_load_dwordx4 v[112:115], v5, s[4:7], s49 offen offset:0
    v_mfma_f32_16x16x32_bf16 v[28:31], v[48:51], v[132:135], v[28:31]
    buffer_load_dwordx4 v[116:119], v5, s[4:7], s49 offen offset:1024
    s_add_u32 s49, s49, 262144
    v_mfma_f32_16x16x32_bf16 v[32:35], v[52:55], v[128:131], v[32:35]
    v_mfma_f32_16x16x32_bf16 v[36:39], v[52:55], v[132:135], v[36:39]
    s_waitcnt lgkmcnt(0)
    s_nop 0
    v_mfma_f32_16x16x32_bf16 v[8:11], v[56:59], v[136:139], v[8:11]
    ds_read_b128 v[40:43], v4 offset:24576
    v_mfma_f32_16x16x32_bf16 v[12:15], v[56:59], v[140:143], v[12:15]
    ds_read_b128 v[44:47], v4 offset:25600
    v_mfma_f32_16x16x32_bf16 v[16:19], v[60:63], v[136:139], v[16:19]
    ds_read_b128 v[48:51], v4 offset:26624
    v_mfma_f32_16x16x32_bf16 v[20:23], v[60:63], v[140:143], v[20:23]
    ds_read_b128 v[52:55], v4 offset:27648
    v_mfma_f32_16x16x32_bf16 v[24:27], v[64:67], v[136:139], v[24:27]
    buffer_load_dwordx4 v[120:123], v5, s[4:7], s51 offen offset:0
    v_mfma_f32_16x16x32_bf16 v[28:31], v[64:67], v[140:143], v[28:31]
    buffer_load_dwordx4 v[124:127], v5, s[4:7], s51 offen offset:1024
    s_add_u32 s51, s51, 262144
    v_mfma_f32_16x16x32_bf16 v[32:35], v[68:71], v[136:139], v[32:35]
    v_mfma_f32_16x16x32_bf16 v[36:39], v[68:71], v[140:143], v[36:39]
    s_waitcnt vmcnt(8) lgkmcnt(0)
    s_nop 0
    v_mfma_f32_16x16x32_bf16 v[8:11], v[40:43], v[144:147], v[8:11]
    ds_read_b128 v[56:59], v4 offset:28672
    v_mfma_f32_16x16x32_bf16 v[12:15], v[40:43], v[148:151], v[12:15]
    ds_read_b128 v[60:63], v4 offset:29696
    v_mfma_f32_16x16x32_bf16 v[16:19], v[44:47], v[144:147], v[16:19]
    ds_read_b128 v[64:67], v4 offset:30720
    v_mfma_f32_16x16x32_bf16 v[20:23], v[44:47], v[148:151], v[20:23]
    ds_read_b128 v[68:71], v4 offset:31744
    v_mfma_f32_16x16x32_bf16 v[24:27], v[48:51], v[144:147], v[24:27]
    buffer_load_dwordx4 v[128:131], v5, s[4:7], s49 offen offset:0
    v_mfma_f32_16x16x32_bf16 v[28:31], v[48:51], v[148:151], v[28:31]
    buffer_load_dwordx4 v[132:135], v5, s[4:7], s49 offen offset:1024
    s_add_u32 s49, s49, 262144
    s_add_u32 s54, s44, 32768
    s_cmp_eq_u32 s54, 131072
    .long 0x853636ff, 0x0
    s_sub_u32 s54, s54, s44
    s_add_u32 s44, s44, s54
    v_mfma_f32_16x16x32_bf16 v[32:35], v[52:55], v[144:147], v[32:35]
    v_add_u32_e64 v4, s54, v4
    v_mfma_f32_16x16x32_bf16 v[36:39], v[52:55], v[148:151], v[36:39]
    s_waitcnt lgkmcnt(0)
    s_barrier
    v_mfma_f32_16x16x32_bf16 v[8:11], v[56:59], v[152:155], v[8:11]
    ds_read_b128 v[40:43], v4 offset:0
    v_mfma_f32_16x16x32_bf16 v[12:15], v[56:59], v[156:159], v[12:15]
    ds_read_b128 v[44:47], v4 offset:1024
    v_mfma_f32_16x16x32_bf16 v[16:19], v[60:63], v[152:155], v[16:19]
    ds_read_b128 v[48:51], v4 offset:2048
    v_mfma_f32_16x16x32_bf16 v[20:23], v[60:63], v[156:159], v[20:23]
    ds_read_b128 v[52:55], v4 offset:3072
    v_mfma_f32_16x16x32_bf16 v[24:27], v[64:67], v[152:155], v[24:27]
    buffer_load_dwordx4 v[136:139], v5, s[4:7], s51 offen offset:0
    v_mfma_f32_16x16x32_bf16 v[28:31], v[64:67], v[156:159], v[28:31]
    buffer_load_dwordx4 v[140:143], v5, s[4:7], s51 offen offset:1024
    s_add_u32 s51, s51, 262144
    v_mfma_f32_16x16x32_bf16 v[32:35], v[68:71], v[152:155], v[32:35]
    v_mfma_f32_16x16x32_bf16 v[36:39], v[68:71], v[156:159], v[36:39]
    s_add_u32 s43, s43, 1
    s_cmp_lt_u32 s43, 12
    s_cbranch_scc1 interleave_layers__linear_kernel_hedgehog__geglu_ffn__prompt_kernel_loop93
    s_waitcnt vmcnt(8) lgkmcnt(0)
    v_mfma_f32_16x16x32_bf16 v[8:11], v[40:43], v[96:99], v[8:11]
    ds_read_b128 v[56:59], v4 offset:4096
    v_mfma_f32_16x16x32_bf16 v[12:15], v[40:43], v[100:103], v[12:15]
    ds_read_b128 v[60:63], v4 offset:5120
    v_mfma_f32_16x16x32_bf16 v[16:19], v[44:47], v[96:99], v[16:19]
    ds_read_b128 v[64:67], v4 offset:6144
    v_mfma_f32_16x16x32_bf16 v[20:23], v[44:47], v[100:103], v[20:23]
    ds_read_b128 v[68:71], v4 offset:7168
    v_mfma_f32_16x16x32_bf16 v[24:27], v[48:51], v[96:99], v[24:27]
    buffer_load_dwordx4 v[144:147], v5, s[4:7], s49 offen offset:0
    v_mfma_f32_16x16x32_bf16 v[28:31], v[48:51], v[100:103], v[28:31]
    buffer_load_dwordx4 v[148:151], v5, s[4:7], s49 offen offset:1024
    s_add_u32 s49, s49, 262144
    v_mfma_f32_16x16x32_bf16 v[32:35], v[52:55], v[96:99], v[32:35]
    v_mfma_f32_16x16x32_bf16 v[36:39], v[52:55], v[100:103], v[36:39]
    s_waitcnt lgkmcnt(0)
    s_nop 0
    v_mfma_f32_16x16x32_bf16 v[8:11], v[56:59], v[104:107], v[8:11]
    ds_read_b128 v[40:43], v4 offset:8192
    v_mfma_f32_16x16x32_bf16 v[12:15], v[56:59], v[108:111], v[12:15]
    ds_read_b128 v[44:47], v4 offset:9216
    v_mfma_f32_16x16x32_bf16 v[16:19], v[60:63], v[104:107], v[16:19]
    ds_read_b128 v[48:51], v4 offset:10240
    v_mfma_f32_16x16x32_bf16 v[20:23], v[60:63], v[108:111], v[20:23]
    ds_read_b128 v[52:55], v4 offset:11264
    v_mfma_f32_16x16x32_bf16 v[24:27], v[64:67], v[104:107], v[24:27]
    buffer_load_dwordx4 v[152:155], v5, s[4:7], s51 offen offset:0
    v_mfma_f32_16x16x32_bf16 v[28:31], v[64:67], v[108:111], v[28:31]
    buffer_load_dwordx4 v[156:159], v5, s[4:7], s51 offen offset:1024
    s_add_u32 s51, s51, 262144
    v_mfma_f32_16x16x32_bf16 v[32:35], v[68:71], v[104:107], v[32:35]
    buffer_load_dwordx4 v[72:75], v5, s[12:15], s46 offen offset:0
    buffer_load_dwordx4 v[76:79], v5, s[12:15], s46 offen offset:1024
    v_mfma_f32_16x16x32_bf16 v[36:39], v[68:71], v[108:111], v[36:39]
    buffer_load_dwordx4 v[80:83], v5, s[12:15], s47 offen offset:0
    buffer_load_dwordx4 v[84:87], v5, s[12:15], s47 offen offset:1024
    s_waitcnt vmcnt(12) lgkmcnt(0)
    s_nop 0
    v_mfma_f32_16x16x32_bf16 v[8:11], v[40:43], v[112:115], v[8:11]
    ds_read_b128 v[56:59], v4 offset:12288
    v_mfma_f32_16x16x32_bf16 v[12:15], v[40:43], v[116:119], v[12:15]
    ds_read_b128 v[60:63], v4 offset:13312
    v_mfma_f32_16x16x32_bf16 v[16:19], v[44:47], v[112:115], v[16:19]
    ds_read_b128 v[64:67], v4 offset:14336
    v_mfma_f32_16x16x32_bf16 v[20:23], v[44:47], v[116:119], v[20:23]
    ds_read_b128 v[68:71], v4 offset:15360
    v_mfma_f32_16x16x32_bf16 v[24:27], v[48:51], v[112:115], v[24:27]
    v_mfma_f32_16x16x32_bf16 v[28:31], v[48:51], v[116:119], v[28:31]
    v_mfma_f32_16x16x32_bf16 v[32:35], v[52:55], v[112:115], v[32:35]
    v_mfma_f32_16x16x32_bf16 v[36:39], v[52:55], v[116:119], v[36:39]
    s_waitcnt lgkmcnt(0)
    s_nop 0
    v_mfma_f32_16x16x32_bf16 v[8:11], v[56:59], v[120:123], v[8:11]
    ds_read_b128 v[40:43], v4 offset:16384
    v_mfma_f32_16x16x32_bf16 v[12:15], v[56:59], v[124:127], v[12:15]
    ds_read_b128 v[44:47], v4 offset:17408
    v_mfma_f32_16x16x32_bf16 v[16:19], v[60:63], v[120:123], v[16:19]
    ds_read_b128 v[48:51], v4 offset:18432
    v_mfma_f32_16x16x32_bf16 v[20:23], v[60:63], v[124:127], v[20:23]
    ds_read_b128 v[52:55], v4 offset:19456
    v_mfma_f32_16x16x32_bf16 v[24:27], v[64:67], v[120:123], v[24:27]
    v_mfma_f32_16x16x32_bf16 v[28:31], v[64:67], v[124:127], v[28:31]
    v_mfma_f32_16x16x32_bf16 v[32:35], v[68:71], v[120:123], v[32:35]
    v_mfma_f32_16x16x32_bf16 v[36:39], v[68:71], v[124:127], v[36:39]
    s_waitcnt vmcnt(8) lgkmcnt(0)
    s_nop 0
    v_mfma_f32_16x16x32_bf16 v[8:11], v[40:43], v[128:131], v[8:11]
    ds_read_b128 v[56:59], v4 offset:20480
    v_mfma_f32_16x16x32_bf16 v[12:15], v[40:43], v[132:135], v[12:15]
    ds_read_b128 v[60:63], v4 offset:21504
    v_mfma_f32_16x16x32_bf16 v[16:19], v[44:47], v[128:131], v[16:19]
    ds_read_b128 v[64:67], v4 offset:22528
    v_mfma_f32_16x16x32_bf16 v[20:23], v[44:47], v[132:135], v[20:23]
    ds_read_b128 v[68:71], v4 offset:23552
    v_mfma_f32_16x16x32_bf16 v[24:27], v[48:51], v[128:131], v[24:27]
    v_mfma_f32_16x16x32_bf16 v[28:31], v[48:51], v[132:135], v[28:31]
    v_mfma_f32_16x16x32_bf16 v[32:35], v[52:55], v[128:131], v[32:35]
    v_mfma_f32_16x16x32_bf16 v[36:39], v[52:55], v[132:135], v[36:39]
    s_waitcnt lgkmcnt(0)
    s_nop 0
    v_mfma_f32_16x16x32_bf16 v[8:11], v[56:59], v[136:139], v[8:11]
    ds_read_b128 v[40:43], v4 offset:24576
    v_mfma_f32_16x16x32_bf16 v[12:15], v[56:59], v[140:143], v[12:15]
    ds_read_b128 v[44:47], v4 offset:25600
    v_mfma_f32_16x16x32_bf16 v[16:19], v[60:63], v[136:139], v[16:19]
    ds_read_b128 v[48:51], v4 offset:26624
    v_mfma_f32_16x16x32_bf16 v[20:23], v[60:63], v[140:143], v[20:23]
    ds_read_b128 v[52:55], v4 offset:27648
    v_mfma_f32_16x16x32_bf16 v[24:27], v[64:67], v[136:139], v[24:27]
    v_mfma_f32_16x16x32_bf16 v[28:31], v[64:67], v[140:143], v[28:31]
    v_mfma_f32_16x16x32_bf16 v[32:35], v[68:71], v[136:139], v[32:35]
    v_mfma_f32_16x16x32_bf16 v[36:39], v[68:71], v[140:143], v[36:39]
    s_waitcnt vmcnt(4) lgkmcnt(0)
    s_nop 0
    v_mfma_f32_16x16x32_bf16 v[8:11], v[40:43], v[144:147], v[8:11]
    ds_read_b128 v[56:59], v4 offset:28672
    v_mfma_f32_16x16x32_bf16 v[12:15], v[40:43], v[148:151], v[12:15]
    ds_read_b128 v[60:63], v4 offset:29696
    v_mfma_f32_16x16x32_bf16 v[16:19], v[44:47], v[144:147], v[16:19]
    ds_read_b128 v[64:67], v4 offset:30720
    v_mfma_f32_16x16x32_bf16 v[20:23], v[44:47], v[148:151], v[20:23]
    ds_read_b128 v[68:71], v4 offset:31744
    v_mfma_f32_16x16x32_bf16 v[24:27], v[48:51], v[144:147], v[24:27]
    v_mfma_f32_16x16x32_bf16 v[28:31], v[48:51], v[148:151], v[28:31]
    s_add_u32 s54, s44, 32768
    s_cmp_eq_u32 s54, 131072
    .long 0x853636ff, 0x0
    s_sub_u32 s54, s54, s44
    s_add_u32 s44, s44, s54
    v_mfma_f32_16x16x32_bf16 v[32:35], v[52:55], v[144:147], v[32:35]
    v_add_u32_e64 v4, s54, v4
    v_mfma_f32_16x16x32_bf16 v[36:39], v[52:55], v[148:151], v[36:39]
    s_waitcnt lgkmcnt(0)
    s_barrier
    v_mfma_f32_16x16x32_bf16 v[8:11], v[56:59], v[152:155], v[8:11]
    ds_read_b128 v[40:43], v4 offset:0
    v_mfma_f32_16x16x32_bf16 v[12:15], v[56:59], v[156:159], v[12:15]
    ds_read_b128 v[44:47], v4 offset:1024
    v_mfma_f32_16x16x32_bf16 v[16:19], v[60:63], v[152:155], v[16:19]
    ds_read_b128 v[48:51], v4 offset:2048
    v_mfma_f32_16x16x32_bf16 v[20:23], v[60:63], v[156:159], v[20:23]
    ds_read_b128 v[52:55], v4 offset:3072
    v_mfma_f32_16x16x32_bf16 v[24:27], v[64:67], v[152:155], v[24:27]
    v_mfma_f32_16x16x32_bf16 v[28:31], v[64:67], v[156:159], v[28:31]
    v_mfma_f32_16x16x32_bf16 v[32:35], v[68:71], v[152:155], v[32:35]
    v_mfma_f32_16x16x32_bf16 v[36:39], v[68:71], v[156:159], v[36:39]
    s_mov_b32 s76, 0xffff0000
    s_waitcnt vmcnt(0) lgkmcnt(0)
    v_lshlrev_b32 v96, 16, v72
    v_and_b32 v97, s76, v72
    v_lshlrev_b32 v98, 16, v73
    v_and_b32_e64 v99, s76, v73
    v_pk_add_f32 v[8:9], v[8:9], v[96:97]
    v_pk_add_f32 v[10:11], v[10:11], v[98:99]
    v_lshlrev_b32 v100, 16, v74
    v_and_b32 v101, s76, v74
    v_lshlrev_b32 v102, 16, v75
    v_and_b32 v103, s76, v75
    v_pk_add_f32 v[16:17], v[16:17], v[100:101]
    v_pk_add_f32 v[18:19], v[18:19], v[102:103]
    v_cvt_pk_bf16_f32 v112, v8, v9
    v_cvt_pk_bf16_f32 v113, v10, v11
    v_cvt_pk_bf16_f32 v114, v16, v17
    v_cvt_pk_bf16_f32 v115, v18, v19
    v_lshlrev_b32 v104, 16, v76
    v_and_b32 v105, s76, v76
    v_lshlrev_b32 v106, 16, v77
    v_and_b32 v107, s76, v77
    v_pk_add_f32 v[12:13], v[12:13], v[104:105]
    v_pk_add_f32 v[14:15], v[14:15], v[106:107]
    v_lshlrev_b32 v108, 16, v78
    v_and_b32 v109, s76, v78
    v_lshlrev_b32 v110, 16, v79
    v_and_b32 v111, s76, v79
    v_pk_add_f32 v[20:21], v[20:21], v[108:109]
    v_pk_add_f32 v[22:23], v[22:23], v[110:111]
    v_cvt_pk_bf16_f32 v116, v12, v13
    v_cvt_pk_bf16_f32 v117, v14, v15
    v_cvt_pk_bf16_f32 v118, v20, v21
    v_cvt_pk_bf16_f32 v119, v22, v23
    v_lshlrev_b32 v96, 16, v80
    v_and_b32 v97, s76, v80
    v_lshlrev_b32 v98, 16, v81
    v_and_b32 v99, s76, v81
    v_pk_add_f32 v[24:25], v[24:25], v[96:97]
    v_pk_add_f32 v[26:27], v[26:27], v[98:99]
    v_lshlrev_b32 v100, 16, v82
    v_and_b32 v101, s76, v82
    v_lshlrev_b32 v102, 16, v83
    v_and_b32 v103, s76, v83
    v_pk_add_f32 v[32:33], v[32:33], v[100:101]
    v_pk_add_f32 v[34:35], v[34:35], v[102:103]
    v_cvt_pk_bf16_f32 v120, v24, v25
    v_cvt_pk_bf16_f32 v121, v26, v27
    v_cvt_pk_bf16_f32 v122, v32, v33
    v_cvt_pk_bf16_f32 v123, v34, v35
    v_lshlrev_b32 v104, 16, v84
    v_and_b32 v105, s76, v84
    v_lshlrev_b32 v106, 16, v85
    v_and_b32 v107, s76, v85
    v_pk_add_f32 v[28:29], v[28:29], v[104:105]
    v_pk_add_f32 v[30:31], v[30:31], v[106:107]
    v_lshlrev_b32 v108, 16, v86
    v_and_b32 v109, s76, v86
    v_lshlrev_b32 v110, 16, v87
    v_and_b32 v111, s76, v87
    v_pk_add_f32 v[36:37], v[36:37], v[108:109]
    v_pk_add_f32 v[38:39], v[38:39], v[110:111]
    v_cvt_pk_bf16_f32 v124, v28, v29
    v_cvt_pk_bf16_f32 v125, v30, v31
    v_cvt_pk_bf16_f32 v126, v36, v37
    v_cvt_pk_bf16_f32 v127, v38, v39
    s_lshl_b32 s45, s41, 18
    s_lshl_b32 s48, s40, 16
    s_add_u32 s45, s45, s48
    .long 0x8e30ff2a, 0x7
    s_add_u32 s45, s45, s48
    s_add_u32 s48, s45, 32768
    v_and_b32 v1, 15, v0
    v_lshlrev_b32 v1, 11, v1
    v_lshrrev_b32_e64 v2, 4, v0
    v_lshl_add_u32 v1, v2, 4, v1
    v_permlane32_swap_b32 v112, v114
    v_permlane32_swap_b32 v113, v115
    v_permlane32_swap_b32 v116, v118
    v_permlane32_swap_b32 v117, v119
    v_permlane32_swap_b32 v120, v122
    v_permlane32_swap_b32 v121, v123
    v_permlane32_swap_b32 v124, v126
    v_permlane32_swap_b32 v125, v127
    v_permlane16_swap_b32 v112, v114
    v_permlane16_swap_b32 v113, v115
    v_permlane16_swap_b32 v116, v118
    v_permlane16_swap_b32 v117, v119
    v_permlane16_swap_b32 v120, v122
    v_permlane16_swap_b32 v121, v123
    v_permlane16_swap_b32 v124, v126
    v_permlane16_swap_b32 v125, v127
    buffer_store_dwordx4 v[112:115], v1, s[16:19], s45 offen offset:0 sc0 sc1
    buffer_store_dwordx4 v[116:119], v1, s[16:19], s48 offen offset:0 sc0 sc1
    buffer_store_dwordx4 v[120:123], v1, s[16:19], s45 offen offset:64 sc0 sc1
    buffer_store_dwordx4 v[124:127], v1, s[16:19], s48 offen offset:64 sc0 sc1
    s_waitcnt vmcnt(0) lgkmcnt(0)
    s_endpgm
interleave_layers__linear_kernel_hedgehog__geglu_ffn__prompt_kernel_done1:
    s_endpgm
.section .rodata,"a"
.p2align 6
.amdhsa_kernel interleave_layers__linear_kernel_hedgehog__geglu_ffn__prompt_kernel
  .amdhsa_next_free_vgpr 248
  .amdhsa_next_free_sgpr 100
  .amdhsa_accum_offset 248
  .amdhsa_group_segment_fixed_size 0
  .amdhsa_kernarg_size 88
  .amdhsa_user_sgpr_count 2
  .amdhsa_user_sgpr_kernarg_segment_ptr 1
  .amdhsa_system_sgpr_workgroup_id_x 1
.end_amdhsa_kernel
```
